```python
import torch

def _softmax(x, axis=-1):
    return torch.softmax(x, dim=axis)
def _gelu(x):
    return torch.nn.functional.gelu(x, approximate="tanh")
def _silu(x):
    return torch.nn.functional.silu(x)
def _sigmoid(x):
    return torch.sigmoid(x)
def _layernorm(x, axis=-1, eps=1e-5):
    m = x.mean(dim=axis, keepdim=True)
    v = x.var(dim=axis, keepdim=True, unbiased=False)
    return (x - m) / torch.sqrt(v + eps)
def _scatter_add(tgt, idx, src, axis=0):
    return tgt.clone().index_add_(axis, idx, src)
def _segment_sum(src, seg, n):
    out = torch.zeros((n,) + src.shape[1:], dtype=src.dtype)
    return out.index_add_(0, seg, src)
def _pad(x, pw):
    flat = tuple(v for pair in reversed(pw) for v in pair)
    return torch.nn.functional.pad(x, flat)

kernel_name = 'standalone__mha_block_cached__near_ridge'

def setup_inputs():

    _w = (lambda a: (lambda t: t.to(torch.bfloat16) if t.is_floating_point() else t)(torch.as_tensor(a)))
    B, Sq, D = 8, 128, 640
    H, Sk, Dh = 32, 1024, 128
    return {
        "x": _w((lambda *s: torch.randn(*s, dtype=torch.bfloat16) * 0.8)(B, Sq, D)),
        "k_cache": _w((lambda *s: torch.randn(*s, dtype=torch.bfloat16) * 0.8)(B, H, Sk, Dh)),
        "v_cache": _w((lambda *s: torch.randn(*s, dtype=torch.bfloat16) * 0.05)(B, H, Sk, Dh)),
        "wq": _w((lambda *s: torch.randn(*s, dtype=torch.bfloat16) * 0.8)(D, H * Dh) * (D ** -0.5)),
        "wo": _w((lambda *s: torch.randn(*s, dtype=torch.bfloat16) * 0.05)(H * Dh, D) * ((H * Dh) ** -0.5)),
    }

def reference(x, k_cache, v_cache, wq, wo):
    B, Sq, D = x.shape
    H, Dh = 32, 128
    q = (lambda x, *d: x.permute(*d))((x @ wq).reshape(B, Sq, H, Dh), 0, 2, 1, 3)
    scores = torch.einsum("bhqd,bhkd->bhqk", q, k_cache) * (Dh ** -0.5)
    p = _softmax(scores, axis=-1)
    o = torch.einsum("bhqk,bhkd->bhqd", p, v_cache)
    return (lambda x, *d: x.permute(*d))(o, 0, 2, 1, 3).reshape(B, Sq, H * Dh) @ wo
```

```asm
; @launch kernel=mha_kernel grid=(256,1,1) block=(384,1,1) lds=163840
.amdgcn_target "amdgcn-amd-amdhsa--gfx950"
.text
.globl mha_kernel
.p2align 8
.type mha_kernel,@function
mha_kernel:
    s_cmp_ge_u32 s2, 256
    s_cbranch_scc1 L_end
    s_load_dwordx8 s[4:11], s[0:1], 0
    s_load_dwordx8 s[12:19], s[0:1], 32
    v_and_b32 v1, 63, v0
    v_lshrrev_b32 v4, 6, v0
    s_nop 0
    v_readfirstlane_b32 s40, v4
    s_and_b32 s41, s2, 31
    s_lshr_b32 s42, s2, 5
    s_and_b32 s44, s2, 7
    s_lshr_b32 s45, s41, 3
    s_lshl_b32 s43, s2, 18
    v_lshrrev_b32 v4, 4, v1
    v_and_b32 v5, 15, v1
    v_lshrrev_b32 v6, 5, v1
    v_and_b32 v7, 31, v1
    s_cmp_ge_u32 s40, 4
    s_cbranch_scc1 L_loader
    s_lshl_b32 s50, s40, 12
    s_mov_b32 s49, 0x3e0293ee
    s_mov_b32 s46, 0x41000000
    v_xor_b32 v8, v6, v5
    v_lshlrev_b32 v8, 4, v8
    v_lshl_add_u32 v16, v7, 8, v8
    v_xor_b32 v17, 32, v16
    v_xor_b32 v18, 64, v16
    v_xor_b32 v19, 96, v16
    v_xor_b32 v20, 128, v16
    v_xor_b32 v21, 160, v16
    v_xor_b32 v22, 192, v16
    v_xor_b32 v23, 224, v16
    v_lshrrev_b32 v8, 1, v7
    v_and_b32 v8, 7, v8
    v_xor_b32 v8, v6, v8
    v_lshlrev_b32 v8, 4, v8
    v_lshl_add_u32 v8, v7, 7, v8
    v_add_u32 v180, s50, v8
    v_add_u32 v180, 81920, v180
    v_xor_b32 v181, 32, v180
    v_xor_b32 v182, 64, v180
    v_xor_b32 v183, 96, v180
    v_lshrrev_b32 v8, 2, v5
    v_and_b32 v9, 3, v5
    v_and_b32 v11, 1, v4
    v_lshlrev_b32 v12, 6, v8
    v_lshl_add_u32 v12, v11, 5, v12
    v_lshl_add_u32 v13, v6, 2, v8
    v_lshl_add_u32 v14, v13, 8, v12
    v_lshl_add_u32 v24, v9, 3, v14
    v_add_u32 v24, 81920, v24
    v_xor_b32 v25, 64, v24
    v_xor_b32 v26, 128, v24
    v_xor_b32 v27, 192, v24
    v_lshlrev_b32 v14, 6, v13
    v_lshl_add_u32 v14, v11, 5, v14
    v_lshl_add_u32 v3, v9, 3, v14
    v_lshl_add_u32 v13, v6, 3, v8
    v_lshl_add_u32 v14, v13, 8, v12
    v_and_b32 v13, 1, v9
    v_lshlrev_b32 v13, 1, v13
    v_lshrrev_b32 v12, 1, v9
    v_or_b32 v13, v13, v12
    v_lshl_add_u32 v176, v13, 3, v14
    v_xor_b32 v177, 64, v176
    v_xor_b32 v178, 128, v176
    v_xor_b32 v179, 192, v176
    v_lshlrev_b32 v10, 4, v1
    v_subrev_u32 v8, 81920, v24
    v_mov_b32 v9, v3
    v_add_u32 v0, 0x1000, v10
    v_add_u32 v2, 0x2000, v10
    v_add_u32 v4, s45, v1
    v_add_u32 v4, 1, v4
    v_and_b32 v4, 3, v4
    v_lshlrev_b32 v4, 2, v4
    v_mov_b32 v6, 1
    v_mov_b32 v7, 0
    s_lshl_b32 s47, s2, 15
    s_lshl_b32 s48, s40, 13
    s_add_u32 s47, s47, s48
    s_lshl_b32 s51, s42, 5
    s_add_u32 s76, s45, 1
    s_and_b32 s76, s76, 3
    s_lshl_b32 s76, s76, 3
    s_add_u32 s54, s44, 0
    s_and_b32 s54, s54, 7
    s_add_u32 s76, s76, s54
    s_add_u32 s76, s76, s51
    s_lshl_b32 s76, s76, 15
    s_add_u32 s76, s76, s48
    s_add_u32 s77, s45, 2
    s_and_b32 s77, s77, 3
    s_lshl_b32 s77, s77, 3
    s_add_u32 s54, s44, 0
    s_and_b32 s54, s54, 7
    s_add_u32 s77, s77, s54
    s_add_u32 s77, s77, s51
    s_lshl_b32 s77, s77, 15
    s_add_u32 s77, s77, s48
    s_add_u32 s78, s45, 3
    s_and_b32 s78, s78, 3
    s_lshl_b32 s78, s78, 3
    s_add_u32 s54, s44, 0
    s_and_b32 s54, s54, 7
    s_add_u32 s78, s78, s54
    s_add_u32 s78, s78, s51
    s_lshl_b32 s78, s78, 15
    s_add_u32 s78, s78, s48
    s_lshl_b32 s52, s40, 3
    s_mul_i32 s54, s45, 0
    s_sub_u32 s54, s44, s54
    s_and_b32 s54, s54, 7
    s_add_u32 s52, s52, s54
    s_add_u32 s52, s52, s51
    s_lshl_b32 s52, s52, 8
    s_add_u32 s52, s52, 50331648
    s_lshl_b32 s53, s45, 2
    s_add_u32 s53, s53, s52
    s_lshl_b32 s54, s45, 3
    s_add_u32 s51, s51, s54
    s_lshl_b32 s54, s40, 1
    s_add_u32 s51, s51, s54
    s_lshl_b32 s51, s51, 8
    s_lshl_b32 s54, s44, 2
    s_add_u32 s51, s51, s54
    s_add_u32 s51, s51, 50331776
    s_lshl_b32 s48, s42, 2
    s_add_u32 s48, s48, s45
    s_lshl_b32 s48, s48, 3
    s_add_u32 s48, s48, s44
    s_lshl_b32 s48, s48, 2
    s_add_u32 s48, s48, s40
    s_mul_i32 s48, s48, 10240
    s_add_u32 s48, s48, 8388608
    v_lshrrev_b32 v11, 4, v1
    v_lshrrev_b32 v12, 2, v1
    v_xor_b32 v11, v11, v12
    v_and_b32 v11, 1, v11
    v_add_u32 v11, -1, v11
    v_and_b32 v28, 0x3f803f80, v11
    v_and_b32 v29, 0x3f803f80, v11
    v_and_b32 v30, 0x3f803f80, v11
    v_and_b32 v31, 0x3f803f80, v11
    s_waitcnt lgkmcnt(0)
    s_mov_b32 s36, s18
    s_mov_b32 s37, s19
    s_mov_b32 s38, 268435456
    s_mov_b32 s39, 0x00020000
    s_mov_b32 s72, s14
    s_mov_b32 s73, s15
    s_mov_b32 s74, 1310720
    s_mov_b32 s75, 0x00020000
    v_add_u32 v196, 65536, v16
    v_add_u32 v197, 65536, v17
    v_add_u32 v198, 65536, v18
    v_add_u32 v199, 65536, v19
    v_add_u32 v200, 65536, v20
    v_add_u32 v201, 65536, v21
    v_add_u32 v202, 65536, v22
    v_add_u32 v203, 65536, v23
    v_add_u32 v204, 65536, v24
    v_add_u32 v205, 65536, v25
    v_add_u32 v206, 65536, v26
    v_add_u32 v207, 65536, v27
    s_barrier
    ds_read_b128 v[128:131], v180 offset:49152
    ds_read_b64_tr_b16 v[208:209], v176 offset:49152
    ds_read_b64_tr_b16 v[210:211], v176 offset:50176
    ds_read_b64_tr_b16 v[212:213], v177 offset:49152
    ds_read_b64_tr_b16 v[214:215], v177 offset:50176
    ds_read_b64_tr_b16 v[216:217], v178 offset:49152
    ds_read_b64_tr_b16 v[218:219], v178 offset:50176
    ds_read_b64_tr_b16 v[220:221], v179 offset:49152
    ds_read_b64_tr_b16 v[222:223], v179 offset:50176
    ds_read_b128 v[132:135], v181 offset:49152
    ds_read_b64_tr_b16 v[224:225], v176 offset:53248
    ds_read_b64_tr_b16 v[226:227], v176 offset:54272
    ds_read_b64_tr_b16 v[228:229], v177 offset:53248
    ds_read_b64_tr_b16 v[230:231], v177 offset:54272
    s_waitcnt lgkmcnt(9)
    v_mfma_f32_32x32x16_bf16 v[32:47], v[208:211], v[128:131], 0
    ds_read_b64_tr_b16 v[232:233], v178 offset:53248
    ds_read_b64_tr_b16 v[234:235], v178 offset:54272
    v_mfma_f32_32x32x16_bf16 v[48:63], v[212:215], v[128:131], 0
    ds_read_b64_tr_b16 v[236:237], v179 offset:53248
    ds_read_b64_tr_b16 v[238:239], v179 offset:54272
    s_waitcnt lgkmcnt(9)
    v_mfma_f32_32x32x16_bf16 v[64:79], v[216:219], v[128:131], 0
    ds_read_b128 v[136:139], v182 offset:49152
    ds_read_b64_tr_b16 v[240:241], v176 offset:57344
    ds_read_b64_tr_b16 v[242:243], v176 offset:58368
    v_mfma_f32_32x32x16_bf16 v[80:95], v[220:223], v[128:131], 0
    ds_read_b64_tr_b16 v[244:245], v177 offset:57344
    ds_read_b64_tr_b16 v[246:247], v177 offset:58368
    s_waitcnt lgkmcnt(9)
    v_mfma_f32_32x32x16_bf16 v[32:47], v[224:227], v[132:135], v[32:47]
    ds_read_b64_tr_b16 v[248:249], v178 offset:57344
    ds_read_b64_tr_b16 v[250:251], v178 offset:58368
    v_mfma_f32_32x32x16_bf16 v[48:63], v[228:231], v[132:135], v[48:63]
    ds_read_b64_tr_b16 v[252:253], v179 offset:57344
    ds_read_b64_tr_b16 v[254:255], v179 offset:58368
    s_waitcnt lgkmcnt(9)
    v_mfma_f32_32x32x16_bf16 v[64:79], v[232:235], v[132:135], v[64:79]
    ds_read_b128 v[140:143], v183 offset:49152
    ds_read_b64_tr_b16 v[208:209], v176 offset:61440
    ds_read_b64_tr_b16 v[210:211], v176 offset:62464
    v_mfma_f32_32x32x16_bf16 v[80:95], v[236:239], v[132:135], v[80:95]
    ds_read_b64_tr_b16 v[212:213], v177 offset:61440
    ds_read_b64_tr_b16 v[214:215], v177 offset:62464
    s_waitcnt lgkmcnt(9)
    v_mfma_f32_32x32x16_bf16 v[32:47], v[240:243], v[136:139], v[32:47]
    ds_read_b64_tr_b16 v[216:217], v178 offset:61440
    ds_read_b64_tr_b16 v[218:219], v178 offset:62464
    v_mfma_f32_32x32x16_bf16 v[48:63], v[244:247], v[136:139], v[48:63]
    ds_read_b64_tr_b16 v[220:221], v179 offset:61440
    ds_read_b64_tr_b16 v[222:223], v179 offset:62464
    s_waitcnt lgkmcnt(9)
    v_mfma_f32_32x32x16_bf16 v[64:79], v[248:251], v[136:139], v[64:79]
    v_mfma_f32_32x32x16_bf16 v[80:95], v[252:255], v[136:139], v[80:95]
    s_waitcnt lgkmcnt(4)
    v_mfma_f32_32x32x16_bf16 v[32:47], v[208:211], v[140:143], v[32:47]
    s_waitcnt lgkmcnt(0)
    s_barrier
    v_add_u32 v180, 0x10000, v180
    v_add_u32 v181, 0x10000, v181
    v_add_u32 v182, 0x10000, v182
    v_add_u32 v183, 0x10000, v183
    ds_read_b128 v[144:147], v180 offset:0
    v_add_u32 v176, 0x10000, v176
    v_add_u32 v177, 0x10000, v177
    v_add_u32 v178, 0x10000, v178
    v_add_u32 v179, 0x10000, v179
    ds_read_b64_tr_b16 v[224:225], v176 offset:0
    ds_read_b64_tr_b16 v[226:227], v176 offset:1024
    v_mfma_f32_32x32x16_bf16 v[48:63], v[212:215], v[140:143], v[48:63]
    ds_read_b64_tr_b16 v[228:229], v177 offset:0
    ds_read_b64_tr_b16 v[230:231], v177 offset:1024
    ds_read_b64_tr_b16 v[232:233], v178 offset:0
    ds_read_b64_tr_b16 v[234:235], v178 offset:1024
    v_mfma_f32_32x32x16_bf16 v[64:79], v[216:219], v[140:143], v[64:79]
    ds_read_b64_tr_b16 v[236:237], v179 offset:0
    ds_read_b64_tr_b16 v[238:239], v179 offset:1024
    ds_read_b128 v[148:151], v181 offset:0
    ds_read_b64_tr_b16 v[240:241], v176 offset:4096
    ds_read_b64_tr_b16 v[242:243], v176 offset:5120
    v_mfma_f32_32x32x16_bf16 v[80:95], v[220:223], v[140:143], v[80:95]
    ds_read_b64_tr_b16 v[244:245], v177 offset:4096
    ds_read_b64_tr_b16 v[246:247], v177 offset:5120
    s_waitcnt lgkmcnt(9)
    v_mfma_f32_32x32x16_bf16 v[32:47], v[224:227], v[144:147], v[32:47]
    ds_read_b64_tr_b16 v[248:249], v178 offset:4096
    ds_read_b64_tr_b16 v[250:251], v178 offset:5120
    v_mfma_f32_32x32x16_bf16 v[48:63], v[228:231], v[144:147], v[48:63]
    ds_read_b64_tr_b16 v[252:253], v179 offset:4096
    ds_read_b64_tr_b16 v[254:255], v179 offset:5120
    s_waitcnt lgkmcnt(9)
    v_mfma_f32_32x32x16_bf16 v[64:79], v[232:235], v[144:147], v[64:79]
    ds_read_b128 v[152:155], v182 offset:0
    ds_read_b64_tr_b16 v[208:209], v176 offset:8192
    ds_read_b64_tr_b16 v[210:211], v176 offset:9216
    v_mfma_f32_32x32x16_bf16 v[80:95], v[236:239], v[144:147], v[80:95]
    ds_read_b64_tr_b16 v[212:213], v177 offset:8192
    ds_read_b64_tr_b16 v[214:215], v177 offset:9216
    s_waitcnt lgkmcnt(9)
    v_mfma_f32_32x32x16_bf16 v[32:47], v[240:243], v[148:151], v[32:47]
    ds_read_b64_tr_b16 v[216:217], v178 offset:8192
    ds_read_b64_tr_b16 v[218:219], v178 offset:9216
    v_mfma_f32_32x32x16_bf16 v[48:63], v[244:247], v[148:151], v[48:63]
    ds_read_b64_tr_b16 v[220:221], v179 offset:8192
    ds_read_b64_tr_b16 v[222:223], v179 offset:9216
    s_waitcnt lgkmcnt(9)
    v_mfma_f32_32x32x16_bf16 v[64:79], v[248:251], v[148:151], v[64:79]
    ds_read_b128 v[156:159], v183 offset:0
    ds_read_b64_tr_b16 v[224:225], v176 offset:12288
    ds_read_b64_tr_b16 v[226:227], v176 offset:13312
    v_mfma_f32_32x32x16_bf16 v[80:95], v[252:255], v[148:151], v[80:95]
    ds_read_b64_tr_b16 v[228:229], v177 offset:12288
    ds_read_b64_tr_b16 v[230:231], v177 offset:13312
    s_waitcnt lgkmcnt(9)
    v_mfma_f32_32x32x16_bf16 v[32:47], v[208:211], v[152:155], v[32:47]
    ds_read_b64_tr_b16 v[232:233], v178 offset:12288
    ds_read_b64_tr_b16 v[234:235], v178 offset:13312
    v_mfma_f32_32x32x16_bf16 v[48:63], v[212:215], v[152:155], v[48:63]
    ds_read_b64_tr_b16 v[236:237], v179 offset:12288
    ds_read_b64_tr_b16 v[238:239], v179 offset:13312
    s_waitcnt lgkmcnt(9)
    v_mfma_f32_32x32x16_bf16 v[64:79], v[216:219], v[152:155], v[64:79]
    v_mfma_f32_32x32x16_bf16 v[80:95], v[220:223], v[152:155], v[80:95]
    s_waitcnt lgkmcnt(4)
    v_mfma_f32_32x32x16_bf16 v[32:47], v[224:227], v[156:159], v[32:47]
    s_waitcnt lgkmcnt(0)
    s_barrier
    v_add_u32 v180, 0xffff4000, v180
    v_add_u32 v181, 0xffff4000, v181
    v_add_u32 v182, 0xffff4000, v182
    v_add_u32 v183, 0xffff4000, v183
    ds_read_b128 v[128:131], v180 offset:0
    v_add_u32 v176, 0xffff4000, v176
    v_add_u32 v177, 0xffff4000, v177
    v_add_u32 v178, 0xffff4000, v178
    v_add_u32 v179, 0xffff4000, v179
    ds_read_b64_tr_b16 v[240:241], v176 offset:0
    ds_read_b64_tr_b16 v[242:243], v176 offset:1024
    v_mfma_f32_32x32x16_bf16 v[48:63], v[228:231], v[156:159], v[48:63]
    ds_read_b64_tr_b16 v[244:245], v177 offset:0
    ds_read_b64_tr_b16 v[246:247], v177 offset:1024
    ds_read_b64_tr_b16 v[248:249], v178 offset:0
    ds_read_b64_tr_b16 v[250:251], v178 offset:1024
    v_mfma_f32_32x32x16_bf16 v[64:79], v[232:235], v[156:159], v[64:79]
    ds_read_b64_tr_b16 v[252:253], v179 offset:0
    ds_read_b64_tr_b16 v[254:255], v179 offset:1024
    ds_read_b128 v[132:135], v181 offset:0
    ds_read_b64_tr_b16 v[208:209], v176 offset:4096
    ds_read_b64_tr_b16 v[210:211], v176 offset:5120
    v_mfma_f32_32x32x16_bf16 v[80:95], v[236:239], v[156:159], v[80:95]
    ds_read_b64_tr_b16 v[212:213], v177 offset:4096
    ds_read_b64_tr_b16 v[214:215], v177 offset:5120
    s_waitcnt lgkmcnt(9)
    v_mfma_f32_32x32x16_bf16 v[32:47], v[240:243], v[128:131], v[32:47]
    ds_read_b64_tr_b16 v[216:217], v178 offset:4096
    ds_read_b64_tr_b16 v[218:219], v178 offset:5120
    v_mfma_f32_32x32x16_bf16 v[48:63], v[244:247], v[128:131], v[48:63]
    ds_read_b64_tr_b16 v[220:221], v179 offset:4096
    ds_read_b64_tr_b16 v[222:223], v179 offset:5120
    s_waitcnt lgkmcnt(9)
    v_mfma_f32_32x32x16_bf16 v[64:79], v[248:251], v[128:131], v[64:79]
    ds_read_b128 v[136:139], v182 offset:0
    ds_read_b64_tr_b16 v[224:225], v176 offset:8192
    ds_read_b64_tr_b16 v[226:227], v176 offset:9216
    v_mfma_f32_32x32x16_bf16 v[80:95], v[252:255], v[128:131], v[80:95]
    ds_read_b64_tr_b16 v[228:229], v177 offset:8192
    ds_read_b64_tr_b16 v[230:231], v177 offset:9216
    s_waitcnt lgkmcnt(9)
    v_mfma_f32_32x32x16_bf16 v[32:47], v[208:211], v[132:135], v[32:47]
    ds_read_b64_tr_b16 v[232:233], v178 offset:8192
    ds_read_b64_tr_b16 v[234:235], v178 offset:9216
    v_mfma_f32_32x32x16_bf16 v[48:63], v[212:215], v[132:135], v[48:63]
    ds_read_b64_tr_b16 v[236:237], v179 offset:8192
    ds_read_b64_tr_b16 v[238:239], v179 offset:9216
    s_waitcnt lgkmcnt(9)
    v_mfma_f32_32x32x16_bf16 v[64:79], v[216:219], v[132:135], v[64:79]
    ds_read_b128 v[140:143], v183 offset:0
    ds_read_b64_tr_b16 v[240:241], v176 offset:12288
    ds_read_b64_tr_b16 v[242:243], v176 offset:13312
    v_mfma_f32_32x32x16_bf16 v[80:95], v[220:223], v[132:135], v[80:95]
    ds_read_b64_tr_b16 v[244:245], v177 offset:12288
    ds_read_b64_tr_b16 v[246:247], v177 offset:13312
    s_waitcnt lgkmcnt(9)
    v_mfma_f32_32x32x16_bf16 v[32:47], v[224:227], v[136:139], v[32:47]
    ds_read_b64_tr_b16 v[248:249], v178 offset:12288
    ds_read_b64_tr_b16 v[250:251], v178 offset:13312
    v_mfma_f32_32x32x16_bf16 v[48:63], v[228:231], v[136:139], v[48:63]
    ds_read_b64_tr_b16 v[252:253], v179 offset:12288
    ds_read_b64_tr_b16 v[254:255], v179 offset:13312
    s_waitcnt lgkmcnt(9)
    v_mfma_f32_32x32x16_bf16 v[64:79], v[232:235], v[136:139], v[64:79]
    v_mfma_f32_32x32x16_bf16 v[80:95], v[236:239], v[136:139], v[80:95]
    s_waitcnt lgkmcnt(4)
    v_mfma_f32_32x32x16_bf16 v[32:47], v[240:243], v[140:143], v[32:47]
    s_waitcnt lgkmcnt(0)
    s_barrier
    ds_read_b128 v[144:147], v180 offset:16384
    ds_read_b64_tr_b16 v[208:209], v176 offset:16384
    ds_read_b64_tr_b16 v[210:211], v176 offset:17408
    v_mfma_f32_32x32x16_bf16 v[48:63], v[244:247], v[140:143], v[48:63]
    ds_read_b64_tr_b16 v[212:213], v177 offset:16384
    ds_read_b64_tr_b16 v[214:215], v177 offset:17408
    ds_read_b64_tr_b16 v[216:217], v178 offset:16384
    ds_read_b64_tr_b16 v[218:219], v178 offset:17408
    v_mfma_f32_32x32x16_bf16 v[64:79], v[248:251], v[140:143], v[64:79]
    ds_read_b64_tr_b16 v[220:221], v179 offset:16384
    ds_read_b64_tr_b16 v[222:223], v179 offset:17408
    ds_read_b128 v[148:151], v181 offset:16384
    ds_read_b64_tr_b16 v[224:225], v176 offset:20480
    ds_read_b64_tr_b16 v[226:227], v176 offset:21504
    v_mfma_f32_32x32x16_bf16 v[80:95], v[252:255], v[140:143], v[80:95]
    ds_read_b64_tr_b16 v[228:229], v177 offset:20480
    ds_read_b64_tr_b16 v[230:231], v177 offset:21504
    s_waitcnt lgkmcnt(9)
    v_mfma_f32_32x32x16_bf16 v[32:47], v[208:211], v[144:147], v[32:47]
    ds_read_b64_tr_b16 v[232:233], v178 offset:20480
    ds_read_b64_tr_b16 v[234:235], v178 offset:21504
    v_mfma_f32_32x32x16_bf16 v[48:63], v[212:215], v[144:147], v[48:63]
    ds_read_b64_tr_b16 v[236:237], v179 offset:20480
    ds_read_b64_tr_b16 v[238:239], v179 offset:21504
    s_waitcnt lgkmcnt(9)
    v_mfma_f32_32x32x16_bf16 v[64:79], v[216:219], v[144:147], v[64:79]
    ds_read_b128 v[152:155], v182 offset:16384
    ds_read_b64_tr_b16 v[240:241], v176 offset:24576
    ds_read_b64_tr_b16 v[242:243], v176 offset:25600
    v_mfma_f32_32x32x16_bf16 v[80:95], v[220:223], v[144:147], v[80:95]
    ds_read_b64_tr_b16 v[244:245], v177 offset:24576
    ds_read_b64_tr_b16 v[246:247], v177 offset:25600
    s_waitcnt lgkmcnt(9)
    v_mfma_f32_32x32x16_bf16 v[32:47], v[224:227], v[148:151], v[32:47]
    ds_read_b64_tr_b16 v[248:249], v178 offset:24576
    ds_read_b64_tr_b16 v[250:251], v178 offset:25600
    v_mfma_f32_32x32x16_bf16 v[48:63], v[228:231], v[148:151], v[48:63]
    ds_read_b64_tr_b16 v[252:253], v179 offset:24576
    ds_read_b64_tr_b16 v[254:255], v179 offset:25600
    s_waitcnt lgkmcnt(9)
    v_mfma_f32_32x32x16_bf16 v[64:79], v[232:235], v[148:151], v[64:79]
    ds_read_b128 v[156:159], v183 offset:16384
    ds_read_b64_tr_b16 v[208:209], v176 offset:28672
    ds_read_b64_tr_b16 v[210:211], v176 offset:29696
    v_mfma_f32_32x32x16_bf16 v[80:95], v[236:239], v[148:151], v[80:95]
    ds_read_b64_tr_b16 v[212:213], v177 offset:28672
    ds_read_b64_tr_b16 v[214:215], v177 offset:29696
    s_waitcnt lgkmcnt(9)
    v_mfma_f32_32x32x16_bf16 v[32:47], v[240:243], v[152:155], v[32:47]
    ds_read_b64_tr_b16 v[216:217], v178 offset:28672
    ds_read_b64_tr_b16 v[218:219], v178 offset:29696
    v_mfma_f32_32x32x16_bf16 v[48:63], v[244:247], v[152:155], v[48:63]
    ds_read_b64_tr_b16 v[220:221], v179 offset:28672
    ds_read_b64_tr_b16 v[222:223], v179 offset:29696
    s_waitcnt lgkmcnt(9)
    v_mfma_f32_32x32x16_bf16 v[64:79], v[248:251], v[152:155], v[64:79]
    v_mfma_f32_32x32x16_bf16 v[80:95], v[252:255], v[152:155], v[80:95]
    s_waitcnt lgkmcnt(4)
    v_mfma_f32_32x32x16_bf16 v[32:47], v[208:211], v[156:159], v[32:47]
    s_waitcnt lgkmcnt(0)
    s_barrier
    ds_read_b128 v[128:131], v180 offset:32768
    ds_read_b64_tr_b16 v[224:225], v176 offset:32768
    ds_read_b64_tr_b16 v[226:227], v176 offset:33792
    v_mfma_f32_32x32x16_bf16 v[48:63], v[212:215], v[156:159], v[48:63]
    ds_read_b64_tr_b16 v[228:229], v177 offset:32768
    ds_read_b64_tr_b16 v[230:231], v177 offset:33792
    ds_read_b64_tr_b16 v[232:233], v178 offset:32768
    ds_read_b64_tr_b16 v[234:235], v178 offset:33792
    v_mfma_f32_32x32x16_bf16 v[64:79], v[216:219], v[156:159], v[64:79]
    ds_read_b64_tr_b16 v[236:237], v179 offset:32768
    ds_read_b64_tr_b16 v[238:239], v179 offset:33792
    ds_read_b128 v[132:135], v181 offset:32768
    ds_read_b64_tr_b16 v[240:241], v176 offset:36864
    ds_read_b64_tr_b16 v[242:243], v176 offset:37888
    v_mfma_f32_32x32x16_bf16 v[80:95], v[220:223], v[156:159], v[80:95]
    ds_read_b64_tr_b16 v[244:245], v177 offset:36864
    ds_read_b64_tr_b16 v[246:247], v177 offset:37888
    s_waitcnt lgkmcnt(9)
    v_mfma_f32_32x32x16_bf16 v[32:47], v[224:227], v[128:131], v[32:47]
    ds_read_b64_tr_b16 v[248:249], v178 offset:36864
    ds_read_b64_tr_b16 v[250:251], v178 offset:37888
    v_mfma_f32_32x32x16_bf16 v[48:63], v[228:231], v[128:131], v[48:63]
    ds_read_b64_tr_b16 v[252:253], v179 offset:36864
    ds_read_b64_tr_b16 v[254:255], v179 offset:37888
    s_waitcnt lgkmcnt(9)
    v_mfma_f32_32x32x16_bf16 v[64:79], v[232:235], v[128:131], v[64:79]
    ds_read_b128 v[136:139], v182 offset:32768
    ds_read_b64_tr_b16 v[208:209], v176 offset:40960
    ds_read_b64_tr_b16 v[210:211], v176 offset:41984
    v_mfma_f32_32x32x16_bf16 v[80:95], v[236:239], v[128:131], v[80:95]
    ds_read_b64_tr_b16 v[212:213], v177 offset:40960
    ds_read_b64_tr_b16 v[214:215], v177 offset:41984
    s_waitcnt lgkmcnt(9)
    v_mfma_f32_32x32x16_bf16 v[32:47], v[240:243], v[132:135], v[32:47]
    ds_read_b64_tr_b16 v[216:217], v178 offset:40960
    ds_read_b64_tr_b16 v[218:219], v178 offset:41984
    v_mfma_f32_32x32x16_bf16 v[48:63], v[244:247], v[132:135], v[48:63]
    ds_read_b64_tr_b16 v[220:221], v179 offset:40960
    ds_read_b64_tr_b16 v[222:223], v179 offset:41984
    s_waitcnt lgkmcnt(9)
    v_mfma_f32_32x32x16_bf16 v[64:79], v[248:251], v[132:135], v[64:79]
    ds_read_b128 v[140:143], v183 offset:32768
    ds_read_b64_tr_b16 v[224:225], v176 offset:45056
    ds_read_b64_tr_b16 v[226:227], v176 offset:46080
    v_mfma_f32_32x32x16_bf16 v[80:95], v[252:255], v[132:135], v[80:95]
    ds_read_b64_tr_b16 v[228:229], v177 offset:45056
    ds_read_b64_tr_b16 v[230:231], v177 offset:46080
    s_waitcnt lgkmcnt(9)
    v_mfma_f32_32x32x16_bf16 v[32:47], v[208:211], v[136:139], v[32:47]
    ds_read_b64_tr_b16 v[232:233], v178 offset:45056
    ds_read_b64_tr_b16 v[234:235], v178 offset:46080
    v_mfma_f32_32x32x16_bf16 v[48:63], v[212:215], v[136:139], v[48:63]
    ds_read_b64_tr_b16 v[236:237], v179 offset:45056
    ds_read_b64_tr_b16 v[238:239], v179 offset:46080
    s_waitcnt lgkmcnt(9)
    v_mfma_f32_32x32x16_bf16 v[64:79], v[216:219], v[136:139], v[64:79]
    v_mfma_f32_32x32x16_bf16 v[80:95], v[220:223], v[136:139], v[80:95]
    s_waitcnt lgkmcnt(4)
    v_mfma_f32_32x32x16_bf16 v[32:47], v[224:227], v[140:143], v[32:47]
    s_waitcnt lgkmcnt(0)
    s_barrier
    ds_read_b128 v[144:147], v180 offset:49152
    ds_read_b64_tr_b16 v[240:241], v176 offset:49152
    ds_read_b64_tr_b16 v[242:243], v176 offset:50176
    v_mfma_f32_32x32x16_bf16 v[48:63], v[228:231], v[140:143], v[48:63]
    ds_read_b64_tr_b16 v[244:245], v177 offset:49152
    ds_read_b64_tr_b16 v[246:247], v177 offset:50176
    ds_read_b64_tr_b16 v[248:249], v178 offset:49152
    ds_read_b64_tr_b16 v[250:251], v178 offset:50176
    v_mfma_f32_32x32x16_bf16 v[64:79], v[232:235], v[140:143], v[64:79]
    ds_read_b64_tr_b16 v[252:253], v179 offset:49152
    ds_read_b64_tr_b16 v[254:255], v179 offset:50176
    ds_read_b128 v[148:151], v181 offset:49152
    ds_read_b64_tr_b16 v[208:209], v176 offset:53248
    ds_read_b64_tr_b16 v[210:211], v176 offset:54272
    v_mfma_f32_32x32x16_bf16 v[80:95], v[236:239], v[140:143], v[80:95]
    ds_read_b64_tr_b16 v[212:213], v177 offset:53248
    ds_read_b64_tr_b16 v[214:215], v177 offset:54272
    s_waitcnt lgkmcnt(9)
    v_mfma_f32_32x32x16_bf16 v[32:47], v[240:243], v[144:147], v[32:47]
    ds_read_b64_tr_b16 v[216:217], v178 offset:53248
    ds_read_b64_tr_b16 v[218:219], v178 offset:54272
    v_mfma_f32_32x32x16_bf16 v[48:63], v[244:247], v[144:147], v[48:63]
    ds_read_b64_tr_b16 v[220:221], v179 offset:53248
    ds_read_b64_tr_b16 v[222:223], v179 offset:54272
    s_waitcnt lgkmcnt(9)
    v_mfma_f32_32x32x16_bf16 v[64:79], v[248:251], v[144:147], v[64:79]
    ds_read_b128 v[152:155], v182 offset:49152
    ds_read_b64_tr_b16 v[224:225], v176 offset:57344
    ds_read_b64_tr_b16 v[226:227], v176 offset:58368
    v_mfma_f32_32x32x16_bf16 v[80:95], v[252:255], v[144:147], v[80:95]
    ds_read_b64_tr_b16 v[228:229], v177 offset:57344
    ds_read_b64_tr_b16 v[230:231], v177 offset:58368
    s_waitcnt lgkmcnt(9)
    v_mfma_f32_32x32x16_bf16 v[32:47], v[208:211], v[148:151], v[32:47]
    ds_read_b64_tr_b16 v[232:233], v178 offset:57344
    ds_read_b64_tr_b16 v[234:235], v178 offset:58368
    v_mfma_f32_32x32x16_bf16 v[48:63], v[212:215], v[148:151], v[48:63]
    ds_read_b64_tr_b16 v[236:237], v179 offset:57344
    ds_read_b64_tr_b16 v[238:239], v179 offset:58368
    s_waitcnt lgkmcnt(9)
    v_mfma_f32_32x32x16_bf16 v[64:79], v[216:219], v[148:151], v[64:79]
    ds_read_b128 v[156:159], v183 offset:49152
    ds_read_b64_tr_b16 v[240:241], v176 offset:61440
    ds_read_b64_tr_b16 v[242:243], v176 offset:62464
    v_mfma_f32_32x32x16_bf16 v[80:95], v[220:223], v[148:151], v[80:95]
    ds_read_b64_tr_b16 v[244:245], v177 offset:61440
    ds_read_b64_tr_b16 v[246:247], v177 offset:62464
    s_waitcnt lgkmcnt(9)
    v_mfma_f32_32x32x16_bf16 v[32:47], v[224:227], v[152:155], v[32:47]
    ds_read_b64_tr_b16 v[248:249], v178 offset:61440
    ds_read_b64_tr_b16 v[250:251], v178 offset:62464
    v_mfma_f32_32x32x16_bf16 v[48:63], v[228:231], v[152:155], v[48:63]
    ds_read_b64_tr_b16 v[252:253], v179 offset:61440
    ds_read_b64_tr_b16 v[254:255], v179 offset:62464
    s_waitcnt lgkmcnt(9)
    v_mfma_f32_32x32x16_bf16 v[64:79], v[232:235], v[152:155], v[64:79]
    v_mfma_f32_32x32x16_bf16 v[80:95], v[236:239], v[152:155], v[80:95]
    s_waitcnt lgkmcnt(4)
    v_mfma_f32_32x32x16_bf16 v[32:47], v[240:243], v[156:159], v[32:47]
    s_waitcnt lgkmcnt(0)
    s_barrier
    ds_read_b128 v[128:131], v180 offset:0
    ds_read_b64_tr_b16 v[208:209], v176 offset:0
    ds_read_b64_tr_b16 v[210:211], v176 offset:1024
    v_mfma_f32_32x32x16_bf16 v[48:63], v[244:247], v[156:159], v[48:63]
    ds_read_b64_tr_b16 v[212:213], v177 offset:0
    ds_read_b64_tr_b16 v[214:215], v177 offset:1024
    ds_read_b64_tr_b16 v[216:217], v178 offset:0
    ds_read_b64_tr_b16 v[218:219], v178 offset:1024
    v_mfma_f32_32x32x16_bf16 v[64:79], v[248:251], v[156:159], v[64:79]
    ds_read_b64_tr_b16 v[220:221], v179 offset:0
    ds_read_b64_tr_b16 v[222:223], v179 offset:1024
    ds_read_b128 v[132:135], v181 offset:0
    ds_read_b64_tr_b16 v[224:225], v176 offset:4096
    ds_read_b64_tr_b16 v[226:227], v176 offset:5120
    v_mfma_f32_32x32x16_bf16 v[80:95], v[252:255], v[156:159], v[80:95]
    ds_read_b64_tr_b16 v[228:229], v177 offset:4096
    ds_read_b64_tr_b16 v[230:231], v177 offset:5120
    s_waitcnt lgkmcnt(9)
    v_mfma_f32_32x32x16_bf16 v[32:47], v[208:211], v[128:131], v[32:47]
    ds_read_b64_tr_b16 v[232:233], v178 offset:4096
    ds_read_b64_tr_b16 v[234:235], v178 offset:5120
    v_mfma_f32_32x32x16_bf16 v[48:63], v[212:215], v[128:131], v[48:63]
    ds_read_b64_tr_b16 v[236:237], v179 offset:4096
    ds_read_b64_tr_b16 v[238:239], v179 offset:5120
    s_waitcnt lgkmcnt(9)
    v_mfma_f32_32x32x16_bf16 v[64:79], v[216:219], v[128:131], v[64:79]
    ds_read_b128 v[136:139], v182 offset:0
    ds_read_b64_tr_b16 v[240:241], v176 offset:8192
    ds_read_b64_tr_b16 v[242:243], v176 offset:9216
    v_mfma_f32_32x32x16_bf16 v[80:95], v[220:223], v[128:131], v[80:95]
    ds_read_b64_tr_b16 v[244:245], v177 offset:8192
    ds_read_b64_tr_b16 v[246:247], v177 offset:9216
    s_waitcnt lgkmcnt(9)
    v_mfma_f32_32x32x16_bf16 v[32:47], v[224:227], v[132:135], v[32:47]
    ds_read_b64_tr_b16 v[248:249], v178 offset:8192
    ds_read_b64_tr_b16 v[250:251], v178 offset:9216
    v_mfma_f32_32x32x16_bf16 v[48:63], v[228:231], v[132:135], v[48:63]
    ds_read_b64_tr_b16 v[252:253], v179 offset:8192
    ds_read_b64_tr_b16 v[254:255], v179 offset:9216
    s_waitcnt lgkmcnt(9)
    v_mfma_f32_32x32x16_bf16 v[64:79], v[232:235], v[132:135], v[64:79]
    ds_read_b128 v[140:143], v183 offset:0
    ds_read_b64_tr_b16 v[208:209], v176 offset:12288
    ds_read_b64_tr_b16 v[210:211], v176 offset:13312
    v_mfma_f32_32x32x16_bf16 v[80:95], v[236:239], v[132:135], v[80:95]
    ds_read_b64_tr_b16 v[212:213], v177 offset:12288
    ds_read_b64_tr_b16 v[214:215], v177 offset:13312
    s_waitcnt lgkmcnt(9)
    v_mfma_f32_32x32x16_bf16 v[32:47], v[240:243], v[136:139], v[32:47]
    ds_read_b64_tr_b16 v[216:217], v178 offset:12288
    ds_read_b64_tr_b16 v[218:219], v178 offset:13312
    v_mfma_f32_32x32x16_bf16 v[48:63], v[244:247], v[136:139], v[48:63]
    ds_read_b64_tr_b16 v[220:221], v179 offset:12288
    ds_read_b64_tr_b16 v[222:223], v179 offset:13312
    s_waitcnt lgkmcnt(9)
    v_mfma_f32_32x32x16_bf16 v[64:79], v[248:251], v[136:139], v[64:79]
    v_mfma_f32_32x32x16_bf16 v[80:95], v[252:255], v[136:139], v[80:95]
    s_waitcnt lgkmcnt(4)
    v_mfma_f32_32x32x16_bf16 v[32:47], v[208:211], v[140:143], v[32:47]
    s_waitcnt lgkmcnt(0)
    s_barrier
    ds_read_b128 v[144:147], v180 offset:16384
    ds_read_b64_tr_b16 v[224:225], v176 offset:16384
    ds_read_b64_tr_b16 v[226:227], v176 offset:17408
    v_mfma_f32_32x32x16_bf16 v[48:63], v[212:215], v[140:143], v[48:63]
    ds_read_b64_tr_b16 v[228:229], v177 offset:16384
    ds_read_b64_tr_b16 v[230:231], v177 offset:17408
    ds_read_b64_tr_b16 v[232:233], v178 offset:16384
    ds_read_b64_tr_b16 v[234:235], v178 offset:17408
    v_mfma_f32_32x32x16_bf16 v[64:79], v[216:219], v[140:143], v[64:79]
    ds_read_b64_tr_b16 v[236:237], v179 offset:16384
    ds_read_b64_tr_b16 v[238:239], v179 offset:17408
    ds_read_b128 v[148:151], v181 offset:16384
    ds_read_b64_tr_b16 v[240:241], v176 offset:20480
    ds_read_b64_tr_b16 v[242:243], v176 offset:21504
    v_mfma_f32_32x32x16_bf16 v[80:95], v[220:223], v[140:143], v[80:95]
    ds_read_b64_tr_b16 v[244:245], v177 offset:20480
    ds_read_b64_tr_b16 v[246:247], v177 offset:21504
    s_waitcnt lgkmcnt(9)
    v_mfma_f32_32x32x16_bf16 v[32:47], v[224:227], v[144:147], v[32:47]
    ds_read_b64_tr_b16 v[248:249], v178 offset:20480
    ds_read_b64_tr_b16 v[250:251], v178 offset:21504
    v_mfma_f32_32x32x16_bf16 v[48:63], v[228:231], v[144:147], v[48:63]
    ds_read_b64_tr_b16 v[252:253], v179 offset:20480
    ds_read_b64_tr_b16 v[254:255], v179 offset:21504
    s_waitcnt lgkmcnt(9)
    v_mfma_f32_32x32x16_bf16 v[64:79], v[232:235], v[144:147], v[64:79]
    ds_read_b128 v[152:155], v182 offset:16384
    ds_read_b64_tr_b16 v[208:209], v176 offset:24576
    ds_read_b64_tr_b16 v[210:211], v176 offset:25600
    v_mfma_f32_32x32x16_bf16 v[80:95], v[236:239], v[144:147], v[80:95]
    ds_read_b64_tr_b16 v[212:213], v177 offset:24576
    ds_read_b64_tr_b16 v[214:215], v177 offset:25600
    s_waitcnt lgkmcnt(9)
    v_mfma_f32_32x32x16_bf16 v[32:47], v[240:243], v[148:151], v[32:47]
    ds_read_b64_tr_b16 v[216:217], v178 offset:24576
    ds_read_b64_tr_b16 v[218:219], v178 offset:25600
    v_mfma_f32_32x32x16_bf16 v[48:63], v[244:247], v[148:151], v[48:63]
    ds_read_b64_tr_b16 v[220:221], v179 offset:24576
    ds_read_b64_tr_b16 v[222:223], v179 offset:25600
    s_waitcnt lgkmcnt(9)
    v_mfma_f32_32x32x16_bf16 v[64:79], v[248:251], v[148:151], v[64:79]
    ds_read_b128 v[156:159], v183 offset:16384
    ds_read_b64_tr_b16 v[224:225], v176 offset:28672
    ds_read_b64_tr_b16 v[226:227], v176 offset:29696
    v_mfma_f32_32x32x16_bf16 v[80:95], v[252:255], v[148:151], v[80:95]
    ds_read_b64_tr_b16 v[228:229], v177 offset:28672
    ds_read_b64_tr_b16 v[230:231], v177 offset:29696
    s_waitcnt lgkmcnt(9)
    v_mfma_f32_32x32x16_bf16 v[32:47], v[208:211], v[152:155], v[32:47]
    ds_read_b64_tr_b16 v[232:233], v178 offset:28672
    ds_read_b64_tr_b16 v[234:235], v178 offset:29696
    v_mfma_f32_32x32x16_bf16 v[48:63], v[212:215], v[152:155], v[48:63]
    ds_read_b64_tr_b16 v[236:237], v179 offset:28672
    ds_read_b64_tr_b16 v[238:239], v179 offset:29696
    s_waitcnt lgkmcnt(9)
    v_mfma_f32_32x32x16_bf16 v[64:79], v[216:219], v[152:155], v[64:79]
    v_mfma_f32_32x32x16_bf16 v[80:95], v[220:223], v[152:155], v[80:95]
    s_waitcnt lgkmcnt(4)
    v_mfma_f32_32x32x16_bf16 v[32:47], v[224:227], v[156:159], v[32:47]
    s_waitcnt lgkmcnt(0)
    s_barrier
    ds_read_b128 v[128:131], v180 offset:32768
    ds_read_b64_tr_b16 v[240:241], v176 offset:32768
    ds_read_b64_tr_b16 v[242:243], v176 offset:33792
    v_mfma_f32_32x32x16_bf16 v[48:63], v[228:231], v[156:159], v[48:63]
    ds_read_b64_tr_b16 v[244:245], v177 offset:32768
    ds_read_b64_tr_b16 v[246:247], v177 offset:33792
    ds_read_b64_tr_b16 v[248:249], v178 offset:32768
    ds_read_b64_tr_b16 v[250:251], v178 offset:33792
    v_mfma_f32_32x32x16_bf16 v[64:79], v[232:235], v[156:159], v[64:79]
    ds_read_b64_tr_b16 v[252:253], v179 offset:32768
    ds_read_b64_tr_b16 v[254:255], v179 offset:33792
    ds_read_b128 v[132:135], v181 offset:32768
    ds_read_b64_tr_b16 v[208:209], v176 offset:36864
    ds_read_b64_tr_b16 v[210:211], v176 offset:37888
    v_mfma_f32_32x32x16_bf16 v[80:95], v[236:239], v[156:159], v[80:95]
    ds_read_b64_tr_b16 v[212:213], v177 offset:36864
    ds_read_b64_tr_b16 v[214:215], v177 offset:37888
    s_waitcnt lgkmcnt(9)
    v_mfma_f32_32x32x16_bf16 v[32:47], v[240:243], v[128:131], v[32:47]
    ds_read_b64_tr_b16 v[216:217], v178 offset:36864
    ds_read_b64_tr_b16 v[218:219], v178 offset:37888
    v_mfma_f32_32x32x16_bf16 v[48:63], v[244:247], v[128:131], v[48:63]
    ds_read_b64_tr_b16 v[220:221], v179 offset:36864
    ds_read_b64_tr_b16 v[222:223], v179 offset:37888
    s_waitcnt lgkmcnt(9)
    v_mfma_f32_32x32x16_bf16 v[64:79], v[248:251], v[128:131], v[64:79]
    ds_read_b128 v[136:139], v182 offset:32768
    ds_read_b64_tr_b16 v[224:225], v176 offset:40960
    ds_read_b64_tr_b16 v[226:227], v176 offset:41984
    v_mfma_f32_32x32x16_bf16 v[80:95], v[252:255], v[128:131], v[80:95]
    ds_read_b64_tr_b16 v[228:229], v177 offset:40960
    ds_read_b64_tr_b16 v[230:231], v177 offset:41984
    s_waitcnt lgkmcnt(9)
    v_mfma_f32_32x32x16_bf16 v[32:47], v[208:211], v[132:135], v[32:47]
    ds_read_b64_tr_b16 v[232:233], v178 offset:40960
    ds_read_b64_tr_b16 v[234:235], v178 offset:41984
    v_mfma_f32_32x32x16_bf16 v[48:63], v[212:215], v[132:135], v[48:63]
    ds_read_b64_tr_b16 v[236:237], v179 offset:40960
    ds_read_b64_tr_b16 v[238:239], v179 offset:41984
    s_waitcnt lgkmcnt(9)
    v_mfma_f32_32x32x16_bf16 v[64:79], v[216:219], v[132:135], v[64:79]
    ds_read_b128 v[140:143], v183 offset:32768
    ds_read_b64_tr_b16 v[240:241], v176 offset:45056
    ds_read_b64_tr_b16 v[242:243], v176 offset:46080
    v_mfma_f32_32x32x16_bf16 v[80:95], v[220:223], v[132:135], v[80:95]
    ds_read_b64_tr_b16 v[244:245], v177 offset:45056
    ds_read_b64_tr_b16 v[246:247], v177 offset:46080
    s_waitcnt lgkmcnt(9)
    v_mfma_f32_32x32x16_bf16 v[32:47], v[224:227], v[136:139], v[32:47]
    ds_read_b64_tr_b16 v[248:249], v178 offset:45056
    ds_read_b64_tr_b16 v[250:251], v178 offset:46080
    v_mfma_f32_32x32x16_bf16 v[48:63], v[228:231], v[136:139], v[48:63]
    ds_read_b64_tr_b16 v[252:253], v179 offset:45056
    ds_read_b64_tr_b16 v[254:255], v179 offset:46080
    s_waitcnt lgkmcnt(9)
    v_mfma_f32_32x32x16_bf16 v[64:79], v[232:235], v[136:139], v[64:79]
    v_mfma_f32_32x32x16_bf16 v[80:95], v[236:239], v[136:139], v[80:95]
    s_waitcnt lgkmcnt(4)
    v_mfma_f32_32x32x16_bf16 v[32:47], v[240:243], v[140:143], v[32:47]
    s_waitcnt lgkmcnt(0)
    s_barrier
    ds_read_b128 v[144:147], v180 offset:49152
    ds_read_b64_tr_b16 v[208:209], v176 offset:49152
    ds_read_b64_tr_b16 v[210:211], v176 offset:50176
    v_mfma_f32_32x32x16_bf16 v[48:63], v[244:247], v[140:143], v[48:63]
    ds_read_b128 v[148:151], v181 offset:49152
    ds_read_b64_tr_b16 v[212:213], v176 offset:53248
    ds_read_b64_tr_b16 v[214:215], v176 offset:54272
    v_mfma_f32_32x32x16_bf16 v[64:79], v[248:251], v[140:143], v[64:79]
    ds_read_b128 v[152:155], v182 offset:49152
    ds_read_b64_tr_b16 v[216:217], v176 offset:57344
    ds_read_b64_tr_b16 v[218:219], v176 offset:58368
    v_mfma_f32_32x32x16_bf16 v[80:95], v[252:255], v[140:143], v[80:95]
    ds_read_b128 v[156:159], v183 offset:49152
    ds_read_b64_tr_b16 v[220:221], v176 offset:61440
    ds_read_b64_tr_b16 v[222:223], v176 offset:62464
    s_waitcnt lgkmcnt(6)
    v_mfma_f32_32x32x16_bf16 v[32:47], v[208:211], v[144:147], v[32:47]
    ds_read_b64_tr_b16 v[224:225], v177 offset:49152
    ds_read_b64_tr_b16 v[226:227], v177 offset:50176
    ds_read_b64_tr_b16 v[228:229], v177 offset:53248
    ds_read_b64_tr_b16 v[230:231], v177 offset:54272
    v_mfma_f32_32x32x16_bf16 v[32:47], v[212:215], v[148:151], v[32:47]
    ds_read_b64_tr_b16 v[232:233], v177 offset:57344
    ds_read_b64_tr_b16 v[234:235], v177 offset:58368
    ds_read_b64_tr_b16 v[236:237], v177 offset:61440
    ds_read_b64_tr_b16 v[238:239], v177 offset:62464
    s_waitcnt lgkmcnt(8)
    v_mfma_f32_32x32x16_bf16 v[32:47], v[216:219], v[152:155], v[32:47]
    ds_read_b64_tr_b16 v[240:241], v178 offset:49152
    ds_read_b64_tr_b16 v[242:243], v178 offset:50176
    v_mfma_f32_32x32x16_bf16 v[32:47], v[220:223], v[156:159], v[32:47]
    ds_read_b64_tr_b16 v[244:245], v178 offset:53248
    ds_read_b64_tr_b16 v[246:247], v178 offset:54272
    s_waitcnt lgkmcnt(8)
    v_mfma_f32_32x32x16_bf16 v[48:63], v[224:227], v[144:147], v[48:63]
    ds_read_b64_tr_b16 v[248:249], v178 offset:57344
    ds_read_b64_tr_b16 v[250:251], v178 offset:58368
    v_mfma_f32_32x32x16_bf16 v[48:63], v[228:231], v[148:151], v[48:63]
    ds_read_b64_tr_b16 v[252:253], v178 offset:61440
    ds_read_b64_tr_b16 v[254:255], v178 offset:62464
    s_waitcnt lgkmcnt(8)
    v_mfma_f32_32x32x16_bf16 v[48:63], v[232:235], v[152:155], v[48:63]
    ds_read_b64_tr_b16 v[208:209], v179 offset:49152
    ds_read_b64_tr_b16 v[210:211], v179 offset:50176
    v_mul_f32 v32, s49, v32
    v_mul_f32 v33, s49, v33
    v_mul_f32 v34, s49, v34
    v_mul_f32 v35, s49, v35
    v_mul_f32 v36, s49, v36
    v_mul_f32 v37, s49, v37
    v_mfma_f32_32x32x16_bf16 v[48:63], v[236:239], v[156:159], v[48:63]
    ds_read_b64_tr_b16 v[212:213], v179 offset:53248
    ds_read_b64_tr_b16 v[214:215], v179 offset:54272
    v_mul_f32 v38, s49, v38
    v_mul_f32 v39, s49, v39
    v_mul_f32 v40, s49, v40
    v_mul_f32 v41, s49, v41
    v_mul_f32 v42, s49, v42
    v_mul_f32 v43, s49, v43
    s_waitcnt lgkmcnt(8)
    v_mfma_f32_32x32x16_bf16 v[64:79], v[240:243], v[144:147], v[64:79]
    ds_read_b64_tr_b16 v[216:217], v179 offset:57344
    ds_read_b64_tr_b16 v[218:219], v179 offset:58368
    v_mul_f32 v44, s49, v44
    v_mul_f32 v45, s49, v45
    v_mul_f32 v46, s49, v46
    v_mul_f32 v47, s49, v47
    v_cvt_pk_bf16_f32 v96, v32, v33
    v_cvt_pk_bf16_f32 v97, v34, v35
    v_mfma_f32_32x32x16_bf16 v[64:79], v[244:247], v[148:151], v[64:79]
    ds_read_b64_tr_b16 v[220:221], v179 offset:61440
    ds_read_b64_tr_b16 v[222:223], v179 offset:62464
    v_cvt_pk_bf16_f32 v98, v36, v37
    v_cvt_pk_bf16_f32 v99, v38, v39
    v_cvt_pk_bf16_f32 v100, v40, v41
    v_cvt_pk_bf16_f32 v101, v42, v43
    v_cvt_pk_bf16_f32 v102, v44, v45
    v_cvt_pk_bf16_f32 v103, v46, v47
    s_waitcnt lgkmcnt(8)
    v_mfma_f32_32x32x16_bf16 v[64:79], v[248:251], v[152:155], v[64:79]
    v_mul_f32 v48, s49, v48
    v_mul_f32 v49, s49, v49
    v_mul_f32 v50, s49, v50
    v_mul_f32 v51, s49, v51
    v_mul_f32 v52, s49, v52
    v_mul_f32 v53, s49, v53
    v_mfma_f32_32x32x16_bf16 v[64:79], v[252:255], v[156:159], v[64:79]
    v_mul_f32 v54, s49, v54
    v_mul_f32 v55, s49, v55
    v_mul_f32 v56, s49, v56
    v_mul_f32 v57, s49, v57
    v_mul_f32 v58, s49, v58
    v_mul_f32 v59, s49, v59
    s_waitcnt lgkmcnt(4)
    v_mfma_f32_32x32x16_bf16 v[80:95], v[208:211], v[144:147], v[80:95]
    s_waitcnt lgkmcnt(0)
    s_barrier
    ds_read_b128 v[224:227], v16 offset:0
    ds_read_b128 v[228:231], v17 offset:0
    ds_read_b128 v[232:235], v18 offset:0
    v_mul_f32 v60, s49, v60
    v_mul_f32 v61, s49, v61
    v_mul_f32 v62, s49, v62
    v_mul_f32 v63, s49, v63
    v_cvt_pk_bf16_f32 v104, v48, v49
    v_cvt_pk_bf16_f32 v105, v50, v51
    v_mfma_f32_32x32x16_bf16 v[80:95], v[212:215], v[148:151], v[80:95]
    ds_read_b128 v[236:239], v19 offset:0
    v_cvt_pk_bf16_f32 v106, v52, v53
    v_cvt_pk_bf16_f32 v107, v54, v55
    v_cvt_pk_bf16_f32 v108, v56, v57
    v_cvt_pk_bf16_f32 v109, v58, v59
    v_cvt_pk_bf16_f32 v110, v60, v61
    v_cvt_pk_bf16_f32 v111, v62, v63
    v_mfma_f32_32x32x16_bf16 v[80:95], v[216:219], v[152:155], v[80:95]
    ds_read_b128 v[240:243], v20 offset:0
    v_mul_f32 v64, s49, v64
    v_mul_f32 v65, s49, v65
    v_mul_f32 v66, s49, v66
    v_mul_f32 v67, s49, v67
    v_mul_f32 v68, s49, v68
    v_mul_f32 v69, s49, v69
    v_mfma_f32_32x32x16_bf16 v[80:95], v[220:223], v[156:159], v[80:95]
    ds_read_b128 v[244:247], v21 offset:0
    v_mul_f32 v70, s49, v70
    v_mul_f32 v71, s49, v71
    v_mul_f32 v72, s49, v72
    v_mul_f32 v73, s49, v73
    v_mul_f32 v74, s49, v74
    v_mul_f32 v75, s49, v75
    s_waitcnt lgkmcnt(4)
    v_mfma_f32_32x32x16_bf16 v[128:143], v[224:227], v[96:99], 0
    ds_read_b128 v[248:251], v22 offset:0
    v_mul_f32 v76, s49, v76
    v_mul_f32 v77, s49, v77
    v_mul_f32 v78, s49, v78
    v_mul_f32 v79, s49, v79
    v_cvt_pk_bf16_f32 v112, v64, v65
    v_cvt_pk_bf16_f32 v113, v66, v67
    v_mfma_f32_32x32x16_bf16 v[128:143], v[228:231], v[100:103], v[128:143]
    ds_read_b128 v[252:255], v23 offset:0
    v_cvt_pk_bf16_f32 v114, v68, v69
    v_cvt_pk_bf16_f32 v115, v70, v71
    v_cvt_pk_bf16_f32 v116, v72, v73
    v_cvt_pk_bf16_f32 v117, v74, v75
    v_cvt_pk_bf16_f32 v118, v76, v77
    v_cvt_pk_bf16_f32 v119, v78, v79
    s_waitcnt lgkmcnt(4)
    v_mfma_f32_32x32x16_bf16 v[128:143], v[232:235], v[104:107], v[128:143]
    ds_read_b128 v[208:211], v16 offset:8192
    v_mul_f32 v80, s49, v80
    v_mul_f32 v81, s49, v81
    v_mul_f32 v82, s49, v82
    v_mul_f32 v83, s49, v83
    v_mul_f32 v84, s49, v84
    v_mul_f32 v85, s49, v85
    v_mfma_f32_32x32x16_bf16 v[128:143], v[236:239], v[108:111], v[128:143]
    ds_read_b128 v[212:215], v17 offset:8192
    v_mul_f32 v86, s49, v86
    v_mul_f32 v87, s49, v87
    v_mul_f32 v88, s49, v88
    v_mul_f32 v89, s49, v89
    v_mul_f32 v90, s49, v90
    v_mul_f32 v91, s49, v91
    s_waitcnt lgkmcnt(4)
    v_mfma_f32_32x32x16_bf16 v[128:143], v[240:243], v[112:115], v[128:143]
    ds_read_b128 v[216:219], v18 offset:8192
    v_mul_f32 v92, s49, v92
    v_mul_f32 v93, s49, v93
    v_mul_f32 v94, s49, v94
    v_mul_f32 v95, s49, v95
    v_cvt_pk_bf16_f32 v120, v80, v81
    v_cvt_pk_bf16_f32 v121, v82, v83
    v_mfma_f32_32x32x16_bf16 v[128:143], v[244:247], v[116:119], v[128:143]
    ds_read_b128 v[220:223], v19 offset:8192
    v_cvt_pk_bf16_f32 v122, v84, v85
    v_cvt_pk_bf16_f32 v123, v86, v87
    v_cvt_pk_bf16_f32 v124, v88, v89
    v_cvt_pk_bf16_f32 v125, v90, v91
    v_cvt_pk_bf16_f32 v126, v92, v93
    v_cvt_pk_bf16_f32 v127, v94, v95
    s_waitcnt lgkmcnt(4)
    v_mfma_f32_32x32x16_bf16 v[128:143], v[248:251], v[120:123], v[128:143]
    ds_read_b128 v[224:227], v20 offset:8192
    v_mfma_f32_32x32x16_bf16 v[128:143], v[252:255], v[124:127], v[128:143]
    ds_read_b128 v[228:231], v21 offset:8192
    s_waitcnt lgkmcnt(4)
    v_mfma_f32_32x32x16_bf16 v[144:159], v[208:211], v[96:99], 0
    ds_read_b128 v[232:235], v22 offset:8192
    v_mfma_f32_32x32x16_bf16 v[144:159], v[212:215], v[100:103], v[144:159]
    ds_read_b128 v[236:239], v23 offset:8192
    s_waitcnt lgkmcnt(4)
    v_mfma_f32_32x32x16_bf16 v[144:159], v[216:219], v[104:107], v[144:159]
    v_mfma_f32_32x32x16_bf16 v[144:159], v[220:223], v[108:111], v[144:159]
    s_waitcnt lgkmcnt(3)
    v_mfma_f32_32x32x16_bf16 v[144:159], v[224:227], v[112:115], v[144:159]
    s_nop 0
    v_max3_f32 v11, v128, v129, v130
    v_max3_f32 v11, v11, v131, v132
    v_max3_f32 v11, v11, v133, v134
    v_max3_f32 v11, v11, v135, v136
    v_max3_f32 v11, v11, v137, v138
    v_max3_f32 v11, v11, v139, v140
    v_max3_f32 v11, v11, v141, v142
    v_max_f32 v11, v11, v143
    v_mov_b32 v12, v11
    s_nop 1
    v_permlane32_swap_b32 v11, v12
    s_waitcnt lgkmcnt(2)
    v_mfma_f32_32x32x16_bf16 v[144:159], v[228:231], v[116:119], v[144:159]
    s_nop 0
    v_max_f32 v11, v11, v12
    v_sub_f32 v176, 0, v11
    v_sub_f32 v177, 0, v11
    v_sub_f32 v178, 0, v11
    v_sub_f32 v179, 0, v11
    v_sub_f32 v180, 0, v11
    v_sub_f32 v181, 0, v11
    v_sub_f32 v182, 0, v11
    v_sub_f32 v183, 0, v11
    v_sub_f32 v184, 0, v11
    s_waitcnt lgkmcnt(1)
    v_mfma_f32_32x32x16_bf16 v[144:159], v[232:235], v[120:123], v[144:159]
    v_sub_f32 v185, 0, v11
    v_sub_f32 v186, 0, v11
    v_sub_f32 v187, 0, v11
    v_sub_f32 v188, 0, v11
    v_sub_f32 v189, 0, v11
    v_sub_f32 v190, 0, v11
    v_sub_f32 v191, 0, v11
    v_sub_f32 v128, v128, v11
    v_sub_f32 v129, v129, v11
    v_sub_f32 v130, v130, v11
    v_sub_f32 v131, v131, v11
    v_sub_f32 v132, v132, v11
    s_waitcnt lgkmcnt(0)
    v_mfma_f32_32x32x16_bf16 v[144:159], v[236:239], v[124:127], v[144:159]
    s_barrier
    ds_read_b128 v[240:243], v16 offset:16384
    ds_read_b128 v[244:247], v17 offset:16384
    ds_read_b128 v[248:251], v18 offset:16384
    v_sub_f32 v133, v133, v11
    v_sub_f32 v134, v134, v11
    v_sub_f32 v135, v135, v11
    v_sub_f32 v136, v136, v11
    v_sub_f32 v137, v137, v11
    v_sub_f32 v138, v138, v11
    v_sub_f32 v139, v139, v11
    v_sub_f32 v140, v140, v11
    v_sub_f32 v141, v141, v11
    v_sub_f32 v142, v142, v11
    v_sub_f32 v143, v143, v11
    v_exp_f32 v128, v128
    v_exp_f32 v129, v129
    v_exp_f32 v130, v130
    v_exp_f32 v131, v131
    v_exp_f32 v132, v132
    v_exp_f32 v133, v133
    v_exp_f32 v134, v134
    v_exp_f32 v135, v135
    v_cvt_pk_bf16_f32 v160, v128, v129
    v_cvt_pk_bf16_f32 v161, v130, v131
    v_exp_f32 v136, v136
    v_exp_f32 v137, v137
    v_exp_f32 v138, v138
    v_exp_f32 v139, v139
    v_cvt_pk_bf16_f32 v162, v132, v133
    v_cvt_pk_bf16_f32 v163, v134, v135
    v_exp_f32 v140, v140
    v_exp_f32 v141, v141
    v_exp_f32 v142, v142
    v_exp_f32 v143, v143
    v_cvt_pk_bf16_f32 v164, v136, v137
    v_cvt_pk_bf16_f32 v165, v138, v139
    v_cvt_pk_bf16_f32 v166, v140, v141
    v_cvt_pk_bf16_f32 v167, v142, v143
    v_add_f32 v144, v144, v176
    v_add_f32 v145, v145, v176
    v_add_f32 v146, v146, v176
    v_add_f32 v147, v147, v176
    v_add_f32 v148, v148, v176
    v_add_f32 v149, v149, v176
    v_add_f32 v150, v150, v176
    v_add_f32 v151, v151, v176
    v_add_f32 v152, v152, v176
    v_add_f32 v153, v153, v176
    v_add_f32 v154, v154, v176
    v_add_f32 v155, v155, v176
    v_add_f32 v156, v156, v176
    v_add_f32 v157, v157, v176
    v_add_f32 v158, v158, v176
    v_add_f32 v159, v159, v176
    v_max3_f32 v11, v144, v145, v146
    v_max3_f32 v11, v11, v147, v148
    v_max3_f32 v11, v11, v149, v150
    v_max3_f32 v11, v11, v151, v152
    v_max3_f32 v11, v11, v153, v154
    v_max3_f32 v11, v11, v155, v156
    v_max3_f32 v11, v11, v157, v158
    v_max_f32 v11, v11, v159
    v_cmp_lt_f32 vcc, s46, v11
    s_nop 0
    s_cbranch_vccnz L_rare_0
L_back_0:
    s_waitcnt lgkmcnt(2)
    v_mfma_f32_32x32x16_bf16 v[128:143], v[240:243], v[96:99], v[176:191]
    ds_read_b128 v[252:255], v19 offset:16384
    ds_read_b128 v[208:211], v20 offset:16384
    ds_read_b128 v[212:215], v21 offset:16384
    v_exp_f32 v144, v144
    s_waitcnt lgkmcnt(4)
    v_mfma_f32_32x32x16_bf16 v[128:143], v[244:247], v[100:103], v[128:143]
    ds_read_b128 v[216:219], v22 offset:16384
    ds_read_b128 v[220:223], v23 offset:16384
    v_exp_f32 v145, v145
    s_waitcnt lgkmcnt(4)
    v_mfma_f32_32x32x16_bf16 v[128:143], v[248:251], v[104:107], v[128:143]
    ds_read_b64_tr_b16 v[224:225], v24 offset:0
    ds_read_b64_tr_b16 v[226:227], v24 offset:2048
    v_exp_f32 v146, v146
    v_exp_f32 v147, v147
    v_mfma_f32_32x32x16_bf16 v[128:143], v[252:255], v[108:111], v[128:143]
    ds_read_b64_tr_b16 v[228:229], v25 offset:0
    ds_read_b64_tr_b16 v[230:231], v25 offset:2048
    v_exp_f32 v148, v148
    s_waitcnt lgkmcnt(6)
    v_mfma_f32_32x32x16_bf16 v[128:143], v[208:211], v[112:115], v[128:143]
    ds_read_b64_tr_b16 v[232:233], v26 offset:0
    ds_read_b64_tr_b16 v[234:235], v26 offset:2048
    v_exp_f32 v149, v149
    v_mfma_f32_32x32x16_bf16 v[128:143], v[212:215], v[116:119], v[128:143]
    ds_read_b64_tr_b16 v[236:237], v27 offset:0
    ds_read_b64_tr_b16 v[238:239], v27 offset:2048
    v_exp_f32 v150, v150
    s_waitcnt lgkmcnt(8)
    v_mfma_f32_32x32x16_bf16 v[128:143], v[216:219], v[120:123], v[128:143]
    v_exp_f32 v151, v151
    v_cvt_pk_bf16_f32 v168, v144, v145
    v_cvt_pk_bf16_f32 v169, v146, v147
    v_exp_f32 v152, v152
    v_mfma_f32_32x32x16_bf16 v[128:143], v[220:223], v[124:127], v[128:143]
    ds_read_b64_tr_b16 v[240:241], v24 offset:4096
    ds_read_b64_tr_b16 v[242:243], v24 offset:6144
    v_exp_f32 v153, v153
    s_waitcnt lgkmcnt(6)
    v_mfma_f32_32x32x16_bf16 v[32:47], v[224:227], v[160:163], 0
    ds_read_b64_tr_b16 v[244:245], v25 offset:4096
    ds_read_b64_tr_b16 v[246:247], v25 offset:6144
    v_exp_f32 v154, v154
    v_mfma_f32_32x32x16_bf16 v[48:63], v[228:231], v[160:163], 0
    ds_read_b64_tr_b16 v[248:249], v26 offset:4096
    ds_read_b64_tr_b16 v[250:251], v26 offset:6144
    v_exp_f32 v155, v155
    v_cvt_pk_bf16_f32 v170, v148, v149
    s_waitcnt lgkmcnt(6)
    v_mfma_f32_32x32x16_bf16 v[64:79], v[232:235], v[160:163], 0
    ds_read_b64_tr_b16 v[252:253], v27 offset:4096
    ds_read_b64_tr_b16 v[254:255], v27 offset:6144
    v_max3_f32 v11, v128, v129, v130
    v_max3_f32 v11, v11, v131, v132
    v_cvt_pk_bf16_f32 v171, v150, v151
    v_mfma_f32_32x32x16_bf16 v[80:95], v[236:239], v[160:163], 0
    v_max3_f32 v11, v11, v133, v134
    v_max3_f32 v11, v11, v135, v136
    v_exp_f32 v156, v156
    v_exp_f32 v157, v157
    v_mfma_f32_16x16x32_bf16 v[192:195], v[28:31], v[160:163], 0
    ds_read_b128 v[208:211], v16 offset:24576
    s_waitcnt lgkmcnt(5)
    v_mfma_f32_32x32x16_bf16 v[32:47], v[240:243], v[164:167], v[32:47]
    ds_read_b128 v[212:215], v17 offset:24576
    v_max3_f32 v11, v11, v137, v138
    v_max3_f32 v11, v11, v139, v140
    v_exp_f32 v158, v158
    v_mfma_f32_32x32x16_bf16 v[48:63], v[244:247], v[164:167], v[48:63]
    ds_read_b128 v[216:219], v18 offset:24576
    v_max3_f32 v11, v11, v141, v142
    v_exp_f32 v159, v159
    s_waitcnt lgkmcnt(5)
    v_mfma_f32_32x32x16_bf16 v[64:79], v[248:251], v[164:167], v[64:79]
    ds_read_b128 v[220:223], v19 offset:24576
    v_max_f32 v11, v11, v143
    v_cvt_pk_bf16_f32 v172, v152, v153
    v_cvt_pk_bf16_f32 v173, v154, v155
    s_waitcnt lgkmcnt(4)
    v_mfma_f32_32x32x16_bf16 v[80:95], v[252:255], v[164:167], v[80:95]
    ds_read_b128 v[224:227], v20 offset:24576
    v_cmp_lt_f32 vcc, s46, v11
    v_cvt_pk_bf16_f32 v174, v156, v157
    v_cvt_pk_bf16_f32 v175, v158, v159
    v_mfma_f32_16x16x32_bf16 v[192:195], v[28:31], v[164:167], v[192:195]
    ds_read_b128 v[228:231], v21 offset:24576
    s_cbranch_vccnz L_rare_1
L_back_1:
    s_waitcnt lgkmcnt(4)
    v_mfma_f32_32x32x16_bf16 v[144:159], v[208:211], v[96:99], v[176:191]
    ds_read_b128 v[232:235], v22 offset:24576
    v_exp_f32 v128, v128
    v_exp_f32 v129, v129
    v_mfma_f32_32x32x16_bf16 v[144:159], v[212:215], v[100:103], v[144:159]
    ds_read_b128 v[236:239], v23 offset:24576
    v_exp_f32 v130, v130
    v_exp_f32 v131, v131
    s_waitcnt lgkmcnt(4)
    v_mfma_f32_32x32x16_bf16 v[144:159], v[216:219], v[104:107], v[144:159]
    ds_read_b64_tr_b16 v[240:241], v24 offset:8192
    ds_read_b64_tr_b16 v[242:243], v24 offset:10240
    v_exp_f32 v132, v132
    v_mfma_f32_32x32x16_bf16 v[144:159], v[220:223], v[108:111], v[144:159]
    ds_read_b64_tr_b16 v[244:245], v25 offset:8192
    ds_read_b64_tr_b16 v[246:247], v25 offset:10240
    v_exp_f32 v133, v133
    s_waitcnt lgkmcnt(6)
    v_mfma_f32_32x32x16_bf16 v[144:159], v[224:227], v[112:115], v[144:159]
    ds_read_b64_tr_b16 v[248:249], v26 offset:8192
    ds_read_b64_tr_b16 v[250:251], v26 offset:10240
    v_exp_f32 v134, v134
    v_mfma_f32_32x32x16_bf16 v[144:159], v[228:231], v[116:119], v[144:159]
    ds_read_b64_tr_b16 v[252:253], v27 offset:8192
    ds_read_b64_tr_b16 v[254:255], v27 offset:10240
    v_exp_f32 v135, v135
    v_cvt_pk_bf16_f32 v160, v128, v129
    s_waitcnt lgkmcnt(8)
    v_mfma_f32_32x32x16_bf16 v[144:159], v[232:235], v[120:123], v[144:159]
    v_cvt_pk_bf16_f32 v161, v130, v131
    v_exp_f32 v136, v136
    v_mfma_f32_32x32x16_bf16 v[144:159], v[236:239], v[124:127], v[144:159]
    ds_read_b64_tr_b16 v[208:209], v24 offset:12288
    ds_read_b64_tr_b16 v[210:211], v24 offset:14336
    v_exp_f32 v137, v137
    s_waitcnt lgkmcnt(6)
    v_mfma_f32_32x32x16_bf16 v[32:47], v[240:243], v[168:171], v[32:47]
    ds_read_b64_tr_b16 v[212:213], v25 offset:12288
    ds_read_b64_tr_b16 v[214:215], v25 offset:14336
    v_exp_f32 v138, v138
    v_exp_f32 v139, v139
    v_mfma_f32_32x32x16_bf16 v[48:63], v[244:247], v[168:171], v[48:63]
    ds_read_b64_tr_b16 v[216:217], v26 offset:12288
    ds_read_b64_tr_b16 v[218:219], v26 offset:14336
    v_cvt_pk_bf16_f32 v162, v132, v133
    v_cvt_pk_bf16_f32 v163, v134, v135
    s_waitcnt lgkmcnt(6)
    v_mfma_f32_32x32x16_bf16 v[64:79], v[248:251], v[168:171], v[64:79]
    ds_read_b64_tr_b16 v[220:221], v27 offset:12288
    ds_read_b64_tr_b16 v[222:223], v27 offset:14336
    v_max3_f32 v11, v144, v145, v146
    v_max3_f32 v11, v11, v147, v148
    v_exp_f32 v140, v140
    v_mfma_f32_32x32x16_bf16 v[80:95], v[252:255], v[168:171], v[80:95]
    v_max3_f32 v11, v11, v149, v150
    v_max3_f32 v11, v11, v151, v152
    v_exp_f32 v141, v141
    v_mfma_f32_16x16x32_bf16 v[192:195], v[28:31], v[168:171], v[192:195]
    v_max3_f32 v11, v11, v153, v154
    s_waitcnt lgkmcnt(4)
    v_mfma_f32_32x32x16_bf16 v[32:47], v[208:211], v[172:175], v[32:47]
    v_max3_f32 v11, v11, v155, v156
    v_exp_f32 v142, v142
    v_exp_f32 v143, v143
    v_mfma_f32_32x32x16_bf16 v[48:63], v[212:215], v[172:175], v[48:63]
    s_waitcnt lgkmcnt(0)
    s_barrier
    ds_read_b128 v[224:227], v16 offset:32768
    ds_read_b128 v[228:231], v17 offset:32768
    ds_read_b128 v[232:235], v18 offset:32768
    v_max3_f32 v11, v11, v157, v158
    v_mfma_f32_32x32x16_bf16 v[64:79], v[216:219], v[172:175], v[64:79]
    ds_read_b128 v[236:239], v19 offset:32768
    v_max_f32 v11, v11, v159
    v_cvt_pk_bf16_f32 v164, v136, v137
    v_cvt_pk_bf16_f32 v165, v138, v139
    v_mfma_f32_32x32x16_bf16 v[80:95], v[220:223], v[172:175], v[80:95]
    ds_read_b128 v[240:243], v20 offset:32768
    v_cmp_lt_f32 vcc, s46, v11
    v_cvt_pk_bf16_f32 v166, v140, v141
    v_cvt_pk_bf16_f32 v167, v142, v143
    v_mfma_f32_16x16x32_bf16 v[192:195], v[28:31], v[172:175], v[192:195]
    ds_read_b128 v[244:247], v21 offset:32768
    s_cbranch_vccnz L_rare_2
L_back_2:
    s_waitcnt lgkmcnt(4)
    v_mfma_f32_32x32x16_bf16 v[128:143], v[224:227], v[96:99], v[176:191]
    ds_read_b128 v[248:251], v22 offset:32768
    v_exp_f32 v144, v144
    v_exp_f32 v145, v145
    v_mfma_f32_32x32x16_bf16 v[128:143], v[228:231], v[100:103], v[128:143]
    ds_read_b128 v[252:255], v23 offset:32768
    v_exp_f32 v146, v146
    v_exp_f32 v147, v147
    s_waitcnt lgkmcnt(4)
    v_mfma_f32_32x32x16_bf16 v[128:143], v[232:235], v[104:107], v[128:143]
    ds_read_b64_tr_b16 v[208:209], v24 offset:16384
    ds_read_b64_tr_b16 v[210:211], v24 offset:18432
    v_exp_f32 v148, v148
    v_mfma_f32_32x32x16_bf16 v[128:143], v[236:239], v[108:111], v[128:143]
    ds_read_b64_tr_b16 v[212:213], v25 offset:16384
    ds_read_b64_tr_b16 v[214:215], v25 offset:18432
    v_exp_f32 v149, v149
    s_waitcnt lgkmcnt(6)
    v_mfma_f32_32x32x16_bf16 v[128:143], v[240:243], v[112:115], v[128:143]
    ds_read_b64_tr_b16 v[216:217], v26 offset:16384
    ds_read_b64_tr_b16 v[218:219], v26 offset:18432
    v_exp_f32 v150, v150
    v_mfma_f32_32x32x16_bf16 v[128:143], v[244:247], v[116:119], v[128:143]
    ds_read_b64_tr_b16 v[220:221], v27 offset:16384
    ds_read_b64_tr_b16 v[222:223], v27 offset:18432
    v_exp_f32 v151, v151
    v_cvt_pk_bf16_f32 v168, v144, v145
    s_waitcnt lgkmcnt(8)
    v_mfma_f32_32x32x16_bf16 v[128:143], v[248:251], v[120:123], v[128:143]
    v_cvt_pk_bf16_f32 v169, v146, v147
    v_exp_f32 v152, v152
    v_mfma_f32_32x32x16_bf16 v[128:143], v[252:255], v[124:127], v[128:143]
    ds_read_b64_tr_b16 v[224:225], v24 offset:20480
    ds_read_b64_tr_b16 v[226:227], v24 offset:22528
    v_exp_f32 v153, v153
    s_waitcnt lgkmcnt(6)
    v_mfma_f32_32x32x16_bf16 v[32:47], v[208:211], v[160:163], v[32:47]
    ds_read_b64_tr_b16 v[228:229], v25 offset:20480
    ds_read_b64_tr_b16 v[230:231], v25 offset:22528
    v_exp_f32 v154, v154
    v_exp_f32 v155, v155
    v_mfma_f32_32x32x16_bf16 v[48:63], v[212:215], v[160:163], v[48:63]
    ds_read_b64_tr_b16 v[232:233], v26 offset:20480
    ds_read_b64_tr_b16 v[234:235], v26 offset:22528
    v_cvt_pk_bf16_f32 v170, v148, v149
    v_cvt_pk_bf16_f32 v171, v150, v151
    s_waitcnt lgkmcnt(6)
    v_mfma_f32_32x32x16_bf16 v[64:79], v[216:219], v[160:163], v[64:79]
    ds_read_b64_tr_b16 v[236:237], v27 offset:20480
    ds_read_b64_tr_b16 v[238:239], v27 offset:22528
    v_max3_f32 v11, v128, v129, v130
    v_max3_f32 v11, v11, v131, v132
    v_exp_f32 v156, v156
    v_mfma_f32_32x32x16_bf16 v[80:95], v[220:223], v[160:163], v[80:95]
    v_max3_f32 v11, v11, v133, v134
    v_max3_f32 v11, v11, v135, v136
    v_exp_f32 v157, v157
    v_mfma_f32_16x16x32_bf16 v[192:195], v[28:31], v[160:163], v[192:195]
    ds_read_b128 v[240:243], v16 offset:40960
    s_waitcnt lgkmcnt(5)
    v_mfma_f32_32x32x16_bf16 v[32:47], v[224:227], v[164:167], v[32:47]
    ds_read_b128 v[244:247], v17 offset:40960
    v_max3_f32 v11, v11, v137, v138
    v_max3_f32 v11, v11, v139, v140
    v_exp_f32 v158, v158
    v_mfma_f32_32x32x16_bf16 v[48:63], v[228:231], v[164:167], v[48:63]
    ds_read_b128 v[248:251], v18 offset:40960
    v_max3_f32 v11, v11, v141, v142
    v_exp_f32 v159, v159
    s_waitcnt lgkmcnt(5)
    v_mfma_f32_32x32x16_bf16 v[64:79], v[232:235], v[164:167], v[64:79]
    ds_read_b128 v[252:255], v19 offset:40960
    v_max_f32 v11, v11, v143
    v_cvt_pk_bf16_f32 v172, v152, v153
    v_cvt_pk_bf16_f32 v173, v154, v155
    s_waitcnt lgkmcnt(4)
    v_mfma_f32_32x32x16_bf16 v[80:95], v[236:239], v[164:167], v[80:95]
    ds_read_b128 v[208:211], v20 offset:40960
    v_cmp_lt_f32 vcc, s46, v11
    v_cvt_pk_bf16_f32 v174, v156, v157
    v_cvt_pk_bf16_f32 v175, v158, v159
    v_mfma_f32_16x16x32_bf16 v[192:195], v[28:31], v[164:167], v[192:195]
    ds_read_b128 v[212:215], v21 offset:40960
    s_cbranch_vccnz L_rare_3
L_back_3:
    s_waitcnt lgkmcnt(4)
    v_mfma_f32_32x32x16_bf16 v[144:159], v[240:243], v[96:99], v[176:191]
    ds_read_b128 v[216:219], v22 offset:40960
    v_exp_f32 v128, v128
    v_exp_f32 v129, v129
    v_mfma_f32_32x32x16_bf16 v[144:159], v[244:247], v[100:103], v[144:159]
    ds_read_b128 v[220:223], v23 offset:40960
    v_exp_f32 v130, v130
    v_exp_f32 v131, v131
    s_waitcnt lgkmcnt(4)
    v_mfma_f32_32x32x16_bf16 v[144:159], v[248:251], v[104:107], v[144:159]
    ds_read_b64_tr_b16 v[224:225], v24 offset:24576
    ds_read_b64_tr_b16 v[226:227], v24 offset:26624
    v_exp_f32 v132, v132
    v_mfma_f32_32x32x16_bf16 v[144:159], v[252:255], v[108:111], v[144:159]
    ds_read_b64_tr_b16 v[228:229], v25 offset:24576
    ds_read_b64_tr_b16 v[230:231], v25 offset:26624
    v_exp_f32 v133, v133
    s_waitcnt lgkmcnt(6)
    v_mfma_f32_32x32x16_bf16 v[144:159], v[208:211], v[112:115], v[144:159]
    ds_read_b64_tr_b16 v[232:233], v26 offset:24576
    ds_read_b64_tr_b16 v[234:235], v26 offset:26624
    v_exp_f32 v134, v134
    v_mfma_f32_32x32x16_bf16 v[144:159], v[212:215], v[116:119], v[144:159]
    ds_read_b64_tr_b16 v[236:237], v27 offset:24576
    ds_read_b64_tr_b16 v[238:239], v27 offset:26624
    v_exp_f32 v135, v135
    v_cvt_pk_bf16_f32 v160, v128, v129
    s_waitcnt lgkmcnt(8)
    v_mfma_f32_32x32x16_bf16 v[144:159], v[216:219], v[120:123], v[144:159]
    v_cvt_pk_bf16_f32 v161, v130, v131
    v_exp_f32 v136, v136
    v_mfma_f32_32x32x16_bf16 v[144:159], v[220:223], v[124:127], v[144:159]
    ds_read_b64_tr_b16 v[240:241], v24 offset:28672
    ds_read_b64_tr_b16 v[242:243], v24 offset:30720
    v_exp_f32 v137, v137
    s_waitcnt lgkmcnt(6)
    v_mfma_f32_32x32x16_bf16 v[32:47], v[224:227], v[168:171], v[32:47]
    ds_read_b64_tr_b16 v[244:245], v25 offset:28672
    ds_read_b64_tr_b16 v[246:247], v25 offset:30720
    v_exp_f32 v138, v138
    v_exp_f32 v139, v139
    v_mfma_f32_32x32x16_bf16 v[48:63], v[228:231], v[168:171], v[48:63]
    ds_read_b64_tr_b16 v[248:249], v26 offset:28672
    ds_read_b64_tr_b16 v[250:251], v26 offset:30720
    v_cvt_pk_bf16_f32 v162, v132, v133
    v_cvt_pk_bf16_f32 v163, v134, v135
    s_waitcnt lgkmcnt(6)
    v_mfma_f32_32x32x16_bf16 v[64:79], v[232:235], v[168:171], v[64:79]
    ds_read_b64_tr_b16 v[252:253], v27 offset:28672
    ds_read_b64_tr_b16 v[254:255], v27 offset:30720
    v_max3_f32 v11, v144, v145, v146
    v_max3_f32 v11, v11, v147, v148
    v_exp_f32 v140, v140
    v_mfma_f32_32x32x16_bf16 v[80:95], v[236:239], v[168:171], v[80:95]
    v_max3_f32 v11, v11, v149, v150
    v_max3_f32 v11, v11, v151, v152
    v_exp_f32 v141, v141
    v_mfma_f32_16x16x32_bf16 v[192:195], v[28:31], v[168:171], v[192:195]
    v_max3_f32 v11, v11, v153, v154
    s_waitcnt lgkmcnt(4)
    v_mfma_f32_32x32x16_bf16 v[32:47], v[240:243], v[172:175], v[32:47]
    v_max3_f32 v11, v11, v155, v156
    v_exp_f32 v142, v142
    v_exp_f32 v143, v143
    v_mfma_f32_32x32x16_bf16 v[48:63], v[244:247], v[172:175], v[48:63]
    s_waitcnt lgkmcnt(0)
    s_barrier
    ds_read_b128 v[208:211], v16 offset:49152
    ds_read_b128 v[212:215], v17 offset:49152
    ds_read_b128 v[216:219], v18 offset:49152
    v_max3_f32 v11, v11, v157, v158
    v_mfma_f32_32x32x16_bf16 v[64:79], v[248:251], v[172:175], v[64:79]
    ds_read_b128 v[220:223], v19 offset:49152
    v_max_f32 v11, v11, v159
    v_cvt_pk_bf16_f32 v164, v136, v137
    v_cvt_pk_bf16_f32 v165, v138, v139
    v_mfma_f32_32x32x16_bf16 v[80:95], v[252:255], v[172:175], v[80:95]
    ds_read_b128 v[224:227], v20 offset:49152
    v_cmp_lt_f32 vcc, s46, v11
    v_cvt_pk_bf16_f32 v166, v140, v141
    v_cvt_pk_bf16_f32 v167, v142, v143
    v_mfma_f32_16x16x32_bf16 v[192:195], v[28:31], v[172:175], v[192:195]
    ds_read_b128 v[228:231], v21 offset:49152
    s_cbranch_vccnz L_rare_4
L_back_4:
    s_waitcnt lgkmcnt(4)
    v_mfma_f32_32x32x16_bf16 v[128:143], v[208:211], v[96:99], v[176:191]
    ds_read_b128 v[232:235], v22 offset:49152
    v_exp_f32 v144, v144
    v_exp_f32 v145, v145
    v_mfma_f32_32x32x16_bf16 v[128:143], v[212:215], v[100:103], v[128:143]
    ds_read_b128 v[236:239], v23 offset:49152
    v_exp_f32 v146, v146
    v_exp_f32 v147, v147
    s_waitcnt lgkmcnt(4)
    v_mfma_f32_32x32x16_bf16 v[128:143], v[216:219], v[104:107], v[128:143]
    ds_read_b64_tr_b16 v[240:241], v24 offset:32768
    ds_read_b64_tr_b16 v[242:243], v24 offset:34816
    v_exp_f32 v148, v148
    v_mfma_f32_32x32x16_bf16 v[128:143], v[220:223], v[108:111], v[128:143]
    ds_read_b64_tr_b16 v[244:245], v25 offset:32768
    ds_read_b64_tr_b16 v[246:247], v25 offset:34816
    v_exp_f32 v149, v149
    s_waitcnt lgkmcnt(6)
    v_mfma_f32_32x32x16_bf16 v[128:143], v[224:227], v[112:115], v[128:143]
    ds_read_b64_tr_b16 v[248:249], v26 offset:32768
    ds_read_b64_tr_b16 v[250:251], v26 offset:34816
    v_exp_f32 v150, v150
    v_mfma_f32_32x32x16_bf16 v[128:143], v[228:231], v[116:119], v[128:143]
    ds_read_b64_tr_b16 v[252:253], v27 offset:32768
    ds_read_b64_tr_b16 v[254:255], v27 offset:34816
    v_exp_f32 v151, v151
    v_cvt_pk_bf16_f32 v168, v144, v145
    s_waitcnt lgkmcnt(8)
    v_mfma_f32_32x32x16_bf16 v[128:143], v[232:235], v[120:123], v[128:143]
    v_cvt_pk_bf16_f32 v169, v146, v147
    v_exp_f32 v152, v152
    v_mfma_f32_32x32x16_bf16 v[128:143], v[236:239], v[124:127], v[128:143]
    ds_read_b64_tr_b16 v[208:209], v24 offset:36864
    ds_read_b64_tr_b16 v[210:211], v24 offset:38912
    v_exp_f32 v153, v153
    s_waitcnt lgkmcnt(6)
    v_mfma_f32_32x32x16_bf16 v[32:47], v[240:243], v[160:163], v[32:47]
    ds_read_b64_tr_b16 v[212:213], v25 offset:36864
    ds_read_b64_tr_b16 v[214:215], v25 offset:38912
    v_exp_f32 v154, v154
    v_exp_f32 v155, v155
    v_mfma_f32_32x32x16_bf16 v[48:63], v[244:247], v[160:163], v[48:63]
    ds_read_b64_tr_b16 v[216:217], v26 offset:36864
    ds_read_b64_tr_b16 v[218:219], v26 offset:38912
    v_cvt_pk_bf16_f32 v170, v148, v149
    v_cvt_pk_bf16_f32 v171, v150, v151
    s_waitcnt lgkmcnt(6)
    v_mfma_f32_32x32x16_bf16 v[64:79], v[248:251], v[160:163], v[64:79]
    ds_read_b64_tr_b16 v[220:221], v27 offset:36864
    ds_read_b64_tr_b16 v[222:223], v27 offset:38912
    v_max3_f32 v11, v128, v129, v130
    v_max3_f32 v11, v11, v131, v132
    v_exp_f32 v156, v156
    v_mfma_f32_32x32x16_bf16 v[80:95], v[252:255], v[160:163], v[80:95]
    v_max3_f32 v11, v11, v133, v134
    v_max3_f32 v11, v11, v135, v136
    v_exp_f32 v157, v157
    v_mfma_f32_16x16x32_bf16 v[192:195], v[28:31], v[160:163], v[192:195]
    ds_read_b128 v[224:227], v16 offset:57344
    s_waitcnt lgkmcnt(5)
    v_mfma_f32_32x32x16_bf16 v[32:47], v[208:211], v[164:167], v[32:47]
    ds_read_b128 v[228:231], v17 offset:57344
    v_max3_f32 v11, v11, v137, v138
    v_max3_f32 v11, v11, v139, v140
    v_exp_f32 v158, v158
    v_mfma_f32_32x32x16_bf16 v[48:63], v[212:215], v[164:167], v[48:63]
    ds_read_b128 v[232:235], v18 offset:57344
    v_max3_f32 v11, v11, v141, v142
    v_exp_f32 v159, v159
    s_waitcnt lgkmcnt(5)
    v_mfma_f32_32x32x16_bf16 v[64:79], v[216:219], v[164:167], v[64:79]
    ds_read_b128 v[236:239], v19 offset:57344
    v_max_f32 v11, v11, v143
    v_cvt_pk_bf16_f32 v172, v152, v153
    v_cvt_pk_bf16_f32 v173, v154, v155
    s_waitcnt lgkmcnt(4)
    v_mfma_f32_32x32x16_bf16 v[80:95], v[220:223], v[164:167], v[80:95]
    ds_read_b128 v[240:243], v20 offset:57344
    v_cmp_lt_f32 vcc, s46, v11
    v_cvt_pk_bf16_f32 v174, v156, v157
    v_cvt_pk_bf16_f32 v175, v158, v159
    v_mfma_f32_16x16x32_bf16 v[192:195], v[28:31], v[164:167], v[192:195]
    ds_read_b128 v[244:247], v21 offset:57344
    s_cbranch_vccnz L_rare_5
L_back_5:
    s_waitcnt lgkmcnt(4)
    v_mfma_f32_32x32x16_bf16 v[144:159], v[224:227], v[96:99], v[176:191]
    ds_read_b128 v[248:251], v22 offset:57344
    v_exp_f32 v128, v128
    v_exp_f32 v129, v129
    v_mfma_f32_32x32x16_bf16 v[144:159], v[228:231], v[100:103], v[144:159]
    ds_read_b128 v[252:255], v23 offset:57344
    v_exp_f32 v130, v130
    v_exp_f32 v131, v131
    s_waitcnt lgkmcnt(4)
    v_mfma_f32_32x32x16_bf16 v[144:159], v[232:235], v[104:107], v[144:159]
    ds_read_b64_tr_b16 v[208:209], v24 offset:40960
    ds_read_b64_tr_b16 v[210:211], v24 offset:43008
    v_exp_f32 v132, v132
    v_mfma_f32_32x32x16_bf16 v[144:159], v[236:239], v[108:111], v[144:159]
    ds_read_b64_tr_b16 v[212:213], v25 offset:40960
    ds_read_b64_tr_b16 v[214:215], v25 offset:43008
    v_exp_f32 v133, v133
    s_waitcnt lgkmcnt(6)
    v_mfma_f32_32x32x16_bf16 v[144:159], v[240:243], v[112:115], v[144:159]
    ds_read_b64_tr_b16 v[216:217], v26 offset:40960
    ds_read_b64_tr_b16 v[218:219], v26 offset:43008
    v_exp_f32 v134, v134
    v_mfma_f32_32x32x16_bf16 v[144:159], v[244:247], v[116:119], v[144:159]
    ds_read_b64_tr_b16 v[220:221], v27 offset:40960
    ds_read_b64_tr_b16 v[222:223], v27 offset:43008
    v_exp_f32 v135, v135
    v_cvt_pk_bf16_f32 v160, v128, v129
    s_waitcnt lgkmcnt(8)
    v_mfma_f32_32x32x16_bf16 v[144:159], v[248:251], v[120:123], v[144:159]
    v_cvt_pk_bf16_f32 v161, v130, v131
    v_exp_f32 v136, v136
    v_mfma_f32_32x32x16_bf16 v[144:159], v[252:255], v[124:127], v[144:159]
    ds_read_b64_tr_b16 v[224:225], v24 offset:45056
    ds_read_b64_tr_b16 v[226:227], v24 offset:47104
    v_exp_f32 v137, v137
    s_waitcnt lgkmcnt(6)
    v_mfma_f32_32x32x16_bf16 v[32:47], v[208:211], v[168:171], v[32:47]
    ds_read_b64_tr_b16 v[228:229], v25 offset:45056
    ds_read_b64_tr_b16 v[230:231], v25 offset:47104
    v_exp_f32 v138, v138
    v_exp_f32 v139, v139
    v_mfma_f32_32x32x16_bf16 v[48:63], v[212:215], v[168:171], v[48:63]
    ds_read_b64_tr_b16 v[232:233], v26 offset:45056
    ds_read_b64_tr_b16 v[234:235], v26 offset:47104
    v_cvt_pk_bf16_f32 v162, v132, v133
    v_cvt_pk_bf16_f32 v163, v134, v135
    s_waitcnt lgkmcnt(6)
    v_mfma_f32_32x32x16_bf16 v[64:79], v[216:219], v[168:171], v[64:79]
    ds_read_b64_tr_b16 v[236:237], v27 offset:45056
    ds_read_b64_tr_b16 v[238:239], v27 offset:47104
    v_max3_f32 v11, v144, v145, v146
    v_max3_f32 v11, v11, v147, v148
    v_exp_f32 v140, v140
    v_mfma_f32_32x32x16_bf16 v[80:95], v[220:223], v[168:171], v[80:95]
    v_max3_f32 v11, v11, v149, v150
    v_max3_f32 v11, v11, v151, v152
    v_exp_f32 v141, v141
    v_mfma_f32_16x16x32_bf16 v[192:195], v[28:31], v[168:171], v[192:195]
    v_max3_f32 v11, v11, v153, v154
    s_waitcnt lgkmcnt(4)
    v_mfma_f32_32x32x16_bf16 v[32:47], v[224:227], v[172:175], v[32:47]
    v_max3_f32 v11, v11, v155, v156
    v_exp_f32 v142, v142
    v_exp_f32 v143, v143
    v_mfma_f32_32x32x16_bf16 v[48:63], v[228:231], v[172:175], v[48:63]
    s_waitcnt lgkmcnt(0)
    s_barrier
    ds_read_b128 v[240:243], v196 offset:0
    ds_read_b128 v[244:247], v197 offset:0
    ds_read_b128 v[248:251], v198 offset:0
    v_max3_f32 v11, v11, v157, v158
    v_mfma_f32_32x32x16_bf16 v[64:79], v[232:235], v[172:175], v[64:79]
    ds_read_b128 v[252:255], v199 offset:0
    v_max_f32 v11, v11, v159
    v_cvt_pk_bf16_f32 v164, v136, v137
    v_cvt_pk_bf16_f32 v165, v138, v139
    v_mfma_f32_32x32x16_bf16 v[80:95], v[236:239], v[172:175], v[80:95]
    ds_read_b128 v[208:211], v200 offset:0
    v_cmp_lt_f32 vcc, s46, v11
    v_cvt_pk_bf16_f32 v166, v140, v141
    v_cvt_pk_bf16_f32 v167, v142, v143
    v_mfma_f32_16x16x32_bf16 v[192:195], v[28:31], v[172:175], v[192:195]
    ds_read_b128 v[212:215], v201 offset:0
    s_cbranch_vccnz L_rare_6
L_back_6:
    s_waitcnt lgkmcnt(4)
    v_mfma_f32_32x32x16_bf16 v[128:143], v[240:243], v[96:99], v[176:191]
    ds_read_b128 v[216:219], v202 offset:0
    v_exp_f32 v144, v144
    v_exp_f32 v145, v145
    v_mfma_f32_32x32x16_bf16 v[128:143], v[244:247], v[100:103], v[128:143]
    ds_read_b128 v[220:223], v203 offset:0
    v_exp_f32 v146, v146
    v_exp_f32 v147, v147
    s_waitcnt lgkmcnt(4)
    v_mfma_f32_32x32x16_bf16 v[128:143], v[248:251], v[104:107], v[128:143]
    ds_read_b64_tr_b16 v[224:225], v24 offset:49152
    ds_read_b64_tr_b16 v[226:227], v24 offset:51200
    v_exp_f32 v148, v148
    v_mfma_f32_32x32x16_bf16 v[128:143], v[252:255], v[108:111], v[128:143]
    ds_read_b64_tr_b16 v[228:229], v25 offset:49152
    ds_read_b64_tr_b16 v[230:231], v25 offset:51200
    v_exp_f32 v149, v149
    s_waitcnt lgkmcnt(6)
    v_mfma_f32_32x32x16_bf16 v[128:143], v[208:211], v[112:115], v[128:143]
    ds_read_b64_tr_b16 v[232:233], v26 offset:49152
    ds_read_b64_tr_b16 v[234:235], v26 offset:51200
    v_exp_f32 v150, v150
    v_mfma_f32_32x32x16_bf16 v[128:143], v[212:215], v[116:119], v[128:143]
    ds_read_b64_tr_b16 v[236:237], v27 offset:49152
    ds_read_b64_tr_b16 v[238:239], v27 offset:51200
    v_exp_f32 v151, v151
    v_cvt_pk_bf16_f32 v168, v144, v145
    s_waitcnt lgkmcnt(8)
    v_mfma_f32_32x32x16_bf16 v[128:143], v[216:219], v[120:123], v[128:143]
    v_cvt_pk_bf16_f32 v169, v146, v147
    v_exp_f32 v152, v152
    v_mfma_f32_32x32x16_bf16 v[128:143], v[220:223], v[124:127], v[128:143]
    ds_read_b64_tr_b16 v[240:241], v24 offset:53248
    ds_read_b64_tr_b16 v[242:243], v24 offset:55296
    v_exp_f32 v153, v153
    s_waitcnt lgkmcnt(6)
    v_mfma_f32_32x32x16_bf16 v[32:47], v[224:227], v[160:163], v[32:47]
    ds_read_b64_tr_b16 v[244:245], v25 offset:53248
    ds_read_b64_tr_b16 v[246:247], v25 offset:55296
    v_exp_f32 v154, v154
    v_exp_f32 v155, v155
    v_mfma_f32_32x32x16_bf16 v[48:63], v[228:231], v[160:163], v[48:63]
    ds_read_b64_tr_b16 v[248:249], v26 offset:53248
    ds_read_b64_tr_b16 v[250:251], v26 offset:55296
    v_cvt_pk_bf16_f32 v170, v148, v149
    v_cvt_pk_bf16_f32 v171, v150, v151
    s_waitcnt lgkmcnt(6)
    v_mfma_f32_32x32x16_bf16 v[64:79], v[232:235], v[160:163], v[64:79]
    ds_read_b64_tr_b16 v[252:253], v27 offset:53248
    ds_read_b64_tr_b16 v[254:255], v27 offset:55296
    v_max3_f32 v11, v128, v129, v130
    v_max3_f32 v11, v11, v131, v132
    v_exp_f32 v156, v156
    v_mfma_f32_32x32x16_bf16 v[80:95], v[236:239], v[160:163], v[80:95]
    v_max3_f32 v11, v11, v133, v134
    v_max3_f32 v11, v11, v135, v136
    v_exp_f32 v157, v157
    v_mfma_f32_16x16x32_bf16 v[192:195], v[28:31], v[160:163], v[192:195]
    ds_read_b128 v[208:211], v196 offset:8192
    s_waitcnt lgkmcnt(5)
    v_mfma_f32_32x32x16_bf16 v[32:47], v[240:243], v[164:167], v[32:47]
    ds_read_b128 v[212:215], v197 offset:8192
    v_max3_f32 v11, v11, v137, v138
    v_max3_f32 v11, v11, v139, v140
    v_exp_f32 v158, v158
    v_mfma_f32_32x32x16_bf16 v[48:63], v[244:247], v[164:167], v[48:63]
    ds_read_b128 v[216:219], v198 offset:8192
    v_max3_f32 v11, v11, v141, v142
    v_exp_f32 v159, v159
    s_waitcnt lgkmcnt(5)
    v_mfma_f32_32x32x16_bf16 v[64:79], v[248:251], v[164:167], v[64:79]
    ds_read_b128 v[220:223], v199 offset:8192
    v_max_f32 v11, v11, v143
    v_cvt_pk_bf16_f32 v172, v152, v153
    v_cvt_pk_bf16_f32 v173, v154, v155
    s_waitcnt lgkmcnt(4)
    v_mfma_f32_32x32x16_bf16 v[80:95], v[252:255], v[164:167], v[80:95]
    ds_read_b128 v[224:227], v200 offset:8192
    v_cmp_lt_f32 vcc, s46, v11
    v_cvt_pk_bf16_f32 v174, v156, v157
    v_cvt_pk_bf16_f32 v175, v158, v159
    v_mfma_f32_16x16x32_bf16 v[192:195], v[28:31], v[164:167], v[192:195]
    ds_read_b128 v[228:231], v201 offset:8192
    s_cbranch_vccnz L_rare_7
L_back_7:
    s_waitcnt lgkmcnt(4)
    v_mfma_f32_32x32x16_bf16 v[144:159], v[208:211], v[96:99], v[176:191]
    ds_read_b128 v[232:235], v202 offset:8192
    v_exp_f32 v128, v128
    v_exp_f32 v129, v129
    v_mfma_f32_32x32x16_bf16 v[144:159], v[212:215], v[100:103], v[144:159]
    ds_read_b128 v[236:239], v203 offset:8192
    v_exp_f32 v130, v130
    v_exp_f32 v131, v131
    s_waitcnt lgkmcnt(4)
    v_mfma_f32_32x32x16_bf16 v[144:159], v[216:219], v[104:107], v[144:159]
    ds_read_b64_tr_b16 v[240:241], v24 offset:57344
    ds_read_b64_tr_b16 v[242:243], v24 offset:59392
    v_exp_f32 v132, v132
    v_mfma_f32_32x32x16_bf16 v[144:159], v[220:223], v[108:111], v[144:159]
    ds_read_b64_tr_b16 v[244:245], v25 offset:57344
    ds_read_b64_tr_b16 v[246:247], v25 offset:59392
    v_exp_f32 v133, v133
    s_waitcnt lgkmcnt(6)
    v_mfma_f32_32x32x16_bf16 v[144:159], v[224:227], v[112:115], v[144:159]
    ds_read_b64_tr_b16 v[248:249], v26 offset:57344
    ds_read_b64_tr_b16 v[250:251], v26 offset:59392
    v_exp_f32 v134, v134
    v_mfma_f32_32x32x16_bf16 v[144:159], v[228:231], v[116:119], v[144:159]
    ds_read_b64_tr_b16 v[252:253], v27 offset:57344
    ds_read_b64_tr_b16 v[254:255], v27 offset:59392
    v_exp_f32 v135, v135
    v_cvt_pk_bf16_f32 v160, v128, v129
    s_waitcnt lgkmcnt(8)
    v_mfma_f32_32x32x16_bf16 v[144:159], v[232:235], v[120:123], v[144:159]
    v_cvt_pk_bf16_f32 v161, v130, v131
    v_exp_f32 v136, v136
    v_mfma_f32_32x32x16_bf16 v[144:159], v[236:239], v[124:127], v[144:159]
    ds_read_b64_tr_b16 v[208:209], v24 offset:61440
    ds_read_b64_tr_b16 v[210:211], v24 offset:63488
    v_exp_f32 v137, v137
    s_waitcnt lgkmcnt(6)
    v_mfma_f32_32x32x16_bf16 v[32:47], v[240:243], v[168:171], v[32:47]
    ds_read_b64_tr_b16 v[212:213], v25 offset:61440
    ds_read_b64_tr_b16 v[214:215], v25 offset:63488
    v_exp_f32 v138, v138
    v_exp_f32 v139, v139
    v_mfma_f32_32x32x16_bf16 v[48:63], v[244:247], v[168:171], v[48:63]
    ds_read_b64_tr_b16 v[216:217], v26 offset:61440
    ds_read_b64_tr_b16 v[218:219], v26 offset:63488
    v_cvt_pk_bf16_f32 v162, v132, v133
    v_cvt_pk_bf16_f32 v163, v134, v135
    s_waitcnt lgkmcnt(6)
    v_mfma_f32_32x32x16_bf16 v[64:79], v[248:251], v[168:171], v[64:79]
    ds_read_b64_tr_b16 v[220:221], v27 offset:61440
    ds_read_b64_tr_b16 v[222:223], v27 offset:63488
    v_max3_f32 v11, v144, v145, v146
    v_max3_f32 v11, v11, v147, v148
    v_exp_f32 v140, v140
    v_mfma_f32_32x32x16_bf16 v[80:95], v[252:255], v[168:171], v[80:95]
    v_max3_f32 v11, v11, v149, v150
    v_max3_f32 v11, v11, v151, v152
    v_exp_f32 v141, v141
    v_mfma_f32_16x16x32_bf16 v[192:195], v[28:31], v[168:171], v[192:195]
    v_max3_f32 v11, v11, v153, v154
    s_waitcnt lgkmcnt(4)
    v_mfma_f32_32x32x16_bf16 v[32:47], v[208:211], v[172:175], v[32:47]
    v_max3_f32 v11, v11, v155, v156
    v_exp_f32 v142, v142
    v_exp_f32 v143, v143
    v_mfma_f32_32x32x16_bf16 v[48:63], v[212:215], v[172:175], v[48:63]
    s_waitcnt lgkmcnt(0)
    s_barrier
    ds_read_b128 v[224:227], v16 offset:0
    ds_read_b128 v[228:231], v17 offset:0
    ds_read_b128 v[232:235], v18 offset:0
    v_max3_f32 v11, v11, v157, v158
    v_mfma_f32_32x32x16_bf16 v[64:79], v[216:219], v[172:175], v[64:79]
    ds_read_b128 v[236:239], v19 offset:0
    v_max_f32 v11, v11, v159
    v_cvt_pk_bf16_f32 v164, v136, v137
    v_cvt_pk_bf16_f32 v165, v138, v139
    v_mfma_f32_32x32x16_bf16 v[80:95], v[220:223], v[172:175], v[80:95]
    ds_read_b128 v[240:243], v20 offset:0
    v_cmp_lt_f32 vcc, s46, v11
    v_cvt_pk_bf16_f32 v166, v140, v141
    v_cvt_pk_bf16_f32 v167, v142, v143
    v_mfma_f32_16x16x32_bf16 v[192:195], v[28:31], v[172:175], v[192:195]
    ds_read_b128 v[244:247], v21 offset:0
    s_cbranch_vccnz L_rare_8
L_back_8:
    s_waitcnt lgkmcnt(4)
    v_mfma_f32_32x32x16_bf16 v[128:143], v[224:227], v[96:99], v[176:191]
    ds_read_b128 v[248:251], v22 offset:0
    v_exp_f32 v144, v144
    v_exp_f32 v145, v145
    v_mfma_f32_32x32x16_bf16 v[128:143], v[228:231], v[100:103], v[128:143]
    ds_read_b128 v[252:255], v23 offset:0
    v_exp_f32 v146, v146
    v_exp_f32 v147, v147
    s_waitcnt lgkmcnt(4)
    v_mfma_f32_32x32x16_bf16 v[128:143], v[232:235], v[104:107], v[128:143]
    ds_read_b64_tr_b16 v[208:209], v204 offset:0
    ds_read_b64_tr_b16 v[210:211], v204 offset:2048
    v_exp_f32 v148, v148
    v_mfma_f32_32x32x16_bf16 v[128:143], v[236:239], v[108:111], v[128:143]
    ds_read_b64_tr_b16 v[212:213], v205 offset:0
    ds_read_b64_tr_b16 v[214:215], v205 offset:2048
    v_exp_f32 v149, v149
    s_waitcnt lgkmcnt(6)
    v_mfma_f32_32x32x16_bf16 v[128:143], v[240:243], v[112:115], v[128:143]
    ds_read_b64_tr_b16 v[216:217], v206 offset:0
    ds_read_b64_tr_b16 v[218:219], v206 offset:2048
    v_exp_f32 v150, v150
    v_mfma_f32_32x32x16_bf16 v[128:143], v[244:247], v[116:119], v[128:143]
    ds_read_b64_tr_b16 v[220:221], v207 offset:0
    ds_read_b64_tr_b16 v[222:223], v207 offset:2048
    v_exp_f32 v151, v151
    v_cvt_pk_bf16_f32 v168, v144, v145
    s_waitcnt lgkmcnt(8)
    v_mfma_f32_32x32x16_bf16 v[128:143], v[248:251], v[120:123], v[128:143]
    v_cvt_pk_bf16_f32 v169, v146, v147
    v_exp_f32 v152, v152
    v_mfma_f32_32x32x16_bf16 v[128:143], v[252:255], v[124:127], v[128:143]
    ds_read_b64_tr_b16 v[224:225], v204 offset:4096
    ds_read_b64_tr_b16 v[226:227], v204 offset:6144
    v_exp_f32 v153, v153
    s_waitcnt lgkmcnt(6)
    v_mfma_f32_32x32x16_bf16 v[32:47], v[208:211], v[160:163], v[32:47]
    ds_read_b64_tr_b16 v[228:229], v205 offset:4096
    ds_read_b64_tr_b16 v[230:231], v205 offset:6144
    v_exp_f32 v154, v154
    v_exp_f32 v155, v155
    v_mfma_f32_32x32x16_bf16 v[48:63], v[212:215], v[160:163], v[48:63]
    ds_read_b64_tr_b16 v[232:233], v206 offset:4096
    ds_read_b64_tr_b16 v[234:235], v206 offset:6144
    v_cvt_pk_bf16_f32 v170, v148, v149
    v_cvt_pk_bf16_f32 v171, v150, v151
    s_waitcnt lgkmcnt(6)
    v_mfma_f32_32x32x16_bf16 v[64:79], v[216:219], v[160:163], v[64:79]
    ds_read_b64_tr_b16 v[236:237], v207 offset:4096
    ds_read_b64_tr_b16 v[238:239], v207 offset:6144
    v_max3_f32 v11, v128, v129, v130
    v_max3_f32 v11, v11, v131, v132
    v_exp_f32 v156, v156
    v_mfma_f32_32x32x16_bf16 v[80:95], v[220:223], v[160:163], v[80:95]
    v_max3_f32 v11, v11, v133, v134
    v_max3_f32 v11, v11, v135, v136
    v_exp_f32 v157, v157
    v_mfma_f32_16x16x32_bf16 v[192:195], v[28:31], v[160:163], v[192:195]
    ds_read_b128 v[240:243], v16 offset:8192
    s_waitcnt lgkmcnt(5)
    v_mfma_f32_32x32x16_bf16 v[32:47], v[224:227], v[164:167], v[32:47]
    ds_read_b128 v[244:247], v17 offset:8192
    v_max3_f32 v11, v11, v137, v138
    v_max3_f32 v11, v11, v139, v140
    v_exp_f32 v158, v158
    v_mfma_f32_32x32x16_bf16 v[48:63], v[228:231], v[164:167], v[48:63]
    ds_read_b128 v[248:251], v18 offset:8192
    v_max3_f32 v11, v11, v141, v142
    v_exp_f32 v159, v159
    s_waitcnt lgkmcnt(5)
    v_mfma_f32_32x32x16_bf16 v[64:79], v[232:235], v[164:167], v[64:79]
    ds_read_b128 v[252:255], v19 offset:8192
    v_max_f32 v11, v11, v143
    v_cvt_pk_bf16_f32 v172, v152, v153
    v_cvt_pk_bf16_f32 v173, v154, v155
    s_waitcnt lgkmcnt(4)
    v_mfma_f32_32x32x16_bf16 v[80:95], v[236:239], v[164:167], v[80:95]
    ds_read_b128 v[208:211], v20 offset:8192
    v_cmp_lt_f32 vcc, s46, v11
    v_cvt_pk_bf16_f32 v174, v156, v157
    v_cvt_pk_bf16_f32 v175, v158, v159
    v_mfma_f32_16x16x32_bf16 v[192:195], v[28:31], v[164:167], v[192:195]
    ds_read_b128 v[212:215], v21 offset:8192
    s_cbranch_vccnz L_rare_9
L_back_9:
    s_waitcnt lgkmcnt(4)
    v_mfma_f32_32x32x16_bf16 v[144:159], v[240:243], v[96:99], v[176:191]
    ds_read_b128 v[216:219], v22 offset:8192
    v_exp_f32 v128, v128
    v_exp_f32 v129, v129
    v_mfma_f32_32x32x16_bf16 v[144:159], v[244:247], v[100:103], v[144:159]
    ds_read_b128 v[220:223], v23 offset:8192
    v_exp_f32 v130, v130
    v_exp_f32 v131, v131
    s_waitcnt lgkmcnt(4)
    v_mfma_f32_32x32x16_bf16 v[144:159], v[248:251], v[104:107], v[144:159]
    ds_read_b64_tr_b16 v[224:225], v204 offset:8192
    ds_read_b64_tr_b16 v[226:227], v204 offset:10240
    v_exp_f32 v132, v132
    v_mfma_f32_32x32x16_bf16 v[144:159], v[252:255], v[108:111], v[144:159]
    ds_read_b64_tr_b16 v[228:229], v205 offset:8192
    ds_read_b64_tr_b16 v[230:231], v205 offset:10240
    v_exp_f32 v133, v133
    s_waitcnt lgkmcnt(6)
    v_mfma_f32_32x32x16_bf16 v[144:159], v[208:211], v[112:115], v[144:159]
    ds_read_b64_tr_b16 v[232:233], v206 offset:8192
    ds_read_b64_tr_b16 v[234:235], v206 offset:10240
    v_exp_f32 v134, v134
    v_mfma_f32_32x32x16_bf16 v[144:159], v[212:215], v[116:119], v[144:159]
    ds_read_b64_tr_b16 v[236:237], v207 offset:8192
    ds_read_b64_tr_b16 v[238:239], v207 offset:10240
    v_exp_f32 v135, v135
    v_cvt_pk_bf16_f32 v160, v128, v129
    s_waitcnt lgkmcnt(8)
    v_mfma_f32_32x32x16_bf16 v[144:159], v[216:219], v[120:123], v[144:159]
    v_cvt_pk_bf16_f32 v161, v130, v131
    v_exp_f32 v136, v136
    v_mfma_f32_32x32x16_bf16 v[144:159], v[220:223], v[124:127], v[144:159]
    ds_read_b64_tr_b16 v[240:241], v204 offset:12288
    ds_read_b64_tr_b16 v[242:243], v204 offset:14336
    v_exp_f32 v137, v137
    s_waitcnt lgkmcnt(6)
    v_mfma_f32_32x32x16_bf16 v[32:47], v[224:227], v[168:171], v[32:47]
    ds_read_b64_tr_b16 v[244:245], v205 offset:12288
    ds_read_b64_tr_b16 v[246:247], v205 offset:14336
    v_exp_f32 v138, v138
    v_exp_f32 v139, v139
    v_mfma_f32_32x32x16_bf16 v[48:63], v[228:231], v[168:171], v[48:63]
    ds_read_b64_tr_b16 v[248:249], v206 offset:12288
    ds_read_b64_tr_b16 v[250:251], v206 offset:14336
    v_cvt_pk_bf16_f32 v162, v132, v133
    v_cvt_pk_bf16_f32 v163, v134, v135
    s_waitcnt lgkmcnt(6)
    v_mfma_f32_32x32x16_bf16 v[64:79], v[232:235], v[168:171], v[64:79]
    ds_read_b64_tr_b16 v[252:253], v207 offset:12288
    ds_read_b64_tr_b16 v[254:255], v207 offset:14336
    v_max3_f32 v11, v144, v145, v146
    v_max3_f32 v11, v11, v147, v148
    v_exp_f32 v140, v140
    v_mfma_f32_32x32x16_bf16 v[80:95], v[236:239], v[168:171], v[80:95]
    v_max3_f32 v11, v11, v149, v150
    v_max3_f32 v11, v11, v151, v152
    v_exp_f32 v141, v141
    v_mfma_f32_16x16x32_bf16 v[192:195], v[28:31], v[168:171], v[192:195]
    v_max3_f32 v11, v11, v153, v154
    s_waitcnt lgkmcnt(4)
    v_mfma_f32_32x32x16_bf16 v[32:47], v[240:243], v[172:175], v[32:47]
    v_max3_f32 v11, v11, v155, v156
    v_exp_f32 v142, v142
    v_exp_f32 v143, v143
    v_mfma_f32_32x32x16_bf16 v[48:63], v[244:247], v[172:175], v[48:63]
    s_waitcnt lgkmcnt(0)
    s_barrier
    ds_read_b128 v[208:211], v16 offset:16384
    ds_read_b128 v[212:215], v17 offset:16384
    ds_read_b128 v[216:219], v18 offset:16384
    v_max3_f32 v11, v11, v157, v158
    v_mfma_f32_32x32x16_bf16 v[64:79], v[248:251], v[172:175], v[64:79]
    ds_read_b128 v[220:223], v19 offset:16384
    v_max_f32 v11, v11, v159
    v_cvt_pk_bf16_f32 v164, v136, v137
    v_cvt_pk_bf16_f32 v165, v138, v139
    v_mfma_f32_32x32x16_bf16 v[80:95], v[252:255], v[172:175], v[80:95]
    ds_read_b128 v[224:227], v20 offset:16384
    v_cmp_lt_f32 vcc, s46, v11
    v_cvt_pk_bf16_f32 v166, v140, v141
    v_cvt_pk_bf16_f32 v167, v142, v143
    v_mfma_f32_16x16x32_bf16 v[192:195], v[28:31], v[172:175], v[192:195]
    ds_read_b128 v[228:231], v21 offset:16384
    s_cbranch_vccnz L_rare_10
L_back_10:
    s_waitcnt lgkmcnt(4)
    v_mfma_f32_32x32x16_bf16 v[128:143], v[208:211], v[96:99], v[176:191]
    ds_read_b128 v[232:235], v22 offset:16384
    v_exp_f32 v144, v144
    v_exp_f32 v145, v145
    v_mfma_f32_32x32x16_bf16 v[128:143], v[212:215], v[100:103], v[128:143]
    ds_read_b128 v[236:239], v23 offset:16384
    v_exp_f32 v146, v146
    v_exp_f32 v147, v147
    s_waitcnt lgkmcnt(4)
    v_mfma_f32_32x32x16_bf16 v[128:143], v[216:219], v[104:107], v[128:143]
    ds_read_b64_tr_b16 v[240:241], v24 offset:0
    ds_read_b64_tr_b16 v[242:243], v24 offset:2048
    v_exp_f32 v148, v148
    v_mfma_f32_32x32x16_bf16 v[128:143], v[220:223], v[108:111], v[128:143]
    ds_read_b64_tr_b16 v[244:245], v25 offset:0
    ds_read_b64_tr_b16 v[246:247], v25 offset:2048
    v_exp_f32 v149, v149
    s_waitcnt lgkmcnt(6)
    v_mfma_f32_32x32x16_bf16 v[128:143], v[224:227], v[112:115], v[128:143]
    ds_read_b64_tr_b16 v[248:249], v26 offset:0
    ds_read_b64_tr_b16 v[250:251], v26 offset:2048
    v_exp_f32 v150, v150
    v_mfma_f32_32x32x16_bf16 v[128:143], v[228:231], v[116:119], v[128:143]
    ds_read_b64_tr_b16 v[252:253], v27 offset:0
    ds_read_b64_tr_b16 v[254:255], v27 offset:2048
    v_exp_f32 v151, v151
    v_cvt_pk_bf16_f32 v168, v144, v145
    s_waitcnt lgkmcnt(8)
    v_mfma_f32_32x32x16_bf16 v[128:143], v[232:235], v[120:123], v[128:143]
    v_cvt_pk_bf16_f32 v169, v146, v147
    v_exp_f32 v152, v152
    v_mfma_f32_32x32x16_bf16 v[128:143], v[236:239], v[124:127], v[128:143]
    ds_read_b64_tr_b16 v[208:209], v24 offset:4096
    ds_read_b64_tr_b16 v[210:211], v24 offset:6144
    v_exp_f32 v153, v153
    s_waitcnt lgkmcnt(6)
    v_mfma_f32_32x32x16_bf16 v[32:47], v[240:243], v[160:163], v[32:47]
    ds_read_b64_tr_b16 v[212:213], v25 offset:4096
    ds_read_b64_tr_b16 v[214:215], v25 offset:6144
    v_exp_f32 v154, v154
    v_exp_f32 v155, v155
    v_mfma_f32_32x32x16_bf16 v[48:63], v[244:247], v[160:163], v[48:63]
    ds_read_b64_tr_b16 v[216:217], v26 offset:4096
    ds_read_b64_tr_b16 v[218:219], v26 offset:6144
    v_cvt_pk_bf16_f32 v170, v148, v149
    v_cvt_pk_bf16_f32 v171, v150, v151
    s_waitcnt lgkmcnt(6)
    v_mfma_f32_32x32x16_bf16 v[64:79], v[248:251], v[160:163], v[64:79]
    ds_read_b64_tr_b16 v[220:221], v27 offset:4096
    ds_read_b64_tr_b16 v[222:223], v27 offset:6144
    v_max3_f32 v11, v128, v129, v130
    v_max3_f32 v11, v11, v131, v132
    v_exp_f32 v156, v156
    v_mfma_f32_32x32x16_bf16 v[80:95], v[252:255], v[160:163], v[80:95]
    v_max3_f32 v11, v11, v133, v134
    v_max3_f32 v11, v11, v135, v136
    v_exp_f32 v157, v157
    v_mfma_f32_16x16x32_bf16 v[192:195], v[28:31], v[160:163], v[192:195]
    ds_read_b128 v[224:227], v16 offset:24576
    s_waitcnt lgkmcnt(5)
    v_mfma_f32_32x32x16_bf16 v[32:47], v[208:211], v[164:167], v[32:47]
    ds_read_b128 v[228:231], v17 offset:24576
    v_max3_f32 v11, v11, v137, v138
    v_max3_f32 v11, v11, v139, v140
    v_exp_f32 v158, v158
    v_mfma_f32_32x32x16_bf16 v[48:63], v[212:215], v[164:167], v[48:63]
    ds_read_b128 v[232:235], v18 offset:24576
    v_max3_f32 v11, v11, v141, v142
    v_exp_f32 v159, v159
    s_waitcnt lgkmcnt(5)
    v_mfma_f32_32x32x16_bf16 v[64:79], v[216:219], v[164:167], v[64:79]
    ds_read_b128 v[236:239], v19 offset:24576
    v_max_f32 v11, v11, v143
    v_cvt_pk_bf16_f32 v172, v152, v153
    v_cvt_pk_bf16_f32 v173, v154, v155
    s_waitcnt lgkmcnt(4)
    v_mfma_f32_32x32x16_bf16 v[80:95], v[220:223], v[164:167], v[80:95]
    ds_read_b128 v[240:243], v20 offset:24576
    v_cmp_lt_f32 vcc, s46, v11
    v_cvt_pk_bf16_f32 v174, v156, v157
    v_cvt_pk_bf16_f32 v175, v158, v159
    v_mfma_f32_16x16x32_bf16 v[192:195], v[28:31], v[164:167], v[192:195]
    ds_read_b128 v[244:247], v21 offset:24576
    s_cbranch_vccnz L_rare_11
L_back_11:
    s_waitcnt lgkmcnt(4)
    v_mfma_f32_32x32x16_bf16 v[144:159], v[224:227], v[96:99], v[176:191]
    ds_read_b128 v[248:251], v22 offset:24576
    v_exp_f32 v128, v128
    v_exp_f32 v129, v129
    v_mfma_f32_32x32x16_bf16 v[144:159], v[228:231], v[100:103], v[144:159]
    ds_read_b128 v[252:255], v23 offset:24576
    v_exp_f32 v130, v130
    v_exp_f32 v131, v131
    s_waitcnt lgkmcnt(4)
    v_mfma_f32_32x32x16_bf16 v[144:159], v[232:235], v[104:107], v[144:159]
    ds_read_b64_tr_b16 v[208:209], v24 offset:8192
    ds_read_b64_tr_b16 v[210:211], v24 offset:10240
    v_exp_f32 v132, v132
    v_mfma_f32_32x32x16_bf16 v[144:159], v[236:239], v[108:111], v[144:159]
    ds_read_b64_tr_b16 v[212:213], v25 offset:8192
    ds_read_b64_tr_b16 v[214:215], v25 offset:10240
    v_exp_f32 v133, v133
    s_waitcnt lgkmcnt(6)
    v_mfma_f32_32x32x16_bf16 v[144:159], v[240:243], v[112:115], v[144:159]
    ds_read_b64_tr_b16 v[216:217], v26 offset:8192
    ds_read_b64_tr_b16 v[218:219], v26 offset:10240
    v_exp_f32 v134, v134
    v_mfma_f32_32x32x16_bf16 v[144:159], v[244:247], v[116:119], v[144:159]
    ds_read_b64_tr_b16 v[220:221], v27 offset:8192
    ds_read_b64_tr_b16 v[222:223], v27 offset:10240
    v_exp_f32 v135, v135
    v_cvt_pk_bf16_f32 v160, v128, v129
    s_waitcnt lgkmcnt(8)
    v_mfma_f32_32x32x16_bf16 v[144:159], v[248:251], v[120:123], v[144:159]
    v_cvt_pk_bf16_f32 v161, v130, v131
    v_exp_f32 v136, v136
    v_mfma_f32_32x32x16_bf16 v[144:159], v[252:255], v[124:127], v[144:159]
    ds_read_b64_tr_b16 v[224:225], v24 offset:12288
    ds_read_b64_tr_b16 v[226:227], v24 offset:14336
    v_exp_f32 v137, v137
    s_waitcnt lgkmcnt(6)
    v_mfma_f32_32x32x16_bf16 v[32:47], v[208:211], v[168:171], v[32:47]
    ds_read_b64_tr_b16 v[228:229], v25 offset:12288
    ds_read_b64_tr_b16 v[230:231], v25 offset:14336
    v_exp_f32 v138, v138
    v_exp_f32 v139, v139
    v_mfma_f32_32x32x16_bf16 v[48:63], v[212:215], v[168:171], v[48:63]
    ds_read_b64_tr_b16 v[232:233], v26 offset:12288
    ds_read_b64_tr_b16 v[234:235], v26 offset:14336
    v_cvt_pk_bf16_f32 v162, v132, v133
    v_cvt_pk_bf16_f32 v163, v134, v135
    s_waitcnt lgkmcnt(6)
    v_mfma_f32_32x32x16_bf16 v[64:79], v[216:219], v[168:171], v[64:79]
    ds_read_b64_tr_b16 v[236:237], v27 offset:12288
    ds_read_b64_tr_b16 v[238:239], v27 offset:14336
    v_max3_f32 v11, v144, v145, v146
    v_max3_f32 v11, v11, v147, v148
    v_exp_f32 v140, v140
    v_mfma_f32_32x32x16_bf16 v[80:95], v[220:223], v[168:171], v[80:95]
    v_max3_f32 v11, v11, v149, v150
    v_max3_f32 v11, v11, v151, v152
    v_exp_f32 v141, v141
    v_mfma_f32_16x16x32_bf16 v[192:195], v[28:31], v[168:171], v[192:195]
    v_max3_f32 v11, v11, v153, v154
    s_waitcnt lgkmcnt(4)
    v_mfma_f32_32x32x16_bf16 v[32:47], v[224:227], v[172:175], v[32:47]
    v_max3_f32 v11, v11, v155, v156
    v_exp_f32 v142, v142
    v_exp_f32 v143, v143
    v_mfma_f32_32x32x16_bf16 v[48:63], v[228:231], v[172:175], v[48:63]
    s_waitcnt lgkmcnt(0)
    s_barrier
    ds_read_b128 v[240:243], v16 offset:32768
    ds_read_b128 v[244:247], v17 offset:32768
    ds_read_b128 v[248:251], v18 offset:32768
    v_max3_f32 v11, v11, v157, v158
    v_mfma_f32_32x32x16_bf16 v[64:79], v[232:235], v[172:175], v[64:79]
    ds_read_b128 v[252:255], v19 offset:32768
    v_max_f32 v11, v11, v159
    v_cvt_pk_bf16_f32 v164, v136, v137
    v_cvt_pk_bf16_f32 v165, v138, v139
    v_mfma_f32_32x32x16_bf16 v[80:95], v[236:239], v[172:175], v[80:95]
    ds_read_b128 v[208:211], v20 offset:32768
    v_cmp_lt_f32 vcc, s46, v11
    v_cvt_pk_bf16_f32 v166, v140, v141
    v_cvt_pk_bf16_f32 v167, v142, v143
    v_mfma_f32_16x16x32_bf16 v[192:195], v[28:31], v[172:175], v[192:195]
    ds_read_b128 v[212:215], v21 offset:32768
    s_cbranch_vccnz L_rare_12
L_back_12:
    s_waitcnt lgkmcnt(4)
    v_mfma_f32_32x32x16_bf16 v[128:143], v[240:243], v[96:99], v[176:191]
    ds_read_b128 v[216:219], v22 offset:32768
    v_exp_f32 v144, v144
    v_exp_f32 v145, v145
    v_mfma_f32_32x32x16_bf16 v[128:143], v[244:247], v[100:103], v[128:143]
    ds_read_b128 v[220:223], v23 offset:32768
    v_exp_f32 v146, v146
    v_exp_f32 v147, v147
    s_waitcnt lgkmcnt(4)
    v_mfma_f32_32x32x16_bf16 v[128:143], v[248:251], v[104:107], v[128:143]
    ds_read_b64_tr_b16 v[224:225], v24 offset:16384
    ds_read_b64_tr_b16 v[226:227], v24 offset:18432
    v_exp_f32 v148, v148
    v_mfma_f32_32x32x16_bf16 v[128:143], v[252:255], v[108:111], v[128:143]
    ds_read_b64_tr_b16 v[228:229], v25 offset:16384
    ds_read_b64_tr_b16 v[230:231], v25 offset:18432
    v_exp_f32 v149, v149
    s_waitcnt lgkmcnt(6)
    v_mfma_f32_32x32x16_bf16 v[128:143], v[208:211], v[112:115], v[128:143]
    ds_read_b64_tr_b16 v[232:233], v26 offset:16384
    ds_read_b64_tr_b16 v[234:235], v26 offset:18432
    v_exp_f32 v150, v150
    v_mfma_f32_32x32x16_bf16 v[128:143], v[212:215], v[116:119], v[128:143]
    ds_read_b64_tr_b16 v[236:237], v27 offset:16384
    ds_read_b64_tr_b16 v[238:239], v27 offset:18432
    v_exp_f32 v151, v151
    v_cvt_pk_bf16_f32 v168, v144, v145
    s_waitcnt lgkmcnt(8)
    v_mfma_f32_32x32x16_bf16 v[128:143], v[216:219], v[120:123], v[128:143]
    v_cvt_pk_bf16_f32 v169, v146, v147
    v_exp_f32 v152, v152
    v_mfma_f32_32x32x16_bf16 v[128:143], v[220:223], v[124:127], v[128:143]
    ds_read_b64_tr_b16 v[240:241], v24 offset:20480
    ds_read_b64_tr_b16 v[242:243], v24 offset:22528
    v_exp_f32 v153, v153
    s_waitcnt lgkmcnt(6)
    v_mfma_f32_32x32x16_bf16 v[32:47], v[224:227], v[160:163], v[32:47]
    ds_read_b64_tr_b16 v[244:245], v25 offset:20480
    ds_read_b64_tr_b16 v[246:247], v25 offset:22528
    v_exp_f32 v154, v154
    v_exp_f32 v155, v155
    v_mfma_f32_32x32x16_bf16 v[48:63], v[228:231], v[160:163], v[48:63]
    ds_read_b64_tr_b16 v[248:249], v26 offset:20480
    ds_read_b64_tr_b16 v[250:251], v26 offset:22528
    v_cvt_pk_bf16_f32 v170, v148, v149
    v_cvt_pk_bf16_f32 v171, v150, v151
    s_waitcnt lgkmcnt(6)
    v_mfma_f32_32x32x16_bf16 v[64:79], v[232:235], v[160:163], v[64:79]
    ds_read_b64_tr_b16 v[252:253], v27 offset:20480
    ds_read_b64_tr_b16 v[254:255], v27 offset:22528
    v_max3_f32 v11, v128, v129, v130
    v_max3_f32 v11, v11, v131, v132
    v_exp_f32 v156, v156
    v_mfma_f32_32x32x16_bf16 v[80:95], v[236:239], v[160:163], v[80:95]
    v_max3_f32 v11, v11, v133, v134
    v_max3_f32 v11, v11, v135, v136
    v_exp_f32 v157, v157
    v_mfma_f32_16x16x32_bf16 v[192:195], v[28:31], v[160:163], v[192:195]
    ds_read_b128 v[208:211], v16 offset:40960
    s_waitcnt lgkmcnt(5)
    v_mfma_f32_32x32x16_bf16 v[32:47], v[240:243], v[164:167], v[32:47]
    ds_read_b128 v[212:215], v17 offset:40960
    v_max3_f32 v11, v11, v137, v138
    v_max3_f32 v11, v11, v139, v140
    v_exp_f32 v158, v158
    v_mfma_f32_32x32x16_bf16 v[48:63], v[244:247], v[164:167], v[48:63]
    ds_read_b128 v[216:219], v18 offset:40960
    v_max3_f32 v11, v11, v141, v142
    v_exp_f32 v159, v159
    s_waitcnt lgkmcnt(5)
    v_mfma_f32_32x32x16_bf16 v[64:79], v[248:251], v[164:167], v[64:79]
    ds_read_b128 v[220:223], v19 offset:40960
    v_max_f32 v11, v11, v143
    v_cvt_pk_bf16_f32 v172, v152, v153
    v_cvt_pk_bf16_f32 v173, v154, v155
    s_waitcnt lgkmcnt(4)
    v_mfma_f32_32x32x16_bf16 v[80:95], v[252:255], v[164:167], v[80:95]
    ds_read_b128 v[224:227], v20 offset:40960
    v_cmp_lt_f32 vcc, s46, v11
    v_cvt_pk_bf16_f32 v174, v156, v157
    v_cvt_pk_bf16_f32 v175, v158, v159
    v_mfma_f32_16x16x32_bf16 v[192:195], v[28:31], v[164:167], v[192:195]
    ds_read_b128 v[228:231], v21 offset:40960
    s_cbranch_vccnz L_rare_13
L_back_13:
    s_waitcnt lgkmcnt(4)
    v_mfma_f32_32x32x16_bf16 v[144:159], v[208:211], v[96:99], v[176:191]
    ds_read_b128 v[232:235], v22 offset:40960
    v_exp_f32 v128, v128
    v_exp_f32 v129, v129
    v_mfma_f32_32x32x16_bf16 v[144:159], v[212:215], v[100:103], v[144:159]
    ds_read_b128 v[236:239], v23 offset:40960
    v_exp_f32 v130, v130
    v_exp_f32 v131, v131
    s_waitcnt lgkmcnt(4)
    v_mfma_f32_32x32x16_bf16 v[144:159], v[216:219], v[104:107], v[144:159]
    ds_read_b64_tr_b16 v[240:241], v24 offset:24576
    ds_read_b64_tr_b16 v[242:243], v24 offset:26624
    v_exp_f32 v132, v132
    v_mfma_f32_32x32x16_bf16 v[144:159], v[220:223], v[108:111], v[144:159]
    ds_read_b64_tr_b16 v[244:245], v25 offset:24576
    ds_read_b64_tr_b16 v[246:247], v25 offset:26624
    v_exp_f32 v133, v133
    s_waitcnt lgkmcnt(6)
    v_mfma_f32_32x32x16_bf16 v[144:159], v[224:227], v[112:115], v[144:159]
    ds_read_b64_tr_b16 v[248:249], v26 offset:24576
    ds_read_b64_tr_b16 v[250:251], v26 offset:26624
    v_exp_f32 v134, v134
    v_mfma_f32_32x32x16_bf16 v[144:159], v[228:231], v[116:119], v[144:159]
    ds_read_b64_tr_b16 v[252:253], v27 offset:24576
    ds_read_b64_tr_b16 v[254:255], v27 offset:26624
    v_exp_f32 v135, v135
    v_cvt_pk_bf16_f32 v160, v128, v129
    s_waitcnt lgkmcnt(8)
    v_mfma_f32_32x32x16_bf16 v[144:159], v[232:235], v[120:123], v[144:159]
    v_cvt_pk_bf16_f32 v161, v130, v131
    v_exp_f32 v136, v136
    v_mfma_f32_32x32x16_bf16 v[144:159], v[236:239], v[124:127], v[144:159]
    ds_read_b64_tr_b16 v[208:209], v24 offset:28672
    ds_read_b64_tr_b16 v[210:211], v24 offset:30720
    v_exp_f32 v137, v137
    s_waitcnt lgkmcnt(6)
    v_mfma_f32_32x32x16_bf16 v[32:47], v[240:243], v[168:171], v[32:47]
    ds_read_b64_tr_b16 v[212:213], v25 offset:28672
    ds_read_b64_tr_b16 v[214:215], v25 offset:30720
    v_exp_f32 v138, v138
    v_exp_f32 v139, v139
    v_mfma_f32_32x32x16_bf16 v[48:63], v[244:247], v[168:171], v[48:63]
    ds_read_b64_tr_b16 v[216:217], v26 offset:28672
    ds_read_b64_tr_b16 v[218:219], v26 offset:30720
    v_cvt_pk_bf16_f32 v162, v132, v133
    v_cvt_pk_bf16_f32 v163, v134, v135
    s_waitcnt lgkmcnt(6)
    v_mfma_f32_32x32x16_bf16 v[64:79], v[248:251], v[168:171], v[64:79]
    ds_read_b64_tr_b16 v[220:221], v27 offset:28672
    ds_read_b64_tr_b16 v[222:223], v27 offset:30720
    v_max3_f32 v11, v144, v145, v146
    v_max3_f32 v11, v11, v147, v148
    v_exp_f32 v140, v140
    v_mfma_f32_32x32x16_bf16 v[80:95], v[252:255], v[168:171], v[80:95]
    v_max3_f32 v11, v11, v149, v150
    v_max3_f32 v11, v11, v151, v152
    v_exp_f32 v141, v141
    v_mfma_f32_16x16x32_bf16 v[192:195], v[28:31], v[168:171], v[192:195]
    v_max3_f32 v11, v11, v153, v154
    s_waitcnt lgkmcnt(4)
    v_mfma_f32_32x32x16_bf16 v[32:47], v[208:211], v[172:175], v[32:47]
    v_max3_f32 v11, v11, v155, v156
    v_exp_f32 v142, v142
    v_exp_f32 v143, v143
    v_mfma_f32_32x32x16_bf16 v[48:63], v[212:215], v[172:175], v[48:63]
    s_waitcnt lgkmcnt(0)
    s_barrier
    ds_read_b128 v[224:227], v16 offset:49152
    ds_read_b128 v[228:231], v17 offset:49152
    ds_read_b128 v[232:235], v18 offset:49152
    v_max3_f32 v11, v11, v157, v158
    v_mfma_f32_32x32x16_bf16 v[64:79], v[216:219], v[172:175], v[64:79]
    ds_read_b128 v[236:239], v19 offset:49152
    v_max_f32 v11, v11, v159
    v_cvt_pk_bf16_f32 v164, v136, v137
    v_cvt_pk_bf16_f32 v165, v138, v139
    v_mfma_f32_32x32x16_bf16 v[80:95], v[220:223], v[172:175], v[80:95]
    ds_read_b128 v[240:243], v20 offset:49152
    v_cmp_lt_f32 vcc, s46, v11
    v_cvt_pk_bf16_f32 v166, v140, v141
    v_cvt_pk_bf16_f32 v167, v142, v143
    v_mfma_f32_16x16x32_bf16 v[192:195], v[28:31], v[172:175], v[192:195]
    ds_read_b128 v[244:247], v21 offset:49152
    s_cbranch_vccnz L_rare_14
L_back_14:
    s_waitcnt lgkmcnt(4)
    v_mfma_f32_32x32x16_bf16 v[128:143], v[224:227], v[96:99], v[176:191]
    ds_read_b128 v[248:251], v22 offset:49152
    v_exp_f32 v144, v144
    v_exp_f32 v145, v145
    v_mfma_f32_32x32x16_bf16 v[128:143], v[228:231], v[100:103], v[128:143]
    ds_read_b128 v[252:255], v23 offset:49152
    v_exp_f32 v146, v146
    v_exp_f32 v147, v147
    s_waitcnt lgkmcnt(4)
    v_mfma_f32_32x32x16_bf16 v[128:143], v[232:235], v[104:107], v[128:143]
    ds_read_b64_tr_b16 v[208:209], v24 offset:32768
    ds_read_b64_tr_b16 v[210:211], v24 offset:34816
    v_exp_f32 v148, v148
    v_mfma_f32_32x32x16_bf16 v[128:143], v[236:239], v[108:111], v[128:143]
    ds_read_b64_tr_b16 v[212:213], v25 offset:32768
    ds_read_b64_tr_b16 v[214:215], v25 offset:34816
    v_exp_f32 v149, v149
    s_waitcnt lgkmcnt(6)
    v_mfma_f32_32x32x16_bf16 v[128:143], v[240:243], v[112:115], v[128:143]
    ds_read_b64_tr_b16 v[216:217], v26 offset:32768
    ds_read_b64_tr_b16 v[218:219], v26 offset:34816
    v_exp_f32 v150, v150
    v_mfma_f32_32x32x16_bf16 v[128:143], v[244:247], v[116:119], v[128:143]
    ds_read_b64_tr_b16 v[220:221], v27 offset:32768
    ds_read_b64_tr_b16 v[222:223], v27 offset:34816
    v_exp_f32 v151, v151
    v_cvt_pk_bf16_f32 v168, v144, v145
    s_waitcnt lgkmcnt(8)
    v_mfma_f32_32x32x16_bf16 v[128:143], v[248:251], v[120:123], v[128:143]
    v_cvt_pk_bf16_f32 v169, v146, v147
    v_exp_f32 v152, v152
    v_mfma_f32_32x32x16_bf16 v[128:143], v[252:255], v[124:127], v[128:143]
    ds_read_b64_tr_b16 v[224:225], v24 offset:36864
    ds_read_b64_tr_b16 v[226:227], v24 offset:38912
    v_exp_f32 v153, v153
    s_waitcnt lgkmcnt(6)
    v_mfma_f32_32x32x16_bf16 v[32:47], v[208:211], v[160:163], v[32:47]
    ds_read_b64_tr_b16 v[228:229], v25 offset:36864
    ds_read_b64_tr_b16 v[230:231], v25 offset:38912
    v_exp_f32 v154, v154
    v_exp_f32 v155, v155
    v_mfma_f32_32x32x16_bf16 v[48:63], v[212:215], v[160:163], v[48:63]
    ds_read_b64_tr_b16 v[232:233], v26 offset:36864
    ds_read_b64_tr_b16 v[234:235], v26 offset:38912
    v_cvt_pk_bf16_f32 v170, v148, v149
    v_cvt_pk_bf16_f32 v171, v150, v151
    s_waitcnt lgkmcnt(6)
    v_mfma_f32_32x32x16_bf16 v[64:79], v[216:219], v[160:163], v[64:79]
    ds_read_b64_tr_b16 v[236:237], v27 offset:36864
    ds_read_b64_tr_b16 v[238:239], v27 offset:38912
    v_max3_f32 v11, v128, v129, v130
    v_max3_f32 v11, v11, v131, v132
    v_exp_f32 v156, v156
    v_mfma_f32_32x32x16_bf16 v[80:95], v[220:223], v[160:163], v[80:95]
    v_max3_f32 v11, v11, v133, v134
    v_max3_f32 v11, v11, v135, v136
    v_exp_f32 v157, v157
    v_mfma_f32_16x16x32_bf16 v[192:195], v[28:31], v[160:163], v[192:195]
    ds_read_b128 v[240:243], v16 offset:57344
    s_waitcnt lgkmcnt(5)
    v_mfma_f32_32x32x16_bf16 v[32:47], v[224:227], v[164:167], v[32:47]
    ds_read_b128 v[244:247], v17 offset:57344
    v_max3_f32 v11, v11, v137, v138
    v_max3_f32 v11, v11, v139, v140
    v_exp_f32 v158, v158
    v_mfma_f32_32x32x16_bf16 v[48:63], v[228:231], v[164:167], v[48:63]
    ds_read_b128 v[248:251], v18 offset:57344
    v_max3_f32 v11, v11, v141, v142
    v_exp_f32 v159, v159
    s_waitcnt lgkmcnt(5)
    v_mfma_f32_32x32x16_bf16 v[64:79], v[232:235], v[164:167], v[64:79]
    ds_read_b128 v[252:255], v19 offset:57344
    v_max_f32 v11, v11, v143
    v_cvt_pk_bf16_f32 v172, v152, v153
    v_cvt_pk_bf16_f32 v173, v154, v155
    s_waitcnt lgkmcnt(4)
    v_mfma_f32_32x32x16_bf16 v[80:95], v[236:239], v[164:167], v[80:95]
    ds_read_b128 v[208:211], v20 offset:57344
    v_cmp_lt_f32 vcc, s46, v11
    v_cvt_pk_bf16_f32 v174, v156, v157
    v_cvt_pk_bf16_f32 v175, v158, v159
    v_mfma_f32_16x16x32_bf16 v[192:195], v[28:31], v[164:167], v[192:195]
    ds_read_b128 v[212:215], v21 offset:57344
    s_cbranch_vccnz L_rare_15
L_back_15:
    s_waitcnt lgkmcnt(4)
    v_mfma_f32_32x32x16_bf16 v[144:159], v[240:243], v[96:99], v[176:191]
    ds_read_b128 v[216:219], v22 offset:57344
    v_exp_f32 v128, v128
    v_exp_f32 v129, v129
    v_mfma_f32_32x32x16_bf16 v[144:159], v[244:247], v[100:103], v[144:159]
    ds_read_b128 v[220:223], v23 offset:57344
    v_exp_f32 v130, v130
    v_exp_f32 v131, v131
    s_waitcnt lgkmcnt(4)
    v_mfma_f32_32x32x16_bf16 v[144:159], v[248:251], v[104:107], v[144:159]
    ds_read_b64_tr_b16 v[224:225], v24 offset:40960
    ds_read_b64_tr_b16 v[226:227], v24 offset:43008
    v_exp_f32 v132, v132
    v_mfma_f32_32x32x16_bf16 v[144:159], v[252:255], v[108:111], v[144:159]
    ds_read_b64_tr_b16 v[228:229], v25 offset:40960
    ds_read_b64_tr_b16 v[230:231], v25 offset:43008
    v_exp_f32 v133, v133
    s_waitcnt lgkmcnt(6)
    v_mfma_f32_32x32x16_bf16 v[144:159], v[208:211], v[112:115], v[144:159]
    ds_read_b64_tr_b16 v[232:233], v26 offset:40960
    ds_read_b64_tr_b16 v[234:235], v26 offset:43008
    v_exp_f32 v134, v134
    v_mfma_f32_32x32x16_bf16 v[144:159], v[212:215], v[116:119], v[144:159]
    ds_read_b64_tr_b16 v[236:237], v27 offset:40960
    ds_read_b64_tr_b16 v[238:239], v27 offset:43008
    v_exp_f32 v135, v135
    v_cvt_pk_bf16_f32 v160, v128, v129
    s_waitcnt lgkmcnt(8)
    v_mfma_f32_32x32x16_bf16 v[144:159], v[216:219], v[120:123], v[144:159]
    v_cvt_pk_bf16_f32 v161, v130, v131
    v_exp_f32 v136, v136
    v_mfma_f32_32x32x16_bf16 v[144:159], v[220:223], v[124:127], v[144:159]
    ds_read_b64_tr_b16 v[240:241], v24 offset:45056
    ds_read_b64_tr_b16 v[242:243], v24 offset:47104
    v_exp_f32 v137, v137
    s_waitcnt lgkmcnt(6)
    v_mfma_f32_32x32x16_bf16 v[32:47], v[224:227], v[168:171], v[32:47]
    ds_read_b64_tr_b16 v[244:245], v25 offset:45056
    ds_read_b64_tr_b16 v[246:247], v25 offset:47104
    v_exp_f32 v138, v138
    v_exp_f32 v139, v139
    v_mfma_f32_32x32x16_bf16 v[48:63], v[228:231], v[168:171], v[48:63]
    ds_read_b64_tr_b16 v[248:249], v26 offset:45056
    ds_read_b64_tr_b16 v[250:251], v26 offset:47104
    v_cvt_pk_bf16_f32 v162, v132, v133
    v_cvt_pk_bf16_f32 v163, v134, v135
    s_waitcnt lgkmcnt(6)
    v_mfma_f32_32x32x16_bf16 v[64:79], v[232:235], v[168:171], v[64:79]
    ds_read_b64_tr_b16 v[252:253], v27 offset:45056
    ds_read_b64_tr_b16 v[254:255], v27 offset:47104
    v_max3_f32 v11, v144, v145, v146
    v_max3_f32 v11, v11, v147, v148
    v_exp_f32 v140, v140
    v_mfma_f32_32x32x16_bf16 v[80:95], v[236:239], v[168:171], v[80:95]
    v_max3_f32 v11, v11, v149, v150
    v_max3_f32 v11, v11, v151, v152
    v_exp_f32 v141, v141
    v_mfma_f32_16x16x32_bf16 v[192:195], v[28:31], v[168:171], v[192:195]
    v_max3_f32 v11, v11, v153, v154
    s_waitcnt lgkmcnt(4)
    v_mfma_f32_32x32x16_bf16 v[32:47], v[240:243], v[172:175], v[32:47]
    v_max3_f32 v11, v11, v155, v156
    v_exp_f32 v142, v142
    v_exp_f32 v143, v143
    v_mfma_f32_32x32x16_bf16 v[48:63], v[244:247], v[172:175], v[48:63]
    s_waitcnt lgkmcnt(0)
    s_barrier
    ds_read_b128 v[208:211], v196 offset:0
    ds_read_b128 v[212:215], v197 offset:0
    ds_read_b128 v[216:219], v198 offset:0
    v_max3_f32 v11, v11, v157, v158
    v_mfma_f32_32x32x16_bf16 v[64:79], v[248:251], v[172:175], v[64:79]
    ds_read_b128 v[220:223], v199 offset:0
    v_max_f32 v11, v11, v159
    v_cvt_pk_bf16_f32 v164, v136, v137
    v_cvt_pk_bf16_f32 v165, v138, v139
    v_mfma_f32_32x32x16_bf16 v[80:95], v[252:255], v[172:175], v[80:95]
    ds_read_b128 v[224:227], v200 offset:0
    v_cmp_lt_f32 vcc, s46, v11
    v_cvt_pk_bf16_f32 v166, v140, v141
    v_cvt_pk_bf16_f32 v167, v142, v143
    v_mfma_f32_16x16x32_bf16 v[192:195], v[28:31], v[172:175], v[192:195]
    ds_read_b128 v[228:231], v201 offset:0
    s_cbranch_vccnz L_rare_16
L_back_16:
    s_waitcnt lgkmcnt(4)
    v_mfma_f32_32x32x16_bf16 v[128:143], v[208:211], v[96:99], v[176:191]
    ds_read_b128 v[232:235], v202 offset:0
    v_exp_f32 v144, v144
    v_exp_f32 v145, v145
    v_mfma_f32_32x32x16_bf16 v[128:143], v[212:215], v[100:103], v[128:143]
    ds_read_b128 v[236:239], v203 offset:0
    v_exp_f32 v146, v146
    v_exp_f32 v147, v147
    s_waitcnt lgkmcnt(4)
    v_mfma_f32_32x32x16_bf16 v[128:143], v[216:219], v[104:107], v[128:143]
    ds_read_b64_tr_b16 v[240:241], v24 offset:49152
    ds_read_b64_tr_b16 v[242:243], v24 offset:51200
    v_exp_f32 v148, v148
    v_mfma_f32_32x32x16_bf16 v[128:143], v[220:223], v[108:111], v[128:143]
    ds_read_b64_tr_b16 v[244:245], v25 offset:49152
    ds_read_b64_tr_b16 v[246:247], v25 offset:51200
    v_exp_f32 v149, v149
    s_waitcnt lgkmcnt(6)
    v_mfma_f32_32x32x16_bf16 v[128:143], v[224:227], v[112:115], v[128:143]
    ds_read_b64_tr_b16 v[248:249], v26 offset:49152
    ds_read_b64_tr_b16 v[250:251], v26 offset:51200
    v_exp_f32 v150, v150
    v_mfma_f32_32x32x16_bf16 v[128:143], v[228:231], v[116:119], v[128:143]
    ds_read_b64_tr_b16 v[252:253], v27 offset:49152
    ds_read_b64_tr_b16 v[254:255], v27 offset:51200
    v_exp_f32 v151, v151
    v_cvt_pk_bf16_f32 v168, v144, v145
    s_waitcnt lgkmcnt(8)
    v_mfma_f32_32x32x16_bf16 v[128:143], v[232:235], v[120:123], v[128:143]
    v_cvt_pk_bf16_f32 v169, v146, v147
    v_exp_f32 v152, v152
    v_mfma_f32_32x32x16_bf16 v[128:143], v[236:239], v[124:127], v[128:143]
    ds_read_b64_tr_b16 v[208:209], v24 offset:53248
    ds_read_b64_tr_b16 v[210:211], v24 offset:55296
    v_exp_f32 v153, v153
    s_waitcnt lgkmcnt(6)
    v_mfma_f32_32x32x16_bf16 v[32:47], v[240:243], v[160:163], v[32:47]
    ds_read_b64_tr_b16 v[212:213], v25 offset:53248
    ds_read_b64_tr_b16 v[214:215], v25 offset:55296
    v_exp_f32 v154, v154
    v_exp_f32 v155, v155
    v_mfma_f32_32x32x16_bf16 v[48:63], v[244:247], v[160:163], v[48:63]
    ds_read_b64_tr_b16 v[216:217], v26 offset:53248
    ds_read_b64_tr_b16 v[218:219], v26 offset:55296
    v_cvt_pk_bf16_f32 v170, v148, v149
    v_cvt_pk_bf16_f32 v171, v150, v151
    s_waitcnt lgkmcnt(6)
    v_mfma_f32_32x32x16_bf16 v[64:79], v[248:251], v[160:163], v[64:79]
    ds_read_b64_tr_b16 v[220:221], v27 offset:53248
    ds_read_b64_tr_b16 v[222:223], v27 offset:55296
    v_max3_f32 v11, v128, v129, v130
    v_max3_f32 v11, v11, v131, v132
    v_exp_f32 v156, v156
    v_mfma_f32_32x32x16_bf16 v[80:95], v[252:255], v[160:163], v[80:95]
    v_max3_f32 v11, v11, v133, v134
    v_max3_f32 v11, v11, v135, v136
    v_exp_f32 v157, v157
    v_mfma_f32_16x16x32_bf16 v[192:195], v[28:31], v[160:163], v[192:195]
    ds_read_b128 v[224:227], v196 offset:8192
    s_waitcnt lgkmcnt(5)
    v_mfma_f32_32x32x16_bf16 v[32:47], v[208:211], v[164:167], v[32:47]
    ds_read_b128 v[228:231], v197 offset:8192
    v_max3_f32 v11, v11, v137, v138
    v_max3_f32 v11, v11, v139, v140
    v_exp_f32 v158, v158
    v_mfma_f32_32x32x16_bf16 v[48:63], v[212:215], v[164:167], v[48:63]
    ds_read_b128 v[232:235], v198 offset:8192
    v_max3_f32 v11, v11, v141, v142
    v_exp_f32 v159, v159
    s_waitcnt lgkmcnt(5)
    v_mfma_f32_32x32x16_bf16 v[64:79], v[216:219], v[164:167], v[64:79]
    ds_read_b128 v[236:239], v199 offset:8192
    v_max_f32 v11, v11, v143
    v_cvt_pk_bf16_f32 v172, v152, v153
    v_cvt_pk_bf16_f32 v173, v154, v155
    s_waitcnt lgkmcnt(4)
    v_mfma_f32_32x32x16_bf16 v[80:95], v[220:223], v[164:167], v[80:95]
    ds_read_b128 v[240:243], v200 offset:8192
    v_cmp_lt_f32 vcc, s46, v11
    v_cvt_pk_bf16_f32 v174, v156, v157
    v_cvt_pk_bf16_f32 v175, v158, v159
    v_mfma_f32_16x16x32_bf16 v[192:195], v[28:31], v[164:167], v[192:195]
    ds_read_b128 v[244:247], v201 offset:8192
    s_cbranch_vccnz L_rare_17
L_back_17:
    s_waitcnt lgkmcnt(4)
    v_mfma_f32_32x32x16_bf16 v[144:159], v[224:227], v[96:99], v[176:191]
    ds_read_b128 v[248:251], v202 offset:8192
    v_exp_f32 v128, v128
    v_exp_f32 v129, v129
    v_mfma_f32_32x32x16_bf16 v[144:159], v[228:231], v[100:103], v[144:159]
    ds_read_b128 v[252:255], v203 offset:8192
    v_exp_f32 v130, v130
    v_exp_f32 v131, v131
    s_waitcnt lgkmcnt(4)
    v_mfma_f32_32x32x16_bf16 v[144:159], v[232:235], v[104:107], v[144:159]
    ds_read_b64_tr_b16 v[208:209], v24 offset:57344
    ds_read_b64_tr_b16 v[210:211], v24 offset:59392
    v_exp_f32 v132, v132
    v_mfma_f32_32x32x16_bf16 v[144:159], v[236:239], v[108:111], v[144:159]
    ds_read_b64_tr_b16 v[212:213], v25 offset:57344
    ds_read_b64_tr_b16 v[214:215], v25 offset:59392
    v_exp_f32 v133, v133
    s_waitcnt lgkmcnt(6)
    v_mfma_f32_32x32x16_bf16 v[144:159], v[240:243], v[112:115], v[144:159]
    ds_read_b64_tr_b16 v[216:217], v26 offset:57344
    ds_read_b64_tr_b16 v[218:219], v26 offset:59392
    v_exp_f32 v134, v134
    v_mfma_f32_32x32x16_bf16 v[144:159], v[244:247], v[116:119], v[144:159]
    ds_read_b64_tr_b16 v[220:221], v27 offset:57344
    ds_read_b64_tr_b16 v[222:223], v27 offset:59392
    v_exp_f32 v135, v135
    v_cvt_pk_bf16_f32 v160, v128, v129
    s_waitcnt lgkmcnt(8)
    v_mfma_f32_32x32x16_bf16 v[144:159], v[248:251], v[120:123], v[144:159]
    v_cvt_pk_bf16_f32 v161, v130, v131
    v_exp_f32 v136, v136
    v_mfma_f32_32x32x16_bf16 v[144:159], v[252:255], v[124:127], v[144:159]
    ds_read_b64_tr_b16 v[224:225], v24 offset:61440
    ds_read_b64_tr_b16 v[226:227], v24 offset:63488
    v_exp_f32 v137, v137
    s_waitcnt lgkmcnt(6)
    v_mfma_f32_32x32x16_bf16 v[32:47], v[208:211], v[168:171], v[32:47]
    ds_read_b64_tr_b16 v[228:229], v25 offset:61440
    ds_read_b64_tr_b16 v[230:231], v25 offset:63488
    v_exp_f32 v138, v138
    v_exp_f32 v139, v139
    v_mfma_f32_32x32x16_bf16 v[48:63], v[212:215], v[168:171], v[48:63]
    ds_read_b64_tr_b16 v[232:233], v26 offset:61440
    ds_read_b64_tr_b16 v[234:235], v26 offset:63488
    v_cvt_pk_bf16_f32 v162, v132, v133
    v_cvt_pk_bf16_f32 v163, v134, v135
    s_waitcnt lgkmcnt(6)
    v_mfma_f32_32x32x16_bf16 v[64:79], v[216:219], v[168:171], v[64:79]
    ds_read_b64_tr_b16 v[236:237], v27 offset:61440
    ds_read_b64_tr_b16 v[238:239], v27 offset:63488
    v_max3_f32 v11, v144, v145, v146
    v_max3_f32 v11, v11, v147, v148
    v_exp_f32 v140, v140
    v_mfma_f32_32x32x16_bf16 v[80:95], v[220:223], v[168:171], v[80:95]
    v_max3_f32 v11, v11, v149, v150
    v_max3_f32 v11, v11, v151, v152
    v_exp_f32 v141, v141
    v_mfma_f32_16x16x32_bf16 v[192:195], v[28:31], v[168:171], v[192:195]
    v_max3_f32 v11, v11, v153, v154
    s_waitcnt lgkmcnt(4)
    v_mfma_f32_32x32x16_bf16 v[32:47], v[224:227], v[172:175], v[32:47]
    v_max3_f32 v11, v11, v155, v156
    v_exp_f32 v142, v142
    v_exp_f32 v143, v143
    v_mfma_f32_32x32x16_bf16 v[48:63], v[228:231], v[172:175], v[48:63]
    s_waitcnt lgkmcnt(0)
    s_barrier
    ds_read_b128 v[240:243], v16 offset:0
    ds_read_b128 v[244:247], v17 offset:0
    ds_read_b128 v[248:251], v18 offset:0
    v_max3_f32 v11, v11, v157, v158
    v_mfma_f32_32x32x16_bf16 v[64:79], v[232:235], v[172:175], v[64:79]
    ds_read_b128 v[252:255], v19 offset:0
    v_max_f32 v11, v11, v159
    v_cvt_pk_bf16_f32 v164, v136, v137
    v_cvt_pk_bf16_f32 v165, v138, v139
    v_mfma_f32_32x32x16_bf16 v[80:95], v[236:239], v[172:175], v[80:95]
    ds_read_b128 v[208:211], v20 offset:0
    v_cmp_lt_f32 vcc, s46, v11
    v_cvt_pk_bf16_f32 v166, v140, v141
    v_cvt_pk_bf16_f32 v167, v142, v143
    v_mfma_f32_16x16x32_bf16 v[192:195], v[28:31], v[172:175], v[192:195]
    ds_read_b128 v[212:215], v21 offset:0
    s_cbranch_vccnz L_rare_18
L_back_18:
    s_waitcnt lgkmcnt(4)
    v_mfma_f32_32x32x16_bf16 v[128:143], v[240:243], v[96:99], v[176:191]
    ds_read_b128 v[216:219], v22 offset:0
    v_exp_f32 v144, v144
    v_exp_f32 v145, v145
    v_mfma_f32_32x32x16_bf16 v[128:143], v[244:247], v[100:103], v[128:143]
    ds_read_b128 v[220:223], v23 offset:0
    v_exp_f32 v146, v146
    v_exp_f32 v147, v147
    s_waitcnt lgkmcnt(4)
    v_mfma_f32_32x32x16_bf16 v[128:143], v[248:251], v[104:107], v[128:143]
    ds_read_b64_tr_b16 v[224:225], v204 offset:0
    ds_read_b64_tr_b16 v[226:227], v204 offset:2048
    v_exp_f32 v148, v148
    v_mfma_f32_32x32x16_bf16 v[128:143], v[252:255], v[108:111], v[128:143]
    ds_read_b64_tr_b16 v[228:229], v205 offset:0
    ds_read_b64_tr_b16 v[230:231], v205 offset:2048
    v_exp_f32 v149, v149
    s_waitcnt lgkmcnt(6)
    v_mfma_f32_32x32x16_bf16 v[128:143], v[208:211], v[112:115], v[128:143]
    ds_read_b64_tr_b16 v[232:233], v206 offset:0
    ds_read_b64_tr_b16 v[234:235], v206 offset:2048
    v_exp_f32 v150, v150
    v_mfma_f32_32x32x16_bf16 v[128:143], v[212:215], v[116:119], v[128:143]
    ds_read_b64_tr_b16 v[236:237], v207 offset:0
    ds_read_b64_tr_b16 v[238:239], v207 offset:2048
    v_exp_f32 v151, v151
    v_cvt_pk_bf16_f32 v168, v144, v145
    s_waitcnt lgkmcnt(8)
    v_mfma_f32_32x32x16_bf16 v[128:143], v[216:219], v[120:123], v[128:143]
    v_cvt_pk_bf16_f32 v169, v146, v147
    v_exp_f32 v152, v152
    v_mfma_f32_32x32x16_bf16 v[128:143], v[220:223], v[124:127], v[128:143]
    ds_read_b64_tr_b16 v[240:241], v204 offset:4096
    ds_read_b64_tr_b16 v[242:243], v204 offset:6144
    v_exp_f32 v153, v153
    s_waitcnt lgkmcnt(6)
    v_mfma_f32_32x32x16_bf16 v[32:47], v[224:227], v[160:163], v[32:47]
    ds_read_b64_tr_b16 v[244:245], v205 offset:4096
    ds_read_b64_tr_b16 v[246:247], v205 offset:6144
    v_exp_f32 v154, v154
    v_exp_f32 v155, v155
    v_mfma_f32_32x32x16_bf16 v[48:63], v[228:231], v[160:163], v[48:63]
    ds_read_b64_tr_b16 v[248:249], v206 offset:4096
    ds_read_b64_tr_b16 v[250:251], v206 offset:6144
    v_cvt_pk_bf16_f32 v170, v148, v149
    v_cvt_pk_bf16_f32 v171, v150, v151
    s_waitcnt lgkmcnt(6)
    v_mfma_f32_32x32x16_bf16 v[64:79], v[232:235], v[160:163], v[64:79]
    ds_read_b64_tr_b16 v[252:253], v207 offset:4096
    ds_read_b64_tr_b16 v[254:255], v207 offset:6144
    v_max3_f32 v11, v128, v129, v130
    v_max3_f32 v11, v11, v131, v132
    v_exp_f32 v156, v156
    v_mfma_f32_32x32x16_bf16 v[80:95], v[236:239], v[160:163], v[80:95]
    v_max3_f32 v11, v11, v133, v134
    v_max3_f32 v11, v11, v135, v136
    v_exp_f32 v157, v157
    v_mfma_f32_16x16x32_bf16 v[192:195], v[28:31], v[160:163], v[192:195]
    ds_read_b128 v[208:211], v16 offset:8192
    s_waitcnt lgkmcnt(5)
    v_mfma_f32_32x32x16_bf16 v[32:47], v[240:243], v[164:167], v[32:47]
    ds_read_b128 v[212:215], v17 offset:8192
    v_max3_f32 v11, v11, v137, v138
    v_max3_f32 v11, v11, v139, v140
    v_exp_f32 v158, v158
    v_mfma_f32_32x32x16_bf16 v[48:63], v[244:247], v[164:167], v[48:63]
    ds_read_b128 v[216:219], v18 offset:8192
    v_max3_f32 v11, v11, v141, v142
    v_exp_f32 v159, v159
    s_waitcnt lgkmcnt(5)
    v_mfma_f32_32x32x16_bf16 v[64:79], v[248:251], v[164:167], v[64:79]
    ds_read_b128 v[220:223], v19 offset:8192
    v_max_f32 v11, v11, v143
    v_cvt_pk_bf16_f32 v172, v152, v153
    v_cvt_pk_bf16_f32 v173, v154, v155
    s_waitcnt lgkmcnt(4)
    v_mfma_f32_32x32x16_bf16 v[80:95], v[252:255], v[164:167], v[80:95]
    ds_read_b128 v[224:227], v20 offset:8192
    v_cmp_lt_f32 vcc, s46, v11
    v_cvt_pk_bf16_f32 v174, v156, v157
    v_cvt_pk_bf16_f32 v175, v158, v159
    v_mfma_f32_16x16x32_bf16 v[192:195], v[28:31], v[164:167], v[192:195]
    ds_read_b128 v[228:231], v21 offset:8192
    s_cbranch_vccnz L_rare_19
L_back_19:
    s_waitcnt lgkmcnt(4)
    v_mfma_f32_32x32x16_bf16 v[144:159], v[208:211], v[96:99], v[176:191]
    ds_read_b128 v[232:235], v22 offset:8192
    v_exp_f32 v128, v128
    v_exp_f32 v129, v129
    v_mfma_f32_32x32x16_bf16 v[144:159], v[212:215], v[100:103], v[144:159]
    ds_read_b128 v[236:239], v23 offset:8192
    v_exp_f32 v130, v130
    v_exp_f32 v131, v131
    s_waitcnt lgkmcnt(4)
    v_mfma_f32_32x32x16_bf16 v[144:159], v[216:219], v[104:107], v[144:159]
    ds_read_b64_tr_b16 v[240:241], v204 offset:8192
    ds_read_b64_tr_b16 v[242:243], v204 offset:10240
    v_exp_f32 v132, v132
    v_mfma_f32_32x32x16_bf16 v[144:159], v[220:223], v[108:111], v[144:159]
    ds_read_b64_tr_b16 v[244:245], v205 offset:8192
    ds_read_b64_tr_b16 v[246:247], v205 offset:10240
    v_exp_f32 v133, v133
    s_waitcnt lgkmcnt(6)
    v_mfma_f32_32x32x16_bf16 v[144:159], v[224:227], v[112:115], v[144:159]
    ds_read_b64_tr_b16 v[248:249], v206 offset:8192
    ds_read_b64_tr_b16 v[250:251], v206 offset:10240
    v_exp_f32 v134, v134
    v_mfma_f32_32x32x16_bf16 v[144:159], v[228:231], v[116:119], v[144:159]
    ds_read_b64_tr_b16 v[252:253], v207 offset:8192
    ds_read_b64_tr_b16 v[254:255], v207 offset:10240
    v_exp_f32 v135, v135
    v_cvt_pk_bf16_f32 v160, v128, v129
    s_waitcnt lgkmcnt(8)
    v_mfma_f32_32x32x16_bf16 v[144:159], v[232:235], v[120:123], v[144:159]
    v_cvt_pk_bf16_f32 v161, v130, v131
    v_exp_f32 v136, v136
    v_mfma_f32_32x32x16_bf16 v[144:159], v[236:239], v[124:127], v[144:159]
    ds_read_b64_tr_b16 v[208:209], v204 offset:12288
    ds_read_b64_tr_b16 v[210:211], v204 offset:14336
    v_exp_f32 v137, v137
    s_waitcnt lgkmcnt(6)
    v_mfma_f32_32x32x16_bf16 v[32:47], v[240:243], v[168:171], v[32:47]
    ds_read_b64_tr_b16 v[212:213], v205 offset:12288
    ds_read_b64_tr_b16 v[214:215], v205 offset:14336
    v_exp_f32 v138, v138
    v_exp_f32 v139, v139
    v_mfma_f32_32x32x16_bf16 v[48:63], v[244:247], v[168:171], v[48:63]
    ds_read_b64_tr_b16 v[216:217], v206 offset:12288
    ds_read_b64_tr_b16 v[218:219], v206 offset:14336
    v_cvt_pk_bf16_f32 v162, v132, v133
    v_cvt_pk_bf16_f32 v163, v134, v135
    s_waitcnt lgkmcnt(6)
    v_mfma_f32_32x32x16_bf16 v[64:79], v[248:251], v[168:171], v[64:79]
    ds_read_b64_tr_b16 v[220:221], v207 offset:12288
    ds_read_b64_tr_b16 v[222:223], v207 offset:14336
    v_max3_f32 v11, v144, v145, v146
    v_max3_f32 v11, v11, v147, v148
    v_exp_f32 v140, v140
    v_mfma_f32_32x32x16_bf16 v[80:95], v[252:255], v[168:171], v[80:95]
    v_max3_f32 v11, v11, v149, v150
    v_max3_f32 v11, v11, v151, v152
    v_exp_f32 v141, v141
    v_mfma_f32_16x16x32_bf16 v[192:195], v[28:31], v[168:171], v[192:195]
    v_max3_f32 v11, v11, v153, v154
    s_waitcnt lgkmcnt(4)
    v_mfma_f32_32x32x16_bf16 v[32:47], v[208:211], v[172:175], v[32:47]
    v_max3_f32 v11, v11, v155, v156
    v_exp_f32 v142, v142
    v_exp_f32 v143, v143
    v_mfma_f32_32x32x16_bf16 v[48:63], v[212:215], v[172:175], v[48:63]
    s_waitcnt lgkmcnt(0)
    s_barrier
    ds_read_b128 v[224:227], v16 offset:16384
    ds_read_b128 v[228:231], v17 offset:16384
    ds_read_b128 v[232:235], v18 offset:16384
    v_max3_f32 v11, v11, v157, v158
    v_mfma_f32_32x32x16_bf16 v[64:79], v[216:219], v[172:175], v[64:79]
    ds_read_b128 v[236:239], v19 offset:16384
    v_max_f32 v11, v11, v159
    v_cvt_pk_bf16_f32 v164, v136, v137
    v_cvt_pk_bf16_f32 v165, v138, v139
    v_mfma_f32_32x32x16_bf16 v[80:95], v[220:223], v[172:175], v[80:95]
    ds_read_b128 v[240:243], v20 offset:16384
    v_cmp_lt_f32 vcc, s46, v11
    v_cvt_pk_bf16_f32 v166, v140, v141
    v_cvt_pk_bf16_f32 v167, v142, v143
    v_mfma_f32_16x16x32_bf16 v[192:195], v[28:31], v[172:175], v[192:195]
    ds_read_b128 v[244:247], v21 offset:16384
    s_cbranch_vccnz L_rare_20
L_back_20:
    s_waitcnt lgkmcnt(4)
    v_mfma_f32_32x32x16_bf16 v[128:143], v[224:227], v[96:99], v[176:191]
    ds_read_b128 v[248:251], v22 offset:16384
    v_exp_f32 v144, v144
    v_exp_f32 v145, v145
    v_mfma_f32_32x32x16_bf16 v[128:143], v[228:231], v[100:103], v[128:143]
    ds_read_b128 v[252:255], v23 offset:16384
    v_exp_f32 v146, v146
    v_exp_f32 v147, v147
    s_waitcnt lgkmcnt(4)
    v_mfma_f32_32x32x16_bf16 v[128:143], v[232:235], v[104:107], v[128:143]
    ds_read_b64_tr_b16 v[208:209], v24 offset:0
    ds_read_b64_tr_b16 v[210:211], v24 offset:2048
    v_exp_f32 v148, v148
    v_mfma_f32_32x32x16_bf16 v[128:143], v[236:239], v[108:111], v[128:143]
    ds_read_b64_tr_b16 v[212:213], v25 offset:0
    ds_read_b64_tr_b16 v[214:215], v25 offset:2048
    v_exp_f32 v149, v149
    s_waitcnt lgkmcnt(6)
    v_mfma_f32_32x32x16_bf16 v[128:143], v[240:243], v[112:115], v[128:143]
    ds_read_b64_tr_b16 v[216:217], v26 offset:0
    ds_read_b64_tr_b16 v[218:219], v26 offset:2048
    v_exp_f32 v150, v150
    v_mfma_f32_32x32x16_bf16 v[128:143], v[244:247], v[116:119], v[128:143]
    ds_read_b64_tr_b16 v[220:221], v27 offset:0
    ds_read_b64_tr_b16 v[222:223], v27 offset:2048
    v_exp_f32 v151, v151
    v_cvt_pk_bf16_f32 v168, v144, v145
    s_waitcnt lgkmcnt(8)
    v_mfma_f32_32x32x16_bf16 v[128:143], v[248:251], v[120:123], v[128:143]
    v_cvt_pk_bf16_f32 v169, v146, v147
    v_exp_f32 v152, v152
    v_mfma_f32_32x32x16_bf16 v[128:143], v[252:255], v[124:127], v[128:143]
    ds_read_b64_tr_b16 v[224:225], v24 offset:4096
    ds_read_b64_tr_b16 v[226:227], v24 offset:6144
    v_exp_f32 v153, v153
    s_waitcnt lgkmcnt(6)
    v_mfma_f32_32x32x16_bf16 v[32:47], v[208:211], v[160:163], v[32:47]
    ds_read_b64_tr_b16 v[228:229], v25 offset:4096
    ds_read_b64_tr_b16 v[230:231], v25 offset:6144
    v_exp_f32 v154, v154
    v_exp_f32 v155, v155
    v_mfma_f32_32x32x16_bf16 v[48:63], v[212:215], v[160:163], v[48:63]
    ds_read_b64_tr_b16 v[232:233], v26 offset:4096
    ds_read_b64_tr_b16 v[234:235], v26 offset:6144
    v_cvt_pk_bf16_f32 v170, v148, v149
    v_cvt_pk_bf16_f32 v171, v150, v151
    s_waitcnt lgkmcnt(6)
    v_mfma_f32_32x32x16_bf16 v[64:79], v[216:219], v[160:163], v[64:79]
    ds_read_b64_tr_b16 v[236:237], v27 offset:4096
    ds_read_b64_tr_b16 v[238:239], v27 offset:6144
    v_max3_f32 v11, v128, v129, v130
    v_max3_f32 v11, v11, v131, v132
    v_exp_f32 v156, v156
    v_mfma_f32_32x32x16_bf16 v[80:95], v[220:223], v[160:163], v[80:95]
    v_max3_f32 v11, v11, v133, v134
    v_max3_f32 v11, v11, v135, v136
    v_exp_f32 v157, v157
    v_mfma_f32_16x16x32_bf16 v[192:195], v[28:31], v[160:163], v[192:195]
    ds_read_b128 v[240:243], v16 offset:24576
    s_waitcnt lgkmcnt(5)
    v_mfma_f32_32x32x16_bf16 v[32:47], v[224:227], v[164:167], v[32:47]
    ds_read_b128 v[244:247], v17 offset:24576
    v_max3_f32 v11, v11, v137, v138
    v_max3_f32 v11, v11, v139, v140
    v_exp_f32 v158, v158
    v_mfma_f32_32x32x16_bf16 v[48:63], v[228:231], v[164:167], v[48:63]
    ds_read_b128 v[248:251], v18 offset:24576
    v_max3_f32 v11, v11, v141, v142
    v_exp_f32 v159, v159
    s_waitcnt lgkmcnt(5)
    v_mfma_f32_32x32x16_bf16 v[64:79], v[232:235], v[164:167], v[64:79]
    ds_read_b128 v[252:255], v19 offset:24576
    v_max_f32 v11, v11, v143
    v_cvt_pk_bf16_f32 v172, v152, v153
    v_cvt_pk_bf16_f32 v173, v154, v155
    s_waitcnt lgkmcnt(4)
    v_mfma_f32_32x32x16_bf16 v[80:95], v[236:239], v[164:167], v[80:95]
    ds_read_b128 v[208:211], v20 offset:24576
    v_cmp_lt_f32 vcc, s46, v11
    v_cvt_pk_bf16_f32 v174, v156, v157
    v_cvt_pk_bf16_f32 v175, v158, v159
    v_mfma_f32_16x16x32_bf16 v[192:195], v[28:31], v[164:167], v[192:195]
    ds_read_b128 v[212:215], v21 offset:24576
    s_cbranch_vccnz L_rare_21
L_back_21:
    s_waitcnt lgkmcnt(4)
    v_mfma_f32_32x32x16_bf16 v[144:159], v[240:243], v[96:99], v[176:191]
    ds_read_b128 v[216:219], v22 offset:24576
    v_exp_f32 v128, v128
    v_exp_f32 v129, v129
    v_mfma_f32_32x32x16_bf16 v[144:159], v[244:247], v[100:103], v[144:159]
    ds_read_b128 v[220:223], v23 offset:24576
    v_exp_f32 v130, v130
    v_exp_f32 v131, v131
    s_waitcnt lgkmcnt(4)
    v_mfma_f32_32x32x16_bf16 v[144:159], v[248:251], v[104:107], v[144:159]
    ds_read_b64_tr_b16 v[224:225], v24 offset:8192
    ds_read_b64_tr_b16 v[226:227], v24 offset:10240
    v_exp_f32 v132, v132
    v_mfma_f32_32x32x16_bf16 v[144:159], v[252:255], v[108:111], v[144:159]
    ds_read_b64_tr_b16 v[228:229], v25 offset:8192
    ds_read_b64_tr_b16 v[230:231], v25 offset:10240
    v_exp_f32 v133, v133
    s_waitcnt lgkmcnt(6)
    v_mfma_f32_32x32x16_bf16 v[144:159], v[208:211], v[112:115], v[144:159]
    ds_read_b64_tr_b16 v[232:233], v26 offset:8192
    ds_read_b64_tr_b16 v[234:235], v26 offset:10240
    v_exp_f32 v134, v134
    v_mfma_f32_32x32x16_bf16 v[144:159], v[212:215], v[116:119], v[144:159]
    ds_read_b64_tr_b16 v[236:237], v27 offset:8192
    ds_read_b64_tr_b16 v[238:239], v27 offset:10240
    v_exp_f32 v135, v135
    v_cvt_pk_bf16_f32 v160, v128, v129
    s_waitcnt lgkmcnt(8)
    v_mfma_f32_32x32x16_bf16 v[144:159], v[216:219], v[120:123], v[144:159]
    v_cvt_pk_bf16_f32 v161, v130, v131
    v_exp_f32 v136, v136
    v_mfma_f32_32x32x16_bf16 v[144:159], v[220:223], v[124:127], v[144:159]
    ds_read_b64_tr_b16 v[240:241], v24 offset:12288
    ds_read_b64_tr_b16 v[242:243], v24 offset:14336
    v_exp_f32 v137, v137
    s_waitcnt lgkmcnt(6)
    v_mfma_f32_32x32x16_bf16 v[32:47], v[224:227], v[168:171], v[32:47]
    ds_read_b64_tr_b16 v[244:245], v25 offset:12288
    ds_read_b64_tr_b16 v[246:247], v25 offset:14336
    v_exp_f32 v138, v138
    v_exp_f32 v139, v139
    v_mfma_f32_32x32x16_bf16 v[48:63], v[228:231], v[168:171], v[48:63]
    ds_read_b64_tr_b16 v[248:249], v26 offset:12288
    ds_read_b64_tr_b16 v[250:251], v26 offset:14336
    v_cvt_pk_bf16_f32 v162, v132, v133
    v_cvt_pk_bf16_f32 v163, v134, v135
    s_waitcnt lgkmcnt(6)
    v_mfma_f32_32x32x16_bf16 v[64:79], v[232:235], v[168:171], v[64:79]
    ds_read_b64_tr_b16 v[252:253], v27 offset:12288
    ds_read_b64_tr_b16 v[254:255], v27 offset:14336
    v_max3_f32 v11, v144, v145, v146
    v_max3_f32 v11, v11, v147, v148
    v_exp_f32 v140, v140
    v_mfma_f32_32x32x16_bf16 v[80:95], v[236:239], v[168:171], v[80:95]
    v_max3_f32 v11, v11, v149, v150
    v_max3_f32 v11, v11, v151, v152
    v_exp_f32 v141, v141
    v_mfma_f32_16x16x32_bf16 v[192:195], v[28:31], v[168:171], v[192:195]
    v_max3_f32 v11, v11, v153, v154
    s_waitcnt lgkmcnt(4)
    v_mfma_f32_32x32x16_bf16 v[32:47], v[240:243], v[172:175], v[32:47]
    v_max3_f32 v11, v11, v155, v156
    v_exp_f32 v142, v142
    v_exp_f32 v143, v143
    v_mfma_f32_32x32x16_bf16 v[48:63], v[244:247], v[172:175], v[48:63]
    s_waitcnt lgkmcnt(0)
    s_barrier
    ds_read_b128 v[208:211], v16 offset:32768
    ds_read_b128 v[212:215], v17 offset:32768
    ds_read_b128 v[216:219], v18 offset:32768
    v_max3_f32 v11, v11, v157, v158
    v_mfma_f32_32x32x16_bf16 v[64:79], v[248:251], v[172:175], v[64:79]
    ds_read_b128 v[220:223], v19 offset:32768
    v_max_f32 v11, v11, v159
    v_cvt_pk_bf16_f32 v164, v136, v137
    v_cvt_pk_bf16_f32 v165, v138, v139
    v_mfma_f32_32x32x16_bf16 v[80:95], v[252:255], v[172:175], v[80:95]
    ds_read_b128 v[224:227], v20 offset:32768
    v_cmp_lt_f32 vcc, s46, v11
    v_cvt_pk_bf16_f32 v166, v140, v141
    v_cvt_pk_bf16_f32 v167, v142, v143
    v_mfma_f32_16x16x32_bf16 v[192:195], v[28:31], v[172:175], v[192:195]
    ds_read_b128 v[228:231], v21 offset:32768
    s_cbranch_vccnz L_rare_22
L_back_22:
    s_waitcnt lgkmcnt(4)
    v_mfma_f32_32x32x16_bf16 v[128:143], v[208:211], v[96:99], v[176:191]
    ds_read_b128 v[232:235], v22 offset:32768
    v_exp_f32 v144, v144
    v_exp_f32 v145, v145
    v_mfma_f32_32x32x16_bf16 v[128:143], v[212:215], v[100:103], v[128:143]
    ds_read_b128 v[236:239], v23 offset:32768
    v_exp_f32 v146, v146
    v_exp_f32 v147, v147
    s_waitcnt lgkmcnt(4)
    v_mfma_f32_32x32x16_bf16 v[128:143], v[216:219], v[104:107], v[128:143]
    ds_read_b64_tr_b16 v[240:241], v24 offset:16384
    ds_read_b64_tr_b16 v[242:243], v24 offset:18432
    v_exp_f32 v148, v148
    v_mfma_f32_32x32x16_bf16 v[128:143], v[220:223], v[108:111], v[128:143]
    ds_read_b64_tr_b16 v[244:245], v25 offset:16384
    ds_read_b64_tr_b16 v[246:247], v25 offset:18432
    v_exp_f32 v149, v149
    s_waitcnt lgkmcnt(6)
    v_mfma_f32_32x32x16_bf16 v[128:143], v[224:227], v[112:115], v[128:143]
    ds_read_b64_tr_b16 v[248:249], v26 offset:16384
    ds_read_b64_tr_b16 v[250:251], v26 offset:18432
    v_exp_f32 v150, v150
    v_mfma_f32_32x32x16_bf16 v[128:143], v[228:231], v[116:119], v[128:143]
    ds_read_b64_tr_b16 v[252:253], v27 offset:16384
    ds_read_b64_tr_b16 v[254:255], v27 offset:18432
    v_exp_f32 v151, v151
    v_cvt_pk_bf16_f32 v168, v144, v145
    s_waitcnt lgkmcnt(8)
    v_mfma_f32_32x32x16_bf16 v[128:143], v[232:235], v[120:123], v[128:143]
    v_cvt_pk_bf16_f32 v169, v146, v147
    v_exp_f32 v152, v152
    v_mfma_f32_32x32x16_bf16 v[128:143], v[236:239], v[124:127], v[128:143]
    ds_read_b64_tr_b16 v[208:209], v24 offset:20480
    ds_read_b64_tr_b16 v[210:211], v24 offset:22528
    v_exp_f32 v153, v153
    s_waitcnt lgkmcnt(6)
    v_mfma_f32_32x32x16_bf16 v[32:47], v[240:243], v[160:163], v[32:47]
    ds_read_b64_tr_b16 v[212:213], v25 offset:20480
    ds_read_b64_tr_b16 v[214:215], v25 offset:22528
    v_exp_f32 v154, v154
    v_exp_f32 v155, v155
    v_mfma_f32_32x32x16_bf16 v[48:63], v[244:247], v[160:163], v[48:63]
    ds_read_b64_tr_b16 v[216:217], v26 offset:20480
    ds_read_b64_tr_b16 v[218:219], v26 offset:22528
    v_cvt_pk_bf16_f32 v170, v148, v149
    v_cvt_pk_bf16_f32 v171, v150, v151
    s_waitcnt lgkmcnt(6)
    v_mfma_f32_32x32x16_bf16 v[64:79], v[248:251], v[160:163], v[64:79]
    ds_read_b64_tr_b16 v[220:221], v27 offset:20480
    ds_read_b64_tr_b16 v[222:223], v27 offset:22528
    v_max3_f32 v11, v128, v129, v130
    v_max3_f32 v11, v11, v131, v132
    v_exp_f32 v156, v156
    v_mfma_f32_32x32x16_bf16 v[80:95], v[252:255], v[160:163], v[80:95]
    v_max3_f32 v11, v11, v133, v134
    v_max3_f32 v11, v11, v135, v136
    v_exp_f32 v157, v157
    v_mfma_f32_16x16x32_bf16 v[192:195], v[28:31], v[160:163], v[192:195]
    ds_read_b128 v[224:227], v16 offset:40960
    s_waitcnt lgkmcnt(5)
    v_mfma_f32_32x32x16_bf16 v[32:47], v[208:211], v[164:167], v[32:47]
    ds_read_b128 v[228:231], v17 offset:40960
    v_max3_f32 v11, v11, v137, v138
    v_max3_f32 v11, v11, v139, v140
    v_exp_f32 v158, v158
    v_mfma_f32_32x32x16_bf16 v[48:63], v[212:215], v[164:167], v[48:63]
    ds_read_b128 v[232:235], v18 offset:40960
    v_max3_f32 v11, v11, v141, v142
    v_exp_f32 v159, v159
    s_waitcnt lgkmcnt(5)
    v_mfma_f32_32x32x16_bf16 v[64:79], v[216:219], v[164:167], v[64:79]
    ds_read_b128 v[236:239], v19 offset:40960
    v_max_f32 v11, v11, v143
    v_cvt_pk_bf16_f32 v172, v152, v153
    v_cvt_pk_bf16_f32 v173, v154, v155
    s_waitcnt lgkmcnt(4)
    v_mfma_f32_32x32x16_bf16 v[80:95], v[220:223], v[164:167], v[80:95]
    ds_read_b128 v[240:243], v20 offset:40960
    v_cmp_lt_f32 vcc, s46, v11
    v_cvt_pk_bf16_f32 v174, v156, v157
    v_cvt_pk_bf16_f32 v175, v158, v159
    v_mfma_f32_16x16x32_bf16 v[192:195], v[28:31], v[164:167], v[192:195]
    ds_read_b128 v[244:247], v21 offset:40960
    s_cbranch_vccnz L_rare_23
L_back_23:
    s_waitcnt lgkmcnt(4)
    v_mfma_f32_32x32x16_bf16 v[144:159], v[224:227], v[96:99], v[176:191]
    ds_read_b128 v[248:251], v22 offset:40960
    v_exp_f32 v128, v128
    v_exp_f32 v129, v129
    v_mfma_f32_32x32x16_bf16 v[144:159], v[228:231], v[100:103], v[144:159]
    ds_read_b128 v[252:255], v23 offset:40960
    v_exp_f32 v130, v130
    v_exp_f32 v131, v131
    s_waitcnt lgkmcnt(4)
    v_mfma_f32_32x32x16_bf16 v[144:159], v[232:235], v[104:107], v[144:159]
    ds_read_b64_tr_b16 v[208:209], v24 offset:24576
    ds_read_b64_tr_b16 v[210:211], v24 offset:26624
    v_exp_f32 v132, v132
    v_mfma_f32_32x32x16_bf16 v[144:159], v[236:239], v[108:111], v[144:159]
    ds_read_b64_tr_b16 v[212:213], v25 offset:24576
    ds_read_b64_tr_b16 v[214:215], v25 offset:26624
    v_exp_f32 v133, v133
    s_waitcnt lgkmcnt(6)
    v_mfma_f32_32x32x16_bf16 v[144:159], v[240:243], v[112:115], v[144:159]
    ds_read_b64_tr_b16 v[216:217], v26 offset:24576
    ds_read_b64_tr_b16 v[218:219], v26 offset:26624
    v_exp_f32 v134, v134
    v_mfma_f32_32x32x16_bf16 v[144:159], v[244:247], v[116:119], v[144:159]
    ds_read_b64_tr_b16 v[220:221], v27 offset:24576
    ds_read_b64_tr_b16 v[222:223], v27 offset:26624
    v_exp_f32 v135, v135
    v_cvt_pk_bf16_f32 v160, v128, v129
    s_waitcnt lgkmcnt(8)
    v_mfma_f32_32x32x16_bf16 v[144:159], v[248:251], v[120:123], v[144:159]
    v_cvt_pk_bf16_f32 v161, v130, v131
    v_exp_f32 v136, v136
    v_mfma_f32_32x32x16_bf16 v[144:159], v[252:255], v[124:127], v[144:159]
    ds_read_b64_tr_b16 v[224:225], v24 offset:28672
    ds_read_b64_tr_b16 v[226:227], v24 offset:30720
    v_exp_f32 v137, v137
    s_waitcnt lgkmcnt(6)
    v_mfma_f32_32x32x16_bf16 v[32:47], v[208:211], v[168:171], v[32:47]
    ds_read_b64_tr_b16 v[228:229], v25 offset:28672
    ds_read_b64_tr_b16 v[230:231], v25 offset:30720
    v_exp_f32 v138, v138
    v_exp_f32 v139, v139
    v_mfma_f32_32x32x16_bf16 v[48:63], v[212:215], v[168:171], v[48:63]
    ds_read_b64_tr_b16 v[232:233], v26 offset:28672
    ds_read_b64_tr_b16 v[234:235], v26 offset:30720
    v_cvt_pk_bf16_f32 v162, v132, v133
    v_cvt_pk_bf16_f32 v163, v134, v135
    s_waitcnt lgkmcnt(6)
    v_mfma_f32_32x32x16_bf16 v[64:79], v[216:219], v[168:171], v[64:79]
    ds_read_b64_tr_b16 v[236:237], v27 offset:28672
    ds_read_b64_tr_b16 v[238:239], v27 offset:30720
    v_max3_f32 v11, v144, v145, v146
    v_max3_f32 v11, v11, v147, v148
    v_exp_f32 v140, v140
    v_mfma_f32_32x32x16_bf16 v[80:95], v[220:223], v[168:171], v[80:95]
    v_max3_f32 v11, v11, v149, v150
    v_max3_f32 v11, v11, v151, v152
    v_exp_f32 v141, v141
    v_mfma_f32_16x16x32_bf16 v[192:195], v[28:31], v[168:171], v[192:195]
    v_max3_f32 v11, v11, v153, v154
    s_waitcnt lgkmcnt(4)
    v_mfma_f32_32x32x16_bf16 v[32:47], v[224:227], v[172:175], v[32:47]
    v_max3_f32 v11, v11, v155, v156
    v_exp_f32 v142, v142
    v_exp_f32 v143, v143
    v_mfma_f32_32x32x16_bf16 v[48:63], v[228:231], v[172:175], v[48:63]
    s_waitcnt lgkmcnt(0)
    s_barrier
    ds_read_b128 v[240:243], v16 offset:49152
    ds_read_b128 v[244:247], v17 offset:49152
    ds_read_b128 v[248:251], v18 offset:49152
    v_max3_f32 v11, v11, v157, v158
    v_mfma_f32_32x32x16_bf16 v[64:79], v[232:235], v[172:175], v[64:79]
    ds_read_b128 v[252:255], v19 offset:49152
    v_max_f32 v11, v11, v159
    v_cvt_pk_bf16_f32 v164, v136, v137
    v_cvt_pk_bf16_f32 v165, v138, v139
    v_mfma_f32_32x32x16_bf16 v[80:95], v[236:239], v[172:175], v[80:95]
    ds_read_b128 v[208:211], v20 offset:49152
    v_cmp_lt_f32 vcc, s46, v11
    v_cvt_pk_bf16_f32 v166, v140, v141
    v_cvt_pk_bf16_f32 v167, v142, v143
    v_mfma_f32_16x16x32_bf16 v[192:195], v[28:31], v[172:175], v[192:195]
    ds_read_b128 v[212:215], v21 offset:49152
    s_cbranch_vccnz L_rare_24
L_back_24:
    s_waitcnt lgkmcnt(4)
    v_mfma_f32_32x32x16_bf16 v[128:143], v[240:243], v[96:99], v[176:191]
    ds_read_b128 v[216:219], v22 offset:49152
    v_exp_f32 v144, v144
    v_exp_f32 v145, v145
    v_mfma_f32_32x32x16_bf16 v[128:143], v[244:247], v[100:103], v[128:143]
    ds_read_b128 v[220:223], v23 offset:49152
    v_exp_f32 v146, v146
    v_exp_f32 v147, v147
    s_waitcnt lgkmcnt(4)
    v_mfma_f32_32x32x16_bf16 v[128:143], v[248:251], v[104:107], v[128:143]
    ds_read_b64_tr_b16 v[224:225], v24 offset:32768
    ds_read_b64_tr_b16 v[226:227], v24 offset:34816
    v_exp_f32 v148, v148
    v_mfma_f32_32x32x16_bf16 v[128:143], v[252:255], v[108:111], v[128:143]
    ds_read_b64_tr_b16 v[228:229], v25 offset:32768
    ds_read_b64_tr_b16 v[230:231], v25 offset:34816
    v_exp_f32 v149, v149
    s_waitcnt lgkmcnt(6)
    v_mfma_f32_32x32x16_bf16 v[128:143], v[208:211], v[112:115], v[128:143]
    ds_read_b64_tr_b16 v[232:233], v26 offset:32768
    ds_read_b64_tr_b16 v[234:235], v26 offset:34816
    v_exp_f32 v150, v150
    v_mfma_f32_32x32x16_bf16 v[128:143], v[212:215], v[116:119], v[128:143]
    ds_read_b64_tr_b16 v[236:237], v27 offset:32768
    ds_read_b64_tr_b16 v[238:239], v27 offset:34816
    v_exp_f32 v151, v151
    v_cvt_pk_bf16_f32 v168, v144, v145
    s_waitcnt lgkmcnt(8)
    v_mfma_f32_32x32x16_bf16 v[128:143], v[216:219], v[120:123], v[128:143]
    v_cvt_pk_bf16_f32 v169, v146, v147
    v_exp_f32 v152, v152
    v_mfma_f32_32x32x16_bf16 v[128:143], v[220:223], v[124:127], v[128:143]
    ds_read_b64_tr_b16 v[240:241], v24 offset:36864
    ds_read_b64_tr_b16 v[242:243], v24 offset:38912
    v_exp_f32 v153, v153
    s_waitcnt lgkmcnt(6)
    v_mfma_f32_32x32x16_bf16 v[32:47], v[224:227], v[160:163], v[32:47]
    ds_read_b64_tr_b16 v[244:245], v25 offset:36864
    ds_read_b64_tr_b16 v[246:247], v25 offset:38912
    v_exp_f32 v154, v154
    v_exp_f32 v155, v155
    v_mfma_f32_32x32x16_bf16 v[48:63], v[228:231], v[160:163], v[48:63]
    ds_read_b64_tr_b16 v[248:249], v26 offset:36864
    ds_read_b64_tr_b16 v[250:251], v26 offset:38912
    v_cvt_pk_bf16_f32 v170, v148, v149
    v_cvt_pk_bf16_f32 v171, v150, v151
    s_waitcnt lgkmcnt(6)
    v_mfma_f32_32x32x16_bf16 v[64:79], v[232:235], v[160:163], v[64:79]
    ds_read_b64_tr_b16 v[252:253], v27 offset:36864
    ds_read_b64_tr_b16 v[254:255], v27 offset:38912
    v_max3_f32 v11, v128, v129, v130
    v_max3_f32 v11, v11, v131, v132
    v_exp_f32 v156, v156
    v_mfma_f32_32x32x16_bf16 v[80:95], v[236:239], v[160:163], v[80:95]
    v_max3_f32 v11, v11, v133, v134
    v_max3_f32 v11, v11, v135, v136
    v_exp_f32 v157, v157
    v_mfma_f32_16x16x32_bf16 v[192:195], v[28:31], v[160:163], v[192:195]
    ds_read_b128 v[208:211], v16 offset:57344
    s_waitcnt lgkmcnt(5)
    v_mfma_f32_32x32x16_bf16 v[32:47], v[240:243], v[164:167], v[32:47]
    ds_read_b128 v[212:215], v17 offset:57344
    v_max3_f32 v11, v11, v137, v138
    v_max3_f32 v11, v11, v139, v140
    v_exp_f32 v158, v158
    v_mfma_f32_32x32x16_bf16 v[48:63], v[244:247], v[164:167], v[48:63]
    ds_read_b128 v[216:219], v18 offset:57344
    v_max3_f32 v11, v11, v141, v142
    v_exp_f32 v159, v159
    s_waitcnt lgkmcnt(5)
    v_mfma_f32_32x32x16_bf16 v[64:79], v[248:251], v[164:167], v[64:79]
    ds_read_b128 v[220:223], v19 offset:57344
    v_max_f32 v11, v11, v143
    v_cvt_pk_bf16_f32 v172, v152, v153
    v_cvt_pk_bf16_f32 v173, v154, v155
    s_waitcnt lgkmcnt(4)
    v_mfma_f32_32x32x16_bf16 v[80:95], v[252:255], v[164:167], v[80:95]
    ds_read_b128 v[224:227], v20 offset:57344
    v_cmp_lt_f32 vcc, s46, v11
    v_cvt_pk_bf16_f32 v174, v156, v157
    v_cvt_pk_bf16_f32 v175, v158, v159
    v_mfma_f32_16x16x32_bf16 v[192:195], v[28:31], v[164:167], v[192:195]
    ds_read_b128 v[228:231], v21 offset:57344
    s_cbranch_vccnz L_rare_25
L_back_25:
    s_waitcnt lgkmcnt(4)
    v_mfma_f32_32x32x16_bf16 v[144:159], v[208:211], v[96:99], v[176:191]
    ds_read_b128 v[232:235], v22 offset:57344
    v_exp_f32 v128, v128
    v_exp_f32 v129, v129
    v_mfma_f32_32x32x16_bf16 v[144:159], v[212:215], v[100:103], v[144:159]
    ds_read_b128 v[236:239], v23 offset:57344
    v_exp_f32 v130, v130
    v_exp_f32 v131, v131
    s_waitcnt lgkmcnt(4)
    v_mfma_f32_32x32x16_bf16 v[144:159], v[216:219], v[104:107], v[144:159]
    ds_read_b64_tr_b16 v[240:241], v24 offset:40960
    ds_read_b64_tr_b16 v[242:243], v24 offset:43008
    v_exp_f32 v132, v132
    v_mfma_f32_32x32x16_bf16 v[144:159], v[220:223], v[108:111], v[144:159]
    ds_read_b64_tr_b16 v[244:245], v25 offset:40960
    ds_read_b64_tr_b16 v[246:247], v25 offset:43008
    v_exp_f32 v133, v133
    s_waitcnt lgkmcnt(6)
    v_mfma_f32_32x32x16_bf16 v[144:159], v[224:227], v[112:115], v[144:159]
    ds_read_b64_tr_b16 v[248:249], v26 offset:40960
    ds_read_b64_tr_b16 v[250:251], v26 offset:43008
    v_exp_f32 v134, v134
    v_mfma_f32_32x32x16_bf16 v[144:159], v[228:231], v[116:119], v[144:159]
    ds_read_b64_tr_b16 v[252:253], v27 offset:40960
    ds_read_b64_tr_b16 v[254:255], v27 offset:43008
    v_exp_f32 v135, v135
    v_cvt_pk_bf16_f32 v160, v128, v129
    s_waitcnt lgkmcnt(8)
    v_mfma_f32_32x32x16_bf16 v[144:159], v[232:235], v[120:123], v[144:159]
    v_cvt_pk_bf16_f32 v161, v130, v131
    v_exp_f32 v136, v136
    v_mfma_f32_32x32x16_bf16 v[144:159], v[236:239], v[124:127], v[144:159]
    ds_read_b64_tr_b16 v[208:209], v24 offset:45056
    ds_read_b64_tr_b16 v[210:211], v24 offset:47104
    v_exp_f32 v137, v137
    s_waitcnt lgkmcnt(6)
    v_mfma_f32_32x32x16_bf16 v[32:47], v[240:243], v[168:171], v[32:47]
    ds_read_b64_tr_b16 v[212:213], v25 offset:45056
    ds_read_b64_tr_b16 v[214:215], v25 offset:47104
    v_exp_f32 v138, v138
    v_exp_f32 v139, v139
    v_mfma_f32_32x32x16_bf16 v[48:63], v[244:247], v[168:171], v[48:63]
    ds_read_b64_tr_b16 v[216:217], v26 offset:45056
    ds_read_b64_tr_b16 v[218:219], v26 offset:47104
    v_cvt_pk_bf16_f32 v162, v132, v133
    v_cvt_pk_bf16_f32 v163, v134, v135
    s_waitcnt lgkmcnt(6)
    v_mfma_f32_32x32x16_bf16 v[64:79], v[248:251], v[168:171], v[64:79]
    ds_read_b64_tr_b16 v[220:221], v27 offset:45056
    ds_read_b64_tr_b16 v[222:223], v27 offset:47104
    v_max3_f32 v11, v144, v145, v146
    v_max3_f32 v11, v11, v147, v148
    v_exp_f32 v140, v140
    v_mfma_f32_32x32x16_bf16 v[80:95], v[252:255], v[168:171], v[80:95]
    v_max3_f32 v11, v11, v149, v150
    v_max3_f32 v11, v11, v151, v152
    v_exp_f32 v141, v141
    v_mfma_f32_16x16x32_bf16 v[192:195], v[28:31], v[168:171], v[192:195]
    v_max3_f32 v11, v11, v153, v154
    s_waitcnt lgkmcnt(4)
    v_mfma_f32_32x32x16_bf16 v[32:47], v[208:211], v[172:175], v[32:47]
    v_max3_f32 v11, v11, v155, v156
    v_exp_f32 v142, v142
    v_exp_f32 v143, v143
    v_mfma_f32_32x32x16_bf16 v[48:63], v[212:215], v[172:175], v[48:63]
    s_waitcnt lgkmcnt(0)
    s_barrier
    ds_read_b128 v[224:227], v196 offset:0
    ds_read_b128 v[228:231], v197 offset:0
    ds_read_b128 v[232:235], v198 offset:0
    v_max3_f32 v11, v11, v157, v158
    v_mfma_f32_32x32x16_bf16 v[64:79], v[216:219], v[172:175], v[64:79]
    ds_read_b128 v[236:239], v199 offset:0
    v_max_f32 v11, v11, v159
    v_cvt_pk_bf16_f32 v164, v136, v137
    v_cvt_pk_bf16_f32 v165, v138, v139
    v_mfma_f32_32x32x16_bf16 v[80:95], v[220:223], v[172:175], v[80:95]
    ds_read_b128 v[240:243], v200 offset:0
    v_cmp_lt_f32 vcc, s46, v11
    v_cvt_pk_bf16_f32 v166, v140, v141
    v_cvt_pk_bf16_f32 v167, v142, v143
    v_mfma_f32_16x16x32_bf16 v[192:195], v[28:31], v[172:175], v[192:195]
    ds_read_b128 v[244:247], v201 offset:0
    s_cbranch_vccnz L_rare_26
L_back_26:
    s_waitcnt lgkmcnt(4)
    v_mfma_f32_32x32x16_bf16 v[128:143], v[224:227], v[96:99], v[176:191]
    ds_read_b128 v[248:251], v202 offset:0
    v_exp_f32 v144, v144
    v_exp_f32 v145, v145
    v_mfma_f32_32x32x16_bf16 v[128:143], v[228:231], v[100:103], v[128:143]
    ds_read_b128 v[252:255], v203 offset:0
    v_exp_f32 v146, v146
    v_exp_f32 v147, v147
    s_waitcnt lgkmcnt(4)
    v_mfma_f32_32x32x16_bf16 v[128:143], v[232:235], v[104:107], v[128:143]
    ds_read_b64_tr_b16 v[208:209], v24 offset:49152
    ds_read_b64_tr_b16 v[210:211], v24 offset:51200
    v_exp_f32 v148, v148
    v_mfma_f32_32x32x16_bf16 v[128:143], v[236:239], v[108:111], v[128:143]
    ds_read_b64_tr_b16 v[212:213], v25 offset:49152
    ds_read_b64_tr_b16 v[214:215], v25 offset:51200
    v_exp_f32 v149, v149
    s_waitcnt lgkmcnt(6)
    v_mfma_f32_32x32x16_bf16 v[128:143], v[240:243], v[112:115], v[128:143]
    ds_read_b64_tr_b16 v[216:217], v26 offset:49152
    ds_read_b64_tr_b16 v[218:219], v26 offset:51200
    v_exp_f32 v150, v150
    v_mfma_f32_32x32x16_bf16 v[128:143], v[244:247], v[116:119], v[128:143]
    ds_read_b64_tr_b16 v[220:221], v27 offset:49152
    ds_read_b64_tr_b16 v[222:223], v27 offset:51200
    v_exp_f32 v151, v151
    v_cvt_pk_bf16_f32 v168, v144, v145
    s_waitcnt lgkmcnt(8)
    v_mfma_f32_32x32x16_bf16 v[128:143], v[248:251], v[120:123], v[128:143]
    v_cvt_pk_bf16_f32 v169, v146, v147
    v_exp_f32 v152, v152
    v_mfma_f32_32x32x16_bf16 v[128:143], v[252:255], v[124:127], v[128:143]
    ds_read_b64_tr_b16 v[224:225], v24 offset:53248
    ds_read_b64_tr_b16 v[226:227], v24 offset:55296
    v_exp_f32 v153, v153
    s_waitcnt lgkmcnt(6)
    v_mfma_f32_32x32x16_bf16 v[32:47], v[208:211], v[160:163], v[32:47]
    ds_read_b64_tr_b16 v[228:229], v25 offset:53248
    ds_read_b64_tr_b16 v[230:231], v25 offset:55296
    v_exp_f32 v154, v154
    v_exp_f32 v155, v155
    v_mfma_f32_32x32x16_bf16 v[48:63], v[212:215], v[160:163], v[48:63]
    ds_read_b64_tr_b16 v[232:233], v26 offset:53248
    ds_read_b64_tr_b16 v[234:235], v26 offset:55296
    v_cvt_pk_bf16_f32 v170, v148, v149
    v_cvt_pk_bf16_f32 v171, v150, v151
    s_waitcnt lgkmcnt(6)
    v_mfma_f32_32x32x16_bf16 v[64:79], v[216:219], v[160:163], v[64:79]
    ds_read_b64_tr_b16 v[236:237], v27 offset:53248
    ds_read_b64_tr_b16 v[238:239], v27 offset:55296
    v_max3_f32 v11, v128, v129, v130
    v_max3_f32 v11, v11, v131, v132
    v_exp_f32 v156, v156
    v_mfma_f32_32x32x16_bf16 v[80:95], v[220:223], v[160:163], v[80:95]
    v_max3_f32 v11, v11, v133, v134
    v_max3_f32 v11, v11, v135, v136
    v_exp_f32 v157, v157
    v_mfma_f32_16x16x32_bf16 v[192:195], v[28:31], v[160:163], v[192:195]
    ds_read_b128 v[240:243], v196 offset:8192
    s_waitcnt lgkmcnt(5)
    v_mfma_f32_32x32x16_bf16 v[32:47], v[224:227], v[164:167], v[32:47]
    ds_read_b128 v[244:247], v197 offset:8192
    v_max3_f32 v11, v11, v137, v138
    v_max3_f32 v11, v11, v139, v140
    v_exp_f32 v158, v158
    v_mfma_f32_32x32x16_bf16 v[48:63], v[228:231], v[164:167], v[48:63]
    ds_read_b128 v[248:251], v198 offset:8192
    v_max3_f32 v11, v11, v141, v142
    v_exp_f32 v159, v159
    s_waitcnt lgkmcnt(5)
    v_mfma_f32_32x32x16_bf16 v[64:79], v[232:235], v[164:167], v[64:79]
    ds_read_b128 v[252:255], v199 offset:8192
    v_max_f32 v11, v11, v143
    v_cvt_pk_bf16_f32 v172, v152, v153
    v_cvt_pk_bf16_f32 v173, v154, v155
    s_waitcnt lgkmcnt(4)
    v_mfma_f32_32x32x16_bf16 v[80:95], v[236:239], v[164:167], v[80:95]
    ds_read_b128 v[208:211], v200 offset:8192
    v_cmp_lt_f32 vcc, s46, v11
    v_cvt_pk_bf16_f32 v174, v156, v157
    v_cvt_pk_bf16_f32 v175, v158, v159
    v_mfma_f32_16x16x32_bf16 v[192:195], v[28:31], v[164:167], v[192:195]
    ds_read_b128 v[212:215], v201 offset:8192
    s_cbranch_vccnz L_rare_27
L_back_27:
    s_waitcnt lgkmcnt(4)
    v_mfma_f32_32x32x16_bf16 v[144:159], v[240:243], v[96:99], v[176:191]
    ds_read_b128 v[216:219], v202 offset:8192
    v_exp_f32 v128, v128
    v_exp_f32 v129, v129
    v_mfma_f32_32x32x16_bf16 v[144:159], v[244:247], v[100:103], v[144:159]
    ds_read_b128 v[220:223], v203 offset:8192
    v_exp_f32 v130, v130
    v_exp_f32 v131, v131
    s_waitcnt lgkmcnt(4)
    v_mfma_f32_32x32x16_bf16 v[144:159], v[248:251], v[104:107], v[144:159]
    ds_read_b64_tr_b16 v[224:225], v24 offset:57344
    ds_read_b64_tr_b16 v[226:227], v24 offset:59392
    v_exp_f32 v132, v132
    v_mfma_f32_32x32x16_bf16 v[144:159], v[252:255], v[108:111], v[144:159]
    ds_read_b64_tr_b16 v[228:229], v25 offset:57344
    ds_read_b64_tr_b16 v[230:231], v25 offset:59392
    v_exp_f32 v133, v133
    s_waitcnt lgkmcnt(6)
    v_mfma_f32_32x32x16_bf16 v[144:159], v[208:211], v[112:115], v[144:159]
    ds_read_b64_tr_b16 v[232:233], v26 offset:57344
    ds_read_b64_tr_b16 v[234:235], v26 offset:59392
    v_exp_f32 v134, v134
    v_mfma_f32_32x32x16_bf16 v[144:159], v[212:215], v[116:119], v[144:159]
    ds_read_b64_tr_b16 v[236:237], v27 offset:57344
    ds_read_b64_tr_b16 v[238:239], v27 offset:59392
    v_exp_f32 v135, v135
    v_cvt_pk_bf16_f32 v160, v128, v129
    s_waitcnt lgkmcnt(8)
    v_mfma_f32_32x32x16_bf16 v[144:159], v[216:219], v[120:123], v[144:159]
    v_cvt_pk_bf16_f32 v161, v130, v131
    v_exp_f32 v136, v136
    v_mfma_f32_32x32x16_bf16 v[144:159], v[220:223], v[124:127], v[144:159]
    ds_read_b64_tr_b16 v[240:241], v24 offset:61440
    ds_read_b64_tr_b16 v[242:243], v24 offset:63488
    v_exp_f32 v137, v137
    s_waitcnt lgkmcnt(6)
    v_mfma_f32_32x32x16_bf16 v[32:47], v[224:227], v[168:171], v[32:47]
    ds_read_b64_tr_b16 v[244:245], v25 offset:61440
    ds_read_b64_tr_b16 v[246:247], v25 offset:63488
    v_exp_f32 v138, v138
    v_exp_f32 v139, v139
    v_mfma_f32_32x32x16_bf16 v[48:63], v[228:231], v[168:171], v[48:63]
    ds_read_b64_tr_b16 v[248:249], v26 offset:61440
    ds_read_b64_tr_b16 v[250:251], v26 offset:63488
    v_cvt_pk_bf16_f32 v162, v132, v133
    v_cvt_pk_bf16_f32 v163, v134, v135
    s_waitcnt lgkmcnt(6)
    v_mfma_f32_32x32x16_bf16 v[64:79], v[232:235], v[168:171], v[64:79]
    ds_read_b64_tr_b16 v[252:253], v27 offset:61440
    ds_read_b64_tr_b16 v[254:255], v27 offset:63488
    v_max3_f32 v11, v144, v145, v146
    v_max3_f32 v11, v11, v147, v148
    v_exp_f32 v140, v140
    v_mfma_f32_32x32x16_bf16 v[80:95], v[236:239], v[168:171], v[80:95]
    v_max3_f32 v11, v11, v149, v150
    v_max3_f32 v11, v11, v151, v152
    v_exp_f32 v141, v141
    v_mfma_f32_16x16x32_bf16 v[192:195], v[28:31], v[168:171], v[192:195]
    v_max3_f32 v11, v11, v153, v154
    s_waitcnt lgkmcnt(4)
    v_mfma_f32_32x32x16_bf16 v[32:47], v[240:243], v[172:175], v[32:47]
    v_max3_f32 v11, v11, v155, v156
    v_exp_f32 v142, v142
    v_exp_f32 v143, v143
    v_mfma_f32_32x32x16_bf16 v[48:63], v[244:247], v[172:175], v[48:63]
    s_waitcnt lgkmcnt(0)
    s_barrier
    ds_read_b128 v[208:211], v16 offset:0
    ds_read_b128 v[212:215], v17 offset:0
    ds_read_b128 v[216:219], v18 offset:0
    v_max3_f32 v11, v11, v157, v158
    v_mfma_f32_32x32x16_bf16 v[64:79], v[248:251], v[172:175], v[64:79]
    ds_read_b128 v[220:223], v19 offset:0
    v_max_f32 v11, v11, v159
    v_cvt_pk_bf16_f32 v164, v136, v137
    v_cvt_pk_bf16_f32 v165, v138, v139
    v_mfma_f32_32x32x16_bf16 v[80:95], v[252:255], v[172:175], v[80:95]
    ds_read_b128 v[224:227], v20 offset:0
    v_cmp_lt_f32 vcc, s46, v11
    v_cvt_pk_bf16_f32 v166, v140, v141
    v_cvt_pk_bf16_f32 v167, v142, v143
    v_mfma_f32_16x16x32_bf16 v[192:195], v[28:31], v[172:175], v[192:195]
    ds_read_b128 v[228:231], v21 offset:0
    s_cbranch_vccnz L_rare_28
L_back_28:
    s_waitcnt lgkmcnt(4)
    v_mfma_f32_32x32x16_bf16 v[128:143], v[208:211], v[96:99], v[176:191]
    ds_read_b128 v[232:235], v22 offset:0
    v_exp_f32 v144, v144
    v_exp_f32 v145, v145
    v_mfma_f32_32x32x16_bf16 v[128:143], v[212:215], v[100:103], v[128:143]
    ds_read_b128 v[236:239], v23 offset:0
    v_exp_f32 v146, v146
    v_exp_f32 v147, v147
    s_waitcnt lgkmcnt(4)
    v_mfma_f32_32x32x16_bf16 v[128:143], v[216:219], v[104:107], v[128:143]
    ds_read_b64_tr_b16 v[240:241], v204 offset:0
    ds_read_b64_tr_b16 v[242:243], v204 offset:2048
    v_exp_f32 v148, v148
    v_mfma_f32_32x32x16_bf16 v[128:143], v[220:223], v[108:111], v[128:143]
    ds_read_b64_tr_b16 v[244:245], v205 offset:0
    ds_read_b64_tr_b16 v[246:247], v205 offset:2048
    v_exp_f32 v149, v149
    s_waitcnt lgkmcnt(6)
    v_mfma_f32_32x32x16_bf16 v[128:143], v[224:227], v[112:115], v[128:143]
    ds_read_b64_tr_b16 v[248:249], v206 offset:0
    ds_read_b64_tr_b16 v[250:251], v206 offset:2048
    v_exp_f32 v150, v150
    v_mfma_f32_32x32x16_bf16 v[128:143], v[228:231], v[116:119], v[128:143]
    ds_read_b64_tr_b16 v[252:253], v207 offset:0
    ds_read_b64_tr_b16 v[254:255], v207 offset:2048
    v_exp_f32 v151, v151
    v_cvt_pk_bf16_f32 v168, v144, v145
    s_waitcnt lgkmcnt(8)
    v_mfma_f32_32x32x16_bf16 v[128:143], v[232:235], v[120:123], v[128:143]
    v_cvt_pk_bf16_f32 v169, v146, v147
    v_exp_f32 v152, v152
    v_mfma_f32_32x32x16_bf16 v[128:143], v[236:239], v[124:127], v[128:143]
    ds_read_b64_tr_b16 v[208:209], v204 offset:4096
    ds_read_b64_tr_b16 v[210:211], v204 offset:6144
    v_exp_f32 v153, v153
    s_waitcnt lgkmcnt(6)
    v_mfma_f32_32x32x16_bf16 v[32:47], v[240:243], v[160:163], v[32:47]
    ds_read_b64_tr_b16 v[212:213], v205 offset:4096
    ds_read_b64_tr_b16 v[214:215], v205 offset:6144
    v_exp_f32 v154, v154
    v_exp_f32 v155, v155
    v_mfma_f32_32x32x16_bf16 v[48:63], v[244:247], v[160:163], v[48:63]
    ds_read_b64_tr_b16 v[216:217], v206 offset:4096
    ds_read_b64_tr_b16 v[218:219], v206 offset:6144
    v_cvt_pk_bf16_f32 v170, v148, v149
    v_cvt_pk_bf16_f32 v171, v150, v151
    s_waitcnt lgkmcnt(6)
    v_mfma_f32_32x32x16_bf16 v[64:79], v[248:251], v[160:163], v[64:79]
    ds_read_b64_tr_b16 v[220:221], v207 offset:4096
    ds_read_b64_tr_b16 v[222:223], v207 offset:6144
    v_max3_f32 v11, v128, v129, v130
    v_max3_f32 v11, v11, v131, v132
    v_exp_f32 v156, v156
    v_mfma_f32_32x32x16_bf16 v[80:95], v[252:255], v[160:163], v[80:95]
    v_max3_f32 v11, v11, v133, v134
    v_max3_f32 v11, v11, v135, v136
    v_exp_f32 v157, v157
    v_mfma_f32_16x16x32_bf16 v[192:195], v[28:31], v[160:163], v[192:195]
    ds_read_b128 v[224:227], v16 offset:8192
    s_waitcnt lgkmcnt(5)
    v_mfma_f32_32x32x16_bf16 v[32:47], v[208:211], v[164:167], v[32:47]
    ds_read_b128 v[228:231], v17 offset:8192
    v_max3_f32 v11, v11, v137, v138
    v_max3_f32 v11, v11, v139, v140
    v_exp_f32 v158, v158
    v_mfma_f32_32x32x16_bf16 v[48:63], v[212:215], v[164:167], v[48:63]
    ds_read_b128 v[232:235], v18 offset:8192
    v_max3_f32 v11, v11, v141, v142
    v_exp_f32 v159, v159
    s_waitcnt lgkmcnt(5)
    v_mfma_f32_32x32x16_bf16 v[64:79], v[216:219], v[164:167], v[64:79]
    ds_read_b128 v[236:239], v19 offset:8192
    v_max_f32 v11, v11, v143
    v_cvt_pk_bf16_f32 v172, v152, v153
    v_cvt_pk_bf16_f32 v173, v154, v155
    s_waitcnt lgkmcnt(4)
    v_mfma_f32_32x32x16_bf16 v[80:95], v[220:223], v[164:167], v[80:95]
    ds_read_b128 v[240:243], v20 offset:8192
    v_cmp_lt_f32 vcc, s46, v11
    v_cvt_pk_bf16_f32 v174, v156, v157
    v_cvt_pk_bf16_f32 v175, v158, v159
    v_mfma_f32_16x16x32_bf16 v[192:195], v[28:31], v[164:167], v[192:195]
    ds_read_b128 v[244:247], v21 offset:8192
    s_cbranch_vccnz L_rare_29
L_back_29:
    s_waitcnt lgkmcnt(4)
    v_mfma_f32_32x32x16_bf16 v[144:159], v[224:227], v[96:99], v[176:191]
    ds_read_b128 v[248:251], v22 offset:8192
    v_exp_f32 v128, v128
    v_exp_f32 v129, v129
    v_mfma_f32_32x32x16_bf16 v[144:159], v[228:231], v[100:103], v[144:159]
    ds_read_b128 v[252:255], v23 offset:8192
    v_exp_f32 v130, v130
    v_exp_f32 v131, v131
    s_waitcnt lgkmcnt(4)
    v_mfma_f32_32x32x16_bf16 v[144:159], v[232:235], v[104:107], v[144:159]
    ds_read_b64_tr_b16 v[208:209], v204 offset:8192
    ds_read_b64_tr_b16 v[210:211], v204 offset:10240
    v_exp_f32 v132, v132
    v_mfma_f32_32x32x16_bf16 v[144:159], v[236:239], v[108:111], v[144:159]
    ds_read_b64_tr_b16 v[212:213], v205 offset:8192
    ds_read_b64_tr_b16 v[214:215], v205 offset:10240
    v_exp_f32 v133, v133
    s_waitcnt lgkmcnt(6)
    v_mfma_f32_32x32x16_bf16 v[144:159], v[240:243], v[112:115], v[144:159]
    ds_read_b64_tr_b16 v[216:217], v206 offset:8192
    ds_read_b64_tr_b16 v[218:219], v206 offset:10240
    v_exp_f32 v134, v134
    v_exp_f32 v135, v135
    v_mfma_f32_32x32x16_bf16 v[144:159], v[244:247], v[116:119], v[144:159]
    ds_read_b64_tr_b16 v[220:221], v207 offset:8192
    ds_read_b64_tr_b16 v[222:223], v207 offset:10240
    v_cvt_pk_bf16_f32 v160, v128, v129
    v_cvt_pk_bf16_f32 v161, v130, v131
    s_waitcnt lgkmcnt(8)
    v_mfma_f32_32x32x16_bf16 v[144:159], v[248:251], v[120:123], v[144:159]
    v_exp_f32 v136, v136
    v_exp_f32 v137, v137
    v_mfma_f32_32x32x16_bf16 v[144:159], v[252:255], v[124:127], v[144:159]
    ds_read_b64_tr_b16 v[224:225], v204 offset:12288
    ds_read_b64_tr_b16 v[226:227], v204 offset:14336
    v_exp_f32 v138, v138
    s_waitcnt lgkmcnt(6)
    v_mfma_f32_32x32x16_bf16 v[32:47], v[208:211], v[168:171], v[32:47]
    ds_read_b64_tr_b16 v[228:229], v205 offset:12288
    ds_read_b64_tr_b16 v[230:231], v205 offset:14336
    v_exp_f32 v139, v139
    v_cvt_pk_bf16_f32 v162, v132, v133
    v_mfma_f32_32x32x16_bf16 v[48:63], v[212:215], v[168:171], v[48:63]
    ds_read_b64_tr_b16 v[232:233], v206 offset:12288
    ds_read_b64_tr_b16 v[234:235], v206 offset:14336
    v_cvt_pk_bf16_f32 v163, v134, v135
    v_exp_f32 v140, v140
    s_waitcnt lgkmcnt(6)
    v_mfma_f32_32x32x16_bf16 v[64:79], v[216:219], v[168:171], v[64:79]
    ds_read_b64_tr_b16 v[236:237], v207 offset:12288
    ds_read_b64_tr_b16 v[238:239], v207 offset:14336
    v_max3_f32 v11, v144, v145, v146
    v_max3_f32 v11, v11, v147, v148
    v_mfma_f32_32x32x16_bf16 v[80:95], v[220:223], v[168:171], v[80:95]
    v_max3_f32 v11, v11, v149, v150
    v_max3_f32 v11, v11, v151, v152
    v_max3_f32 v11, v11, v153, v154
    v_exp_f32 v141, v141
    v_mfma_f32_16x16x32_bf16 v[192:195], v[28:31], v[168:171], v[192:195]
    s_waitcnt lgkmcnt(4)
    v_mfma_f32_32x32x16_bf16 v[32:47], v[224:227], v[172:175], v[32:47]
    v_max3_f32 v11, v11, v155, v156
    v_max3_f32 v11, v11, v157, v158
    v_exp_f32 v142, v142
    v_exp_f32 v143, v143
    v_mfma_f32_32x32x16_bf16 v[48:63], v[228:231], v[172:175], v[48:63]
    s_waitcnt lgkmcnt(0)
    s_barrier
    ds_read_b64_tr_b16 v[240:241], v24 offset:0
    ds_read_b64_tr_b16 v[242:243], v24 offset:2048
    ds_read_b64_tr_b16 v[244:245], v25 offset:0
    ds_read_b64_tr_b16 v[246:247], v25 offset:2048
    v_mfma_f32_32x32x16_bf16 v[64:79], v[232:235], v[172:175], v[64:79]
    ds_read_b64_tr_b16 v[248:249], v26 offset:0
    ds_read_b64_tr_b16 v[250:251], v26 offset:2048
    ds_read_b64_tr_b16 v[252:253], v27 offset:0
    ds_read_b64_tr_b16 v[254:255], v27 offset:2048
    v_max_f32 v11, v11, v159
    v_cvt_pk_bf16_f32 v164, v136, v137
    v_mfma_f32_32x32x16_bf16 v[80:95], v[236:239], v[172:175], v[80:95]
    v_cmp_lt_f32 vcc, s46, v11
    v_cvt_pk_bf16_f32 v165, v138, v139
    v_cvt_pk_bf16_f32 v166, v140, v141
    v_cvt_pk_bf16_f32 v167, v142, v143
    v_mfma_f32_16x16x32_bf16 v[192:195], v[28:31], v[172:175], v[192:195]
    ds_read_b64_tr_b16 v[208:209], v24 offset:4096
    ds_read_b64_tr_b16 v[210:211], v24 offset:6144
    s_cbranch_vccnz L_rare_30
L_back_30:
    s_waitcnt lgkmcnt(6)
    v_mfma_f32_32x32x16_bf16 v[32:47], v[240:243], v[160:163], v[32:47]
    ds_read_b64_tr_b16 v[212:213], v25 offset:4096
    ds_read_b64_tr_b16 v[214:215], v25 offset:6144
    v_exp_f32 v144, v144
    v_exp_f32 v145, v145
    v_mfma_f32_32x32x16_bf16 v[48:63], v[244:247], v[160:163], v[48:63]
    ds_read_b64_tr_b16 v[216:217], v26 offset:4096
    ds_read_b64_tr_b16 v[218:219], v26 offset:6144
    v_exp_f32 v146, v146
    s_waitcnt lgkmcnt(6)
    v_mfma_f32_32x32x16_bf16 v[64:79], v[248:251], v[160:163], v[64:79]
    ds_read_b64_tr_b16 v[220:221], v27 offset:4096
    ds_read_b64_tr_b16 v[222:223], v27 offset:6144
    v_exp_f32 v147, v147
    v_exp_f32 v148, v148
    v_mfma_f32_32x32x16_bf16 v[80:95], v[252:255], v[160:163], v[80:95]
    v_exp_f32 v149, v149
    v_exp_f32 v150, v150
    v_exp_f32 v151, v151
    v_cvt_pk_bf16_f32 v168, v144, v145
    v_mfma_f32_16x16x32_bf16 v[192:195], v[28:31], v[160:163], v[192:195]
    s_mov_b64 exec, 7
    buffer_load_dword v5, v4, s[36:39], s52 offen sc1
    s_mov_b64 exec, -1
    s_waitcnt lgkmcnt(4)
    v_mfma_f32_32x32x16_bf16 v[32:47], v[208:211], v[164:167], v[32:47]
    v_cvt_pk_bf16_f32 v169, v146, v147
    v_exp_f32 v152, v152
    v_exp_f32 v153, v153
    v_exp_f32 v154, v154
    v_mfma_f32_32x32x16_bf16 v[48:63], v[212:215], v[164:167], v[48:63]
    ds_read_b64_tr_b16 v[224:225], v24 offset:8192
    ds_read_b64_tr_b16 v[226:227], v24 offset:10240
    v_exp_f32 v155, v155
    v_cvt_pk_bf16_f32 v170, v148, v149
    v_cvt_pk_bf16_f32 v171, v150, v151
    s_waitcnt lgkmcnt(4)
    v_mfma_f32_32x32x16_bf16 v[64:79], v[216:219], v[164:167], v[64:79]
    ds_read_b64_tr_b16 v[228:229], v24 offset:12288
    ds_read_b64_tr_b16 v[230:231], v24 offset:14336
    v_exp_f32 v156, v156
    v_exp_f32 v157, v157
    s_waitcnt lgkmcnt(4)
    v_mfma_f32_32x32x16_bf16 v[80:95], v[220:223], v[164:167], v[80:95]
    ds_read_b64_tr_b16 v[232:233], v25 offset:8192
    ds_read_b64_tr_b16 v[234:235], v25 offset:10240
    v_exp_f32 v158, v158
    v_exp_f32 v159, v159
    v_cvt_pk_bf16_f32 v172, v152, v153
    v_cvt_pk_bf16_f32 v173, v154, v155
    v_cvt_pk_bf16_f32 v174, v156, v157
    v_cvt_pk_bf16_f32 v175, v158, v159
    v_mfma_f32_16x16x32_bf16 v[192:195], v[28:31], v[164:167], v[192:195]
    ds_read_b64_tr_b16 v[236:237], v25 offset:12288
    ds_read_b64_tr_b16 v[238:239], v25 offset:14336
    v_mfma_f32_16x16x32_bf16 v[192:195], v[28:31], v[168:171], v[192:195]
    ds_read_b64_tr_b16 v[240:241], v26 offset:8192
    ds_read_b64_tr_b16 v[242:243], v26 offset:10240
    v_mfma_f32_16x16x32_bf16 v[192:195], v[28:31], v[172:175], v[192:195]
    ds_read_b64_tr_b16 v[244:245], v26 offset:12288
    ds_read_b64_tr_b16 v[246:247], v26 offset:14336
    s_waitcnt lgkmcnt(8)
    v_mfma_f32_32x32x16_bf16 v[32:47], v[224:227], v[168:171], v[32:47]
    ds_read_b64_tr_b16 v[248:249], v27 offset:8192
    ds_read_b64_tr_b16 v[250:251], v27 offset:10240
    v_mfma_f32_32x32x16_bf16 v[32:47], v[228:231], v[172:175], v[32:47]
    ds_read_b64_tr_b16 v[252:253], v27 offset:12288
    ds_read_b64_tr_b16 v[254:255], v27 offset:14336
    s_waitcnt lgkmcnt(8)
    v_mfma_f32_32x32x16_bf16 v[48:63], v[232:235], v[168:171], v[48:63]
    v_mfma_f32_32x32x16_bf16 v[48:63], v[236:239], v[172:175], v[48:63]
    v_rcp_f32 v11, v192
    s_mov_b32 s55, 7
    s_mov_b32 s57, 0
    s_mov_b32 s79, 0xd0e06
    s_waitcnt lgkmcnt(4)
    v_mfma_f32_32x32x16_bf16 v[64:79], v[240:243], v[168:171], v[64:79]
    s_waitcnt lgkmcnt(0)
    s_barrier
    v_add_u32 v24, 0xffff0000, v24
    v_add_u32 v25, 0xffff0000, v25
    v_add_u32 v26, 0xffff0000, v26
    v_add_u32 v27, 0xffff0000, v27
    ds_read_b64_tr_b16 v[208:209], v24 offset:0
    ds_read_b64_tr_b16 v[210:211], v24 offset:2048
    ds_read_b64_tr_b16 v[212:213], v25 offset:0
    ds_read_b64_tr_b16 v[214:215], v25 offset:2048
    v_mfma_f32_32x32x16_bf16 v[64:79], v[244:247], v[172:175], v[64:79]
    ds_read_b64_tr_b16 v[216:217], v26 offset:0
    ds_read_b64_tr_b16 v[218:219], v26 offset:2048
    ds_read_b64_tr_b16 v[220:221], v27 offset:0
    ds_read_b64_tr_b16 v[222:223], v27 offset:2048
    v_mul_f32 v32, v32, v11
    v_mul_f32 v33, v33, v11
    v_mul_f32 v34, v34, v11
    v_mul_f32 v35, v35, v11
    v_mul_f32 v36, v36, v11
    v_mul_f32 v37, v37, v11
    v_mul_f32 v38, v38, v11
    v_mul_f32 v39, v39, v11
    v_cvt_pk_bf16_f32 v96, v32, v33
    v_cvt_pk_bf16_f32 v97, v34, v35
    v_cvt_pk_bf16_f32 v98, v36, v37
    v_cvt_pk_bf16_f32 v99, v38, v39
    v_mfma_f32_32x32x16_bf16 v[80:95], v[248:251], v[168:171], v[80:95]
    v_add_u32 v3, 0x18000, v3
    ds_read_b64_tr_b16 v[224:225], v3 offset:0
    ds_read_b64_tr_b16 v[226:227], v3 offset:512
    buffer_store_dwordx4 v[96:99], v10, s[36:39], s47 offen offset:0 sc1
    v_mul_f32 v40, v40, v11
    v_mul_f32 v41, v41, v11
    v_mul_f32 v42, v42, v11
    v_mul_f32 v43, v43, v11
    v_mul_f32 v44, v44, v11
    v_mul_f32 v45, v45, v11
    v_mul_f32 v46, v46, v11
    v_mul_f32 v47, v47, v11
    v_cvt_pk_bf16_f32 v100, v40, v41
    v_cvt_pk_bf16_f32 v101, v42, v43
    v_cvt_pk_bf16_f32 v102, v44, v45
    v_mfma_f32_32x32x16_bf16 v[80:95], v[252:255], v[172:175], v[80:95]
    ds_read_b64_tr_b16 v[228:229], v24 offset:4096
    ds_read_b64_tr_b16 v[230:231], v24 offset:6144
    v_cvt_pk_bf16_f32 v103, v46, v47
    buffer_store_dwordx4 v[100:103], v10, s[36:39], s47 offen offset:1024 sc1
    v_mul_f32 v48, v48, v11
    v_mul_f32 v49, v49, v11
    v_mul_f32 v50, v50, v11
    v_mul_f32 v51, v51, v11
    v_mul_f32 v52, v52, v11
    v_mul_f32 v53, v53, v11
    v_mul_f32 v54, v54, v11
    v_mul_f32 v55, v55, v11
    v_cvt_pk_bf16_f32 v104, v48, v49
    v_cvt_pk_bf16_f32 v105, v50, v51
    s_waitcnt lgkmcnt(8)
    v_mfma_f32_32x32x16_bf16 v[128:143], v[208:211], v[96:99], 0
    ds_read_b64_tr_b16 v[232:233], v25 offset:4096
    ds_read_b64_tr_b16 v[234:235], v25 offset:6144
    v_cvt_pk_bf16_f32 v106, v52, v53
    v_cvt_pk_bf16_f32 v107, v54, v55
    buffer_store_dwordx4 v[104:107], v10, s[36:39], s47 offen offset:2048 sc1
    v_mul_f32 v56, v56, v11
    v_mul_f32 v57, v57, v11
    v_mul_f32 v58, v58, v11
    v_mul_f32 v59, v59, v11
    v_mul_f32 v60, v60, v11
    v_mul_f32 v61, v61, v11
    v_mul_f32 v62, v62, v11
    v_mul_f32 v63, v63, v11
    v_cvt_pk_bf16_f32 v108, v56, v57
    v_mfma_f32_32x32x16_bf16 v[144:159], v[212:215], v[96:99], 0
    ds_read_b64_tr_b16 v[236:237], v26 offset:4096
    ds_read_b64_tr_b16 v[238:239], v26 offset:6144
    v_cvt_pk_bf16_f32 v109, v58, v59
    v_cvt_pk_bf16_f32 v110, v60, v61
    v_cvt_pk_bf16_f32 v111, v62, v63
    buffer_store_dwordx4 v[108:111], v10, s[36:39], s47 offen offset:3072 sc1
    v_mul_f32 v64, v64, v11
    v_mul_f32 v65, v65, v11
    v_mul_f32 v66, v66, v11
    v_mul_f32 v67, v67, v11
    v_mul_f32 v68, v68, v11
    v_mul_f32 v69, v69, v11
    v_mul_f32 v70, v70, v11
    v_mul_f32 v71, v71, v11
    s_waitcnt lgkmcnt(8)
    v_mfma_f32_32x32x16_bf16 v[160:175], v[216:219], v[96:99], 0
    ds_read_b64_tr_b16 v[240:241], v27 offset:4096
    ds_read_b64_tr_b16 v[242:243], v27 offset:6144
    v_cvt_pk_bf16_f32 v112, v64, v65
    v_cvt_pk_bf16_f32 v113, v66, v67
    v_cvt_pk_bf16_f32 v114, v68, v69
    v_cvt_pk_bf16_f32 v115, v70, v71
    buffer_store_dwordx4 v[112:115], v0, s[36:39], s47 offen offset:0 sc1
    v_mul_f32 v72, v72, v11
    v_mul_f32 v73, v73, v11
    v_mul_f32 v74, v74, v11
    v_mul_f32 v75, v75, v11
    v_mul_f32 v76, v76, v11
    v_mul_f32 v77, v77, v11
    v_mul_f32 v78, v78, v11
    v_mfma_f32_32x32x16_bf16 v[176:191], v[220:223], v[96:99], 0
    ds_read_b64_tr_b16 v[244:245], v3 offset:1024
    ds_read_b64_tr_b16 v[246:247], v3 offset:1536
    v_mul_f32 v79, v79, v11
    v_cvt_pk_bf16_f32 v116, v72, v73
    v_cvt_pk_bf16_f32 v117, v74, v75
    v_cvt_pk_bf16_f32 v118, v76, v77
    v_cvt_pk_bf16_f32 v119, v78, v79
    buffer_store_dwordx4 v[116:119], v0, s[36:39], s47 offen offset:1024 sc1
    v_mul_f32 v80, v80, v11
    v_mul_f32 v81, v81, v11
    v_mul_f32 v82, v82, v11
    v_mul_f32 v83, v83, v11
    v_mul_f32 v84, v84, v11
    v_mul_f32 v85, v85, v11
    s_waitcnt lgkmcnt(8)
    v_mfma_f32_32x32x16_bf16 v[192:207], v[224:227], v[96:99], 0
    ds_read_b64_tr_b16 v[248:249], v24 offset:8192
    ds_read_b64_tr_b16 v[250:251], v24 offset:10240
    v_mul_f32 v86, v86, v11
    v_mul_f32 v87, v87, v11
    v_cvt_pk_bf16_f32 v120, v80, v81
    v_cvt_pk_bf16_f32 v121, v82, v83
    v_cvt_pk_bf16_f32 v122, v84, v85
    v_cvt_pk_bf16_f32 v123, v86, v87
    buffer_store_dwordx4 v[120:123], v0, s[36:39], s47 offen offset:2048 sc1
    v_mul_f32 v88, v88, v11
    v_mul_f32 v89, v89, v11
    v_mul_f32 v90, v90, v11
    v_mul_f32 v91, v91, v11
    v_mul_f32 v92, v92, v11
    v_mfma_f32_32x32x16_bf16 v[128:143], v[228:231], v[100:103], v[128:143]
    ds_read_b64_tr_b16 v[252:253], v25 offset:8192
    ds_read_b64_tr_b16 v[254:255], v25 offset:10240
    v_mul_f32 v93, v93, v11
    v_mul_f32 v94, v94, v11
    v_mul_f32 v95, v95, v11
    v_cvt_pk_bf16_f32 v124, v88, v89
    v_cvt_pk_bf16_f32 v125, v90, v91
    v_cvt_pk_bf16_f32 v126, v92, v93
    v_cvt_pk_bf16_f32 v127, v94, v95
    buffer_store_dwordx4 v[124:127], v0, s[36:39], s47 offen offset:3072 sc1
    s_mov_b32 s85, 0
    s_waitcnt vmcnt(8)
    v_cmp_eq_u32 vcc, 1, v5
    s_nop 0
    s_and_b32 s56, vcc_lo, s55
    s_cbranch_scc0 L_noearly
    s_ff1_i32_b32 s59, s56
    s_cmp_eq_u32 s59, 1
    s_cselect_b32 s80, s77, s76
    s_cselect_b32 s81, 0x1008, s79
    s_cmp_eq_u32 s59, 2
    s_cselect_b32 s80, s78, s80
    s_cselect_b32 s81, 0x10a12, s81
    buffer_load_dwordx4 v[32:35], v10, s[36:39], s80 offen offset:0 sc1
    buffer_load_dwordx4 v[36:39], v10, s[36:39], s80 offen offset:1024 sc1
    buffer_load_dwordx4 v[40:43], v10, s[36:39], s80 offen offset:2048 sc1
    buffer_load_dwordx4 v[44:47], v10, s[36:39], s80 offen offset:3072 sc1
    buffer_load_dwordx4 v[48:51], v0, s[36:39], s80 offen offset:0 sc1
    buffer_load_dwordx4 v[52:55], v0, s[36:39], s80 offen offset:1024 sc1
    buffer_load_dwordx4 v[56:59], v0, s[36:39], s80 offen offset:2048 sc1
    buffer_load_dwordx4 v[60:63], v0, s[36:39], s80 offen offset:3072 sc1
    s_lshl_b32 s58, 1, s59
    s_andn2_b32 s55, s55, s58
    s_andn2_b32 s56, s56, s58
    s_bfe_u32 s82, s81, 0x80000
    s_bfe_u32 s83, s81, 0x80008
    s_bfe_u32 s84, s81, 0x80010
    s_lshl_b32 s82, s82, 13
    s_lshl_b32 s83, s83, 13
    s_lshl_b32 s84, s84, 13
    s_mov_b32 s85, 1
L_noearly:
    s_waitcnt lgkmcnt(8)
    v_mfma_f32_32x32x16_bf16 v[144:159], v[232:235], v[100:103], v[144:159]
    ds_read_b64_tr_b16 v[208:209], v26 offset:8192
    ds_read_b64_tr_b16 v[210:211], v26 offset:10240
    v_mfma_f32_32x32x16_bf16 v[160:175], v[236:239], v[100:103], v[160:175]
    ds_read_b64_tr_b16 v[212:213], v27 offset:8192
    ds_read_b64_tr_b16 v[214:215], v27 offset:10240
    s_waitcnt lgkmcnt(8)
    v_mfma_f32_32x32x16_bf16 v[176:191], v[240:243], v[100:103], v[176:191]
    ds_read_b64_tr_b16 v[216:217], v3 offset:2048
    ds_read_b64_tr_b16 v[218:219], v3 offset:2560
    v_mfma_f32_32x32x16_bf16 v[192:207], v[244:247], v[100:103], v[192:207]
    ds_read_b64_tr_b16 v[220:221], v24 offset:12288
    ds_read_b64_tr_b16 v[222:223], v24 offset:14336
    s_waitcnt lgkmcnt(8)
    v_mfma_f32_32x32x16_bf16 v[128:143], v[248:251], v[104:107], v[128:143]
    ds_read_b64_tr_b16 v[224:225], v25 offset:12288
    ds_read_b64_tr_b16 v[226:227], v25 offset:14336
    v_mfma_f32_32x32x16_bf16 v[144:159], v[252:255], v[104:107], v[144:159]
    ds_read_b64_tr_b16 v[228:229], v26 offset:12288
    ds_read_b64_tr_b16 v[230:231], v26 offset:14336
    s_waitcnt lgkmcnt(8)
    v_mfma_f32_32x32x16_bf16 v[160:175], v[208:211], v[104:107], v[160:175]
    ds_read_b64_tr_b16 v[232:233], v27 offset:12288
    ds_read_b64_tr_b16 v[234:235], v27 offset:14336
    v_mfma_f32_32x32x16_bf16 v[176:191], v[212:215], v[104:107], v[176:191]
    ds_read_b64_tr_b16 v[236:237], v3 offset:3072
    ds_read_b64_tr_b16 v[238:239], v3 offset:3584
    s_waitcnt lgkmcnt(8)
    v_mfma_f32_32x32x16_bf16 v[192:207], v[216:219], v[104:107], v[192:207]
    ds_read_b64_tr_b16 v[240:241], v24 offset:16384
    ds_read_b64_tr_b16 v[242:243], v24 offset:18432
    v_mfma_f32_32x32x16_bf16 v[128:143], v[220:223], v[108:111], v[128:143]
    ds_read_b64_tr_b16 v[244:245], v25 offset:16384
    ds_read_b64_tr_b16 v[246:247], v25 offset:18432
    s_waitcnt lgkmcnt(8)
    v_mfma_f32_32x32x16_bf16 v[144:159], v[224:227], v[108:111], v[144:159]
    ds_read_b64_tr_b16 v[248:249], v26 offset:16384
    ds_read_b64_tr_b16 v[250:251], v26 offset:18432
    v_mfma_f32_32x32x16_bf16 v[160:175], v[228:231], v[108:111], v[160:175]
    ds_read_b64_tr_b16 v[252:253], v27 offset:16384
    ds_read_b64_tr_b16 v[254:255], v27 offset:18432
    s_waitcnt lgkmcnt(8)
    v_mfma_f32_32x32x16_bf16 v[176:191], v[232:235], v[108:111], v[176:191]
    ds_read_b64_tr_b16 v[208:209], v3 offset:4096
    ds_read_b64_tr_b16 v[210:211], v3 offset:4608
    v_mfma_f32_32x32x16_bf16 v[192:207], v[236:239], v[108:111], v[192:207]
    ds_read_b64_tr_b16 v[212:213], v24 offset:20480
    ds_read_b64_tr_b16 v[214:215], v24 offset:22528
    s_waitcnt lgkmcnt(8)
    v_mfma_f32_32x32x16_bf16 v[128:143], v[240:243], v[112:115], v[128:143]
    ds_read_b64_tr_b16 v[216:217], v25 offset:20480
    ds_read_b64_tr_b16 v[218:219], v25 offset:22528
    v_mfma_f32_32x32x16_bf16 v[144:159], v[244:247], v[112:115], v[144:159]
    ds_read_b64_tr_b16 v[220:221], v26 offset:20480
    ds_read_b64_tr_b16 v[222:223], v26 offset:22528
    s_cmp_eq_u32 s85, 1
    s_cbranch_scc1 L_nopoll1
    s_mov_b64 exec, 7
    buffer_load_dword v5, v4, s[36:39], s52 offen sc1
    s_mov_b64 exec, -1
L_nopoll1:
    s_barrier
    s_waitcnt lgkmcnt(8)
    v_mfma_f32_32x32x16_bf16 v[160:175], v[248:251], v[112:115], v[160:175]
    ds_read_b64_tr_b16 v[224:225], v27 offset:20480
    ds_read_b64_tr_b16 v[226:227], v27 offset:22528
    s_cmp_eq_u32 s85, 1
    s_cbranch_scc0 L_late1
    s_waitcnt vmcnt(8)
    s_mov_b64 exec, 1
    buffer_store_dword v6, v7, s[36:39], s53 offen sc1
    s_mov_b64 exec, -1
    s_branch L_done1
L_late1:
    s_waitcnt vmcnt(1)
    s_mov_b64 exec, 1
    buffer_store_dword v6, v7, s[36:39], s53 offen sc1
    s_mov_b64 exec, -1
    s_mov_b64 exec, 7
    buffer_load_dword v12, v4, s[36:39], s52 offen sc1
    s_waitcnt vmcnt(2)
    v_cmp_eq_u32 vcc, 1, v5
    s_add_u32 s57, s57, 1
    s_and_b32 s56, vcc_lo, s55
    s_cbranch_scc1 L_got1
    buffer_load_dword v13, v4, s[36:39], s52 offen sc1
    s_sleep 2
    buffer_load_dword v14, v4, s[36:39], s52 offen sc1
    s_sleep 2
L_spin1:
    s_waitcnt vmcnt(2)
    v_cmp_eq_u32 vcc, 1, v12
    s_add_u32 s57, s57, 1
    s_and_b32 s56, vcc_lo, s55
    s_cbranch_scc1 L_got1
    buffer_load_dword v12, v4, s[36:39], s52 offen sc1
    s_sleep 2
    s_waitcnt vmcnt(2)
    v_cmp_eq_u32 vcc, 1, v13
    s_add_u32 s57, s57, 1
    s_and_b32 s56, vcc_lo, s55
    s_cbranch_scc1 L_got1
    buffer_load_dword v13, v4, s[36:39], s52 offen sc1
    s_sleep 2
    s_waitcnt vmcnt(2)
    v_cmp_eq_u32 vcc, 1, v14
    s_add_u32 s57, s57, 1
    s_and_b32 s56, vcc_lo, s55
    s_cbranch_scc1 L_got1
    buffer_load_dword v14, v4, s[36:39], s52 offen sc1
    s_sleep 2
    s_cmp_lt_u32 s57, 0x40000
    s_cbranch_scc1 L_spin1
    s_mov_b32 s56, s55
L_got1:
    s_mov_b64 exec, -1
L_have1:
    s_ff1_i32_b32 s59, s56
    s_cmp_eq_u32 s59, 1
    s_cselect_b32 s80, s77, s76
    s_cselect_b32 s81, 0x1008, s79
    s_cmp_eq_u32 s59, 2
    s_cselect_b32 s80, s78, s80
    s_cselect_b32 s81, 0x10a12, s81
    buffer_load_dwordx4 v[32:35], v10, s[36:39], s80 offen offset:0 sc1
    buffer_load_dwordx4 v[36:39], v10, s[36:39], s80 offen offset:1024 sc1
    buffer_load_dwordx4 v[40:43], v10, s[36:39], s80 offen offset:2048 sc1
    buffer_load_dwordx4 v[44:47], v10, s[36:39], s80 offen offset:3072 sc1
    buffer_load_dwordx4 v[48:51], v0, s[36:39], s80 offen offset:0 sc1
    buffer_load_dwordx4 v[52:55], v0, s[36:39], s80 offen offset:1024 sc1
    buffer_load_dwordx4 v[56:59], v0, s[36:39], s80 offen offset:2048 sc1
    buffer_load_dwordx4 v[60:63], v0, s[36:39], s80 offen offset:3072 sc1
    s_lshl_b32 s58, 1, s59
    s_andn2_b32 s55, s55, s58
    s_andn2_b32 s56, s56, s58
    s_bfe_u32 s82, s81, 0x80000
    s_bfe_u32 s83, s81, 0x80008
    s_bfe_u32 s84, s81, 0x80010
    s_lshl_b32 s82, s82, 13
    s_lshl_b32 s83, s83, 13
    s_lshl_b32 s84, s84, 13
L_done1:
    v_mfma_f32_32x32x16_bf16 v[176:191], v[252:255], v[112:115], v[176:191]
    ds_read_b64_tr_b16 v[228:229], v3 offset:5120
    ds_read_b64_tr_b16 v[230:231], v3 offset:5632
    s_waitcnt lgkmcnt(8)
    v_mfma_f32_32x32x16_bf16 v[192:207], v[208:211], v[112:115], v[192:207]
    ds_read_b64_tr_b16 v[232:233], v24 offset:24576
    ds_read_b64_tr_b16 v[234:235], v24 offset:26624
    v_mfma_f32_32x32x16_bf16 v[128:143], v[212:215], v[116:119], v[128:143]
    ds_read_b64_tr_b16 v[236:237], v25 offset:24576
    ds_read_b64_tr_b16 v[238:239], v25 offset:26624
    s_waitcnt lgkmcnt(8)
    v_mfma_f32_32x32x16_bf16 v[144:159], v[216:219], v[116:119], v[144:159]
    ds_read_b64_tr_b16 v[240:241], v26 offset:24576
    ds_read_b64_tr_b16 v[242:243], v26 offset:26624
    v_mfma_f32_32x32x16_bf16 v[160:175], v[220:223], v[116:119], v[160:175]
    ds_read_b64_tr_b16 v[244:245], v27 offset:24576
    ds_read_b64_tr_b16 v[246:247], v27 offset:26624
    s_waitcnt lgkmcnt(8)
    v_mfma_f32_32x32x16_bf16 v[176:191], v[224:227], v[116:119], v[176:191]
    ds_read_b64_tr_b16 v[248:249], v3 offset:6144
    ds_read_b64_tr_b16 v[250:251], v3 offset:6656
    v_mfma_f32_32x32x16_bf16 v[192:207], v[228:231], v[116:119], v[192:207]
    ds_read_b64_tr_b16 v[252:253], v24 offset:28672
    ds_read_b64_tr_b16 v[254:255], v24 offset:30720
    s_waitcnt lgkmcnt(8)
    v_mfma_f32_32x32x16_bf16 v[128:143], v[232:235], v[120:123], v[128:143]
    ds_read_b64_tr_b16 v[208:209], v25 offset:28672
    ds_read_b64_tr_b16 v[210:211], v25 offset:30720
    v_mfma_f32_32x32x16_bf16 v[144:159], v[236:239], v[120:123], v[144:159]
    ds_read_b64_tr_b16 v[212:213], v26 offset:28672
    ds_read_b64_tr_b16 v[214:215], v26 offset:30720
    s_waitcnt lgkmcnt(8)
    v_mfma_f32_32x32x16_bf16 v[160:175], v[240:243], v[120:123], v[160:175]
    ds_read_b64_tr_b16 v[216:217], v27 offset:28672
    ds_read_b64_tr_b16 v[218:219], v27 offset:30720
    s_mov_b64 exec, 7
    buffer_load_dword v5, v4, s[36:39], s52 offen sc1
    s_mov_b64 exec, -1
    v_mfma_f32_32x32x16_bf16 v[176:191], v[244:247], v[120:123], v[176:191]
    ds_read_b64_tr_b16 v[220:221], v3 offset:7168
    ds_read_b64_tr_b16 v[222:223], v3 offset:7680
    s_waitcnt lgkmcnt(8)
    v_mfma_f32_32x32x16_bf16 v[192:207], v[248:251], v[120:123], v[192:207]
    v_add_u32 v24, s82, v8
    v_add_u32 v16, s83, v8
    v_xor_b32 v25, 64, v24
    v_xor_b32 v17, 64, v16
    v_xor_b32 v26, 128, v24
    v_xor_b32 v18, 128, v16
    v_xor_b32 v27, 192, v24
    v_xor_b32 v19, 192, v16
    ds_read_b64_tr_b16 v[224:225], v24 offset:0
    ds_read_b64_tr_b16 v[226:227], v24 offset:2048
    v_mfma_f32_32x32x16_bf16 v[128:143], v[252:255], v[124:127], v[128:143]
    ds_read_b64_tr_b16 v[228:229], v25 offset:0
    ds_read_b64_tr_b16 v[230:231], v25 offset:2048
    s_waitcnt lgkmcnt(8)
    v_mfma_f32_32x32x16_bf16 v[144:159], v[208:211], v[124:127], v[144:159]
    ds_read_b64_tr_b16 v[232:233], v24 offset:4096
    ds_read_b64_tr_b16 v[234:235], v24 offset:6144
    v_mfma_f32_32x32x16_bf16 v[160:175], v[212:215], v[124:127], v[160:175]
    ds_read_b64_tr_b16 v[236:237], v25 offset:4096
    ds_read_b64_tr_b16 v[238:239], v25 offset:6144
    s_waitcnt lgkmcnt(8)
    v_mfma_f32_32x32x16_bf16 v[176:191], v[216:219], v[124:127], v[176:191]
    ds_read_b64_tr_b16 v[240:241], v24 offset:8192
    ds_read_b64_tr_b16 v[242:243], v24 offset:10240
    v_mfma_f32_32x32x16_bf16 v[192:207], v[220:223], v[124:127], v[192:207]
    ds_read_b64_tr_b16 v[244:245], v25 offset:8192
    ds_read_b64_tr_b16 v[246:247], v25 offset:10240
    s_waitcnt lgkmcnt(8)
    s_waitcnt vmcnt(8)
    v_mfma_f32_32x32x16_bf16 v[128:143], v[224:227], v[32:35], v[128:143]
    ds_read_b64_tr_b16 v[248:249], v24 offset:12288
    ds_read_b64_tr_b16 v[250:251], v24 offset:14336
    v_mfma_f32_32x32x16_bf16 v[144:159], v[228:231], v[32:35], v[144:159]
    ds_read_b64_tr_b16 v[252:253], v25 offset:12288
    ds_read_b64_tr_b16 v[254:255], v25 offset:14336
    s_waitcnt lgkmcnt(8)
    s_waitcnt vmcnt(7)
    v_mfma_f32_32x32x16_bf16 v[128:143], v[232:235], v[36:39], v[128:143]
    v_add_u32 v3, s84, v9
    ds_read_b64_tr_b16 v[208:209], v16 offset:0
    ds_read_b64_tr_b16 v[210:211], v16 offset:2048
    v_mfma_f32_32x32x16_bf16 v[144:159], v[236:239], v[36:39], v[144:159]
    ds_read_b64_tr_b16 v[212:213], v17 offset:0
    ds_read_b64_tr_b16 v[214:215], v17 offset:2048
    s_waitcnt lgkmcnt(8)
    s_waitcnt vmcnt(6)
    v_mfma_f32_32x32x16_bf16 v[128:143], v[240:243], v[40:43], v[128:143]
    ds_read_b64_tr_b16 v[216:217], v16 offset:4096
    ds_read_b64_tr_b16 v[218:219], v16 offset:6144
    v_mfma_f32_32x32x16_bf16 v[144:159], v[244:247], v[40:43], v[144:159]
    ds_read_b64_tr_b16 v[220:221], v17 offset:4096
    ds_read_b64_tr_b16 v[222:223], v17 offset:6144
    s_waitcnt lgkmcnt(8)
    s_waitcnt vmcnt(5)
    v_mfma_f32_32x32x16_bf16 v[128:143], v[248:251], v[44:47], v[128:143]
    ds_read_b64_tr_b16 v[224:225], v16 offset:8192
    ds_read_b64_tr_b16 v[226:227], v16 offset:10240
    v_mfma_f32_32x32x16_bf16 v[144:159], v[252:255], v[44:47], v[144:159]
    ds_read_b64_tr_b16 v[228:229], v17 offset:8192
    ds_read_b64_tr_b16 v[230:231], v17 offset:10240
    s_waitcnt lgkmcnt(8)
    s_waitcnt vmcnt(4)
    v_mfma_f32_32x32x16_bf16 v[128:143], v[208:211], v[48:51], v[128:143]
    ds_read_b64_tr_b16 v[232:233], v16 offset:12288
    ds_read_b64_tr_b16 v[234:235], v16 offset:14336
    v_mfma_f32_32x32x16_bf16 v[144:159], v[212:215], v[48:51], v[144:159]
    ds_read_b64_tr_b16 v[236:237], v17 offset:12288
    ds_read_b64_tr_b16 v[238:239], v17 offset:14336
    s_waitcnt lgkmcnt(8)
    s_waitcnt vmcnt(3)
    v_mfma_f32_32x32x16_bf16 v[128:143], v[216:219], v[52:55], v[128:143]
    ds_read_b64_tr_b16 v[240:241], v26 offset:0
    ds_read_b64_tr_b16 v[242:243], v26 offset:2048
    v_mfma_f32_32x32x16_bf16 v[144:159], v[220:223], v[52:55], v[144:159]
    ds_read_b64_tr_b16 v[244:245], v26 offset:4096
    ds_read_b64_tr_b16 v[246:247], v26 offset:6144
    s_waitcnt lgkmcnt(8)
    s_waitcnt vmcnt(2)
    v_mfma_f32_32x32x16_bf16 v[128:143], v[224:227], v[56:59], v[128:143]
    ds_read_b64_tr_b16 v[248:249], v26 offset:8192
    ds_read_b64_tr_b16 v[250:251], v26 offset:10240
    v_mfma_f32_32x32x16_bf16 v[144:159], v[228:231], v[56:59], v[144:159]
    ds_read_b64_tr_b16 v[252:253], v26 offset:12288
    ds_read_b64_tr_b16 v[254:255], v26 offset:14336
    s_waitcnt lgkmcnt(8)
    s_waitcnt vmcnt(1)
    v_mfma_f32_32x32x16_bf16 v[128:143], v[232:235], v[60:63], v[128:143]
    ds_read_b64_tr_b16 v[208:209], v18 offset:0
    ds_read_b64_tr_b16 v[210:211], v18 offset:2048
    v_mfma_f32_32x32x16_bf16 v[144:159], v[236:239], v[60:63], v[144:159]
    ds_read_b64_tr_b16 v[212:213], v18 offset:4096
    ds_read_b64_tr_b16 v[214:215], v18 offset:6144
    s_waitcnt lgkmcnt(8)
    v_mfma_f32_32x32x16_bf16 v[160:175], v[240:243], v[32:35], v[160:175]
    ds_read_b64_tr_b16 v[216:217], v18 offset:8192
    ds_read_b64_tr_b16 v[218:219], v18 offset:10240
    s_cmp_lg_u32 s56, 0
    s_cbranch_scc1 L_have2
    s_mov_b64 exec, 7
    buffer_load_dword v12, v4, s[36:39], s52 offen sc1
    s_waitcnt vmcnt(1)
    v_cmp_eq_u32 vcc, 1, v5
    s_add_u32 s57, s57, 1
    s_and_b32 s56, vcc_lo, s55
    s_cbranch_scc1 L_got2
    buffer_load_dword v13, v4, s[36:39], s52 offen sc1
    s_sleep 2
    buffer_load_dword v14, v4, s[36:39], s52 offen sc1
    s_sleep 2
L_spin2:
    s_waitcnt vmcnt(2)
    v_cmp_eq_u32 vcc, 1, v12
    s_add_u32 s57, s57, 1
    s_and_b32 s56, vcc_lo, s55
    s_cbranch_scc1 L_got2
    buffer_load_dword v12, v4, s[36:39], s52 offen sc1
    s_sleep 2
    s_waitcnt vmcnt(2)
    v_cmp_eq_u32 vcc, 1, v13
    s_add_u32 s57, s57, 1
    s_and_b32 s56, vcc_lo, s55
    s_cbranch_scc1 L_got2
    buffer_load_dword v13, v4, s[36:39], s52 offen sc1
    s_sleep 2
    s_waitcnt vmcnt(2)
    v_cmp_eq_u32 vcc, 1, v14
    s_add_u32 s57, s57, 1
    s_and_b32 s56, vcc_lo, s55
    s_cbranch_scc1 L_got2
    buffer_load_dword v14, v4, s[36:39], s52 offen sc1
    s_sleep 2
    s_cmp_lt_u32 s57, 0x40000
    s_cbranch_scc1 L_spin2
    s_mov_b32 s56, s55
L_got2:
    s_mov_b64 exec, -1
L_have2:
    s_ff1_i32_b32 s59, s56
    s_cmp_eq_u32 s59, 1
    s_cselect_b32 s80, s77, s76
    s_cselect_b32 s81, 0x1008, s79
    s_cmp_eq_u32 s59, 2
    s_cselect_b32 s80, s78, s80
    s_cselect_b32 s81, 0x10a12, s81
    buffer_load_dwordx4 v[64:67], v10, s[36:39], s80 offen offset:0 sc1
    v_mfma_f32_32x32x16_bf16 v[160:175], v[244:247], v[36:39], v[160:175]
    ds_read_b64_tr_b16 v[220:221], v18 offset:12288
    ds_read_b64_tr_b16 v[222:223], v18 offset:14336
    s_lshl_b32 s58, 1, s59
    s_andn2_b32 s55, s55, s58
    s_andn2_b32 s56, s56, s58
    s_bfe_u32 s82, s81, 0x80000
    s_bfe_u32 s83, s81, 0x80008
    s_bfe_u32 s84, s81, 0x80010
    s_lshl_b32 s82, s82, 13
    s_lshl_b32 s83, s83, 13
    s_lshl_b32 s84, s84, 13
    s_waitcnt lgkmcnt(8)
    v_mfma_f32_32x32x16_bf16 v[160:175], v[248:251], v[40:43], v[160:175]
    ds_read_b64_tr_b16 v[224:225], v27 offset:0
    ds_read_b64_tr_b16 v[226:227], v27 offset:2048
    buffer_load_dwordx4 v[68:71], v10, s[36:39], s80 offen offset:1024 sc1
    v_mfma_f32_32x32x16_bf16 v[160:175], v[252:255], v[44:47], v[160:175]
    ds_read_b64_tr_b16 v[228:229], v27 offset:4096
    ds_read_b64_tr_b16 v[230:231], v27 offset:6144
    buffer_load_dwordx4 v[72:75], v10, s[36:39], s80 offen offset:2048 sc1
    s_waitcnt lgkmcnt(8)
    v_mfma_f32_32x32x16_bf16 v[160:175], v[208:211], v[48:51], v[160:175]
    ds_read_b64_tr_b16 v[232:233], v27 offset:8192
    ds_read_b64_tr_b16 v[234:235], v27 offset:10240
    buffer_load_dwordx4 v[76:79], v10, s[36:39], s80 offen offset:3072 sc1
    v_mfma_f32_32x32x16_bf16 v[160:175], v[212:215], v[52:55], v[160:175]
    ds_read_b64_tr_b16 v[236:237], v27 offset:12288
    ds_read_b64_tr_b16 v[238:239], v27 offset:14336
    s_waitcnt lgkmcnt(8)
    v_mfma_f32_32x32x16_bf16 v[160:175], v[216:219], v[56:59], v[160:175]
    ds_read_b64_tr_b16 v[240:241], v19 offset:0
    ds_read_b64_tr_b16 v[242:243], v19 offset:2048
    buffer_load_dwordx4 v[80:83], v0, s[36:39], s80 offen offset:0 sc1
    v_mfma_f32_32x32x16_bf16 v[160:175], v[220:223], v[60:63], v[160:175]
    ds_read_b64_tr_b16 v[244:245], v19 offset:4096
    ds_read_b64_tr_b16 v[246:247], v19 offset:6144
    buffer_load_dwordx4 v[84:87], v0, s[36:39], s80 offen offset:1024 sc1
    s_waitcnt lgkmcnt(8)
    v_mfma_f32_32x32x16_bf16 v[176:191], v[224:227], v[32:35], v[176:191]
    ds_read_b64_tr_b16 v[248:249], v19 offset:8192
    ds_read_b64_tr_b16 v[250:251], v19 offset:10240
    buffer_load_dwordx4 v[88:91], v0, s[36:39], s80 offen offset:2048 sc1
    v_mfma_f32_32x32x16_bf16 v[176:191], v[228:231], v[36:39], v[176:191]
    ds_read_b64_tr_b16 v[252:253], v19 offset:12288
    ds_read_b64_tr_b16 v[254:255], v19 offset:14336
    buffer_load_dwordx4 v[92:95], v0, s[36:39], s80 offen offset:3072 sc1
    s_waitcnt lgkmcnt(8)
    v_mfma_f32_32x32x16_bf16 v[176:191], v[232:235], v[40:43], v[176:191]
    ds_read_b64_tr_b16 v[208:209], v3 offset:0
    ds_read_b64_tr_b16 v[210:211], v3 offset:512
    v_mfma_f32_32x32x16_bf16 v[176:191], v[236:239], v[44:47], v[176:191]
    ds_read_b64_tr_b16 v[212:213], v3 offset:1024
    ds_read_b64_tr_b16 v[214:215], v3 offset:1536
    s_waitcnt lgkmcnt(8)
    v_mfma_f32_32x32x16_bf16 v[176:191], v[240:243], v[48:51], v[176:191]
    ds_read_b64_tr_b16 v[216:217], v3 offset:2048
    ds_read_b64_tr_b16 v[218:219], v3 offset:2560
    v_mfma_f32_32x32x16_bf16 v[176:191], v[244:247], v[52:55], v[176:191]
    ds_read_b64_tr_b16 v[220:221], v3 offset:3072
    ds_read_b64_tr_b16 v[222:223], v3 offset:3584
    s_waitcnt lgkmcnt(8)
    v_mfma_f32_32x32x16_bf16 v[176:191], v[248:251], v[56:59], v[176:191]
    ds_read_b64_tr_b16 v[224:225], v3 offset:4096
    ds_read_b64_tr_b16 v[226:227], v3 offset:4608
    v_mfma_f32_32x32x16_bf16 v[176:191], v[252:255], v[60:63], v[176:191]
    ds_read_b64_tr_b16 v[228:229], v3 offset:5120
    ds_read_b64_tr_b16 v[230:231], v3 offset:5632
    s_waitcnt lgkmcnt(8)
    v_mfma_f32_32x32x16_bf16 v[192:207], v[208:211], v[32:35], v[192:207]
    ds_read_b64_tr_b16 v[232:233], v3 offset:6144
    ds_read_b64_tr_b16 v[234:235], v3 offset:6656
    s_mov_b64 exec, 7
    buffer_load_dword v5, v4, s[36:39], s52 offen sc1
    s_mov_b64 exec, -1
    v_mfma_f32_32x32x16_bf16 v[192:207], v[212:215], v[36:39], v[192:207]
    ds_read_b64_tr_b16 v[236:237], v3 offset:7168
    ds_read_b64_tr_b16 v[238:239], v3 offset:7680
    s_waitcnt lgkmcnt(8)
    v_mfma_f32_32x32x16_bf16 v[192:207], v[216:219], v[40:43], v[192:207]
    v_add_u32 v24, s82, v8
    v_add_u32 v16, s83, v8
    v_xor_b32 v25, 64, v24
    v_xor_b32 v17, 64, v16
    v_xor_b32 v26, 128, v24
    v_xor_b32 v18, 128, v16
    v_xor_b32 v27, 192, v24
    v_xor_b32 v19, 192, v16
    ds_read_b64_tr_b16 v[240:241], v24 offset:0
    ds_read_b64_tr_b16 v[242:243], v24 offset:2048
    v_mfma_f32_32x32x16_bf16 v[192:207], v[220:223], v[44:47], v[192:207]
    ds_read_b64_tr_b16 v[244:245], v25 offset:0
    ds_read_b64_tr_b16 v[246:247], v25 offset:2048
    s_waitcnt lgkmcnt(8)
    v_mfma_f32_32x32x16_bf16 v[192:207], v[224:227], v[48:51], v[192:207]
    ds_read_b64_tr_b16 v[248:249], v24 offset:4096
    ds_read_b64_tr_b16 v[250:251], v24 offset:6144
    v_mfma_f32_32x32x16_bf16 v[192:207], v[228:231], v[52:55], v[192:207]
    ds_read_b64_tr_b16 v[252:253], v25 offset:4096
    ds_read_b64_tr_b16 v[254:255], v25 offset:6144
    s_waitcnt lgkmcnt(8)
    v_mfma_f32_32x32x16_bf16 v[192:207], v[232:235], v[56:59], v[192:207]
    ds_read_b64_tr_b16 v[208:209], v24 offset:8192
    ds_read_b64_tr_b16 v[210:211], v24 offset:10240
    v_mfma_f32_32x32x16_bf16 v[192:207], v[236:239], v[60:63], v[192:207]
    ds_read_b64_tr_b16 v[212:213], v25 offset:8192
    ds_read_b64_tr_b16 v[214:215], v25 offset:10240
    s_waitcnt lgkmcnt(8)
    s_waitcnt vmcnt(8)
    v_mfma_f32_32x32x16_bf16 v[128:143], v[240:243], v[64:67], v[128:143]
    ds_read_b64_tr_b16 v[216:217], v24 offset:12288
    ds_read_b64_tr_b16 v[218:219], v24 offset:14336
    v_mfma_f32_32x32x16_bf16 v[144:159], v[244:247], v[64:67], v[144:159]
    ds_read_b64_tr_b16 v[220:221], v25 offset:12288
    ds_read_b64_tr_b16 v[222:223], v25 offset:14336
    s_waitcnt lgkmcnt(8)
    s_waitcnt vmcnt(7)
    v_mfma_f32_32x32x16_bf16 v[128:143], v[248:251], v[68:71], v[128:143]
    v_add_u32 v3, s84, v9
    ds_read_b64_tr_b16 v[224:225], v16 offset:0
    ds_read_b64_tr_b16 v[226:227], v16 offset:2048
    v_mfma_f32_32x32x16_bf16 v[144:159], v[252:255], v[68:71], v[144:159]
    ds_read_b64_tr_b16 v[228:229], v17 offset:0
    ds_read_b64_tr_b16 v[230:231], v17 offset:2048
    s_waitcnt lgkmcnt(8)
    s_waitcnt vmcnt(6)
    v_mfma_f32_32x32x16_bf16 v[128:143], v[208:211], v[72:75], v[128:143]
    ds_read_b64_tr_b16 v[232:233], v16 offset:4096
    ds_read_b64_tr_b16 v[234:235], v16 offset:6144
    v_mfma_f32_32x32x16_bf16 v[144:159], v[212:215], v[72:75], v[144:159]
    ds_read_b64_tr_b16 v[236:237], v17 offset:4096
    ds_read_b64_tr_b16 v[238:239], v17 offset:6144
    s_waitcnt lgkmcnt(8)
    s_waitcnt vmcnt(5)
    v_mfma_f32_32x32x16_bf16 v[128:143], v[216:219], v[76:79], v[128:143]
    ds_read_b64_tr_b16 v[240:241], v16 offset:8192
    ds_read_b64_tr_b16 v[242:243], v16 offset:10240
    v_mfma_f32_32x32x16_bf16 v[144:159], v[220:223], v[76:79], v[144:159]
    ds_read_b64_tr_b16 v[244:245], v17 offset:8192
    ds_read_b64_tr_b16 v[246:247], v17 offset:10240
    s_waitcnt lgkmcnt(8)
    s_waitcnt vmcnt(4)
    v_mfma_f32_32x32x16_bf16 v[128:143], v[224:227], v[80:83], v[128:143]
    ds_read_b64_tr_b16 v[248:249], v16 offset:12288
    ds_read_b64_tr_b16 v[250:251], v16 offset:14336
    v_mfma_f32_32x32x16_bf16 v[144:159], v[228:231], v[80:83], v[144:159]
    ds_read_b64_tr_b16 v[252:253], v17 offset:12288
    ds_read_b64_tr_b16 v[254:255], v17 offset:14336
    s_waitcnt lgkmcnt(8)
    s_waitcnt vmcnt(3)
    v_mfma_f32_32x32x16_bf16 v[128:143], v[232:235], v[84:87], v[128:143]
    ds_read_b64_tr_b16 v[208:209], v26 offset:0
    ds_read_b64_tr_b16 v[210:211], v26 offset:2048
    v_mfma_f32_32x32x16_bf16 v[144:159], v[236:239], v[84:87], v[144:159]
    ds_read_b64_tr_b16 v[212:213], v26 offset:4096
    ds_read_b64_tr_b16 v[214:215], v26 offset:6144
    s_waitcnt lgkmcnt(8)
    s_waitcnt vmcnt(2)
    v_mfma_f32_32x32x16_bf16 v[128:143], v[240:243], v[88:91], v[128:143]
    ds_read_b64_tr_b16 v[216:217], v26 offset:8192
    ds_read_b64_tr_b16 v[218:219], v26 offset:10240
    v_mfma_f32_32x32x16_bf16 v[144:159], v[244:247], v[88:91], v[144:159]
    ds_read_b64_tr_b16 v[220:221], v26 offset:12288
    ds_read_b64_tr_b16 v[222:223], v26 offset:14336
    s_waitcnt lgkmcnt(8)
    s_waitcnt vmcnt(1)
    v_mfma_f32_32x32x16_bf16 v[128:143], v[248:251], v[92:95], v[128:143]
    ds_read_b64_tr_b16 v[224:225], v18 offset:0
    ds_read_b64_tr_b16 v[226:227], v18 offset:2048
    v_mfma_f32_32x32x16_bf16 v[144:159], v[252:255], v[92:95], v[144:159]
    ds_read_b64_tr_b16 v[228:229], v18 offset:4096
    ds_read_b64_tr_b16 v[230:231], v18 offset:6144
    s_waitcnt lgkmcnt(8)
    v_mfma_f32_32x32x16_bf16 v[160:175], v[208:211], v[64:67], v[160:175]
    ds_read_b64_tr_b16 v[232:233], v18 offset:8192
    ds_read_b64_tr_b16 v[234:235], v18 offset:10240
    s_cmp_lg_u32 s56, 0
    s_cbranch_scc1 L_have3
    s_mov_b64 exec, 7
    buffer_load_dword v12, v4, s[36:39], s52 offen sc1
    s_waitcnt vmcnt(1)
    v_cmp_eq_u32 vcc, 1, v5
    s_add_u32 s57, s57, 1
    s_and_b32 s56, vcc_lo, s55
    s_cbranch_scc1 L_got3
    buffer_load_dword v13, v4, s[36:39], s52 offen sc1
    s_sleep 2
    buffer_load_dword v14, v4, s[36:39], s52 offen sc1
    s_sleep 2
L_spin3:
    s_waitcnt vmcnt(2)
    v_cmp_eq_u32 vcc, 1, v12
    s_add_u32 s57, s57, 1
    s_and_b32 s56, vcc_lo, s55
    s_cbranch_scc1 L_got3
    buffer_load_dword v12, v4, s[36:39], s52 offen sc1
    s_sleep 2
    s_waitcnt vmcnt(2)
    v_cmp_eq_u32 vcc, 1, v13
    s_add_u32 s57, s57, 1
    s_and_b32 s56, vcc_lo, s55
    s_cbranch_scc1 L_got3
    buffer_load_dword v13, v4, s[36:39], s52 offen sc1
    s_sleep 2
    s_waitcnt vmcnt(2)
    v_cmp_eq_u32 vcc, 1, v14
    s_add_u32 s57, s57, 1
    s_and_b32 s56, vcc_lo, s55
    s_cbranch_scc1 L_got3
    buffer_load_dword v14, v4, s[36:39], s52 offen sc1
    s_sleep 2
    s_cmp_lt_u32 s57, 0x40000
    s_cbranch_scc1 L_spin3
    s_mov_b32 s56, s55
L_got3:
    s_mov_b64 exec, -1
L_have3:
    s_ff1_i32_b32 s59, s56
    s_cmp_eq_u32 s59, 1
    s_cselect_b32 s80, s77, s76
    s_cselect_b32 s81, 0x1008, s79
    s_cmp_eq_u32 s59, 2
    s_cselect_b32 s80, s78, s80
    s_cselect_b32 s81, 0x10a12, s81
    buffer_load_dwordx4 v[96:99], v10, s[36:39], s80 offen offset:0 sc1
    v_mfma_f32_32x32x16_bf16 v[160:175], v[212:215], v[68:71], v[160:175]
    ds_read_b64_tr_b16 v[236:237], v18 offset:12288
    ds_read_b64_tr_b16 v[238:239], v18 offset:14336
    s_lshl_b32 s58, 1, s59
    s_andn2_b32 s55, s55, s58
    s_andn2_b32 s56, s56, s58
    s_bfe_u32 s82, s81, 0x80000
    s_bfe_u32 s83, s81, 0x80008
    s_bfe_u32 s84, s81, 0x80010
    s_lshl_b32 s82, s82, 13
    s_lshl_b32 s83, s83, 13
    s_lshl_b32 s84, s84, 13
    s_waitcnt lgkmcnt(8)
    v_mfma_f32_32x32x16_bf16 v[160:175], v[216:219], v[72:75], v[160:175]
    ds_read_b64_tr_b16 v[240:241], v27 offset:0
    ds_read_b64_tr_b16 v[242:243], v27 offset:2048
    buffer_load_dwordx4 v[100:103], v10, s[36:39], s80 offen offset:1024 sc1
    v_mfma_f32_32x32x16_bf16 v[160:175], v[220:223], v[76:79], v[160:175]
    ds_read_b64_tr_b16 v[244:245], v27 offset:4096
    ds_read_b64_tr_b16 v[246:247], v27 offset:6144
    buffer_load_dwordx4 v[104:107], v10, s[36:39], s80 offen offset:2048 sc1
    s_waitcnt lgkmcnt(8)
    v_mfma_f32_32x32x16_bf16 v[160:175], v[224:227], v[80:83], v[160:175]
    ds_read_b64_tr_b16 v[248:249], v27 offset:8192
    ds_read_b64_tr_b16 v[250:251], v27 offset:10240
    buffer_load_dwordx4 v[108:111], v10, s[36:39], s80 offen offset:3072 sc1
    v_mfma_f32_32x32x16_bf16 v[160:175], v[228:231], v[84:87], v[160:175]
    ds_read_b64_tr_b16 v[252:253], v27 offset:12288
    ds_read_b64_tr_b16 v[254:255], v27 offset:14336
    s_waitcnt lgkmcnt(8)
    v_mfma_f32_32x32x16_bf16 v[160:175], v[232:235], v[88:91], v[160:175]
    ds_read_b64_tr_b16 v[208:209], v19 offset:0
    ds_read_b64_tr_b16 v[210:211], v19 offset:2048
    buffer_load_dwordx4 v[112:115], v0, s[36:39], s80 offen offset:0 sc1
    v_mfma_f32_32x32x16_bf16 v[160:175], v[236:239], v[92:95], v[160:175]
    ds_read_b64_tr_b16 v[212:213], v19 offset:4096
    ds_read_b64_tr_b16 v[214:215], v19 offset:6144
    buffer_load_dwordx4 v[116:119], v0, s[36:39], s80 offen offset:1024 sc1
    s_waitcnt lgkmcnt(8)
    v_mfma_f32_32x32x16_bf16 v[176:191], v[240:243], v[64:67], v[176:191]
    ds_read_b64_tr_b16 v[216:217], v19 offset:8192
    ds_read_b64_tr_b16 v[218:219], v19 offset:10240
    buffer_load_dwordx4 v[120:123], v0, s[36:39], s80 offen offset:2048 sc1
    v_mfma_f32_32x32x16_bf16 v[176:191], v[244:247], v[68:71], v[176:191]
    ds_read_b64_tr_b16 v[220:221], v19 offset:12288
    ds_read_b64_tr_b16 v[222:223], v19 offset:14336
    buffer_load_dwordx4 v[124:127], v0, s[36:39], s80 offen offset:3072 sc1
    s_waitcnt lgkmcnt(8)
    v_mfma_f32_32x32x16_bf16 v[176:191], v[248:251], v[72:75], v[176:191]
    ds_read_b64_tr_b16 v[224:225], v3 offset:0
    ds_read_b64_tr_b16 v[226:227], v3 offset:512
    v_mfma_f32_32x32x16_bf16 v[176:191], v[252:255], v[76:79], v[176:191]
    ds_read_b64_tr_b16 v[228:229], v3 offset:1024
    ds_read_b64_tr_b16 v[230:231], v3 offset:1536
    s_waitcnt lgkmcnt(8)
    v_mfma_f32_32x32x16_bf16 v[176:191], v[208:211], v[80:83], v[176:191]
    ds_read_b64_tr_b16 v[232:233], v3 offset:2048
    ds_read_b64_tr_b16 v[234:235], v3 offset:2560
    v_mfma_f32_32x32x16_bf16 v[176:191], v[212:215], v[84:87], v[176:191]
    ds_read_b64_tr_b16 v[236:237], v3 offset:3072
    ds_read_b64_tr_b16 v[238:239], v3 offset:3584
    s_waitcnt lgkmcnt(8)
    v_mfma_f32_32x32x16_bf16 v[176:191], v[216:219], v[88:91], v[176:191]
    ds_read_b64_tr_b16 v[240:241], v3 offset:4096
    ds_read_b64_tr_b16 v[242:243], v3 offset:4608
    v_mfma_f32_32x32x16_bf16 v[176:191], v[220:223], v[92:95], v[176:191]
    ds_read_b64_tr_b16 v[244:245], v3 offset:5120
    ds_read_b64_tr_b16 v[246:247], v3 offset:5632
    s_waitcnt lgkmcnt(8)
    v_mfma_f32_32x32x16_bf16 v[192:207], v[224:227], v[64:67], v[192:207]
    ds_read_b64_tr_b16 v[248:249], v3 offset:6144
    ds_read_b64_tr_b16 v[250:251], v3 offset:6656
    v_mfma_f32_32x32x16_bf16 v[192:207], v[228:231], v[68:71], v[192:207]
    ds_read_b64_tr_b16 v[252:253], v3 offset:7168
    ds_read_b64_tr_b16 v[254:255], v3 offset:7680
    s_waitcnt lgkmcnt(8)
    v_mfma_f32_32x32x16_bf16 v[192:207], v[232:235], v[72:75], v[192:207]
    v_add_u32 v24, s82, v8
    v_add_u32 v16, s83, v8
    v_xor_b32 v25, 64, v24
    v_xor_b32 v17, 64, v16
    v_xor_b32 v26, 128, v24
    v_xor_b32 v18, 128, v16
    v_xor_b32 v27, 192, v24
    v_xor_b32 v19, 192, v16
    ds_read_b64_tr_b16 v[208:209], v24 offset:0
    ds_read_b64_tr_b16 v[210:211], v24 offset:2048
    v_mfma_f32_32x32x16_bf16 v[192:207], v[236:239], v[76:79], v[192:207]
    ds_read_b64_tr_b16 v[212:213], v25 offset:0
    ds_read_b64_tr_b16 v[214:215], v25 offset:2048
    s_waitcnt lgkmcnt(8)
    v_mfma_f32_32x32x16_bf16 v[192:207], v[240:243], v[80:83], v[192:207]
    ds_read_b64_tr_b16 v[216:217], v24 offset:4096
    ds_read_b64_tr_b16 v[218:219], v24 offset:6144
    v_mfma_f32_32x32x16_bf16 v[192:207], v[244:247], v[84:87], v[192:207]
    ds_read_b64_tr_b16 v[220:221], v25 offset:4096
    ds_read_b64_tr_b16 v[222:223], v25 offset:6144
    s_waitcnt lgkmcnt(8)
    v_mfma_f32_32x32x16_bf16 v[192:207], v[248:251], v[88:91], v[192:207]
    ds_read_b64_tr_b16 v[224:225], v24 offset:8192
    ds_read_b64_tr_b16 v[226:227], v24 offset:10240
    v_mfma_f32_32x32x16_bf16 v[192:207], v[252:255], v[92:95], v[192:207]
    ds_read_b64_tr_b16 v[228:229], v25 offset:8192
    ds_read_b64_tr_b16 v[230:231], v25 offset:10240
    s_waitcnt lgkmcnt(8)
    s_waitcnt vmcnt(7)
    v_mfma_f32_32x32x16_bf16 v[128:143], v[208:211], v[96:99], v[128:143]
    ds_read_b64_tr_b16 v[232:233], v24 offset:12288
    ds_read_b64_tr_b16 v[234:235], v24 offset:14336
    v_mfma_f32_32x32x16_bf16 v[144:159], v[212:215], v[96:99], v[144:159]
    ds_read_b64_tr_b16 v[236:237], v25 offset:12288
    ds_read_b64_tr_b16 v[238:239], v25 offset:14336
    s_waitcnt lgkmcnt(8)
    s_waitcnt vmcnt(6)
    v_mfma_f32_32x32x16_bf16 v[128:143], v[216:219], v[100:103], v[128:143]
    v_add_u32 v3, s84, v9
    ds_read_b64_tr_b16 v[240:241], v16 offset:0
    ds_read_b64_tr_b16 v[242:243], v16 offset:2048
    v_mfma_f32_32x32x16_bf16 v[144:159], v[220:223], v[100:103], v[144:159]
    ds_read_b64_tr_b16 v[244:245], v17 offset:0
    ds_read_b64_tr_b16 v[246:247], v17 offset:2048
    s_waitcnt lgkmcnt(8)
    s_waitcnt vmcnt(5)
    v_mfma_f32_32x32x16_bf16 v[128:143], v[224:227], v[104:107], v[128:143]
    ds_read_b64_tr_b16 v[248:249], v16 offset:4096
    ds_read_b64_tr_b16 v[250:251], v16 offset:6144
    v_mfma_f32_32x32x16_bf16 v[144:159], v[228:231], v[104:107], v[144:159]
    ds_read_b64_tr_b16 v[252:253], v17 offset:4096
    ds_read_b64_tr_b16 v[254:255], v17 offset:6144
    s_waitcnt lgkmcnt(8)
    s_waitcnt vmcnt(4)
    v_mfma_f32_32x32x16_bf16 v[128:143], v[232:235], v[108:111], v[128:143]
    ds_read_b64_tr_b16 v[208:209], v16 offset:8192
    ds_read_b64_tr_b16 v[210:211], v16 offset:10240
    v_mfma_f32_32x32x16_bf16 v[144:159], v[236:239], v[108:111], v[144:159]
    ds_read_b64_tr_b16 v[212:213], v17 offset:8192
    ds_read_b64_tr_b16 v[214:215], v17 offset:10240
    s_waitcnt lgkmcnt(8)
    s_waitcnt vmcnt(3)
    v_mfma_f32_32x32x16_bf16 v[128:143], v[240:243], v[112:115], v[128:143]
    ds_read_b64_tr_b16 v[216:217], v16 offset:12288
    ds_read_b64_tr_b16 v[218:219], v16 offset:14336
    v_mfma_f32_32x32x16_bf16 v[144:159], v[244:247], v[112:115], v[144:159]
    ds_read_b64_tr_b16 v[220:221], v17 offset:12288
    ds_read_b64_tr_b16 v[222:223], v17 offset:14336
    s_waitcnt lgkmcnt(8)
    s_waitcnt vmcnt(2)
    v_mfma_f32_32x32x16_bf16 v[128:143], v[248:251], v[116:119], v[128:143]
    ds_read_b64_tr_b16 v[224:225], v26 offset:0
    ds_read_b64_tr_b16 v[226:227], v26 offset:2048
    v_mfma_f32_32x32x16_bf16 v[144:159], v[252:255], v[116:119], v[144:159]
    ds_read_b64_tr_b16 v[228:229], v26 offset:4096
    ds_read_b64_tr_b16 v[230:231], v26 offset:6144
    s_waitcnt lgkmcnt(8)
    s_waitcnt vmcnt(1)
    v_mfma_f32_32x32x16_bf16 v[128:143], v[208:211], v[120:123], v[128:143]
    ds_read_b64_tr_b16 v[232:233], v26 offset:8192
    ds_read_b64_tr_b16 v[234:235], v26 offset:10240
    v_mfma_f32_32x32x16_bf16 v[144:159], v[212:215], v[120:123], v[144:159]
    ds_read_b64_tr_b16 v[236:237], v26 offset:12288
    ds_read_b64_tr_b16 v[238:239], v26 offset:14336
    s_waitcnt lgkmcnt(8)
    s_waitcnt vmcnt(0)
    v_mfma_f32_32x32x16_bf16 v[128:143], v[216:219], v[124:127], v[128:143]
    ds_read_b64_tr_b16 v[240:241], v18 offset:0
    ds_read_b64_tr_b16 v[242:243], v18 offset:2048
    v_mfma_f32_32x32x16_bf16 v[144:159], v[220:223], v[124:127], v[144:159]
    ds_read_b64_tr_b16 v[244:245], v18 offset:4096
    ds_read_b64_tr_b16 v[246:247], v18 offset:6144
    s_waitcnt lgkmcnt(8)
    v_mfma_f32_32x32x16_bf16 v[160:175], v[224:227], v[96:99], v[160:175]
    ds_read_b64_tr_b16 v[248:249], v18 offset:8192
    ds_read_b64_tr_b16 v[250:251], v18 offset:10240
    v_mfma_f32_32x32x16_bf16 v[160:175], v[228:231], v[100:103], v[160:175]
    ds_read_b64_tr_b16 v[252:253], v18 offset:12288
    ds_read_b64_tr_b16 v[254:255], v18 offset:14336
    s_waitcnt lgkmcnt(8)
    v_mfma_f32_32x32x16_bf16 v[160:175], v[232:235], v[104:107], v[160:175]
    ds_read_b64_tr_b16 v[208:209], v27 offset:0
    ds_read_b64_tr_b16 v[210:211], v27 offset:2048
    v_mfma_f32_32x32x16_bf16 v[160:175], v[236:239], v[108:111], v[160:175]
    ds_read_b64_tr_b16 v[212:213], v27 offset:4096
    ds_read_b64_tr_b16 v[214:215], v27 offset:6144
    v_cvt_pk_bf16_f32 v128, v128, v129
    v_cvt_pk_bf16_f32 v129, v130, v131
    v_cvt_pk_bf16_f32 v130, v132, v133
    v_cvt_pk_bf16_f32 v131, v134, v135
    v_cvt_pk_bf16_f32 v132, v136, v137
    s_waitcnt lgkmcnt(8)
    v_mfma_f32_32x32x16_bf16 v[160:175], v[240:243], v[112:115], v[160:175]
    ds_read_b64_tr_b16 v[216:217], v27 offset:8192
    ds_read_b64_tr_b16 v[218:219], v27 offset:10240
    v_cvt_pk_bf16_f32 v133, v138, v139
    v_cvt_pk_bf16_f32 v134, v140, v141
    v_cvt_pk_bf16_f32 v135, v142, v143
    buffer_store_dwordx4 v[128:131], v10, s[36:39], s48 offen offset:0 sc1
    buffer_store_dwordx4 v[132:135], v10, s[36:39], s48 offen offset:1024 sc1
    v_mfma_f32_32x32x16_bf16 v[160:175], v[244:247], v[116:119], v[160:175]
    ds_read_b64_tr_b16 v[220:221], v27 offset:12288
    ds_read_b64_tr_b16 v[222:223], v27 offset:14336
    s_waitcnt lgkmcnt(8)
    v_mfma_f32_32x32x16_bf16 v[160:175], v[248:251], v[120:123], v[160:175]
    ds_read_b64_tr_b16 v[224:225], v19 offset:0
    ds_read_b64_tr_b16 v[226:227], v19 offset:2048
    v_cvt_pk_bf16_f32 v144, v144, v145
    v_cvt_pk_bf16_f32 v145, v146, v147
    v_cvt_pk_bf16_f32 v146, v148, v149
    v_cvt_pk_bf16_f32 v147, v150, v151
    v_cvt_pk_bf16_f32 v148, v152, v153
    v_mfma_f32_32x32x16_bf16 v[160:175], v[252:255], v[124:127], v[160:175]
    ds_read_b64_tr_b16 v[228:229], v19 offset:4096
    ds_read_b64_tr_b16 v[230:231], v19 offset:6144
    v_cvt_pk_bf16_f32 v149, v154, v155
    v_cvt_pk_bf16_f32 v150, v156, v157
    v_cvt_pk_bf16_f32 v151, v158, v159
    buffer_store_dwordx4 v[144:147], v10, s[36:39], s48 offen offset:2048 sc1
    buffer_store_dwordx4 v[148:151], v10, s[36:39], s48 offen offset:3072 sc1
    s_waitcnt lgkmcnt(8)
    v_mfma_f32_32x32x16_bf16 v[176:191], v[208:211], v[96:99], v[176:191]
    ds_read_b64_tr_b16 v[232:233], v19 offset:8192
    ds_read_b64_tr_b16 v[234:235], v19 offset:10240
    v_mfma_f32_32x32x16_bf16 v[176:191], v[212:215], v[100:103], v[176:191]
    ds_read_b64_tr_b16 v[236:237], v19 offset:12288
    ds_read_b64_tr_b16 v[238:239], v19 offset:14336
    s_waitcnt lgkmcnt(8)
    v_mfma_f32_32x32x16_bf16 v[176:191], v[216:219], v[104:107], v[176:191]
    ds_read_b64_tr_b16 v[240:241], v3 offset:0
    ds_read_b64_tr_b16 v[242:243], v3 offset:512
    v_mfma_f32_32x32x16_bf16 v[176:191], v[220:223], v[108:111], v[176:191]
    ds_read_b64_tr_b16 v[244:245], v3 offset:1024
    ds_read_b64_tr_b16 v[246:247], v3 offset:1536
    s_waitcnt lgkmcnt(8)
    v_mfma_f32_32x32x16_bf16 v[176:191], v[224:227], v[112:115], v[176:191]
    ds_read_b64_tr_b16 v[248:249], v3 offset:2048
    ds_read_b64_tr_b16 v[250:251], v3 offset:2560
    v_cvt_pk_bf16_f32 v160, v160, v161
    v_cvt_pk_bf16_f32 v161, v162, v163
    v_cvt_pk_bf16_f32 v162, v164, v165
    v_cvt_pk_bf16_f32 v163, v166, v167
    v_cvt_pk_bf16_f32 v164, v168, v169
    v_mfma_f32_32x32x16_bf16 v[176:191], v[228:231], v[116:119], v[176:191]
    ds_read_b64_tr_b16 v[252:253], v3 offset:3072
    ds_read_b64_tr_b16 v[254:255], v3 offset:3584
    v_cvt_pk_bf16_f32 v165, v170, v171
    v_cvt_pk_bf16_f32 v166, v172, v173
    v_cvt_pk_bf16_f32 v167, v174, v175
    buffer_store_dwordx4 v[160:163], v0, s[36:39], s48 offen offset:0 sc1
    buffer_store_dwordx4 v[164:167], v0, s[36:39], s48 offen offset:1024 sc1
    s_waitcnt lgkmcnt(8)
    v_mfma_f32_32x32x16_bf16 v[176:191], v[232:235], v[120:123], v[176:191]
    ds_read_b64_tr_b16 v[208:209], v3 offset:4096
    ds_read_b64_tr_b16 v[210:211], v3 offset:4608
    v_mfma_f32_32x32x16_bf16 v[176:191], v[236:239], v[124:127], v[176:191]
    ds_read_b64_tr_b16 v[212:213], v3 offset:5120
    ds_read_b64_tr_b16 v[214:215], v3 offset:5632
    s_waitcnt lgkmcnt(8)
    v_mfma_f32_32x32x16_bf16 v[192:207], v[240:243], v[96:99], v[192:207]
    ds_read_b64_tr_b16 v[216:217], v3 offset:6144
    ds_read_b64_tr_b16 v[218:219], v3 offset:6656
    v_mfma_f32_32x32x16_bf16 v[192:207], v[244:247], v[100:103], v[192:207]
    ds_read_b64_tr_b16 v[220:221], v3 offset:7168
    ds_read_b64_tr_b16 v[222:223], v3 offset:7680
    s_waitcnt lgkmcnt(8)
    v_mfma_f32_32x32x16_bf16 v[192:207], v[248:251], v[104:107], v[192:207]
    v_mfma_f32_32x32x16_bf16 v[192:207], v[252:255], v[108:111], v[192:207]
    s_waitcnt lgkmcnt(4)
    v_mfma_f32_32x32x16_bf16 v[192:207], v[208:211], v[112:115], v[192:207]
    v_cvt_pk_bf16_f32 v176, v176, v177
    v_cvt_pk_bf16_f32 v177, v178, v179
    v_cvt_pk_bf16_f32 v178, v180, v181
    v_cvt_pk_bf16_f32 v179, v182, v183
    v_cvt_pk_bf16_f32 v180, v184, v185
    v_mfma_f32_32x32x16_bf16 v[192:207], v[212:215], v[116:119], v[192:207]
    v_cvt_pk_bf16_f32 v181, v186, v187
    v_cvt_pk_bf16_f32 v182, v188, v189
    v_cvt_pk_bf16_f32 v183, v190, v191
    buffer_store_dwordx4 v[176:179], v0, s[36:39], s48 offen offset:2048 sc1
    buffer_store_dwordx4 v[180:183], v0, s[36:39], s48 offen offset:3072 sc1
    s_waitcnt lgkmcnt(2)
    v_mfma_f32_32x32x16_bf16 v[192:207], v[216:219], v[120:123], v[192:207]
    s_waitcnt lgkmcnt(0)
    v_mfma_f32_32x32x16_bf16 v[192:207], v[220:223], v[124:127], v[192:207]
    s_nop 7
    s_nop 3
    v_cvt_pk_bf16_f32 v192, v192, v193
    v_cvt_pk_bf16_f32 v193, v194, v195
    v_cvt_pk_bf16_f32 v194, v196, v197
    v_cvt_pk_bf16_f32 v195, v198, v199
    v_cvt_pk_bf16_f32 v196, v200, v201
    v_cvt_pk_bf16_f32 v197, v202, v203
    v_cvt_pk_bf16_f32 v198, v204, v205
    v_cvt_pk_bf16_f32 v199, v206, v207
    buffer_store_dwordx4 v[192:195], v2, s[36:39], s48 offen offset:0 sc1
    buffer_store_dwordx4 v[196:199], v2, s[36:39], s48 offen offset:1024 sc1
    s_waitcnt vmcnt(0)
    s_mov_b64 exec, 1
    buffer_store_dword v6, v7, s[36:39], s51 offen sc1
    s_mov_b64 exec, -1
    s_endpgm
L_rare_0:
    s_nop 15
    s_nop 3
    v_mov_b32 v12, v11
    s_nop 1
    v_permlane32_swap_b32 v11, v12
    s_nop 0
    v_max3_f32 v11, v11, v12, 0
    v_ceil_f32 v11, v11
    v_min_f32 v12, 0x43480000, v11
    v_cvt_i32_f32 v12, v12
    v_sub_u32 v12, 0, v12
    v_ldexp_f32 v12, 1.0, v12
    v_lshlrev_b32 v13, 16, v160
    v_and_b32 v14, 0xffff0000, v160
    v_mul_f32 v13, v13, v12
    v_mul_f32 v14, v14, v12
    v_cvt_pk_bf16_f32 v160, v13, v14
    v_lshlrev_b32 v13, 16, v161
    v_and_b32 v14, 0xffff0000, v161
    v_mul_f32 v13, v13, v12
    v_mul_f32 v14, v14, v12
    v_cvt_pk_bf16_f32 v161, v13, v14
    v_lshlrev_b32 v13, 16, v162
    v_and_b32 v14, 0xffff0000, v162
    v_mul_f32 v13, v13, v12
    v_mul_f32 v14, v14, v12
    v_cvt_pk_bf16_f32 v162, v13, v14
    v_lshlrev_b32 v13, 16, v163
    v_and_b32 v14, 0xffff0000, v163
    v_mul_f32 v13, v13, v12
    v_mul_f32 v14, v14, v12
    v_cvt_pk_bf16_f32 v163, v13, v14
    v_lshlrev_b32 v13, 16, v164
    v_and_b32 v14, 0xffff0000, v164
    v_mul_f32 v13, v13, v12
    v_mul_f32 v14, v14, v12
    v_cvt_pk_bf16_f32 v164, v13, v14
    v_lshlrev_b32 v13, 16, v165
    v_and_b32 v14, 0xffff0000, v165
    v_mul_f32 v13, v13, v12
    v_mul_f32 v14, v14, v12
    v_cvt_pk_bf16_f32 v165, v13, v14
    v_lshlrev_b32 v13, 16, v166
    v_and_b32 v14, 0xffff0000, v166
    v_mul_f32 v13, v13, v12
    v_mul_f32 v14, v14, v12
    v_cvt_pk_bf16_f32 v166, v13, v14
    v_lshlrev_b32 v13, 16, v167
    v_and_b32 v14, 0xffff0000, v167
    v_mul_f32 v13, v13, v12
    v_mul_f32 v14, v14, v12
    v_cvt_pk_bf16_f32 v167, v13, v14
    v_sub_f32 v144, v144, v11
    v_sub_f32 v176, v176, v11
    v_sub_f32 v145, v145, v11
    v_sub_f32 v177, v177, v11
    v_sub_f32 v146, v146, v11
    v_sub_f32 v178, v178, v11
    v_sub_f32 v147, v147, v11
    v_sub_f32 v179, v179, v11
    v_sub_f32 v148, v148, v11
    v_sub_f32 v180, v180, v11
    v_sub_f32 v149, v149, v11
    v_sub_f32 v181, v181, v11
    v_sub_f32 v150, v150, v11
    v_sub_f32 v182, v182, v11
    v_sub_f32 v151, v151, v11
    v_sub_f32 v183, v183, v11
    v_sub_f32 v152, v152, v11
    v_sub_f32 v184, v184, v11
    v_sub_f32 v153, v153, v11
    v_sub_f32 v185, v185, v11
    v_sub_f32 v154, v154, v11
    v_sub_f32 v186, v186, v11
    v_sub_f32 v155, v155, v11
    v_sub_f32 v187, v187, v11
    v_sub_f32 v156, v156, v11
    v_sub_f32 v188, v188, v11
    v_sub_f32 v157, v157, v11
    v_sub_f32 v189, v189, v11
    v_sub_f32 v158, v158, v11
    v_sub_f32 v190, v190, v11
    v_sub_f32 v159, v159, v11
    v_sub_f32 v191, v191, v11
    s_nop 1
    s_branch L_back_0
L_rare_1:
    s_nop 15
    s_nop 3
    v_mov_b32 v12, v11
    s_nop 1
    v_permlane32_swap_b32 v11, v12
    s_nop 0
    v_max3_f32 v11, v11, v12, 0
    v_ceil_f32 v11, v11
    v_min_f32 v12, 0x43480000, v11
    v_cvt_i32_f32 v12, v12
    v_sub_u32 v12, 0, v12
    v_ldexp_f32 v12, 1.0, v12
    v_mul_f32 v32, v32, v12
    v_mul_f32 v33, v33, v12
    v_mul_f32 v34, v34, v12
    v_mul_f32 v35, v35, v12
    v_mul_f32 v36, v36, v12
    v_mul_f32 v37, v37, v12
    v_mul_f32 v38, v38, v12
    v_mul_f32 v39, v39, v12
    v_mul_f32 v40, v40, v12
    v_mul_f32 v41, v41, v12
    v_mul_f32 v42, v42, v12
    v_mul_f32 v43, v43, v12
    v_mul_f32 v44, v44, v12
    v_mul_f32 v45, v45, v12
    v_mul_f32 v46, v46, v12
    v_mul_f32 v47, v47, v12
    v_mul_f32 v48, v48, v12
    v_mul_f32 v49, v49, v12
    v_mul_f32 v50, v50, v12
    v_mul_f32 v51, v51, v12
    v_mul_f32 v52, v52, v12
    v_mul_f32 v53, v53, v12
    v_mul_f32 v54, v54, v12
    v_mul_f32 v55, v55, v12
    v_mul_f32 v56, v56, v12
    v_mul_f32 v57, v57, v12
    v_mul_f32 v58, v58, v12
    v_mul_f32 v59, v59, v12
    v_mul_f32 v60, v60, v12
    v_mul_f32 v61, v61, v12
    v_mul_f32 v62, v62, v12
    v_mul_f32 v63, v63, v12
    v_mul_f32 v64, v64, v12
    v_mul_f32 v65, v65, v12
    v_mul_f32 v66, v66, v12
    v_mul_f32 v67, v67, v12
    v_mul_f32 v68, v68, v12
    v_mul_f32 v69, v69, v12
    v_mul_f32 v70, v70, v12
    v_mul_f32 v71, v71, v12
    v_mul_f32 v72, v72, v12
    v_mul_f32 v73, v73, v12
    v_mul_f32 v74, v74, v12
    v_mul_f32 v75, v75, v12
    v_mul_f32 v76, v76, v12
    v_mul_f32 v77, v77, v12
    v_mul_f32 v78, v78, v12
    v_mul_f32 v79, v79, v12
    v_mul_f32 v80, v80, v12
    v_mul_f32 v81, v81, v12
    v_mul_f32 v82, v82, v12
    v_mul_f32 v83, v83, v12
    v_mul_f32 v84, v84, v12
    v_mul_f32 v85, v85, v12
    v_mul_f32 v86, v86, v12
    v_mul_f32 v87, v87, v12
    v_mul_f32 v88, v88, v12
    v_mul_f32 v89, v89, v12
    v_mul_f32 v90, v90, v12
    v_mul_f32 v91, v91, v12
    v_mul_f32 v92, v92, v12
    v_mul_f32 v93, v93, v12
    v_mul_f32 v94, v94, v12
    v_mul_f32 v95, v95, v12
    v_mul_f32 v192, v192, v12
    v_lshlrev_b32 v13, 16, v168
    v_and_b32 v14, 0xffff0000, v168
    v_mul_f32 v13, v13, v12
    v_mul_f32 v14, v14, v12
    v_cvt_pk_bf16_f32 v168, v13, v14
    v_lshlrev_b32 v13, 16, v169
    v_and_b32 v14, 0xffff0000, v169
    v_mul_f32 v13, v13, v12
    v_mul_f32 v14, v14, v12
    v_cvt_pk_bf16_f32 v169, v13, v14
    v_lshlrev_b32 v13, 16, v170
    v_and_b32 v14, 0xffff0000, v170
    v_mul_f32 v13, v13, v12
    v_mul_f32 v14, v14, v12
    v_cvt_pk_bf16_f32 v170, v13, v14
    v_lshlrev_b32 v13, 16, v171
    v_and_b32 v14, 0xffff0000, v171
    v_mul_f32 v13, v13, v12
    v_mul_f32 v14, v14, v12
    v_cvt_pk_bf16_f32 v171, v13, v14
    v_lshlrev_b32 v13, 16, v172
    v_and_b32 v14, 0xffff0000, v172
    v_mul_f32 v13, v13, v12
    v_mul_f32 v14, v14, v12
    v_cvt_pk_bf16_f32 v172, v13, v14
    v_lshlrev_b32 v13, 16, v173
    v_and_b32 v14, 0xffff0000, v173
    v_mul_f32 v13, v13, v12
    v_mul_f32 v14, v14, v12
    v_cvt_pk_bf16_f32 v173, v13, v14
    v_lshlrev_b32 v13, 16, v174
    v_and_b32 v14, 0xffff0000, v174
    v_mul_f32 v13, v13, v12
    v_mul_f32 v14, v14, v12
    v_cvt_pk_bf16_f32 v174, v13, v14
    v_lshlrev_b32 v13, 16, v175
    v_and_b32 v14, 0xffff0000, v175
    v_mul_f32 v13, v13, v12
    v_mul_f32 v14, v14, v12
    v_cvt_pk_bf16_f32 v175, v13, v14
    v_sub_f32 v128, v128, v11
    v_sub_f32 v176, v176, v11
    v_sub_f32 v129, v129, v11
    v_sub_f32 v177, v177, v11
    v_sub_f32 v130, v130, v11
    v_sub_f32 v178, v178, v11
    v_sub_f32 v131, v131, v11
    v_sub_f32 v179, v179, v11
    v_sub_f32 v132, v132, v11
    v_sub_f32 v180, v180, v11
    v_sub_f32 v133, v133, v11
    v_sub_f32 v181, v181, v11
    v_sub_f32 v134, v134, v11
    v_sub_f32 v182, v182, v11
    v_sub_f32 v135, v135, v11
    v_sub_f32 v183, v183, v11
    v_sub_f32 v136, v136, v11
    v_sub_f32 v184, v184, v11
    v_sub_f32 v137, v137, v11
    v_sub_f32 v185, v185, v11
    v_sub_f32 v138, v138, v11
    v_sub_f32 v186, v186, v11
    v_sub_f32 v139, v139, v11
    v_sub_f32 v187, v187, v11
    v_sub_f32 v140, v140, v11
    v_sub_f32 v188, v188, v11
    v_sub_f32 v141, v141, v11
    v_sub_f32 v189, v189, v11
    v_sub_f32 v142, v142, v11
    v_sub_f32 v190, v190, v11
    v_sub_f32 v143, v143, v11
    v_sub_f32 v191, v191, v11
    s_nop 1
    s_branch L_back_1
L_rare_2:
    s_nop 15
    s_nop 3
    v_mov_b32 v12, v11
    s_nop 1
    v_permlane32_swap_b32 v11, v12
    s_nop 0
    v_max3_f32 v11, v11, v12, 0
    v_ceil_f32 v11, v11
    v_min_f32 v12, 0x43480000, v11
    v_cvt_i32_f32 v12, v12
    v_sub_u32 v12, 0, v12
    v_ldexp_f32 v12, 1.0, v12
    v_mul_f32 v32, v32, v12
    v_mul_f32 v33, v33, v12
    v_mul_f32 v34, v34, v12
    v_mul_f32 v35, v35, v12
    v_mul_f32 v36, v36, v12
    v_mul_f32 v37, v37, v12
    v_mul_f32 v38, v38, v12
    v_mul_f32 v39, v39, v12
    v_mul_f32 v40, v40, v12
    v_mul_f32 v41, v41, v12
    v_mul_f32 v42, v42, v12
    v_mul_f32 v43, v43, v12
    v_mul_f32 v44, v44, v12
    v_mul_f32 v45, v45, v12
    v_mul_f32 v46, v46, v12
    v_mul_f32 v47, v47, v12
    v_mul_f32 v48, v48, v12
    v_mul_f32 v49, v49, v12
    v_mul_f32 v50, v50, v12
    v_mul_f32 v51, v51, v12
    v_mul_f32 v52, v52, v12
    v_mul_f32 v53, v53, v12
    v_mul_f32 v54, v54, v12
    v_mul_f32 v55, v55, v12
    v_mul_f32 v56, v56, v12
    v_mul_f32 v57, v57, v12
    v_mul_f32 v58, v58, v12
    v_mul_f32 v59, v59, v12
    v_mul_f32 v60, v60, v12
    v_mul_f32 v61, v61, v12
    v_mul_f32 v62, v62, v12
    v_mul_f32 v63, v63, v12
    v_mul_f32 v64, v64, v12
    v_mul_f32 v65, v65, v12
    v_mul_f32 v66, v66, v12
    v_mul_f32 v67, v67, v12
    v_mul_f32 v68, v68, v12
    v_mul_f32 v69, v69, v12
    v_mul_f32 v70, v70, v12
    v_mul_f32 v71, v71, v12
    v_mul_f32 v72, v72, v12
    v_mul_f32 v73, v73, v12
    v_mul_f32 v74, v74, v12
    v_mul_f32 v75, v75, v12
    v_mul_f32 v76, v76, v12
    v_mul_f32 v77, v77, v12
    v_mul_f32 v78, v78, v12
    v_mul_f32 v79, v79, v12
    v_mul_f32 v80, v80, v12
    v_mul_f32 v81, v81, v12
    v_mul_f32 v82, v82, v12
    v_mul_f32 v83, v83, v12
    v_mul_f32 v84, v84, v12
    v_mul_f32 v85, v85, v12
    v_mul_f32 v86, v86, v12
    v_mul_f32 v87, v87, v12
    v_mul_f32 v88, v88, v12
    v_mul_f32 v89, v89, v12
    v_mul_f32 v90, v90, v12
    v_mul_f32 v91, v91, v12
    v_mul_f32 v92, v92, v12
    v_mul_f32 v93, v93, v12
    v_mul_f32 v94, v94, v12
    v_mul_f32 v95, v95, v12
    v_mul_f32 v192, v192, v12
    v_lshlrev_b32 v13, 16, v160
    v_and_b32 v14, 0xffff0000, v160
    v_mul_f32 v13, v13, v12
    v_mul_f32 v14, v14, v12
    v_cvt_pk_bf16_f32 v160, v13, v14
    v_lshlrev_b32 v13, 16, v161
    v_and_b32 v14, 0xffff0000, v161
    v_mul_f32 v13, v13, v12
    v_mul_f32 v14, v14, v12
    v_cvt_pk_bf16_f32 v161, v13, v14
    v_lshlrev_b32 v13, 16, v162
    v_and_b32 v14, 0xffff0000, v162
    v_mul_f32 v13, v13, v12
    v_mul_f32 v14, v14, v12
    v_cvt_pk_bf16_f32 v162, v13, v14
    v_lshlrev_b32 v13, 16, v163
    v_and_b32 v14, 0xffff0000, v163
    v_mul_f32 v13, v13, v12
    v_mul_f32 v14, v14, v12
    v_cvt_pk_bf16_f32 v163, v13, v14
    v_lshlrev_b32 v13, 16, v164
    v_and_b32 v14, 0xffff0000, v164
    v_mul_f32 v13, v13, v12
    v_mul_f32 v14, v14, v12
    v_cvt_pk_bf16_f32 v164, v13, v14
    v_lshlrev_b32 v13, 16, v165
    v_and_b32 v14, 0xffff0000, v165
    v_mul_f32 v13, v13, v12
    v_mul_f32 v14, v14, v12
    v_cvt_pk_bf16_f32 v165, v13, v14
    v_lshlrev_b32 v13, 16, v166
    v_and_b32 v14, 0xffff0000, v166
    v_mul_f32 v13, v13, v12
    v_mul_f32 v14, v14, v12
    v_cvt_pk_bf16_f32 v166, v13, v14
    v_lshlrev_b32 v13, 16, v167
    v_and_b32 v14, 0xffff0000, v167
    v_mul_f32 v13, v13, v12
    v_mul_f32 v14, v14, v12
    v_cvt_pk_bf16_f32 v167, v13, v14
    v_sub_f32 v144, v144, v11
    v_sub_f32 v176, v176, v11
    v_sub_f32 v145, v145, v11
    v_sub_f32 v177, v177, v11
    v_sub_f32 v146, v146, v11
    v_sub_f32 v178, v178, v11
    v_sub_f32 v147, v147, v11
    v_sub_f32 v179, v179, v11
    v_sub_f32 v148, v148, v11
    v_sub_f32 v180, v180, v11
    v_sub_f32 v149, v149, v11
    v_sub_f32 v181, v181, v11
    v_sub_f32 v150, v150, v11
    v_sub_f32 v182, v182, v11
    v_sub_f32 v151, v151, v11
    v_sub_f32 v183, v183, v11
    v_sub_f32 v152, v152, v11
    v_sub_f32 v184, v184, v11
    v_sub_f32 v153, v153, v11
    v_sub_f32 v185, v185, v11
    v_sub_f32 v154, v154, v11
    v_sub_f32 v186, v186, v11
    v_sub_f32 v155, v155, v11
    v_sub_f32 v187, v187, v11
    v_sub_f32 v156, v156, v11
    v_sub_f32 v188, v188, v11
    v_sub_f32 v157, v157, v11
    v_sub_f32 v189, v189, v11
    v_sub_f32 v158, v158, v11
    v_sub_f32 v190, v190, v11
    v_sub_f32 v159, v159, v11
    v_sub_f32 v191, v191, v11
    s_nop 1
    s_branch L_back_2
L_rare_3:
    s_nop 15
    s_nop 3
    v_mov_b32 v12, v11
    s_nop 1
    v_permlane32_swap_b32 v11, v12
    s_nop 0
    v_max3_f32 v11, v11, v12, 0
    v_ceil_f32 v11, v11
    v_min_f32 v12, 0x43480000, v11
    v_cvt_i32_f32 v12, v12
    v_sub_u32 v12, 0, v12
    v_ldexp_f32 v12, 1.0, v12
    v_mul_f32 v32, v32, v12
    v_mul_f32 v33, v33, v12
    v_mul_f32 v34, v34, v12
    v_mul_f32 v35, v35, v12
    v_mul_f32 v36, v36, v12
    v_mul_f32 v37, v37, v12
    v_mul_f32 v38, v38, v12
    v_mul_f32 v39, v39, v12
    v_mul_f32 v40, v40, v12
    v_mul_f32 v41, v41, v12
    v_mul_f32 v42, v42, v12
    v_mul_f32 v43, v43, v12
    v_mul_f32 v44, v44, v12
    v_mul_f32 v45, v45, v12
    v_mul_f32 v46, v46, v12
    v_mul_f32 v47, v47, v12
    v_mul_f32 v48, v48, v12
    v_mul_f32 v49, v49, v12
    v_mul_f32 v50, v50, v12
    v_mul_f32 v51, v51, v12
    v_mul_f32 v52, v52, v12
    v_mul_f32 v53, v53, v12
    v_mul_f32 v54, v54, v12
    v_mul_f32 v55, v55, v12
    v_mul_f32 v56, v56, v12
    v_mul_f32 v57, v57, v12
    v_mul_f32 v58, v58, v12
    v_mul_f32 v59, v59, v12
    v_mul_f32 v60, v60, v12
    v_mul_f32 v61, v61, v12
    v_mul_f32 v62, v62, v12
    v_mul_f32 v63, v63, v12
    v_mul_f32 v64, v64, v12
    v_mul_f32 v65, v65, v12
    v_mul_f32 v66, v66, v12
    v_mul_f32 v67, v67, v12
    v_mul_f32 v68, v68, v12
    v_mul_f32 v69, v69, v12
    v_mul_f32 v70, v70, v12
    v_mul_f32 v71, v71, v12
    v_mul_f32 v72, v72, v12
    v_mul_f32 v73, v73, v12
    v_mul_f32 v74, v74, v12
    v_mul_f32 v75, v75, v12
    v_mul_f32 v76, v76, v12
    v_mul_f32 v77, v77, v12
    v_mul_f32 v78, v78, v12
    v_mul_f32 v79, v79, v12
    v_mul_f32 v80, v80, v12
    v_mul_f32 v81, v81, v12
    v_mul_f32 v82, v82, v12
    v_mul_f32 v83, v83, v12
    v_mul_f32 v84, v84, v12
    v_mul_f32 v85, v85, v12
    v_mul_f32 v86, v86, v12
    v_mul_f32 v87, v87, v12
    v_mul_f32 v88, v88, v12
    v_mul_f32 v89, v89, v12
    v_mul_f32 v90, v90, v12
    v_mul_f32 v91, v91, v12
    v_mul_f32 v92, v92, v12
    v_mul_f32 v93, v93, v12
    v_mul_f32 v94, v94, v12
    v_mul_f32 v95, v95, v12
    v_mul_f32 v192, v192, v12
    v_lshlrev_b32 v13, 16, v168
    v_and_b32 v14, 0xffff0000, v168
    v_mul_f32 v13, v13, v12
    v_mul_f32 v14, v14, v12
    v_cvt_pk_bf16_f32 v168, v13, v14
    v_lshlrev_b32 v13, 16, v169
    v_and_b32 v14, 0xffff0000, v169
    v_mul_f32 v13, v13, v12
    v_mul_f32 v14, v14, v12
    v_cvt_pk_bf16_f32 v169, v13, v14
    v_lshlrev_b32 v13, 16, v170
    v_and_b32 v14, 0xffff0000, v170
    v_mul_f32 v13, v13, v12
    v_mul_f32 v14, v14, v12
    v_cvt_pk_bf16_f32 v170, v13, v14
    v_lshlrev_b32 v13, 16, v171
    v_and_b32 v14, 0xffff0000, v171
    v_mul_f32 v13, v13, v12
    v_mul_f32 v14, v14, v12
    v_cvt_pk_bf16_f32 v171, v13, v14
    v_lshlrev_b32 v13, 16, v172
    v_and_b32 v14, 0xffff0000, v172
    v_mul_f32 v13, v13, v12
    v_mul_f32 v14, v14, v12
    v_cvt_pk_bf16_f32 v172, v13, v14
    v_lshlrev_b32 v13, 16, v173
    v_and_b32 v14, 0xffff0000, v173
    v_mul_f32 v13, v13, v12
    v_mul_f32 v14, v14, v12
    v_cvt_pk_bf16_f32 v173, v13, v14
    v_lshlrev_b32 v13, 16, v174
    v_and_b32 v14, 0xffff0000, v174
    v_mul_f32 v13, v13, v12
    v_mul_f32 v14, v14, v12
    v_cvt_pk_bf16_f32 v174, v13, v14
    v_lshlrev_b32 v13, 16, v175
    v_and_b32 v14, 0xffff0000, v175
    v_mul_f32 v13, v13, v12
    v_mul_f32 v14, v14, v12
    v_cvt_pk_bf16_f32 v175, v13, v14
    v_sub_f32 v128, v128, v11
    v_sub_f32 v176, v176, v11
    v_sub_f32 v129, v129, v11
    v_sub_f32 v177, v177, v11
    v_sub_f32 v130, v130, v11
    v_sub_f32 v178, v178, v11
    v_sub_f32 v131, v131, v11
    v_sub_f32 v179, v179, v11
    v_sub_f32 v132, v132, v11
    v_sub_f32 v180, v180, v11
    v_sub_f32 v133, v133, v11
    v_sub_f32 v181, v181, v11
    v_sub_f32 v134, v134, v11
    v_sub_f32 v182, v182, v11
    v_sub_f32 v135, v135, v11
    v_sub_f32 v183, v183, v11
    v_sub_f32 v136, v136, v11
    v_sub_f32 v184, v184, v11
    v_sub_f32 v137, v137, v11
    v_sub_f32 v185, v185, v11
    v_sub_f32 v138, v138, v11
    v_sub_f32 v186, v186, v11
    v_sub_f32 v139, v139, v11
    v_sub_f32 v187, v187, v11
    v_sub_f32 v140, v140, v11
    v_sub_f32 v188, v188, v11
    v_sub_f32 v141, v141, v11
    v_sub_f32 v189, v189, v11
    v_sub_f32 v142, v142, v11
    v_sub_f32 v190, v190, v11
    v_sub_f32 v143, v143, v11
    v_sub_f32 v191, v191, v11
    s_nop 1
    s_branch L_back_3
L_rare_4:
    s_nop 15
    s_nop 3
    v_mov_b32 v12, v11
    s_nop 1
    v_permlane32_swap_b32 v11, v12
    s_nop 0
    v_max3_f32 v11, v11, v12, 0
    v_ceil_f32 v11, v11
    v_min_f32 v12, 0x43480000, v11
    v_cvt_i32_f32 v12, v12
    v_sub_u32 v12, 0, v12
    v_ldexp_f32 v12, 1.0, v12
    v_mul_f32 v32, v32, v12
    v_mul_f32 v33, v33, v12
    v_mul_f32 v34, v34, v12
    v_mul_f32 v35, v35, v12
    v_mul_f32 v36, v36, v12
    v_mul_f32 v37, v37, v12
    v_mul_f32 v38, v38, v12
    v_mul_f32 v39, v39, v12
    v_mul_f32 v40, v40, v12
    v_mul_f32 v41, v41, v12
    v_mul_f32 v42, v42, v12
    v_mul_f32 v43, v43, v12
    v_mul_f32 v44, v44, v12
    v_mul_f32 v45, v45, v12
    v_mul_f32 v46, v46, v12
    v_mul_f32 v47, v47, v12
    v_mul_f32 v48, v48, v12
    v_mul_f32 v49, v49, v12
    v_mul_f32 v50, v50, v12
    v_mul_f32 v51, v51, v12
    v_mul_f32 v52, v52, v12
    v_mul_f32 v53, v53, v12
    v_mul_f32 v54, v54, v12
    v_mul_f32 v55, v55, v12
    v_mul_f32 v56, v56, v12
    v_mul_f32 v57, v57, v12
    v_mul_f32 v58, v58, v12
    v_mul_f32 v59, v59, v12
    v_mul_f32 v60, v60, v12
    v_mul_f32 v61, v61, v12
    v_mul_f32 v62, v62, v12
    v_mul_f32 v63, v63, v12
    v_mul_f32 v64, v64, v12
    v_mul_f32 v65, v65, v12
    v_mul_f32 v66, v66, v12
    v_mul_f32 v67, v67, v12
    v_mul_f32 v68, v68, v12
    v_mul_f32 v69, v69, v12
    v_mul_f32 v70, v70, v12
    v_mul_f32 v71, v71, v12
    v_mul_f32 v72, v72, v12
    v_mul_f32 v73, v73, v12
    v_mul_f32 v74, v74, v12
    v_mul_f32 v75, v75, v12
    v_mul_f32 v76, v76, v12
    v_mul_f32 v77, v77, v12
    v_mul_f32 v78, v78, v12
    v_mul_f32 v79, v79, v12
    v_mul_f32 v80, v80, v12
    v_mul_f32 v81, v81, v12
    v_mul_f32 v82, v82, v12
    v_mul_f32 v83, v83, v12
    v_mul_f32 v84, v84, v12
    v_mul_f32 v85, v85, v12
    v_mul_f32 v86, v86, v12
    v_mul_f32 v87, v87, v12
    v_mul_f32 v88, v88, v12
    v_mul_f32 v89, v89, v12
    v_mul_f32 v90, v90, v12
    v_mul_f32 v91, v91, v12
    v_mul_f32 v92, v92, v12
    v_mul_f32 v93, v93, v12
    v_mul_f32 v94, v94, v12
    v_mul_f32 v95, v95, v12
    v_mul_f32 v192, v192, v12
    v_lshlrev_b32 v13, 16, v160
    v_and_b32 v14, 0xffff0000, v160
    v_mul_f32 v13, v13, v12
    v_mul_f32 v14, v14, v12
    v_cvt_pk_bf16_f32 v160, v13, v14
    v_lshlrev_b32 v13, 16, v161
    v_and_b32 v14, 0xffff0000, v161
    v_mul_f32 v13, v13, v12
    v_mul_f32 v14, v14, v12
    v_cvt_pk_bf16_f32 v161, v13, v14
    v_lshlrev_b32 v13, 16, v162
    v_and_b32 v14, 0xffff0000, v162
    v_mul_f32 v13, v13, v12
    v_mul_f32 v14, v14, v12
    v_cvt_pk_bf16_f32 v162, v13, v14
    v_lshlrev_b32 v13, 16, v163
    v_and_b32 v14, 0xffff0000, v163
    v_mul_f32 v13, v13, v12
    v_mul_f32 v14, v14, v12
    v_cvt_pk_bf16_f32 v163, v13, v14
    v_lshlrev_b32 v13, 16, v164
    v_and_b32 v14, 0xffff0000, v164
    v_mul_f32 v13, v13, v12
    v_mul_f32 v14, v14, v12
    v_cvt_pk_bf16_f32 v164, v13, v14
    v_lshlrev_b32 v13, 16, v165
    v_and_b32 v14, 0xffff0000, v165
    v_mul_f32 v13, v13, v12
    v_mul_f32 v14, v14, v12
    v_cvt_pk_bf16_f32 v165, v13, v14
    v_lshlrev_b32 v13, 16, v166
    v_and_b32 v14, 0xffff0000, v166
    v_mul_f32 v13, v13, v12
    v_mul_f32 v14, v14, v12
    v_cvt_pk_bf16_f32 v166, v13, v14
    v_lshlrev_b32 v13, 16, v167
    v_and_b32 v14, 0xffff0000, v167
    v_mul_f32 v13, v13, v12
    v_mul_f32 v14, v14, v12
    v_cvt_pk_bf16_f32 v167, v13, v14
    v_sub_f32 v144, v144, v11
    v_sub_f32 v176, v176, v11
    v_sub_f32 v145, v145, v11
    v_sub_f32 v177, v177, v11
    v_sub_f32 v146, v146, v11
    v_sub_f32 v178, v178, v11
    v_sub_f32 v147, v147, v11
    v_sub_f32 v179, v179, v11
    v_sub_f32 v148, v148, v11
    v_sub_f32 v180, v180, v11
    v_sub_f32 v149, v149, v11
    v_sub_f32 v181, v181, v11
    v_sub_f32 v150, v150, v11
    v_sub_f32 v182, v182, v11
    v_sub_f32 v151, v151, v11
    v_sub_f32 v183, v183, v11
    v_sub_f32 v152, v152, v11
    v_sub_f32 v184, v184, v11
    v_sub_f32 v153, v153, v11
    v_sub_f32 v185, v185, v11
    v_sub_f32 v154, v154, v11
    v_sub_f32 v186, v186, v11
    v_sub_f32 v155, v155, v11
    v_sub_f32 v187, v187, v11
    v_sub_f32 v156, v156, v11
    v_sub_f32 v188, v188, v11
    v_sub_f32 v157, v157, v11
    v_sub_f32 v189, v189, v11
    v_sub_f32 v158, v158, v11
    v_sub_f32 v190, v190, v11
    v_sub_f32 v159, v159, v11
    v_sub_f32 v191, v191, v11
    s_nop 1
    s_branch L_back_4
L_rare_5:
    s_nop 15
    s_nop 3
    v_mov_b32 v12, v11
    s_nop 1
    v_permlane32_swap_b32 v11, v12
    s_nop 0
    v_max3_f32 v11, v11, v12, 0
    v_ceil_f32 v11, v11
    v_min_f32 v12, 0x43480000, v11
    v_cvt_i32_f32 v12, v12
    v_sub_u32 v12, 0, v12
    v_ldexp_f32 v12, 1.0, v12
    v_mul_f32 v32, v32, v12
    v_mul_f32 v33, v33, v12
    v_mul_f32 v34, v34, v12
    v_mul_f32 v35, v35, v12
    v_mul_f32 v36, v36, v12
    v_mul_f32 v37, v37, v12
    v_mul_f32 v38, v38, v12
    v_mul_f32 v39, v39, v12
    v_mul_f32 v40, v40, v12
    v_mul_f32 v41, v41, v12
    v_mul_f32 v42, v42, v12
    v_mul_f32 v43, v43, v12
    v_mul_f32 v44, v44, v12
    v_mul_f32 v45, v45, v12
    v_mul_f32 v46, v46, v12
    v_mul_f32 v47, v47, v12
    v_mul_f32 v48, v48, v12
    v_mul_f32 v49, v49, v12
    v_mul_f32 v50, v50, v12
    v_mul_f32 v51, v51, v12
    v_mul_f32 v52, v52, v12
    v_mul_f32 v53, v53, v12
    v_mul_f32 v54, v54, v12
    v_mul_f32 v55, v55, v12
    v_mul_f32 v56, v56, v12
    v_mul_f32 v57, v57, v12
    v_mul_f32 v58, v58, v12
    v_mul_f32 v59, v59, v12
    v_mul_f32 v60, v60, v12
    v_mul_f32 v61, v61, v12
    v_mul_f32 v62, v62, v12
    v_mul_f32 v63, v63, v12
    v_mul_f32 v64, v64, v12
    v_mul_f32 v65, v65, v12
    v_mul_f32 v66, v66, v12
    v_mul_f32 v67, v67, v12
    v_mul_f32 v68, v68, v12
    v_mul_f32 v69, v69, v12
    v_mul_f32 v70, v70, v12
    v_mul_f32 v71, v71, v12
    v_mul_f32 v72, v72, v12
    v_mul_f32 v73, v73, v12
    v_mul_f32 v74, v74, v12
    v_mul_f32 v75, v75, v12
    v_mul_f32 v76, v76, v12
    v_mul_f32 v77, v77, v12
    v_mul_f32 v78, v78, v12
    v_mul_f32 v79, v79, v12
    v_mul_f32 v80, v80, v12
    v_mul_f32 v81, v81, v12
    v_mul_f32 v82, v82, v12
    v_mul_f32 v83, v83, v12
    v_mul_f32 v84, v84, v12
    v_mul_f32 v85, v85, v12
    v_mul_f32 v86, v86, v12
    v_mul_f32 v87, v87, v12
    v_mul_f32 v88, v88, v12
    v_mul_f32 v89, v89, v12
    v_mul_f32 v90, v90, v12
    v_mul_f32 v91, v91, v12
    v_mul_f32 v92, v92, v12
    v_mul_f32 v93, v93, v12
    v_mul_f32 v94, v94, v12
    v_mul_f32 v95, v95, v12
    v_mul_f32 v192, v192, v12
    v_lshlrev_b32 v13, 16, v168
    v_and_b32 v14, 0xffff0000, v168
    v_mul_f32 v13, v13, v12
    v_mul_f32 v14, v14, v12
    v_cvt_pk_bf16_f32 v168, v13, v14
    v_lshlrev_b32 v13, 16, v169
    v_and_b32 v14, 0xffff0000, v169
    v_mul_f32 v13, v13, v12
    v_mul_f32 v14, v14, v12
    v_cvt_pk_bf16_f32 v169, v13, v14
    v_lshlrev_b32 v13, 16, v170
    v_and_b32 v14, 0xffff0000, v170
    v_mul_f32 v13, v13, v12
    v_mul_f32 v14, v14, v12
    v_cvt_pk_bf16_f32 v170, v13, v14
    v_lshlrev_b32 v13, 16, v171
    v_and_b32 v14, 0xffff0000, v171
    v_mul_f32 v13, v13, v12
    v_mul_f32 v14, v14, v12
    v_cvt_pk_bf16_f32 v171, v13, v14
    v_lshlrev_b32 v13, 16, v172
    v_and_b32 v14, 0xffff0000, v172
    v_mul_f32 v13, v13, v12
    v_mul_f32 v14, v14, v12
    v_cvt_pk_bf16_f32 v172, v13, v14
    v_lshlrev_b32 v13, 16, v173
    v_and_b32 v14, 0xffff0000, v173
    v_mul_f32 v13, v13, v12
    v_mul_f32 v14, v14, v12
    v_cvt_pk_bf16_f32 v173, v13, v14
    v_lshlrev_b32 v13, 16, v174
    v_and_b32 v14, 0xffff0000, v174
    v_mul_f32 v13, v13, v12
    v_mul_f32 v14, v14, v12
    v_cvt_pk_bf16_f32 v174, v13, v14
    v_lshlrev_b32 v13, 16, v175
    v_and_b32 v14, 0xffff0000, v175
    v_mul_f32 v13, v13, v12
    v_mul_f32 v14, v14, v12
    v_cvt_pk_bf16_f32 v175, v13, v14
    v_sub_f32 v128, v128, v11
    v_sub_f32 v176, v176, v11
    v_sub_f32 v129, v129, v11
    v_sub_f32 v177, v177, v11
    v_sub_f32 v130, v130, v11
    v_sub_f32 v178, v178, v11
    v_sub_f32 v131, v131, v11
    v_sub_f32 v179, v179, v11
    v_sub_f32 v132, v132, v11
    v_sub_f32 v180, v180, v11
    v_sub_f32 v133, v133, v11
    v_sub_f32 v181, v181, v11
    v_sub_f32 v134, v134, v11
    v_sub_f32 v182, v182, v11
    v_sub_f32 v135, v135, v11
    v_sub_f32 v183, v183, v11
    v_sub_f32 v136, v136, v11
    v_sub_f32 v184, v184, v11
    v_sub_f32 v137, v137, v11
    v_sub_f32 v185, v185, v11
    v_sub_f32 v138, v138, v11
    v_sub_f32 v186, v186, v11
    v_sub_f32 v139, v139, v11
    v_sub_f32 v187, v187, v11
    v_sub_f32 v140, v140, v11
    v_sub_f32 v188, v188, v11
    v_sub_f32 v141, v141, v11
    v_sub_f32 v189, v189, v11
    v_sub_f32 v142, v142, v11
    v_sub_f32 v190, v190, v11
    v_sub_f32 v143, v143, v11
    v_sub_f32 v191, v191, v11
    s_nop 1
    s_branch L_back_5
L_rare_6:
    s_nop 15
    s_nop 3
    v_mov_b32 v12, v11
    s_nop 1
    v_permlane32_swap_b32 v11, v12
    s_nop 0
    v_max3_f32 v11, v11, v12, 0
    v_ceil_f32 v11, v11
    v_min_f32 v12, 0x43480000, v11
    v_cvt_i32_f32 v12, v12
    v_sub_u32 v12, 0, v12
    v_ldexp_f32 v12, 1.0, v12
    v_mul_f32 v32, v32, v12
    v_mul_f32 v33, v33, v12
    v_mul_f32 v34, v34, v12
    v_mul_f32 v35, v35, v12
    v_mul_f32 v36, v36, v12
    v_mul_f32 v37, v37, v12
    v_mul_f32 v38, v38, v12
    v_mul_f32 v39, v39, v12
    v_mul_f32 v40, v40, v12
    v_mul_f32 v41, v41, v12
    v_mul_f32 v42, v42, v12
    v_mul_f32 v43, v43, v12
    v_mul_f32 v44, v44, v12
    v_mul_f32 v45, v45, v12
    v_mul_f32 v46, v46, v12
    v_mul_f32 v47, v47, v12
    v_mul_f32 v48, v48, v12
    v_mul_f32 v49, v49, v12
    v_mul_f32 v50, v50, v12
    v_mul_f32 v51, v51, v12
    v_mul_f32 v52, v52, v12
    v_mul_f32 v53, v53, v12
    v_mul_f32 v54, v54, v12
    v_mul_f32 v55, v55, v12
    v_mul_f32 v56, v56, v12
    v_mul_f32 v57, v57, v12
    v_mul_f32 v58, v58, v12
    v_mul_f32 v59, v59, v12
    v_mul_f32 v60, v60, v12
    v_mul_f32 v61, v61, v12
    v_mul_f32 v62, v62, v12
    v_mul_f32 v63, v63, v12
    v_mul_f32 v64, v64, v12
    v_mul_f32 v65, v65, v12
    v_mul_f32 v66, v66, v12
    v_mul_f32 v67, v67, v12
    v_mul_f32 v68, v68, v12
    v_mul_f32 v69, v69, v12
    v_mul_f32 v70, v70, v12
    v_mul_f32 v71, v71, v12
    v_mul_f32 v72, v72, v12
    v_mul_f32 v73, v73, v12
    v_mul_f32 v74, v74, v12
    v_mul_f32 v75, v75, v12
    v_mul_f32 v76, v76, v12
    v_mul_f32 v77, v77, v12
    v_mul_f32 v78, v78, v12
    v_mul_f32 v79, v79, v12
    v_mul_f32 v80, v80, v12
    v_mul_f32 v81, v81, v12
    v_mul_f32 v82, v82, v12
    v_mul_f32 v83, v83, v12
    v_mul_f32 v84, v84, v12
    v_mul_f32 v85, v85, v12
    v_mul_f32 v86, v86, v12
    v_mul_f32 v87, v87, v12
    v_mul_f32 v88, v88, v12
    v_mul_f32 v89, v89, v12
    v_mul_f32 v90, v90, v12
    v_mul_f32 v91, v91, v12
    v_mul_f32 v92, v92, v12
    v_mul_f32 v93, v93, v12
    v_mul_f32 v94, v94, v12
    v_mul_f32 v95, v95, v12
    v_mul_f32 v192, v192, v12
    v_lshlrev_b32 v13, 16, v160
    v_and_b32 v14, 0xffff0000, v160
    v_mul_f32 v13, v13, v12
    v_mul_f32 v14, v14, v12
    v_cvt_pk_bf16_f32 v160, v13, v14
    v_lshlrev_b32 v13, 16, v161
    v_and_b32 v14, 0xffff0000, v161
    v_mul_f32 v13, v13, v12
    v_mul_f32 v14, v14, v12
    v_cvt_pk_bf16_f32 v161, v13, v14
    v_lshlrev_b32 v13, 16, v162
    v_and_b32 v14, 0xffff0000, v162
    v_mul_f32 v13, v13, v12
    v_mul_f32 v14, v14, v12
    v_cvt_pk_bf16_f32 v162, v13, v14
    v_lshlrev_b32 v13, 16, v163
    v_and_b32 v14, 0xffff0000, v163
    v_mul_f32 v13, v13, v12
    v_mul_f32 v14, v14, v12
    v_cvt_pk_bf16_f32 v163, v13, v14
    v_lshlrev_b32 v13, 16, v164
    v_and_b32 v14, 0xffff0000, v164
    v_mul_f32 v13, v13, v12
    v_mul_f32 v14, v14, v12
    v_cvt_pk_bf16_f32 v164, v13, v14
    v_lshlrev_b32 v13, 16, v165
    v_and_b32 v14, 0xffff0000, v165
    v_mul_f32 v13, v13, v12
    v_mul_f32 v14, v14, v12
    v_cvt_pk_bf16_f32 v165, v13, v14
    v_lshlrev_b32 v13, 16, v166
    v_and_b32 v14, 0xffff0000, v166
    v_mul_f32 v13, v13, v12
    v_mul_f32 v14, v14, v12
    v_cvt_pk_bf16_f32 v166, v13, v14
    v_lshlrev_b32 v13, 16, v167
    v_and_b32 v14, 0xffff0000, v167
    v_mul_f32 v13, v13, v12
    v_mul_f32 v14, v14, v12
    v_cvt_pk_bf16_f32 v167, v13, v14
    v_sub_f32 v144, v144, v11
    v_sub_f32 v176, v176, v11
    v_sub_f32 v145, v145, v11
    v_sub_f32 v177, v177, v11
    v_sub_f32 v146, v146, v11
    v_sub_f32 v178, v178, v11
    v_sub_f32 v147, v147, v11
    v_sub_f32 v179, v179, v11
    v_sub_f32 v148, v148, v11
    v_sub_f32 v180, v180, v11
    v_sub_f32 v149, v149, v11
    v_sub_f32 v181, v181, v11
    v_sub_f32 v150, v150, v11
    v_sub_f32 v182, v182, v11
    v_sub_f32 v151, v151, v11
    v_sub_f32 v183, v183, v11
    v_sub_f32 v152, v152, v11
    v_sub_f32 v184, v184, v11
    v_sub_f32 v153, v153, v11
    v_sub_f32 v185, v185, v11
    v_sub_f32 v154, v154, v11
    v_sub_f32 v186, v186, v11
    v_sub_f32 v155, v155, v11
    v_sub_f32 v187, v187, v11
    v_sub_f32 v156, v156, v11
    v_sub_f32 v188, v188, v11
    v_sub_f32 v157, v157, v11
    v_sub_f32 v189, v189, v11
    v_sub_f32 v158, v158, v11
    v_sub_f32 v190, v190, v11
    v_sub_f32 v159, v159, v11
    v_sub_f32 v191, v191, v11
    s_nop 1
    s_branch L_back_6
L_rare_7:
    s_nop 15
    s_nop 3
    v_mov_b32 v12, v11
    s_nop 1
    v_permlane32_swap_b32 v11, v12
    s_nop 0
    v_max3_f32 v11, v11, v12, 0
    v_ceil_f32 v11, v11
    v_min_f32 v12, 0x43480000, v11
    v_cvt_i32_f32 v12, v12
    v_sub_u32 v12, 0, v12
    v_ldexp_f32 v12, 1.0, v12
    v_mul_f32 v32, v32, v12
    v_mul_f32 v33, v33, v12
    v_mul_f32 v34, v34, v12
    v_mul_f32 v35, v35, v12
    v_mul_f32 v36, v36, v12
    v_mul_f32 v37, v37, v12
    v_mul_f32 v38, v38, v12
    v_mul_f32 v39, v39, v12
    v_mul_f32 v40, v40, v12
    v_mul_f32 v41, v41, v12
    v_mul_f32 v42, v42, v12
    v_mul_f32 v43, v43, v12
    v_mul_f32 v44, v44, v12
    v_mul_f32 v45, v45, v12
    v_mul_f32 v46, v46, v12
    v_mul_f32 v47, v47, v12
    v_mul_f32 v48, v48, v12
    v_mul_f32 v49, v49, v12
    v_mul_f32 v50, v50, v12
    v_mul_f32 v51, v51, v12
    v_mul_f32 v52, v52, v12
    v_mul_f32 v53, v53, v12
    v_mul_f32 v54, v54, v12
    v_mul_f32 v55, v55, v12
    v_mul_f32 v56, v56, v12
    v_mul_f32 v57, v57, v12
    v_mul_f32 v58, v58, v12
    v_mul_f32 v59, v59, v12
    v_mul_f32 v60, v60, v12
    v_mul_f32 v61, v61, v12
    v_mul_f32 v62, v62, v12
    v_mul_f32 v63, v63, v12
    v_mul_f32 v64, v64, v12
    v_mul_f32 v65, v65, v12
    v_mul_f32 v66, v66, v12
    v_mul_f32 v67, v67, v12
    v_mul_f32 v68, v68, v12
    v_mul_f32 v69, v69, v12
    v_mul_f32 v70, v70, v12
    v_mul_f32 v71, v71, v12
    v_mul_f32 v72, v72, v12
    v_mul_f32 v73, v73, v12
    v_mul_f32 v74, v74, v12
    v_mul_f32 v75, v75, v12
    v_mul_f32 v76, v76, v12
    v_mul_f32 v77, v77, v12
    v_mul_f32 v78, v78, v12
    v_mul_f32 v79, v79, v12
    v_mul_f32 v80, v80, v12
    v_mul_f32 v81, v81, v12
    v_mul_f32 v82, v82, v12
    v_mul_f32 v83, v83, v12
    v_mul_f32 v84, v84, v12
    v_mul_f32 v85, v85, v12
    v_mul_f32 v86, v86, v12
    v_mul_f32 v87, v87, v12
    v_mul_f32 v88, v88, v12
    v_mul_f32 v89, v89, v12
    v_mul_f32 v90, v90, v12
    v_mul_f32 v91, v91, v12
    v_mul_f32 v92, v92, v12
    v_mul_f32 v93, v93, v12
    v_mul_f32 v94, v94, v12
    v_mul_f32 v95, v95, v12
    v_mul_f32 v192, v192, v12
    v_lshlrev_b32 v13, 16, v168
    v_and_b32 v14, 0xffff0000, v168
    v_mul_f32 v13, v13, v12
    v_mul_f32 v14, v14, v12
    v_cvt_pk_bf16_f32 v168, v13, v14
    v_lshlrev_b32 v13, 16, v169
    v_and_b32 v14, 0xffff0000, v169
    v_mul_f32 v13, v13, v12
    v_mul_f32 v14, v14, v12
    v_cvt_pk_bf16_f32 v169, v13, v14
    v_lshlrev_b32 v13, 16, v170
    v_and_b32 v14, 0xffff0000, v170
    v_mul_f32 v13, v13, v12
    v_mul_f32 v14, v14, v12
    v_cvt_pk_bf16_f32 v170, v13, v14
    v_lshlrev_b32 v13, 16, v171
    v_and_b32 v14, 0xffff0000, v171
    v_mul_f32 v13, v13, v12
    v_mul_f32 v14, v14, v12
    v_cvt_pk_bf16_f32 v171, v13, v14
    v_lshlrev_b32 v13, 16, v172
    v_and_b32 v14, 0xffff0000, v172
    v_mul_f32 v13, v13, v12
    v_mul_f32 v14, v14, v12
    v_cvt_pk_bf16_f32 v172, v13, v14
    v_lshlrev_b32 v13, 16, v173
    v_and_b32 v14, 0xffff0000, v173
    v_mul_f32 v13, v13, v12
    v_mul_f32 v14, v14, v12
    v_cvt_pk_bf16_f32 v173, v13, v14
    v_lshlrev_b32 v13, 16, v174
    v_and_b32 v14, 0xffff0000, v174
    v_mul_f32 v13, v13, v12
    v_mul_f32 v14, v14, v12
    v_cvt_pk_bf16_f32 v174, v13, v14
    v_lshlrev_b32 v13, 16, v175
    v_and_b32 v14, 0xffff0000, v175
    v_mul_f32 v13, v13, v12
    v_mul_f32 v14, v14, v12
    v_cvt_pk_bf16_f32 v175, v13, v14
    v_sub_f32 v128, v128, v11
    v_sub_f32 v176, v176, v11
    v_sub_f32 v129, v129, v11
    v_sub_f32 v177, v177, v11
    v_sub_f32 v130, v130, v11
    v_sub_f32 v178, v178, v11
    v_sub_f32 v131, v131, v11
    v_sub_f32 v179, v179, v11
    v_sub_f32 v132, v132, v11
    v_sub_f32 v180, v180, v11
    v_sub_f32 v133, v133, v11
    v_sub_f32 v181, v181, v11
    v_sub_f32 v134, v134, v11
    v_sub_f32 v182, v182, v11
    v_sub_f32 v135, v135, v11
    v_sub_f32 v183, v183, v11
    v_sub_f32 v136, v136, v11
    v_sub_f32 v184, v184, v11
    v_sub_f32 v137, v137, v11
    v_sub_f32 v185, v185, v11
    v_sub_f32 v138, v138, v11
    v_sub_f32 v186, v186, v11
    v_sub_f32 v139, v139, v11
    v_sub_f32 v187, v187, v11
    v_sub_f32 v140, v140, v11
    v_sub_f32 v188, v188, v11
    v_sub_f32 v141, v141, v11
    v_sub_f32 v189, v189, v11
    v_sub_f32 v142, v142, v11
    v_sub_f32 v190, v190, v11
    v_sub_f32 v143, v143, v11
    v_sub_f32 v191, v191, v11
    s_nop 1
    s_branch L_back_7
L_rare_8:
    s_nop 15
    s_nop 3
    v_mov_b32 v12, v11
    s_nop 1
    v_permlane32_swap_b32 v11, v12
    s_nop 0
    v_max3_f32 v11, v11, v12, 0
    v_ceil_f32 v11, v11
    v_min_f32 v12, 0x43480000, v11
    v_cvt_i32_f32 v12, v12
    v_sub_u32 v12, 0, v12
    v_ldexp_f32 v12, 1.0, v12
    v_mul_f32 v32, v32, v12
    v_mul_f32 v33, v33, v12
    v_mul_f32 v34, v34, v12
    v_mul_f32 v35, v35, v12
    v_mul_f32 v36, v36, v12
    v_mul_f32 v37, v37, v12
    v_mul_f32 v38, v38, v12
    v_mul_f32 v39, v39, v12
    v_mul_f32 v40, v40, v12
    v_mul_f32 v41, v41, v12
    v_mul_f32 v42, v42, v12
    v_mul_f32 v43, v43, v12
    v_mul_f32 v44, v44, v12
    v_mul_f32 v45, v45, v12
    v_mul_f32 v46, v46, v12
    v_mul_f32 v47, v47, v12
    v_mul_f32 v48, v48, v12
    v_mul_f32 v49, v49, v12
    v_mul_f32 v50, v50, v12
    v_mul_f32 v51, v51, v12
    v_mul_f32 v52, v52, v12
    v_mul_f32 v53, v53, v12
    v_mul_f32 v54, v54, v12
    v_mul_f32 v55, v55, v12
    v_mul_f32 v56, v56, v12
    v_mul_f32 v57, v57, v12
    v_mul_f32 v58, v58, v12
    v_mul_f32 v59, v59, v12
    v_mul_f32 v60, v60, v12
    v_mul_f32 v61, v61, v12
    v_mul_f32 v62, v62, v12
    v_mul_f32 v63, v63, v12
    v_mul_f32 v64, v64, v12
    v_mul_f32 v65, v65, v12
    v_mul_f32 v66, v66, v12
    v_mul_f32 v67, v67, v12
    v_mul_f32 v68, v68, v12
    v_mul_f32 v69, v69, v12
    v_mul_f32 v70, v70, v12
    v_mul_f32 v71, v71, v12
    v_mul_f32 v72, v72, v12
    v_mul_f32 v73, v73, v12
    v_mul_f32 v74, v74, v12
    v_mul_f32 v75, v75, v12
    v_mul_f32 v76, v76, v12
    v_mul_f32 v77, v77, v12
    v_mul_f32 v78, v78, v12
    v_mul_f32 v79, v79, v12
    v_mul_f32 v80, v80, v12
    v_mul_f32 v81, v81, v12
    v_mul_f32 v82, v82, v12
    v_mul_f32 v83, v83, v12
    v_mul_f32 v84, v84, v12
    v_mul_f32 v85, v85, v12
    v_mul_f32 v86, v86, v12
    v_mul_f32 v87, v87, v12
    v_mul_f32 v88, v88, v12
    v_mul_f32 v89, v89, v12
    v_mul_f32 v90, v90, v12
    v_mul_f32 v91, v91, v12
    v_mul_f32 v92, v92, v12
    v_mul_f32 v93, v93, v12
    v_mul_f32 v94, v94, v12
    v_mul_f32 v95, v95, v12
    v_mul_f32 v192, v192, v12
    v_lshlrev_b32 v13, 16, v160
    v_and_b32 v14, 0xffff0000, v160
    v_mul_f32 v13, v13, v12
    v_mul_f32 v14, v14, v12
    v_cvt_pk_bf16_f32 v160, v13, v14
    v_lshlrev_b32 v13, 16, v161
    v_and_b32 v14, 0xffff0000, v161
    v_mul_f32 v13, v13, v12
    v_mul_f32 v14, v14, v12
    v_cvt_pk_bf16_f32 v161, v13, v14
    v_lshlrev_b32 v13, 16, v162
    v_and_b32 v14, 0xffff0000, v162
    v_mul_f32 v13, v13, v12
    v_mul_f32 v14, v14, v12
    v_cvt_pk_bf16_f32 v162, v13, v14
    v_lshlrev_b32 v13, 16, v163
    v_and_b32 v14, 0xffff0000, v163
    v_mul_f32 v13, v13, v12
    v_mul_f32 v14, v14, v12
    v_cvt_pk_bf16_f32 v163, v13, v14
    v_lshlrev_b32 v13, 16, v164
    v_and_b32 v14, 0xffff0000, v164
    v_mul_f32 v13, v13, v12
    v_mul_f32 v14, v14, v12
    v_cvt_pk_bf16_f32 v164, v13, v14
    v_lshlrev_b32 v13, 16, v165
    v_and_b32 v14, 0xffff0000, v165
    v_mul_f32 v13, v13, v12
    v_mul_f32 v14, v14, v12
    v_cvt_pk_bf16_f32 v165, v13, v14
    v_lshlrev_b32 v13, 16, v166
    v_and_b32 v14, 0xffff0000, v166
    v_mul_f32 v13, v13, v12
    v_mul_f32 v14, v14, v12
    v_cvt_pk_bf16_f32 v166, v13, v14
    v_lshlrev_b32 v13, 16, v167
    v_and_b32 v14, 0xffff0000, v167
    v_mul_f32 v13, v13, v12
    v_mul_f32 v14, v14, v12
    v_cvt_pk_bf16_f32 v167, v13, v14
    v_sub_f32 v144, v144, v11
    v_sub_f32 v176, v176, v11
    v_sub_f32 v145, v145, v11
    v_sub_f32 v177, v177, v11
    v_sub_f32 v146, v146, v11
    v_sub_f32 v178, v178, v11
    v_sub_f32 v147, v147, v11
    v_sub_f32 v179, v179, v11
    v_sub_f32 v148, v148, v11
    v_sub_f32 v180, v180, v11
    v_sub_f32 v149, v149, v11
    v_sub_f32 v181, v181, v11
    v_sub_f32 v150, v150, v11
    v_sub_f32 v182, v182, v11
    v_sub_f32 v151, v151, v11
    v_sub_f32 v183, v183, v11
    v_sub_f32 v152, v152, v11
    v_sub_f32 v184, v184, v11
    v_sub_f32 v153, v153, v11
    v_sub_f32 v185, v185, v11
    v_sub_f32 v154, v154, v11
    v_sub_f32 v186, v186, v11
    v_sub_f32 v155, v155, v11
    v_sub_f32 v187, v187, v11
    v_sub_f32 v156, v156, v11
    v_sub_f32 v188, v188, v11
    v_sub_f32 v157, v157, v11
    v_sub_f32 v189, v189, v11
    v_sub_f32 v158, v158, v11
    v_sub_f32 v190, v190, v11
    v_sub_f32 v159, v159, v11
    v_sub_f32 v191, v191, v11
    s_nop 1
    s_branch L_back_8
L_rare_9:
    s_nop 15
    s_nop 3
    v_mov_b32 v12, v11
    s_nop 1
    v_permlane32_swap_b32 v11, v12
    s_nop 0
    v_max3_f32 v11, v11, v12, 0
    v_ceil_f32 v11, v11
    v_min_f32 v12, 0x43480000, v11
    v_cvt_i32_f32 v12, v12
    v_sub_u32 v12, 0, v12
    v_ldexp_f32 v12, 1.0, v12
    v_mul_f32 v32, v32, v12
    v_mul_f32 v33, v33, v12
    v_mul_f32 v34, v34, v12
    v_mul_f32 v35, v35, v12
    v_mul_f32 v36, v36, v12
    v_mul_f32 v37, v37, v12
    v_mul_f32 v38, v38, v12
    v_mul_f32 v39, v39, v12
    v_mul_f32 v40, v40, v12
    v_mul_f32 v41, v41, v12
    v_mul_f32 v42, v42, v12
    v_mul_f32 v43, v43, v12
    v_mul_f32 v44, v44, v12
    v_mul_f32 v45, v45, v12
    v_mul_f32 v46, v46, v12
    v_mul_f32 v47, v47, v12
    v_mul_f32 v48, v48, v12
    v_mul_f32 v49, v49, v12
    v_mul_f32 v50, v50, v12
    v_mul_f32 v51, v51, v12
    v_mul_f32 v52, v52, v12
    v_mul_f32 v53, v53, v12
    v_mul_f32 v54, v54, v12
    v_mul_f32 v55, v55, v12
    v_mul_f32 v56, v56, v12
    v_mul_f32 v57, v57, v12
    v_mul_f32 v58, v58, v12
    v_mul_f32 v59, v59, v12
    v_mul_f32 v60, v60, v12
    v_mul_f32 v61, v61, v12
    v_mul_f32 v62, v62, v12
    v_mul_f32 v63, v63, v12
    v_mul_f32 v64, v64, v12
    v_mul_f32 v65, v65, v12
    v_mul_f32 v66, v66, v12
    v_mul_f32 v67, v67, v12
    v_mul_f32 v68, v68, v12
    v_mul_f32 v69, v69, v12
    v_mul_f32 v70, v70, v12
    v_mul_f32 v71, v71, v12
    v_mul_f32 v72, v72, v12
    v_mul_f32 v73, v73, v12
    v_mul_f32 v74, v74, v12
    v_mul_f32 v75, v75, v12
    v_mul_f32 v76, v76, v12
    v_mul_f32 v77, v77, v12
    v_mul_f32 v78, v78, v12
    v_mul_f32 v79, v79, v12
    v_mul_f32 v80, v80, v12
    v_mul_f32 v81, v81, v12
    v_mul_f32 v82, v82, v12
    v_mul_f32 v83, v83, v12
    v_mul_f32 v84, v84, v12
    v_mul_f32 v85, v85, v12
    v_mul_f32 v86, v86, v12
    v_mul_f32 v87, v87, v12
    v_mul_f32 v88, v88, v12
    v_mul_f32 v89, v89, v12
    v_mul_f32 v90, v90, v12
    v_mul_f32 v91, v91, v12
    v_mul_f32 v92, v92, v12
    v_mul_f32 v93, v93, v12
    v_mul_f32 v94, v94, v12
    v_mul_f32 v95, v95, v12
    v_mul_f32 v192, v192, v12
    v_lshlrev_b32 v13, 16, v168
    v_and_b32 v14, 0xffff0000, v168
    v_mul_f32 v13, v13, v12
    v_mul_f32 v14, v14, v12
    v_cvt_pk_bf16_f32 v168, v13, v14
    v_lshlrev_b32 v13, 16, v169
    v_and_b32 v14, 0xffff0000, v169
    v_mul_f32 v13, v13, v12
    v_mul_f32 v14, v14, v12
    v_cvt_pk_bf16_f32 v169, v13, v14
    v_lshlrev_b32 v13, 16, v170
    v_and_b32 v14, 0xffff0000, v170
    v_mul_f32 v13, v13, v12
    v_mul_f32 v14, v14, v12
    v_cvt_pk_bf16_f32 v170, v13, v14
    v_lshlrev_b32 v13, 16, v171
    v_and_b32 v14, 0xffff0000, v171
    v_mul_f32 v13, v13, v12
    v_mul_f32 v14, v14, v12
    v_cvt_pk_bf16_f32 v171, v13, v14
    v_lshlrev_b32 v13, 16, v172
    v_and_b32 v14, 0xffff0000, v172
    v_mul_f32 v13, v13, v12
    v_mul_f32 v14, v14, v12
    v_cvt_pk_bf16_f32 v172, v13, v14
    v_lshlrev_b32 v13, 16, v173
    v_and_b32 v14, 0xffff0000, v173
    v_mul_f32 v13, v13, v12
    v_mul_f32 v14, v14, v12
    v_cvt_pk_bf16_f32 v173, v13, v14
    v_lshlrev_b32 v13, 16, v174
    v_and_b32 v14, 0xffff0000, v174
    v_mul_f32 v13, v13, v12
    v_mul_f32 v14, v14, v12
    v_cvt_pk_bf16_f32 v174, v13, v14
    v_lshlrev_b32 v13, 16, v175
    v_and_b32 v14, 0xffff0000, v175
    v_mul_f32 v13, v13, v12
    v_mul_f32 v14, v14, v12
    v_cvt_pk_bf16_f32 v175, v13, v14
    v_sub_f32 v128, v128, v11
    v_sub_f32 v176, v176, v11
    v_sub_f32 v129, v129, v11
    v_sub_f32 v177, v177, v11
    v_sub_f32 v130, v130, v11
    v_sub_f32 v178, v178, v11
    v_sub_f32 v131, v131, v11
    v_sub_f32 v179, v179, v11
    v_sub_f32 v132, v132, v11
    v_sub_f32 v180, v180, v11
    v_sub_f32 v133, v133, v11
    v_sub_f32 v181, v181, v11
    v_sub_f32 v134, v134, v11
    v_sub_f32 v182, v182, v11
    v_sub_f32 v135, v135, v11
    v_sub_f32 v183, v183, v11
    v_sub_f32 v136, v136, v11
    v_sub_f32 v184, v184, v11
    v_sub_f32 v137, v137, v11
    v_sub_f32 v185, v185, v11
    v_sub_f32 v138, v138, v11
    v_sub_f32 v186, v186, v11
    v_sub_f32 v139, v139, v11
    v_sub_f32 v187, v187, v11
    v_sub_f32 v140, v140, v11
    v_sub_f32 v188, v188, v11
    v_sub_f32 v141, v141, v11
    v_sub_f32 v189, v189, v11
    v_sub_f32 v142, v142, v11
    v_sub_f32 v190, v190, v11
    v_sub_f32 v143, v143, v11
    v_sub_f32 v191, v191, v11
    s_nop 1
    s_branch L_back_9
L_rare_10:
    s_nop 15
    s_nop 3
    v_mov_b32 v12, v11
    s_nop 1
    v_permlane32_swap_b32 v11, v12
    s_nop 0
    v_max3_f32 v11, v11, v12, 0
    v_ceil_f32 v11, v11
    v_min_f32 v12, 0x43480000, v11
    v_cvt_i32_f32 v12, v12
    v_sub_u32 v12, 0, v12
    v_ldexp_f32 v12, 1.0, v12
    v_mul_f32 v32, v32, v12
    v_mul_f32 v33, v33, v12
    v_mul_f32 v34, v34, v12
    v_mul_f32 v35, v35, v12
    v_mul_f32 v36, v36, v12
    v_mul_f32 v37, v37, v12
    v_mul_f32 v38, v38, v12
    v_mul_f32 v39, v39, v12
    v_mul_f32 v40, v40, v12
    v_mul_f32 v41, v41, v12
    v_mul_f32 v42, v42, v12
    v_mul_f32 v43, v43, v12
    v_mul_f32 v44, v44, v12
    v_mul_f32 v45, v45, v12
    v_mul_f32 v46, v46, v12
    v_mul_f32 v47, v47, v12
    v_mul_f32 v48, v48, v12
    v_mul_f32 v49, v49, v12
    v_mul_f32 v50, v50, v12
    v_mul_f32 v51, v51, v12
    v_mul_f32 v52, v52, v12
    v_mul_f32 v53, v53, v12
    v_mul_f32 v54, v54, v12
    v_mul_f32 v55, v55, v12
    v_mul_f32 v56, v56, v12
    v_mul_f32 v57, v57, v12
    v_mul_f32 v58, v58, v12
    v_mul_f32 v59, v59, v12
    v_mul_f32 v60, v60, v12
    v_mul_f32 v61, v61, v12
    v_mul_f32 v62, v62, v12
    v_mul_f32 v63, v63, v12
    v_mul_f32 v64, v64, v12
    v_mul_f32 v65, v65, v12
    v_mul_f32 v66, v66, v12
    v_mul_f32 v67, v67, v12
    v_mul_f32 v68, v68, v12
    v_mul_f32 v69, v69, v12
    v_mul_f32 v70, v70, v12
    v_mul_f32 v71, v71, v12
    v_mul_f32 v72, v72, v12
    v_mul_f32 v73, v73, v12
    v_mul_f32 v74, v74, v12
    v_mul_f32 v75, v75, v12
    v_mul_f32 v76, v76, v12
    v_mul_f32 v77, v77, v12
    v_mul_f32 v78, v78, v12
    v_mul_f32 v79, v79, v12
    v_mul_f32 v80, v80, v12
    v_mul_f32 v81, v81, v12
    v_mul_f32 v82, v82, v12
    v_mul_f32 v83, v83, v12
    v_mul_f32 v84, v84, v12
    v_mul_f32 v85, v85, v12
    v_mul_f32 v86, v86, v12
    v_mul_f32 v87, v87, v12
    v_mul_f32 v88, v88, v12
    v_mul_f32 v89, v89, v12
    v_mul_f32 v90, v90, v12
    v_mul_f32 v91, v91, v12
    v_mul_f32 v92, v92, v12
    v_mul_f32 v93, v93, v12
    v_mul_f32 v94, v94, v12
    v_mul_f32 v95, v95, v12
    v_mul_f32 v192, v192, v12
    v_lshlrev_b32 v13, 16, v160
    v_and_b32 v14, 0xffff0000, v160
    v_mul_f32 v13, v13, v12
    v_mul_f32 v14, v14, v12
    v_cvt_pk_bf16_f32 v160, v13, v14
    v_lshlrev_b32 v13, 16, v161
    v_and_b32 v14, 0xffff0000, v161
    v_mul_f32 v13, v13, v12
    v_mul_f32 v14, v14, v12
    v_cvt_pk_bf16_f32 v161, v13, v14
    v_lshlrev_b32 v13, 16, v162
    v_and_b32 v14, 0xffff0000, v162
    v_mul_f32 v13, v13, v12
    v_mul_f32 v14, v14, v12
    v_cvt_pk_bf16_f32 v162, v13, v14
    v_lshlrev_b32 v13, 16, v163
    v_and_b32 v14, 0xffff0000, v163
    v_mul_f32 v13, v13, v12
    v_mul_f32 v14, v14, v12
    v_cvt_pk_bf16_f32 v163, v13, v14
    v_lshlrev_b32 v13, 16, v164
    v_and_b32 v14, 0xffff0000, v164
    v_mul_f32 v13, v13, v12
    v_mul_f32 v14, v14, v12
    v_cvt_pk_bf16_f32 v164, v13, v14
    v_lshlrev_b32 v13, 16, v165
    v_and_b32 v14, 0xffff0000, v165
    v_mul_f32 v13, v13, v12
    v_mul_f32 v14, v14, v12
    v_cvt_pk_bf16_f32 v165, v13, v14
    v_lshlrev_b32 v13, 16, v166
    v_and_b32 v14, 0xffff0000, v166
    v_mul_f32 v13, v13, v12
    v_mul_f32 v14, v14, v12
    v_cvt_pk_bf16_f32 v166, v13, v14
    v_lshlrev_b32 v13, 16, v167
    v_and_b32 v14, 0xffff0000, v167
    v_mul_f32 v13, v13, v12
    v_mul_f32 v14, v14, v12
    v_cvt_pk_bf16_f32 v167, v13, v14
    v_sub_f32 v144, v144, v11
    v_sub_f32 v176, v176, v11
    v_sub_f32 v145, v145, v11
    v_sub_f32 v177, v177, v11
    v_sub_f32 v146, v146, v11
    v_sub_f32 v178, v178, v11
    v_sub_f32 v147, v147, v11
    v_sub_f32 v179, v179, v11
    v_sub_f32 v148, v148, v11
    v_sub_f32 v180, v180, v11
    v_sub_f32 v149, v149, v11
    v_sub_f32 v181, v181, v11
    v_sub_f32 v150, v150, v11
    v_sub_f32 v182, v182, v11
    v_sub_f32 v151, v151, v11
    v_sub_f32 v183, v183, v11
    v_sub_f32 v152, v152, v11
    v_sub_f32 v184, v184, v11
    v_sub_f32 v153, v153, v11
    v_sub_f32 v185, v185, v11
    v_sub_f32 v154, v154, v11
    v_sub_f32 v186, v186, v11
    v_sub_f32 v155, v155, v11
    v_sub_f32 v187, v187, v11
    v_sub_f32 v156, v156, v11
    v_sub_f32 v188, v188, v11
    v_sub_f32 v157, v157, v11
    v_sub_f32 v189, v189, v11
    v_sub_f32 v158, v158, v11
    v_sub_f32 v190, v190, v11
    v_sub_f32 v159, v159, v11
    v_sub_f32 v191, v191, v11
    s_nop 1
    s_branch L_back_10
L_rare_11:
    s_nop 15
    s_nop 3
    v_mov_b32 v12, v11
    s_nop 1
    v_permlane32_swap_b32 v11, v12
    s_nop 0
    v_max3_f32 v11, v11, v12, 0
    v_ceil_f32 v11, v11
    v_min_f32 v12, 0x43480000, v11
    v_cvt_i32_f32 v12, v12
    v_sub_u32 v12, 0, v12
    v_ldexp_f32 v12, 1.0, v12
    v_mul_f32 v32, v32, v12
    v_mul_f32 v33, v33, v12
    v_mul_f32 v34, v34, v12
    v_mul_f32 v35, v35, v12
    v_mul_f32 v36, v36, v12
    v_mul_f32 v37, v37, v12
    v_mul_f32 v38, v38, v12
    v_mul_f32 v39, v39, v12
    v_mul_f32 v40, v40, v12
    v_mul_f32 v41, v41, v12
    v_mul_f32 v42, v42, v12
    v_mul_f32 v43, v43, v12
    v_mul_f32 v44, v44, v12
    v_mul_f32 v45, v45, v12
    v_mul_f32 v46, v46, v12
    v_mul_f32 v47, v47, v12
    v_mul_f32 v48, v48, v12
    v_mul_f32 v49, v49, v12
    v_mul_f32 v50, v50, v12
    v_mul_f32 v51, v51, v12
    v_mul_f32 v52, v52, v12
    v_mul_f32 v53, v53, v12
    v_mul_f32 v54, v54, v12
    v_mul_f32 v55, v55, v12
    v_mul_f32 v56, v56, v12
    v_mul_f32 v57, v57, v12
    v_mul_f32 v58, v58, v12
    v_mul_f32 v59, v59, v12
    v_mul_f32 v60, v60, v12
    v_mul_f32 v61, v61, v12
    v_mul_f32 v62, v62, v12
    v_mul_f32 v63, v63, v12
    v_mul_f32 v64, v64, v12
    v_mul_f32 v65, v65, v12
    v_mul_f32 v66, v66, v12
    v_mul_f32 v67, v67, v12
    v_mul_f32 v68, v68, v12
    v_mul_f32 v69, v69, v12
    v_mul_f32 v70, v70, v12
    v_mul_f32 v71, v71, v12
    v_mul_f32 v72, v72, v12
    v_mul_f32 v73, v73, v12
    v_mul_f32 v74, v74, v12
    v_mul_f32 v75, v75, v12
    v_mul_f32 v76, v76, v12
    v_mul_f32 v77, v77, v12
    v_mul_f32 v78, v78, v12
    v_mul_f32 v79, v79, v12
    v_mul_f32 v80, v80, v12
    v_mul_f32 v81, v81, v12
    v_mul_f32 v82, v82, v12
    v_mul_f32 v83, v83, v12
    v_mul_f32 v84, v84, v12
    v_mul_f32 v85, v85, v12
    v_mul_f32 v86, v86, v12
    v_mul_f32 v87, v87, v12
    v_mul_f32 v88, v88, v12
    v_mul_f32 v89, v89, v12
    v_mul_f32 v90, v90, v12
    v_mul_f32 v91, v91, v12
    v_mul_f32 v92, v92, v12
    v_mul_f32 v93, v93, v12
    v_mul_f32 v94, v94, v12
    v_mul_f32 v95, v95, v12
    v_mul_f32 v192, v192, v12
    v_lshlrev_b32 v13, 16, v168
    v_and_b32 v14, 0xffff0000, v168
    v_mul_f32 v13, v13, v12
    v_mul_f32 v14, v14, v12
    v_cvt_pk_bf16_f32 v168, v13, v14
    v_lshlrev_b32 v13, 16, v169
    v_and_b32 v14, 0xffff0000, v169
    v_mul_f32 v13, v13, v12
    v_mul_f32 v14, v14, v12
    v_cvt_pk_bf16_f32 v169, v13, v14
    v_lshlrev_b32 v13, 16, v170
    v_and_b32 v14, 0xffff0000, v170
    v_mul_f32 v13, v13, v12
    v_mul_f32 v14, v14, v12
    v_cvt_pk_bf16_f32 v170, v13, v14
    v_lshlrev_b32 v13, 16, v171
    v_and_b32 v14, 0xffff0000, v171
    v_mul_f32 v13, v13, v12
    v_mul_f32 v14, v14, v12
    v_cvt_pk_bf16_f32 v171, v13, v14
    v_lshlrev_b32 v13, 16, v172
    v_and_b32 v14, 0xffff0000, v172
    v_mul_f32 v13, v13, v12
    v_mul_f32 v14, v14, v12
    v_cvt_pk_bf16_f32 v172, v13, v14
    v_lshlrev_b32 v13, 16, v173
    v_and_b32 v14, 0xffff0000, v173
    v_mul_f32 v13, v13, v12
    v_mul_f32 v14, v14, v12
    v_cvt_pk_bf16_f32 v173, v13, v14
    v_lshlrev_b32 v13, 16, v174
    v_and_b32 v14, 0xffff0000, v174
    v_mul_f32 v13, v13, v12
    v_mul_f32 v14, v14, v12
    v_cvt_pk_bf16_f32 v174, v13, v14
    v_lshlrev_b32 v13, 16, v175
    v_and_b32 v14, 0xffff0000, v175
    v_mul_f32 v13, v13, v12
    v_mul_f32 v14, v14, v12
    v_cvt_pk_bf16_f32 v175, v13, v14
    v_sub_f32 v128, v128, v11
    v_sub_f32 v176, v176, v11
    v_sub_f32 v129, v129, v11
    v_sub_f32 v177, v177, v11
    v_sub_f32 v130, v130, v11
    v_sub_f32 v178, v178, v11
    v_sub_f32 v131, v131, v11
    v_sub_f32 v179, v179, v11
    v_sub_f32 v132, v132, v11
    v_sub_f32 v180, v180, v11
    v_sub_f32 v133, v133, v11
    v_sub_f32 v181, v181, v11
    v_sub_f32 v134, v134, v11
    v_sub_f32 v182, v182, v11
    v_sub_f32 v135, v135, v11
    v_sub_f32 v183, v183, v11
    v_sub_f32 v136, v136, v11
    v_sub_f32 v184, v184, v11
    v_sub_f32 v137, v137, v11
    v_sub_f32 v185, v185, v11
    v_sub_f32 v138, v138, v11
    v_sub_f32 v186, v186, v11
    v_sub_f32 v139, v139, v11
    v_sub_f32 v187, v187, v11
    v_sub_f32 v140, v140, v11
    v_sub_f32 v188, v188, v11
    v_sub_f32 v141, v141, v11
    v_sub_f32 v189, v189, v11
    v_sub_f32 v142, v142, v11
    v_sub_f32 v190, v190, v11
    v_sub_f32 v143, v143, v11
    v_sub_f32 v191, v191, v11
    s_nop 1
    s_branch L_back_11
L_rare_12:
    s_nop 15
    s_nop 3
    v_mov_b32 v12, v11
    s_nop 1
    v_permlane32_swap_b32 v11, v12
    s_nop 0
    v_max3_f32 v11, v11, v12, 0
    v_ceil_f32 v11, v11
    v_min_f32 v12, 0x43480000, v11
    v_cvt_i32_f32 v12, v12
    v_sub_u32 v12, 0, v12
    v_ldexp_f32 v12, 1.0, v12
    v_mul_f32 v32, v32, v12
    v_mul_f32 v33, v33, v12
    v_mul_f32 v34, v34, v12
    v_mul_f32 v35, v35, v12
    v_mul_f32 v36, v36, v12
    v_mul_f32 v37, v37, v12
    v_mul_f32 v38, v38, v12
    v_mul_f32 v39, v39, v12
    v_mul_f32 v40, v40, v12
    v_mul_f32 v41, v41, v12
    v_mul_f32 v42, v42, v12
    v_mul_f32 v43, v43, v12
    v_mul_f32 v44, v44, v12
    v_mul_f32 v45, v45, v12
    v_mul_f32 v46, v46, v12
    v_mul_f32 v47, v47, v12
    v_mul_f32 v48, v48, v12
    v_mul_f32 v49, v49, v12
    v_mul_f32 v50, v50, v12
    v_mul_f32 v51, v51, v12
    v_mul_f32 v52, v52, v12
    v_mul_f32 v53, v53, v12
    v_mul_f32 v54, v54, v12
    v_mul_f32 v55, v55, v12
    v_mul_f32 v56, v56, v12
    v_mul_f32 v57, v57, v12
    v_mul_f32 v58, v58, v12
    v_mul_f32 v59, v59, v12
    v_mul_f32 v60, v60, v12
    v_mul_f32 v61, v61, v12
    v_mul_f32 v62, v62, v12
    v_mul_f32 v63, v63, v12
    v_mul_f32 v64, v64, v12
    v_mul_f32 v65, v65, v12
    v_mul_f32 v66, v66, v12
    v_mul_f32 v67, v67, v12
    v_mul_f32 v68, v68, v12
    v_mul_f32 v69, v69, v12
    v_mul_f32 v70, v70, v12
    v_mul_f32 v71, v71, v12
    v_mul_f32 v72, v72, v12
    v_mul_f32 v73, v73, v12
    v_mul_f32 v74, v74, v12
    v_mul_f32 v75, v75, v12
    v_mul_f32 v76, v76, v12
    v_mul_f32 v77, v77, v12
    v_mul_f32 v78, v78, v12
    v_mul_f32 v79, v79, v12
    v_mul_f32 v80, v80, v12
    v_mul_f32 v81, v81, v12
    v_mul_f32 v82, v82, v12
    v_mul_f32 v83, v83, v12
    v_mul_f32 v84, v84, v12
    v_mul_f32 v85, v85, v12
    v_mul_f32 v86, v86, v12
    v_mul_f32 v87, v87, v12
    v_mul_f32 v88, v88, v12
    v_mul_f32 v89, v89, v12
    v_mul_f32 v90, v90, v12
    v_mul_f32 v91, v91, v12
    v_mul_f32 v92, v92, v12
    v_mul_f32 v93, v93, v12
    v_mul_f32 v94, v94, v12
    v_mul_f32 v95, v95, v12
    v_mul_f32 v192, v192, v12
    v_lshlrev_b32 v13, 16, v160
    v_and_b32 v14, 0xffff0000, v160
    v_mul_f32 v13, v13, v12
    v_mul_f32 v14, v14, v12
    v_cvt_pk_bf16_f32 v160, v13, v14
    v_lshlrev_b32 v13, 16, v161
    v_and_b32 v14, 0xffff0000, v161
    v_mul_f32 v13, v13, v12
    v_mul_f32 v14, v14, v12
    v_cvt_pk_bf16_f32 v161, v13, v14
    v_lshlrev_b32 v13, 16, v162
    v_and_b32 v14, 0xffff0000, v162
    v_mul_f32 v13, v13, v12
    v_mul_f32 v14, v14, v12
    v_cvt_pk_bf16_f32 v162, v13, v14
    v_lshlrev_b32 v13, 16, v163
    v_and_b32 v14, 0xffff0000, v163
    v_mul_f32 v13, v13, v12
    v_mul_f32 v14, v14, v12
    v_cvt_pk_bf16_f32 v163, v13, v14
    v_lshlrev_b32 v13, 16, v164
    v_and_b32 v14, 0xffff0000, v164
    v_mul_f32 v13, v13, v12
    v_mul_f32 v14, v14, v12
    v_cvt_pk_bf16_f32 v164, v13, v14
    v_lshlrev_b32 v13, 16, v165
    v_and_b32 v14, 0xffff0000, v165
    v_mul_f32 v13, v13, v12
    v_mul_f32 v14, v14, v12
    v_cvt_pk_bf16_f32 v165, v13, v14
    v_lshlrev_b32 v13, 16, v166
    v_and_b32 v14, 0xffff0000, v166
    v_mul_f32 v13, v13, v12
    v_mul_f32 v14, v14, v12
    v_cvt_pk_bf16_f32 v166, v13, v14
    v_lshlrev_b32 v13, 16, v167
    v_and_b32 v14, 0xffff0000, v167
    v_mul_f32 v13, v13, v12
    v_mul_f32 v14, v14, v12
    v_cvt_pk_bf16_f32 v167, v13, v14
    v_sub_f32 v144, v144, v11
    v_sub_f32 v176, v176, v11
    v_sub_f32 v145, v145, v11
    v_sub_f32 v177, v177, v11
    v_sub_f32 v146, v146, v11
    v_sub_f32 v178, v178, v11
    v_sub_f32 v147, v147, v11
    v_sub_f32 v179, v179, v11
    v_sub_f32 v148, v148, v11
    v_sub_f32 v180, v180, v11
    v_sub_f32 v149, v149, v11
    v_sub_f32 v181, v181, v11
    v_sub_f32 v150, v150, v11
    v_sub_f32 v182, v182, v11
    v_sub_f32 v151, v151, v11
    v_sub_f32 v183, v183, v11
    v_sub_f32 v152, v152, v11
    v_sub_f32 v184, v184, v11
    v_sub_f32 v153, v153, v11
    v_sub_f32 v185, v185, v11
    v_sub_f32 v154, v154, v11
    v_sub_f32 v186, v186, v11
    v_sub_f32 v155, v155, v11
    v_sub_f32 v187, v187, v11
    v_sub_f32 v156, v156, v11
    v_sub_f32 v188, v188, v11
    v_sub_f32 v157, v157, v11
    v_sub_f32 v189, v189, v11
    v_sub_f32 v158, v158, v11
    v_sub_f32 v190, v190, v11
    v_sub_f32 v159, v159, v11
    v_sub_f32 v191, v191, v11
    s_nop 1
    s_branch L_back_12
L_rare_13:
    s_nop 15
    s_nop 3
    v_mov_b32 v12, v11
    s_nop 1
    v_permlane32_swap_b32 v11, v12
    s_nop 0
    v_max3_f32 v11, v11, v12, 0
    v_ceil_f32 v11, v11
    v_min_f32 v12, 0x43480000, v11
    v_cvt_i32_f32 v12, v12
    v_sub_u32 v12, 0, v12
    v_ldexp_f32 v12, 1.0, v12
    v_mul_f32 v32, v32, v12
    v_mul_f32 v33, v33, v12
    v_mul_f32 v34, v34, v12
    v_mul_f32 v35, v35, v12
    v_mul_f32 v36, v36, v12
    v_mul_f32 v37, v37, v12
    v_mul_f32 v38, v38, v12
    v_mul_f32 v39, v39, v12
    v_mul_f32 v40, v40, v12
    v_mul_f32 v41, v41, v12
    v_mul_f32 v42, v42, v12
    v_mul_f32 v43, v43, v12
    v_mul_f32 v44, v44, v12
    v_mul_f32 v45, v45, v12
    v_mul_f32 v46, v46, v12
    v_mul_f32 v47, v47, v12
    v_mul_f32 v48, v48, v12
    v_mul_f32 v49, v49, v12
    v_mul_f32 v50, v50, v12
    v_mul_f32 v51, v51, v12
    v_mul_f32 v52, v52, v12
    v_mul_f32 v53, v53, v12
    v_mul_f32 v54, v54, v12
    v_mul_f32 v55, v55, v12
    v_mul_f32 v56, v56, v12
    v_mul_f32 v57, v57, v12
    v_mul_f32 v58, v58, v12
    v_mul_f32 v59, v59, v12
    v_mul_f32 v60, v60, v12
    v_mul_f32 v61, v61, v12
    v_mul_f32 v62, v62, v12
    v_mul_f32 v63, v63, v12
    v_mul_f32 v64, v64, v12
    v_mul_f32 v65, v65, v12
    v_mul_f32 v66, v66, v12
    v_mul_f32 v67, v67, v12
    v_mul_f32 v68, v68, v12
    v_mul_f32 v69, v69, v12
    v_mul_f32 v70, v70, v12
    v_mul_f32 v71, v71, v12
    v_mul_f32 v72, v72, v12
    v_mul_f32 v73, v73, v12
    v_mul_f32 v74, v74, v12
    v_mul_f32 v75, v75, v12
    v_mul_f32 v76, v76, v12
    v_mul_f32 v77, v77, v12
    v_mul_f32 v78, v78, v12
    v_mul_f32 v79, v79, v12
    v_mul_f32 v80, v80, v12
    v_mul_f32 v81, v81, v12
    v_mul_f32 v82, v82, v12
    v_mul_f32 v83, v83, v12
    v_mul_f32 v84, v84, v12
    v_mul_f32 v85, v85, v12
    v_mul_f32 v86, v86, v12
    v_mul_f32 v87, v87, v12
    v_mul_f32 v88, v88, v12
    v_mul_f32 v89, v89, v12
    v_mul_f32 v90, v90, v12
    v_mul_f32 v91, v91, v12
    v_mul_f32 v92, v92, v12
    v_mul_f32 v93, v93, v12
    v_mul_f32 v94, v94, v12
    v_mul_f32 v95, v95, v12
    v_mul_f32 v192, v192, v12
    v_lshlrev_b32 v13, 16, v168
    v_and_b32 v14, 0xffff0000, v168
    v_mul_f32 v13, v13, v12
    v_mul_f32 v14, v14, v12
    v_cvt_pk_bf16_f32 v168, v13, v14
    v_lshlrev_b32 v13, 16, v169
    v_and_b32 v14, 0xffff0000, v169
    v_mul_f32 v13, v13, v12
    v_mul_f32 v14, v14, v12
    v_cvt_pk_bf16_f32 v169, v13, v14
    v_lshlrev_b32 v13, 16, v170
    v_and_b32 v14, 0xffff0000, v170
    v_mul_f32 v13, v13, v12
    v_mul_f32 v14, v14, v12
    v_cvt_pk_bf16_f32 v170, v13, v14
    v_lshlrev_b32 v13, 16, v171
    v_and_b32 v14, 0xffff0000, v171
    v_mul_f32 v13, v13, v12
    v_mul_f32 v14, v14, v12
    v_cvt_pk_bf16_f32 v171, v13, v14
    v_lshlrev_b32 v13, 16, v172
    v_and_b32 v14, 0xffff0000, v172
    v_mul_f32 v13, v13, v12
    v_mul_f32 v14, v14, v12
    v_cvt_pk_bf16_f32 v172, v13, v14
    v_lshlrev_b32 v13, 16, v173
    v_and_b32 v14, 0xffff0000, v173
    v_mul_f32 v13, v13, v12
    v_mul_f32 v14, v14, v12
    v_cvt_pk_bf16_f32 v173, v13, v14
    v_lshlrev_b32 v13, 16, v174
    v_and_b32 v14, 0xffff0000, v174
    v_mul_f32 v13, v13, v12
    v_mul_f32 v14, v14, v12
    v_cvt_pk_bf16_f32 v174, v13, v14
    v_lshlrev_b32 v13, 16, v175
    v_and_b32 v14, 0xffff0000, v175
    v_mul_f32 v13, v13, v12
    v_mul_f32 v14, v14, v12
    v_cvt_pk_bf16_f32 v175, v13, v14
    v_sub_f32 v128, v128, v11
    v_sub_f32 v176, v176, v11
    v_sub_f32 v129, v129, v11
    v_sub_f32 v177, v177, v11
    v_sub_f32 v130, v130, v11
    v_sub_f32 v178, v178, v11
    v_sub_f32 v131, v131, v11
    v_sub_f32 v179, v179, v11
    v_sub_f32 v132, v132, v11
    v_sub_f32 v180, v180, v11
    v_sub_f32 v133, v133, v11
    v_sub_f32 v181, v181, v11
    v_sub_f32 v134, v134, v11
    v_sub_f32 v182, v182, v11
    v_sub_f32 v135, v135, v11
    v_sub_f32 v183, v183, v11
    v_sub_f32 v136, v136, v11
    v_sub_f32 v184, v184, v11
    v_sub_f32 v137, v137, v11
    v_sub_f32 v185, v185, v11
    v_sub_f32 v138, v138, v11
    v_sub_f32 v186, v186, v11
    v_sub_f32 v139, v139, v11
    v_sub_f32 v187, v187, v11
    v_sub_f32 v140, v140, v11
    v_sub_f32 v188, v188, v11
    v_sub_f32 v141, v141, v11
    v_sub_f32 v189, v189, v11
    v_sub_f32 v142, v142, v11
    v_sub_f32 v190, v190, v11
    v_sub_f32 v143, v143, v11
    v_sub_f32 v191, v191, v11
    s_nop 1
    s_branch L_back_13
L_rare_14:
    s_nop 15
    s_nop 3
    v_mov_b32 v12, v11
    s_nop 1
    v_permlane32_swap_b32 v11, v12
    s_nop 0
    v_max3_f32 v11, v11, v12, 0
    v_ceil_f32 v11, v11
    v_min_f32 v12, 0x43480000, v11
    v_cvt_i32_f32 v12, v12
    v_sub_u32 v12, 0, v12
    v_ldexp_f32 v12, 1.0, v12
    v_mul_f32 v32, v32, v12
    v_mul_f32 v33, v33, v12
    v_mul_f32 v34, v34, v12
    v_mul_f32 v35, v35, v12
    v_mul_f32 v36, v36, v12
    v_mul_f32 v37, v37, v12
    v_mul_f32 v38, v38, v12
    v_mul_f32 v39, v39, v12
    v_mul_f32 v40, v40, v12
    v_mul_f32 v41, v41, v12
    v_mul_f32 v42, v42, v12
    v_mul_f32 v43, v43, v12
    v_mul_f32 v44, v44, v12
    v_mul_f32 v45, v45, v12
    v_mul_f32 v46, v46, v12
    v_mul_f32 v47, v47, v12
    v_mul_f32 v48, v48, v12
    v_mul_f32 v49, v49, v12
    v_mul_f32 v50, v50, v12
    v_mul_f32 v51, v51, v12
    v_mul_f32 v52, v52, v12
    v_mul_f32 v53, v53, v12
    v_mul_f32 v54, v54, v12
    v_mul_f32 v55, v55, v12
    v_mul_f32 v56, v56, v12
    v_mul_f32 v57, v57, v12
    v_mul_f32 v58, v58, v12
    v_mul_f32 v59, v59, v12
    v_mul_f32 v60, v60, v12
    v_mul_f32 v61, v61, v12
    v_mul_f32 v62, v62, v12
    v_mul_f32 v63, v63, v12
    v_mul_f32 v64, v64, v12
    v_mul_f32 v65, v65, v12
    v_mul_f32 v66, v66, v12
    v_mul_f32 v67, v67, v12
    v_mul_f32 v68, v68, v12
    v_mul_f32 v69, v69, v12
    v_mul_f32 v70, v70, v12
    v_mul_f32 v71, v71, v12
    v_mul_f32 v72, v72, v12
    v_mul_f32 v73, v73, v12
    v_mul_f32 v74, v74, v12
    v_mul_f32 v75, v75, v12
    v_mul_f32 v76, v76, v12
    v_mul_f32 v77, v77, v12
    v_mul_f32 v78, v78, v12
    v_mul_f32 v79, v79, v12
    v_mul_f32 v80, v80, v12
    v_mul_f32 v81, v81, v12
    v_mul_f32 v82, v82, v12
    v_mul_f32 v83, v83, v12
    v_mul_f32 v84, v84, v12
    v_mul_f32 v85, v85, v12
    v_mul_f32 v86, v86, v12
    v_mul_f32 v87, v87, v12
    v_mul_f32 v88, v88, v12
    v_mul_f32 v89, v89, v12
    v_mul_f32 v90, v90, v12
    v_mul_f32 v91, v91, v12
    v_mul_f32 v92, v92, v12
    v_mul_f32 v93, v93, v12
    v_mul_f32 v94, v94, v12
    v_mul_f32 v95, v95, v12
    v_mul_f32 v192, v192, v12
    v_lshlrev_b32 v13, 16, v160
    v_and_b32 v14, 0xffff0000, v160
    v_mul_f32 v13, v13, v12
    v_mul_f32 v14, v14, v12
    v_cvt_pk_bf16_f32 v160, v13, v14
    v_lshlrev_b32 v13, 16, v161
    v_and_b32 v14, 0xffff0000, v161
    v_mul_f32 v13, v13, v12
    v_mul_f32 v14, v14, v12
    v_cvt_pk_bf16_f32 v161, v13, v14
    v_lshlrev_b32 v13, 16, v162
    v_and_b32 v14, 0xffff0000, v162
    v_mul_f32 v13, v13, v12
    v_mul_f32 v14, v14, v12
    v_cvt_pk_bf16_f32 v162, v13, v14
    v_lshlrev_b32 v13, 16, v163
    v_and_b32 v14, 0xffff0000, v163
    v_mul_f32 v13, v13, v12
    v_mul_f32 v14, v14, v12
    v_cvt_pk_bf16_f32 v163, v13, v14
    v_lshlrev_b32 v13, 16, v164
    v_and_b32 v14, 0xffff0000, v164
    v_mul_f32 v13, v13, v12
    v_mul_f32 v14, v14, v12
    v_cvt_pk_bf16_f32 v164, v13, v14
    v_lshlrev_b32 v13, 16, v165
    v_and_b32 v14, 0xffff0000, v165
    v_mul_f32 v13, v13, v12
    v_mul_f32 v14, v14, v12
    v_cvt_pk_bf16_f32 v165, v13, v14
    v_lshlrev_b32 v13, 16, v166
    v_and_b32 v14, 0xffff0000, v166
    v_mul_f32 v13, v13, v12
    v_mul_f32 v14, v14, v12
    v_cvt_pk_bf16_f32 v166, v13, v14
    v_lshlrev_b32 v13, 16, v167
    v_and_b32 v14, 0xffff0000, v167
    v_mul_f32 v13, v13, v12
    v_mul_f32 v14, v14, v12
    v_cvt_pk_bf16_f32 v167, v13, v14
    v_sub_f32 v144, v144, v11
    v_sub_f32 v176, v176, v11
    v_sub_f32 v145, v145, v11
    v_sub_f32 v177, v177, v11
    v_sub_f32 v146, v146, v11
    v_sub_f32 v178, v178, v11
    v_sub_f32 v147, v147, v11
    v_sub_f32 v179, v179, v11
    v_sub_f32 v148, v148, v11
    v_sub_f32 v180, v180, v11
    v_sub_f32 v149, v149, v11
    v_sub_f32 v181, v181, v11
    v_sub_f32 v150, v150, v11
    v_sub_f32 v182, v182, v11
    v_sub_f32 v151, v151, v11
    v_sub_f32 v183, v183, v11
    v_sub_f32 v152, v152, v11
    v_sub_f32 v184, v184, v11
    v_sub_f32 v153, v153, v11
    v_sub_f32 v185, v185, v11
    v_sub_f32 v154, v154, v11
    v_sub_f32 v186, v186, v11
    v_sub_f32 v155, v155, v11
    v_sub_f32 v187, v187, v11
    v_sub_f32 v156, v156, v11
    v_sub_f32 v188, v188, v11
    v_sub_f32 v157, v157, v11
    v_sub_f32 v189, v189, v11
    v_sub_f32 v158, v158, v11
    v_sub_f32 v190, v190, v11
    v_sub_f32 v159, v159, v11
    v_sub_f32 v191, v191, v11
    s_nop 1
    s_branch L_back_14
L_rare_15:
    s_nop 15
    s_nop 3
    v_mov_b32 v12, v11
    s_nop 1
    v_permlane32_swap_b32 v11, v12
    s_nop 0
    v_max3_f32 v11, v11, v12, 0
    v_ceil_f32 v11, v11
    v_min_f32 v12, 0x43480000, v11
    v_cvt_i32_f32 v12, v12
    v_sub_u32 v12, 0, v12
    v_ldexp_f32 v12, 1.0, v12
    v_mul_f32 v32, v32, v12
    v_mul_f32 v33, v33, v12
    v_mul_f32 v34, v34, v12
    v_mul_f32 v35, v35, v12
    v_mul_f32 v36, v36, v12
    v_mul_f32 v37, v37, v12
    v_mul_f32 v38, v38, v12
    v_mul_f32 v39, v39, v12
    v_mul_f32 v40, v40, v12
    v_mul_f32 v41, v41, v12
    v_mul_f32 v42, v42, v12
    v_mul_f32 v43, v43, v12
    v_mul_f32 v44, v44, v12
    v_mul_f32 v45, v45, v12
    v_mul_f32 v46, v46, v12
    v_mul_f32 v47, v47, v12
    v_mul_f32 v48, v48, v12
    v_mul_f32 v49, v49, v12
    v_mul_f32 v50, v50, v12
    v_mul_f32 v51, v51, v12
    v_mul_f32 v52, v52, v12
    v_mul_f32 v53, v53, v12
    v_mul_f32 v54, v54, v12
    v_mul_f32 v55, v55, v12
    v_mul_f32 v56, v56, v12
    v_mul_f32 v57, v57, v12
    v_mul_f32 v58, v58, v12
    v_mul_f32 v59, v59, v12
    v_mul_f32 v60, v60, v12
    v_mul_f32 v61, v61, v12
    v_mul_f32 v62, v62, v12
    v_mul_f32 v63, v63, v12
    v_mul_f32 v64, v64, v12
    v_mul_f32 v65, v65, v12
    v_mul_f32 v66, v66, v12
    v_mul_f32 v67, v67, v12
    v_mul_f32 v68, v68, v12
    v_mul_f32 v69, v69, v12
    v_mul_f32 v70, v70, v12
    v_mul_f32 v71, v71, v12
    v_mul_f32 v72, v72, v12
    v_mul_f32 v73, v73, v12
    v_mul_f32 v74, v74, v12
    v_mul_f32 v75, v75, v12
    v_mul_f32 v76, v76, v12
    v_mul_f32 v77, v77, v12
    v_mul_f32 v78, v78, v12
    v_mul_f32 v79, v79, v12
    v_mul_f32 v80, v80, v12
    v_mul_f32 v81, v81, v12
    v_mul_f32 v82, v82, v12
    v_mul_f32 v83, v83, v12
    v_mul_f32 v84, v84, v12
    v_mul_f32 v85, v85, v12
    v_mul_f32 v86, v86, v12
    v_mul_f32 v87, v87, v12
    v_mul_f32 v88, v88, v12
    v_mul_f32 v89, v89, v12
    v_mul_f32 v90, v90, v12
    v_mul_f32 v91, v91, v12
    v_mul_f32 v92, v92, v12
    v_mul_f32 v93, v93, v12
    v_mul_f32 v94, v94, v12
    v_mul_f32 v95, v95, v12
    v_mul_f32 v192, v192, v12
    v_lshlrev_b32 v13, 16, v168
    v_and_b32 v14, 0xffff0000, v168
    v_mul_f32 v13, v13, v12
    v_mul_f32 v14, v14, v12
    v_cvt_pk_bf16_f32 v168, v13, v14
    v_lshlrev_b32 v13, 16, v169
    v_and_b32 v14, 0xffff0000, v169
    v_mul_f32 v13, v13, v12
    v_mul_f32 v14, v14, v12
    v_cvt_pk_bf16_f32 v169, v13, v14
    v_lshlrev_b32 v13, 16, v170
    v_and_b32 v14, 0xffff0000, v170
    v_mul_f32 v13, v13, v12
    v_mul_f32 v14, v14, v12
    v_cvt_pk_bf16_f32 v170, v13, v14
    v_lshlrev_b32 v13, 16, v171
    v_and_b32 v14, 0xffff0000, v171
    v_mul_f32 v13, v13, v12
    v_mul_f32 v14, v14, v12
    v_cvt_pk_bf16_f32 v171, v13, v14
    v_lshlrev_b32 v13, 16, v172
    v_and_b32 v14, 0xffff0000, v172
    v_mul_f32 v13, v13, v12
    v_mul_f32 v14, v14, v12
    v_cvt_pk_bf16_f32 v172, v13, v14
    v_lshlrev_b32 v13, 16, v173
    v_and_b32 v14, 0xffff0000, v173
    v_mul_f32 v13, v13, v12
    v_mul_f32 v14, v14, v12
    v_cvt_pk_bf16_f32 v173, v13, v14
    v_lshlrev_b32 v13, 16, v174
    v_and_b32 v14, 0xffff0000, v174
    v_mul_f32 v13, v13, v12
    v_mul_f32 v14, v14, v12
    v_cvt_pk_bf16_f32 v174, v13, v14
    v_lshlrev_b32 v13, 16, v175
    v_and_b32 v14, 0xffff0000, v175
    v_mul_f32 v13, v13, v12
    v_mul_f32 v14, v14, v12
    v_cvt_pk_bf16_f32 v175, v13, v14
    v_sub_f32 v128, v128, v11
    v_sub_f32 v176, v176, v11
    v_sub_f32 v129, v129, v11
    v_sub_f32 v177, v177, v11
    v_sub_f32 v130, v130, v11
    v_sub_f32 v178, v178, v11
    v_sub_f32 v131, v131, v11
    v_sub_f32 v179, v179, v11
    v_sub_f32 v132, v132, v11
    v_sub_f32 v180, v180, v11
    v_sub_f32 v133, v133, v11
    v_sub_f32 v181, v181, v11
    v_sub_f32 v134, v134, v11
    v_sub_f32 v182, v182, v11
    v_sub_f32 v135, v135, v11
    v_sub_f32 v183, v183, v11
    v_sub_f32 v136, v136, v11
    v_sub_f32 v184, v184, v11
    v_sub_f32 v137, v137, v11
    v_sub_f32 v185, v185, v11
    v_sub_f32 v138, v138, v11
    v_sub_f32 v186, v186, v11
    v_sub_f32 v139, v139, v11
    v_sub_f32 v187, v187, v11
    v_sub_f32 v140, v140, v11
    v_sub_f32 v188, v188, v11
    v_sub_f32 v141, v141, v11
    v_sub_f32 v189, v189, v11
    v_sub_f32 v142, v142, v11
    v_sub_f32 v190, v190, v11
    v_sub_f32 v143, v143, v11
    v_sub_f32 v191, v191, v11
    s_nop 1
    s_branch L_back_15
L_rare_16:
    s_nop 15
    s_nop 3
    v_mov_b32 v12, v11
    s_nop 1
    v_permlane32_swap_b32 v11, v12
    s_nop 0
    v_max3_f32 v11, v11, v12, 0
    v_ceil_f32 v11, v11
    v_min_f32 v12, 0x43480000, v11
    v_cvt_i32_f32 v12, v12
    v_sub_u32 v12, 0, v12
    v_ldexp_f32 v12, 1.0, v12
    v_mul_f32 v32, v32, v12
    v_mul_f32 v33, v33, v12
    v_mul_f32 v34, v34, v12
    v_mul_f32 v35, v35, v12
    v_mul_f32 v36, v36, v12
    v_mul_f32 v37, v37, v12
    v_mul_f32 v38, v38, v12
    v_mul_f32 v39, v39, v12
    v_mul_f32 v40, v40, v12
    v_mul_f32 v41, v41, v12
    v_mul_f32 v42, v42, v12
    v_mul_f32 v43, v43, v12
    v_mul_f32 v44, v44, v12
    v_mul_f32 v45, v45, v12
    v_mul_f32 v46, v46, v12
    v_mul_f32 v47, v47, v12
    v_mul_f32 v48, v48, v12
    v_mul_f32 v49, v49, v12
    v_mul_f32 v50, v50, v12
    v_mul_f32 v51, v51, v12
    v_mul_f32 v52, v52, v12
    v_mul_f32 v53, v53, v12
    v_mul_f32 v54, v54, v12
    v_mul_f32 v55, v55, v12
    v_mul_f32 v56, v56, v12
    v_mul_f32 v57, v57, v12
    v_mul_f32 v58, v58, v12
    v_mul_f32 v59, v59, v12
    v_mul_f32 v60, v60, v12
    v_mul_f32 v61, v61, v12
    v_mul_f32 v62, v62, v12
    v_mul_f32 v63, v63, v12
    v_mul_f32 v64, v64, v12
    v_mul_f32 v65, v65, v12
    v_mul_f32 v66, v66, v12
    v_mul_f32 v67, v67, v12
    v_mul_f32 v68, v68, v12
    v_mul_f32 v69, v69, v12
    v_mul_f32 v70, v70, v12
    v_mul_f32 v71, v71, v12
    v_mul_f32 v72, v72, v12
    v_mul_f32 v73, v73, v12
    v_mul_f32 v74, v74, v12
    v_mul_f32 v75, v75, v12
    v_mul_f32 v76, v76, v12
    v_mul_f32 v77, v77, v12
    v_mul_f32 v78, v78, v12
    v_mul_f32 v79, v79, v12
    v_mul_f32 v80, v80, v12
    v_mul_f32 v81, v81, v12
    v_mul_f32 v82, v82, v12
    v_mul_f32 v83, v83, v12
    v_mul_f32 v84, v84, v12
    v_mul_f32 v85, v85, v12
    v_mul_f32 v86, v86, v12
    v_mul_f32 v87, v87, v12
    v_mul_f32 v88, v88, v12
    v_mul_f32 v89, v89, v12
    v_mul_f32 v90, v90, v12
    v_mul_f32 v91, v91, v12
    v_mul_f32 v92, v92, v12
    v_mul_f32 v93, v93, v12
    v_mul_f32 v94, v94, v12
    v_mul_f32 v95, v95, v12
    v_mul_f32 v192, v192, v12
    v_lshlrev_b32 v13, 16, v160
    v_and_b32 v14, 0xffff0000, v160
    v_mul_f32 v13, v13, v12
    v_mul_f32 v14, v14, v12
    v_cvt_pk_bf16_f32 v160, v13, v14
    v_lshlrev_b32 v13, 16, v161
    v_and_b32 v14, 0xffff0000, v161
    v_mul_f32 v13, v13, v12
    v_mul_f32 v14, v14, v12
    v_cvt_pk_bf16_f32 v161, v13, v14
    v_lshlrev_b32 v13, 16, v162
    v_and_b32 v14, 0xffff0000, v162
    v_mul_f32 v13, v13, v12
    v_mul_f32 v14, v14, v12
    v_cvt_pk_bf16_f32 v162, v13, v14
    v_lshlrev_b32 v13, 16, v163
    v_and_b32 v14, 0xffff0000, v163
    v_mul_f32 v13, v13, v12
    v_mul_f32 v14, v14, v12
    v_cvt_pk_bf16_f32 v163, v13, v14
    v_lshlrev_b32 v13, 16, v164
    v_and_b32 v14, 0xffff0000, v164
    v_mul_f32 v13, v13, v12
    v_mul_f32 v14, v14, v12
    v_cvt_pk_bf16_f32 v164, v13, v14
    v_lshlrev_b32 v13, 16, v165
    v_and_b32 v14, 0xffff0000, v165
    v_mul_f32 v13, v13, v12
    v_mul_f32 v14, v14, v12
    v_cvt_pk_bf16_f32 v165, v13, v14
    v_lshlrev_b32 v13, 16, v166
    v_and_b32 v14, 0xffff0000, v166
    v_mul_f32 v13, v13, v12
    v_mul_f32 v14, v14, v12
    v_cvt_pk_bf16_f32 v166, v13, v14
    v_lshlrev_b32 v13, 16, v167
    v_and_b32 v14, 0xffff0000, v167
    v_mul_f32 v13, v13, v12
    v_mul_f32 v14, v14, v12
    v_cvt_pk_bf16_f32 v167, v13, v14
    v_sub_f32 v144, v144, v11
    v_sub_f32 v176, v176, v11
    v_sub_f32 v145, v145, v11
    v_sub_f32 v177, v177, v11
    v_sub_f32 v146, v146, v11
    v_sub_f32 v178, v178, v11
    v_sub_f32 v147, v147, v11
    v_sub_f32 v179, v179, v11
    v_sub_f32 v148, v148, v11
    v_sub_f32 v180, v180, v11
    v_sub_f32 v149, v149, v11
    v_sub_f32 v181, v181, v11
    v_sub_f32 v150, v150, v11
    v_sub_f32 v182, v182, v11
    v_sub_f32 v151, v151, v11
    v_sub_f32 v183, v183, v11
    v_sub_f32 v152, v152, v11
    v_sub_f32 v184, v184, v11
    v_sub_f32 v153, v153, v11
    v_sub_f32 v185, v185, v11
    v_sub_f32 v154, v154, v11
    v_sub_f32 v186, v186, v11
    v_sub_f32 v155, v155, v11
    v_sub_f32 v187, v187, v11
    v_sub_f32 v156, v156, v11
    v_sub_f32 v188, v188, v11
    v_sub_f32 v157, v157, v11
    v_sub_f32 v189, v189, v11
    v_sub_f32 v158, v158, v11
    v_sub_f32 v190, v190, v11
    v_sub_f32 v159, v159, v11
    v_sub_f32 v191, v191, v11
    s_nop 1
    s_branch L_back_16
L_rare_17:
    s_nop 15
    s_nop 3
    v_mov_b32 v12, v11
    s_nop 1
    v_permlane32_swap_b32 v11, v12
    s_nop 0
    v_max3_f32 v11, v11, v12, 0
    v_ceil_f32 v11, v11
    v_min_f32 v12, 0x43480000, v11
    v_cvt_i32_f32 v12, v12
    v_sub_u32 v12, 0, v12
    v_ldexp_f32 v12, 1.0, v12
    v_mul_f32 v32, v32, v12
    v_mul_f32 v33, v33, v12
    v_mul_f32 v34, v34, v12
    v_mul_f32 v35, v35, v12
    v_mul_f32 v36, v36, v12
    v_mul_f32 v37, v37, v12
    v_mul_f32 v38, v38, v12
    v_mul_f32 v39, v39, v12
    v_mul_f32 v40, v40, v12
    v_mul_f32 v41, v41, v12
    v_mul_f32 v42, v42, v12
    v_mul_f32 v43, v43, v12
    v_mul_f32 v44, v44, v12
    v_mul_f32 v45, v45, v12
    v_mul_f32 v46, v46, v12
    v_mul_f32 v47, v47, v12
    v_mul_f32 v48, v48, v12
    v_mul_f32 v49, v49, v12
    v_mul_f32 v50, v50, v12
    v_mul_f32 v51, v51, v12
    v_mul_f32 v52, v52, v12
    v_mul_f32 v53, v53, v12
    v_mul_f32 v54, v54, v12
    v_mul_f32 v55, v55, v12
    v_mul_f32 v56, v56, v12
    v_mul_f32 v57, v57, v12
    v_mul_f32 v58, v58, v12
    v_mul_f32 v59, v59, v12
    v_mul_f32 v60, v60, v12
    v_mul_f32 v61, v61, v12
    v_mul_f32 v62, v62, v12
    v_mul_f32 v63, v63, v12
    v_mul_f32 v64, v64, v12
    v_mul_f32 v65, v65, v12
    v_mul_f32 v66, v66, v12
    v_mul_f32 v67, v67, v12
    v_mul_f32 v68, v68, v12
    v_mul_f32 v69, v69, v12
    v_mul_f32 v70, v70, v12
    v_mul_f32 v71, v71, v12
    v_mul_f32 v72, v72, v12
    v_mul_f32 v73, v73, v12
    v_mul_f32 v74, v74, v12
    v_mul_f32 v75, v75, v12
    v_mul_f32 v76, v76, v12
    v_mul_f32 v77, v77, v12
    v_mul_f32 v78, v78, v12
    v_mul_f32 v79, v79, v12
    v_mul_f32 v80, v80, v12
    v_mul_f32 v81, v81, v12
    v_mul_f32 v82, v82, v12
    v_mul_f32 v83, v83, v12
    v_mul_f32 v84, v84, v12
    v_mul_f32 v85, v85, v12
    v_mul_f32 v86, v86, v12
    v_mul_f32 v87, v87, v12
    v_mul_f32 v88, v88, v12
    v_mul_f32 v89, v89, v12
    v_mul_f32 v90, v90, v12
    v_mul_f32 v91, v91, v12
    v_mul_f32 v92, v92, v12
    v_mul_f32 v93, v93, v12
    v_mul_f32 v94, v94, v12
    v_mul_f32 v95, v95, v12
    v_mul_f32 v192, v192, v12
    v_lshlrev_b32 v13, 16, v168
    v_and_b32 v14, 0xffff0000, v168
    v_mul_f32 v13, v13, v12
    v_mul_f32 v14, v14, v12
    v_cvt_pk_bf16_f32 v168, v13, v14
    v_lshlrev_b32 v13, 16, v169
    v_and_b32 v14, 0xffff0000, v169
    v_mul_f32 v13, v13, v12
    v_mul_f32 v14, v14, v12
    v_cvt_pk_bf16_f32 v169, v13, v14
    v_lshlrev_b32 v13, 16, v170
    v_and_b32 v14, 0xffff0000, v170
    v_mul_f32 v13, v13, v12
    v_mul_f32 v14, v14, v12
    v_cvt_pk_bf16_f32 v170, v13, v14
    v_lshlrev_b32 v13, 16, v171
    v_and_b32 v14, 0xffff0000, v171
    v_mul_f32 v13, v13, v12
    v_mul_f32 v14, v14, v12
    v_cvt_pk_bf16_f32 v171, v13, v14
    v_lshlrev_b32 v13, 16, v172
    v_and_b32 v14, 0xffff0000, v172
    v_mul_f32 v13, v13, v12
    v_mul_f32 v14, v14, v12
    v_cvt_pk_bf16_f32 v172, v13, v14
    v_lshlrev_b32 v13, 16, v173
    v_and_b32 v14, 0xffff0000, v173
    v_mul_f32 v13, v13, v12
    v_mul_f32 v14, v14, v12
    v_cvt_pk_bf16_f32 v173, v13, v14
    v_lshlrev_b32 v13, 16, v174
    v_and_b32 v14, 0xffff0000, v174
    v_mul_f32 v13, v13, v12
    v_mul_f32 v14, v14, v12
    v_cvt_pk_bf16_f32 v174, v13, v14
    v_lshlrev_b32 v13, 16, v175
    v_and_b32 v14, 0xffff0000, v175
    v_mul_f32 v13, v13, v12
    v_mul_f32 v14, v14, v12
    v_cvt_pk_bf16_f32 v175, v13, v14
    v_sub_f32 v128, v128, v11
    v_sub_f32 v176, v176, v11
    v_sub_f32 v129, v129, v11
    v_sub_f32 v177, v177, v11
    v_sub_f32 v130, v130, v11
    v_sub_f32 v178, v178, v11
    v_sub_f32 v131, v131, v11
    v_sub_f32 v179, v179, v11
    v_sub_f32 v132, v132, v11
    v_sub_f32 v180, v180, v11
    v_sub_f32 v133, v133, v11
    v_sub_f32 v181, v181, v11
    v_sub_f32 v134, v134, v11
    v_sub_f32 v182, v182, v11
    v_sub_f32 v135, v135, v11
    v_sub_f32 v183, v183, v11
    v_sub_f32 v136, v136, v11
    v_sub_f32 v184, v184, v11
    v_sub_f32 v137, v137, v11
    v_sub_f32 v185, v185, v11
    v_sub_f32 v138, v138, v11
    v_sub_f32 v186, v186, v11
    v_sub_f32 v139, v139, v11
    v_sub_f32 v187, v187, v11
    v_sub_f32 v140, v140, v11
    v_sub_f32 v188, v188, v11
    v_sub_f32 v141, v141, v11
    v_sub_f32 v189, v189, v11
    v_sub_f32 v142, v142, v11
    v_sub_f32 v190, v190, v11
    v_sub_f32 v143, v143, v11
    v_sub_f32 v191, v191, v11
    s_nop 1
    s_branch L_back_17
L_rare_18:
    s_nop 15
    s_nop 3
    v_mov_b32 v12, v11
    s_nop 1
    v_permlane32_swap_b32 v11, v12
    s_nop 0
    v_max3_f32 v11, v11, v12, 0
    v_ceil_f32 v11, v11
    v_min_f32 v12, 0x43480000, v11
    v_cvt_i32_f32 v12, v12
    v_sub_u32 v12, 0, v12
    v_ldexp_f32 v12, 1.0, v12
    v_mul_f32 v32, v32, v12
    v_mul_f32 v33, v33, v12
    v_mul_f32 v34, v34, v12
    v_mul_f32 v35, v35, v12
    v_mul_f32 v36, v36, v12
    v_mul_f32 v37, v37, v12
    v_mul_f32 v38, v38, v12
    v_mul_f32 v39, v39, v12
    v_mul_f32 v40, v40, v12
    v_mul_f32 v41, v41, v12
    v_mul_f32 v42, v42, v12
    v_mul_f32 v43, v43, v12
    v_mul_f32 v44, v44, v12
    v_mul_f32 v45, v45, v12
    v_mul_f32 v46, v46, v12
    v_mul_f32 v47, v47, v12
    v_mul_f32 v48, v48, v12
    v_mul_f32 v49, v49, v12
    v_mul_f32 v50, v50, v12
    v_mul_f32 v51, v51, v12
    v_mul_f32 v52, v52, v12
    v_mul_f32 v53, v53, v12
    v_mul_f32 v54, v54, v12
    v_mul_f32 v55, v55, v12
    v_mul_f32 v56, v56, v12
    v_mul_f32 v57, v57, v12
    v_mul_f32 v58, v58, v12
    v_mul_f32 v59, v59, v12
    v_mul_f32 v60, v60, v12
    v_mul_f32 v61, v61, v12
    v_mul_f32 v62, v62, v12
    v_mul_f32 v63, v63, v12
    v_mul_f32 v64, v64, v12
    v_mul_f32 v65, v65, v12
    v_mul_f32 v66, v66, v12
    v_mul_f32 v67, v67, v12
    v_mul_f32 v68, v68, v12
    v_mul_f32 v69, v69, v12
    v_mul_f32 v70, v70, v12
    v_mul_f32 v71, v71, v12
    v_mul_f32 v72, v72, v12
    v_mul_f32 v73, v73, v12
    v_mul_f32 v74, v74, v12
    v_mul_f32 v75, v75, v12
    v_mul_f32 v76, v76, v12
    v_mul_f32 v77, v77, v12
    v_mul_f32 v78, v78, v12
    v_mul_f32 v79, v79, v12
    v_mul_f32 v80, v80, v12
    v_mul_f32 v81, v81, v12
    v_mul_f32 v82, v82, v12
    v_mul_f32 v83, v83, v12
    v_mul_f32 v84, v84, v12
    v_mul_f32 v85, v85, v12
    v_mul_f32 v86, v86, v12
    v_mul_f32 v87, v87, v12
    v_mul_f32 v88, v88, v12
    v_mul_f32 v89, v89, v12
    v_mul_f32 v90, v90, v12
    v_mul_f32 v91, v91, v12
    v_mul_f32 v92, v92, v12
    v_mul_f32 v93, v93, v12
    v_mul_f32 v94, v94, v12
    v_mul_f32 v95, v95, v12
    v_mul_f32 v192, v192, v12
    v_lshlrev_b32 v13, 16, v160
    v_and_b32 v14, 0xffff0000, v160
    v_mul_f32 v13, v13, v12
    v_mul_f32 v14, v14, v12
    v_cvt_pk_bf16_f32 v160, v13, v14
    v_lshlrev_b32 v13, 16, v161
    v_and_b32 v14, 0xffff0000, v161
    v_mul_f32 v13, v13, v12
    v_mul_f32 v14, v14, v12
    v_cvt_pk_bf16_f32 v161, v13, v14
    v_lshlrev_b32 v13, 16, v162
    v_and_b32 v14, 0xffff0000, v162
    v_mul_f32 v13, v13, v12
    v_mul_f32 v14, v14, v12
    v_cvt_pk_bf16_f32 v162, v13, v14
    v_lshlrev_b32 v13, 16, v163
    v_and_b32 v14, 0xffff0000, v163
    v_mul_f32 v13, v13, v12
    v_mul_f32 v14, v14, v12
    v_cvt_pk_bf16_f32 v163, v13, v14
    v_lshlrev_b32 v13, 16, v164
    v_and_b32 v14, 0xffff0000, v164
    v_mul_f32 v13, v13, v12
    v_mul_f32 v14, v14, v12
    v_cvt_pk_bf16_f32 v164, v13, v14
    v_lshlrev_b32 v13, 16, v165
    v_and_b32 v14, 0xffff0000, v165
    v_mul_f32 v13, v13, v12
    v_mul_f32 v14, v14, v12
    v_cvt_pk_bf16_f32 v165, v13, v14
    v_lshlrev_b32 v13, 16, v166
    v_and_b32 v14, 0xffff0000, v166
    v_mul_f32 v13, v13, v12
    v_mul_f32 v14, v14, v12
    v_cvt_pk_bf16_f32 v166, v13, v14
    v_lshlrev_b32 v13, 16, v167
    v_and_b32 v14, 0xffff0000, v167
    v_mul_f32 v13, v13, v12
    v_mul_f32 v14, v14, v12
    v_cvt_pk_bf16_f32 v167, v13, v14
    v_sub_f32 v144, v144, v11
    v_sub_f32 v176, v176, v11
    v_sub_f32 v145, v145, v11
    v_sub_f32 v177, v177, v11
    v_sub_f32 v146, v146, v11
    v_sub_f32 v178, v178, v11
    v_sub_f32 v147, v147, v11
    v_sub_f32 v179, v179, v11
    v_sub_f32 v148, v148, v11
    v_sub_f32 v180, v180, v11
    v_sub_f32 v149, v149, v11
    v_sub_f32 v181, v181, v11
    v_sub_f32 v150, v150, v11
    v_sub_f32 v182, v182, v11
    v_sub_f32 v151, v151, v11
    v_sub_f32 v183, v183, v11
    v_sub_f32 v152, v152, v11
    v_sub_f32 v184, v184, v11
    v_sub_f32 v153, v153, v11
    v_sub_f32 v185, v185, v11
    v_sub_f32 v154, v154, v11
    v_sub_f32 v186, v186, v11
    v_sub_f32 v155, v155, v11
    v_sub_f32 v187, v187, v11
    v_sub_f32 v156, v156, v11
    v_sub_f32 v188, v188, v11
    v_sub_f32 v157, v157, v11
    v_sub_f32 v189, v189, v11
    v_sub_f32 v158, v158, v11
    v_sub_f32 v190, v190, v11
    v_sub_f32 v159, v159, v11
    v_sub_f32 v191, v191, v11
    s_nop 1
    s_branch L_back_18
L_rare_19:
    s_nop 15
    s_nop 3
    v_mov_b32 v12, v11
    s_nop 1
    v_permlane32_swap_b32 v11, v12
    s_nop 0
    v_max3_f32 v11, v11, v12, 0
    v_ceil_f32 v11, v11
    v_min_f32 v12, 0x43480000, v11
    v_cvt_i32_f32 v12, v12
    v_sub_u32 v12, 0, v12
    v_ldexp_f32 v12, 1.0, v12
    v_mul_f32 v32, v32, v12
    v_mul_f32 v33, v33, v12
    v_mul_f32 v34, v34, v12
    v_mul_f32 v35, v35, v12
    v_mul_f32 v36, v36, v12
    v_mul_f32 v37, v37, v12
    v_mul_f32 v38, v38, v12
    v_mul_f32 v39, v39, v12
    v_mul_f32 v40, v40, v12
    v_mul_f32 v41, v41, v12
    v_mul_f32 v42, v42, v12
    v_mul_f32 v43, v43, v12
    v_mul_f32 v44, v44, v12
    v_mul_f32 v45, v45, v12
    v_mul_f32 v46, v46, v12
    v_mul_f32 v47, v47, v12
    v_mul_f32 v48, v48, v12
    v_mul_f32 v49, v49, v12
    v_mul_f32 v50, v50, v12
    v_mul_f32 v51, v51, v12
    v_mul_f32 v52, v52, v12
    v_mul_f32 v53, v53, v12
    v_mul_f32 v54, v54, v12
    v_mul_f32 v55, v55, v12
    v_mul_f32 v56, v56, v12
    v_mul_f32 v57, v57, v12
    v_mul_f32 v58, v58, v12
    v_mul_f32 v59, v59, v12
    v_mul_f32 v60, v60, v12
    v_mul_f32 v61, v61, v12
    v_mul_f32 v62, v62, v12
    v_mul_f32 v63, v63, v12
    v_mul_f32 v64, v64, v12
    v_mul_f32 v65, v65, v12
    v_mul_f32 v66, v66, v12
    v_mul_f32 v67, v67, v12
    v_mul_f32 v68, v68, v12
    v_mul_f32 v69, v69, v12
    v_mul_f32 v70, v70, v12
    v_mul_f32 v71, v71, v12
    v_mul_f32 v72, v72, v12
    v_mul_f32 v73, v73, v12
    v_mul_f32 v74, v74, v12
    v_mul_f32 v75, v75, v12
    v_mul_f32 v76, v76, v12
    v_mul_f32 v77, v77, v12
    v_mul_f32 v78, v78, v12
    v_mul_f32 v79, v79, v12
    v_mul_f32 v80, v80, v12
    v_mul_f32 v81, v81, v12
    v_mul_f32 v82, v82, v12
    v_mul_f32 v83, v83, v12
    v_mul_f32 v84, v84, v12
    v_mul_f32 v85, v85, v12
    v_mul_f32 v86, v86, v12
    v_mul_f32 v87, v87, v12
    v_mul_f32 v88, v88, v12
    v_mul_f32 v89, v89, v12
    v_mul_f32 v90, v90, v12
    v_mul_f32 v91, v91, v12
    v_mul_f32 v92, v92, v12
    v_mul_f32 v93, v93, v12
    v_mul_f32 v94, v94, v12
    v_mul_f32 v95, v95, v12
    v_mul_f32 v192, v192, v12
    v_lshlrev_b32 v13, 16, v168
    v_and_b32 v14, 0xffff0000, v168
    v_mul_f32 v13, v13, v12
    v_mul_f32 v14, v14, v12
    v_cvt_pk_bf16_f32 v168, v13, v14
    v_lshlrev_b32 v13, 16, v169
    v_and_b32 v14, 0xffff0000, v169
    v_mul_f32 v13, v13, v12
    v_mul_f32 v14, v14, v12
    v_cvt_pk_bf16_f32 v169, v13, v14
    v_lshlrev_b32 v13, 16, v170
    v_and_b32 v14, 0xffff0000, v170
    v_mul_f32 v13, v13, v12
    v_mul_f32 v14, v14, v12
    v_cvt_pk_bf16_f32 v170, v13, v14
    v_lshlrev_b32 v13, 16, v171
    v_and_b32 v14, 0xffff0000, v171
    v_mul_f32 v13, v13, v12
    v_mul_f32 v14, v14, v12
    v_cvt_pk_bf16_f32 v171, v13, v14
    v_lshlrev_b32 v13, 16, v172
    v_and_b32 v14, 0xffff0000, v172
    v_mul_f32 v13, v13, v12
    v_mul_f32 v14, v14, v12
    v_cvt_pk_bf16_f32 v172, v13, v14
    v_lshlrev_b32 v13, 16, v173
    v_and_b32 v14, 0xffff0000, v173
    v_mul_f32 v13, v13, v12
    v_mul_f32 v14, v14, v12
    v_cvt_pk_bf16_f32 v173, v13, v14
    v_lshlrev_b32 v13, 16, v174
    v_and_b32 v14, 0xffff0000, v174
    v_mul_f32 v13, v13, v12
    v_mul_f32 v14, v14, v12
    v_cvt_pk_bf16_f32 v174, v13, v14
    v_lshlrev_b32 v13, 16, v175
    v_and_b32 v14, 0xffff0000, v175
    v_mul_f32 v13, v13, v12
    v_mul_f32 v14, v14, v12
    v_cvt_pk_bf16_f32 v175, v13, v14
    v_sub_f32 v128, v128, v11
    v_sub_f32 v176, v176, v11
    v_sub_f32 v129, v129, v11
    v_sub_f32 v177, v177, v11
    v_sub_f32 v130, v130, v11
    v_sub_f32 v178, v178, v11
    v_sub_f32 v131, v131, v11
    v_sub_f32 v179, v179, v11
    v_sub_f32 v132, v132, v11
    v_sub_f32 v180, v180, v11
    v_sub_f32 v133, v133, v11
    v_sub_f32 v181, v181, v11
    v_sub_f32 v134, v134, v11
    v_sub_f32 v182, v182, v11
    v_sub_f32 v135, v135, v11
    v_sub_f32 v183, v183, v11
    v_sub_f32 v136, v136, v11
    v_sub_f32 v184, v184, v11
    v_sub_f32 v137, v137, v11
    v_sub_f32 v185, v185, v11
    v_sub_f32 v138, v138, v11
    v_sub_f32 v186, v186, v11
    v_sub_f32 v139, v139, v11
    v_sub_f32 v187, v187, v11
    v_sub_f32 v140, v140, v11
    v_sub_f32 v188, v188, v11
    v_sub_f32 v141, v141, v11
    v_sub_f32 v189, v189, v11
    v_sub_f32 v142, v142, v11
    v_sub_f32 v190, v190, v11
    v_sub_f32 v143, v143, v11
    v_sub_f32 v191, v191, v11
    s_nop 1
    s_branch L_back_19
L_rare_20:
    s_nop 15
    s_nop 3
    v_mov_b32 v12, v11
    s_nop 1
    v_permlane32_swap_b32 v11, v12
    s_nop 0
    v_max3_f32 v11, v11, v12, 0
    v_ceil_f32 v11, v11
    v_min_f32 v12, 0x43480000, v11
    v_cvt_i32_f32 v12, v12
    v_sub_u32 v12, 0, v12
    v_ldexp_f32 v12, 1.0, v12
    v_mul_f32 v32, v32, v12
    v_mul_f32 v33, v33, v12
    v_mul_f32 v34, v34, v12
    v_mul_f32 v35, v35, v12
    v_mul_f32 v36, v36, v12
    v_mul_f32 v37, v37, v12
    v_mul_f32 v38, v38, v12
    v_mul_f32 v39, v39, v12
    v_mul_f32 v40, v40, v12
    v_mul_f32 v41, v41, v12
    v_mul_f32 v42, v42, v12
    v_mul_f32 v43, v43, v12
    v_mul_f32 v44, v44, v12
    v_mul_f32 v45, v45, v12
    v_mul_f32 v46, v46, v12
    v_mul_f32 v47, v47, v12
    v_mul_f32 v48, v48, v12
    v_mul_f32 v49, v49, v12
    v_mul_f32 v50, v50, v12
    v_mul_f32 v51, v51, v12
    v_mul_f32 v52, v52, v12
    v_mul_f32 v53, v53, v12
    v_mul_f32 v54, v54, v12
    v_mul_f32 v55, v55, v12
    v_mul_f32 v56, v56, v12
    v_mul_f32 v57, v57, v12
    v_mul_f32 v58, v58, v12
    v_mul_f32 v59, v59, v12
    v_mul_f32 v60, v60, v12
    v_mul_f32 v61, v61, v12
    v_mul_f32 v62, v62, v12
    v_mul_f32 v63, v63, v12
    v_mul_f32 v64, v64, v12
    v_mul_f32 v65, v65, v12
    v_mul_f32 v66, v66, v12
    v_mul_f32 v67, v67, v12
    v_mul_f32 v68, v68, v12
    v_mul_f32 v69, v69, v12
    v_mul_f32 v70, v70, v12
    v_mul_f32 v71, v71, v12
    v_mul_f32 v72, v72, v12
    v_mul_f32 v73, v73, v12
    v_mul_f32 v74, v74, v12
    v_mul_f32 v75, v75, v12
    v_mul_f32 v76, v76, v12
    v_mul_f32 v77, v77, v12
    v_mul_f32 v78, v78, v12
    v_mul_f32 v79, v79, v12
    v_mul_f32 v80, v80, v12
    v_mul_f32 v81, v81, v12
    v_mul_f32 v82, v82, v12
    v_mul_f32 v83, v83, v12
    v_mul_f32 v84, v84, v12
    v_mul_f32 v85, v85, v12
    v_mul_f32 v86, v86, v12
    v_mul_f32 v87, v87, v12
    v_mul_f32 v88, v88, v12
    v_mul_f32 v89, v89, v12
    v_mul_f32 v90, v90, v12
    v_mul_f32 v91, v91, v12
    v_mul_f32 v92, v92, v12
    v_mul_f32 v93, v93, v12
    v_mul_f32 v94, v94, v12
    v_mul_f32 v95, v95, v12
    v_mul_f32 v192, v192, v12
    v_lshlrev_b32 v13, 16, v160
    v_and_b32 v14, 0xffff0000, v160
    v_mul_f32 v13, v13, v12
    v_mul_f32 v14, v14, v12
    v_cvt_pk_bf16_f32 v160, v13, v14
    v_lshlrev_b32 v13, 16, v161
    v_and_b32 v14, 0xffff0000, v161
    v_mul_f32 v13, v13, v12
    v_mul_f32 v14, v14, v12
    v_cvt_pk_bf16_f32 v161, v13, v14
    v_lshlrev_b32 v13, 16, v162
    v_and_b32 v14, 0xffff0000, v162
    v_mul_f32 v13, v13, v12
    v_mul_f32 v14, v14, v12
    v_cvt_pk_bf16_f32 v162, v13, v14
    v_lshlrev_b32 v13, 16, v163
    v_and_b32 v14, 0xffff0000, v163
    v_mul_f32 v13, v13, v12
    v_mul_f32 v14, v14, v12
    v_cvt_pk_bf16_f32 v163, v13, v14
    v_lshlrev_b32 v13, 16, v164
    v_and_b32 v14, 0xffff0000, v164
    v_mul_f32 v13, v13, v12
    v_mul_f32 v14, v14, v12
    v_cvt_pk_bf16_f32 v164, v13, v14
    v_lshlrev_b32 v13, 16, v165
    v_and_b32 v14, 0xffff0000, v165
    v_mul_f32 v13, v13, v12
    v_mul_f32 v14, v14, v12
    v_cvt_pk_bf16_f32 v165, v13, v14
    v_lshlrev_b32 v13, 16, v166
    v_and_b32 v14, 0xffff0000, v166
    v_mul_f32 v13, v13, v12
    v_mul_f32 v14, v14, v12
    v_cvt_pk_bf16_f32 v166, v13, v14
    v_lshlrev_b32 v13, 16, v167
    v_and_b32 v14, 0xffff0000, v167
    v_mul_f32 v13, v13, v12
    v_mul_f32 v14, v14, v12
    v_cvt_pk_bf16_f32 v167, v13, v14
    v_sub_f32 v144, v144, v11
    v_sub_f32 v176, v176, v11
    v_sub_f32 v145, v145, v11
    v_sub_f32 v177, v177, v11
    v_sub_f32 v146, v146, v11
    v_sub_f32 v178, v178, v11
    v_sub_f32 v147, v147, v11
    v_sub_f32 v179, v179, v11
    v_sub_f32 v148, v148, v11
    v_sub_f32 v180, v180, v11
    v_sub_f32 v149, v149, v11
    v_sub_f32 v181, v181, v11
    v_sub_f32 v150, v150, v11
    v_sub_f32 v182, v182, v11
    v_sub_f32 v151, v151, v11
    v_sub_f32 v183, v183, v11
    v_sub_f32 v152, v152, v11
    v_sub_f32 v184, v184, v11
    v_sub_f32 v153, v153, v11
    v_sub_f32 v185, v185, v11
    v_sub_f32 v154, v154, v11
    v_sub_f32 v186, v186, v11
    v_sub_f32 v155, v155, v11
    v_sub_f32 v187, v187, v11
    v_sub_f32 v156, v156, v11
    v_sub_f32 v188, v188, v11
    v_sub_f32 v157, v157, v11
    v_sub_f32 v189, v189, v11
    v_sub_f32 v158, v158, v11
    v_sub_f32 v190, v190, v11
    v_sub_f32 v159, v159, v11
    v_sub_f32 v191, v191, v11
    s_nop 1
    s_branch L_back_20
L_rare_21:
    s_nop 15
    s_nop 3
    v_mov_b32 v12, v11
    s_nop 1
    v_permlane32_swap_b32 v11, v12
    s_nop 0
    v_max3_f32 v11, v11, v12, 0
    v_ceil_f32 v11, v11
    v_min_f32 v12, 0x43480000, v11
    v_cvt_i32_f32 v12, v12
    v_sub_u32 v12, 0, v12
    v_ldexp_f32 v12, 1.0, v12
    v_mul_f32 v32, v32, v12
    v_mul_f32 v33, v33, v12
    v_mul_f32 v34, v34, v12
    v_mul_f32 v35, v35, v12
    v_mul_f32 v36, v36, v12
    v_mul_f32 v37, v37, v12
    v_mul_f32 v38, v38, v12
    v_mul_f32 v39, v39, v12
    v_mul_f32 v40, v40, v12
    v_mul_f32 v41, v41, v12
    v_mul_f32 v42, v42, v12
    v_mul_f32 v43, v43, v12
    v_mul_f32 v44, v44, v12
    v_mul_f32 v45, v45, v12
    v_mul_f32 v46, v46, v12
    v_mul_f32 v47, v47, v12
    v_mul_f32 v48, v48, v12
    v_mul_f32 v49, v49, v12
    v_mul_f32 v50, v50, v12
    v_mul_f32 v51, v51, v12
    v_mul_f32 v52, v52, v12
    v_mul_f32 v53, v53, v12
    v_mul_f32 v54, v54, v12
    v_mul_f32 v55, v55, v12
    v_mul_f32 v56, v56, v12
    v_mul_f32 v57, v57, v12
    v_mul_f32 v58, v58, v12
    v_mul_f32 v59, v59, v12
    v_mul_f32 v60, v60, v12
    v_mul_f32 v61, v61, v12
    v_mul_f32 v62, v62, v12
    v_mul_f32 v63, v63, v12
    v_mul_f32 v64, v64, v12
    v_mul_f32 v65, v65, v12
    v_mul_f32 v66, v66, v12
    v_mul_f32 v67, v67, v12
    v_mul_f32 v68, v68, v12
    v_mul_f32 v69, v69, v12
    v_mul_f32 v70, v70, v12
    v_mul_f32 v71, v71, v12
    v_mul_f32 v72, v72, v12
    v_mul_f32 v73, v73, v12
    v_mul_f32 v74, v74, v12
    v_mul_f32 v75, v75, v12
    v_mul_f32 v76, v76, v12
    v_mul_f32 v77, v77, v12
    v_mul_f32 v78, v78, v12
    v_mul_f32 v79, v79, v12
    v_mul_f32 v80, v80, v12
    v_mul_f32 v81, v81, v12
    v_mul_f32 v82, v82, v12
    v_mul_f32 v83, v83, v12
    v_mul_f32 v84, v84, v12
    v_mul_f32 v85, v85, v12
    v_mul_f32 v86, v86, v12
    v_mul_f32 v87, v87, v12
    v_mul_f32 v88, v88, v12
    v_mul_f32 v89, v89, v12
    v_mul_f32 v90, v90, v12
    v_mul_f32 v91, v91, v12
    v_mul_f32 v92, v92, v12
    v_mul_f32 v93, v93, v12
    v_mul_f32 v94, v94, v12
    v_mul_f32 v95, v95, v12
    v_mul_f32 v192, v192, v12
    v_lshlrev_b32 v13, 16, v168
    v_and_b32 v14, 0xffff0000, v168
    v_mul_f32 v13, v13, v12
    v_mul_f32 v14, v14, v12
    v_cvt_pk_bf16_f32 v168, v13, v14
    v_lshlrev_b32 v13, 16, v169
    v_and_b32 v14, 0xffff0000, v169
    v_mul_f32 v13, v13, v12
    v_mul_f32 v14, v14, v12
    v_cvt_pk_bf16_f32 v169, v13, v14
    v_lshlrev_b32 v13, 16, v170
    v_and_b32 v14, 0xffff0000, v170
    v_mul_f32 v13, v13, v12
    v_mul_f32 v14, v14, v12
    v_cvt_pk_bf16_f32 v170, v13, v14
    v_lshlrev_b32 v13, 16, v171
    v_and_b32 v14, 0xffff0000, v171
    v_mul_f32 v13, v13, v12
    v_mul_f32 v14, v14, v12
    v_cvt_pk_bf16_f32 v171, v13, v14
    v_lshlrev_b32 v13, 16, v172
    v_and_b32 v14, 0xffff0000, v172
    v_mul_f32 v13, v13, v12
    v_mul_f32 v14, v14, v12
    v_cvt_pk_bf16_f32 v172, v13, v14
    v_lshlrev_b32 v13, 16, v173
    v_and_b32 v14, 0xffff0000, v173
    v_mul_f32 v13, v13, v12
    v_mul_f32 v14, v14, v12
    v_cvt_pk_bf16_f32 v173, v13, v14
    v_lshlrev_b32 v13, 16, v174
    v_and_b32 v14, 0xffff0000, v174
    v_mul_f32 v13, v13, v12
    v_mul_f32 v14, v14, v12
    v_cvt_pk_bf16_f32 v174, v13, v14
    v_lshlrev_b32 v13, 16, v175
    v_and_b32 v14, 0xffff0000, v175
    v_mul_f32 v13, v13, v12
    v_mul_f32 v14, v14, v12
    v_cvt_pk_bf16_f32 v175, v13, v14
    v_sub_f32 v128, v128, v11
    v_sub_f32 v176, v176, v11
    v_sub_f32 v129, v129, v11
    v_sub_f32 v177, v177, v11
    v_sub_f32 v130, v130, v11
    v_sub_f32 v178, v178, v11
    v_sub_f32 v131, v131, v11
    v_sub_f32 v179, v179, v11
    v_sub_f32 v132, v132, v11
    v_sub_f32 v180, v180, v11
    v_sub_f32 v133, v133, v11
    v_sub_f32 v181, v181, v11
    v_sub_f32 v134, v134, v11
    v_sub_f32 v182, v182, v11
    v_sub_f32 v135, v135, v11
    v_sub_f32 v183, v183, v11
    v_sub_f32 v136, v136, v11
    v_sub_f32 v184, v184, v11
    v_sub_f32 v137, v137, v11
    v_sub_f32 v185, v185, v11
    v_sub_f32 v138, v138, v11
    v_sub_f32 v186, v186, v11
    v_sub_f32 v139, v139, v11
    v_sub_f32 v187, v187, v11
    v_sub_f32 v140, v140, v11
    v_sub_f32 v188, v188, v11
    v_sub_f32 v141, v141, v11
    v_sub_f32 v189, v189, v11
    v_sub_f32 v142, v142, v11
    v_sub_f32 v190, v190, v11
    v_sub_f32 v143, v143, v11
    v_sub_f32 v191, v191, v11
    s_nop 1
    s_branch L_back_21
L_rare_22:
    s_nop 15
    s_nop 3
    v_mov_b32 v12, v11
    s_nop 1
    v_permlane32_swap_b32 v11, v12
    s_nop 0
    v_max3_f32 v11, v11, v12, 0
    v_ceil_f32 v11, v11
    v_min_f32 v12, 0x43480000, v11
    v_cvt_i32_f32 v12, v12
    v_sub_u32 v12, 0, v12
    v_ldexp_f32 v12, 1.0, v12
    v_mul_f32 v32, v32, v12
    v_mul_f32 v33, v33, v12
    v_mul_f32 v34, v34, v12
    v_mul_f32 v35, v35, v12
    v_mul_f32 v36, v36, v12
    v_mul_f32 v37, v37, v12
    v_mul_f32 v38, v38, v12
    v_mul_f32 v39, v39, v12
    v_mul_f32 v40, v40, v12
    v_mul_f32 v41, v41, v12
    v_mul_f32 v42, v42, v12
    v_mul_f32 v43, v43, v12
    v_mul_f32 v44, v44, v12
    v_mul_f32 v45, v45, v12
    v_mul_f32 v46, v46, v12
    v_mul_f32 v47, v47, v12
    v_mul_f32 v48, v48, v12
    v_mul_f32 v49, v49, v12
    v_mul_f32 v50, v50, v12
    v_mul_f32 v51, v51, v12
    v_mul_f32 v52, v52, v12
    v_mul_f32 v53, v53, v12
    v_mul_f32 v54, v54, v12
    v_mul_f32 v55, v55, v12
    v_mul_f32 v56, v56, v12
    v_mul_f32 v57, v57, v12
    v_mul_f32 v58, v58, v12
    v_mul_f32 v59, v59, v12
    v_mul_f32 v60, v60, v12
    v_mul_f32 v61, v61, v12
    v_mul_f32 v62, v62, v12
    v_mul_f32 v63, v63, v12
    v_mul_f32 v64, v64, v12
    v_mul_f32 v65, v65, v12
    v_mul_f32 v66, v66, v12
    v_mul_f32 v67, v67, v12
    v_mul_f32 v68, v68, v12
    v_mul_f32 v69, v69, v12
    v_mul_f32 v70, v70, v12
    v_mul_f32 v71, v71, v12
    v_mul_f32 v72, v72, v12
    v_mul_f32 v73, v73, v12
    v_mul_f32 v74, v74, v12
    v_mul_f32 v75, v75, v12
    v_mul_f32 v76, v76, v12
    v_mul_f32 v77, v77, v12
    v_mul_f32 v78, v78, v12
    v_mul_f32 v79, v79, v12
    v_mul_f32 v80, v80, v12
    v_mul_f32 v81, v81, v12
    v_mul_f32 v82, v82, v12
    v_mul_f32 v83, v83, v12
    v_mul_f32 v84, v84, v12
    v_mul_f32 v85, v85, v12
    v_mul_f32 v86, v86, v12
    v_mul_f32 v87, v87, v12
    v_mul_f32 v88, v88, v12
    v_mul_f32 v89, v89, v12
    v_mul_f32 v90, v90, v12
    v_mul_f32 v91, v91, v12
    v_mul_f32 v92, v92, v12
    v_mul_f32 v93, v93, v12
    v_mul_f32 v94, v94, v12
    v_mul_f32 v95, v95, v12
    v_mul_f32 v192, v192, v12
    v_lshlrev_b32 v13, 16, v160
    v_and_b32 v14, 0xffff0000, v160
    v_mul_f32 v13, v13, v12
    v_mul_f32 v14, v14, v12
    v_cvt_pk_bf16_f32 v160, v13, v14
    v_lshlrev_b32 v13, 16, v161
    v_and_b32 v14, 0xffff0000, v161
    v_mul_f32 v13, v13, v12
    v_mul_f32 v14, v14, v12
    v_cvt_pk_bf16_f32 v161, v13, v14
    v_lshlrev_b32 v13, 16, v162
    v_and_b32 v14, 0xffff0000, v162
    v_mul_f32 v13, v13, v12
    v_mul_f32 v14, v14, v12
    v_cvt_pk_bf16_f32 v162, v13, v14
    v_lshlrev_b32 v13, 16, v163
    v_and_b32 v14, 0xffff0000, v163
    v_mul_f32 v13, v13, v12
    v_mul_f32 v14, v14, v12
    v_cvt_pk_bf16_f32 v163, v13, v14
    v_lshlrev_b32 v13, 16, v164
    v_and_b32 v14, 0xffff0000, v164
    v_mul_f32 v13, v13, v12
    v_mul_f32 v14, v14, v12
    v_cvt_pk_bf16_f32 v164, v13, v14
    v_lshlrev_b32 v13, 16, v165
    v_and_b32 v14, 0xffff0000, v165
    v_mul_f32 v13, v13, v12
    v_mul_f32 v14, v14, v12
    v_cvt_pk_bf16_f32 v165, v13, v14
    v_lshlrev_b32 v13, 16, v166
    v_and_b32 v14, 0xffff0000, v166
    v_mul_f32 v13, v13, v12
    v_mul_f32 v14, v14, v12
    v_cvt_pk_bf16_f32 v166, v13, v14
    v_lshlrev_b32 v13, 16, v167
    v_and_b32 v14, 0xffff0000, v167
    v_mul_f32 v13, v13, v12
    v_mul_f32 v14, v14, v12
    v_cvt_pk_bf16_f32 v167, v13, v14
    v_sub_f32 v144, v144, v11
    v_sub_f32 v176, v176, v11
    v_sub_f32 v145, v145, v11
    v_sub_f32 v177, v177, v11
    v_sub_f32 v146, v146, v11
    v_sub_f32 v178, v178, v11
    v_sub_f32 v147, v147, v11
    v_sub_f32 v179, v179, v11
    v_sub_f32 v148, v148, v11
    v_sub_f32 v180, v180, v11
    v_sub_f32 v149, v149, v11
    v_sub_f32 v181, v181, v11
    v_sub_f32 v150, v150, v11
    v_sub_f32 v182, v182, v11
    v_sub_f32 v151, v151, v11
    v_sub_f32 v183, v183, v11
    v_sub_f32 v152, v152, v11
    v_sub_f32 v184, v184, v11
    v_sub_f32 v153, v153, v11
    v_sub_f32 v185, v185, v11
    v_sub_f32 v154, v154, v11
    v_sub_f32 v186, v186, v11
    v_sub_f32 v155, v155, v11
    v_sub_f32 v187, v187, v11
    v_sub_f32 v156, v156, v11
    v_sub_f32 v188, v188, v11
    v_sub_f32 v157, v157, v11
    v_sub_f32 v189, v189, v11
    v_sub_f32 v158, v158, v11
    v_sub_f32 v190, v190, v11
    v_sub_f32 v159, v159, v11
    v_sub_f32 v191, v191, v11
    s_nop 1
    s_branch L_back_22
L_rare_23:
    s_nop 15
    s_nop 3
    v_mov_b32 v12, v11
    s_nop 1
    v_permlane32_swap_b32 v11, v12
    s_nop 0
    v_max3_f32 v11, v11, v12, 0
    v_ceil_f32 v11, v11
    v_min_f32 v12, 0x43480000, v11
    v_cvt_i32_f32 v12, v12
    v_sub_u32 v12, 0, v12
    v_ldexp_f32 v12, 1.0, v12
    v_mul_f32 v32, v32, v12
    v_mul_f32 v33, v33, v12
    v_mul_f32 v34, v34, v12
    v_mul_f32 v35, v35, v12
    v_mul_f32 v36, v36, v12
    v_mul_f32 v37, v37, v12
    v_mul_f32 v38, v38, v12
    v_mul_f32 v39, v39, v12
    v_mul_f32 v40, v40, v12
    v_mul_f32 v41, v41, v12
    v_mul_f32 v42, v42, v12
    v_mul_f32 v43, v43, v12
    v_mul_f32 v44, v44, v12
    v_mul_f32 v45, v45, v12
    v_mul_f32 v46, v46, v12
    v_mul_f32 v47, v47, v12
    v_mul_f32 v48, v48, v12
    v_mul_f32 v49, v49, v12
    v_mul_f32 v50, v50, v12
    v_mul_f32 v51, v51, v12
    v_mul_f32 v52, v52, v12
    v_mul_f32 v53, v53, v12
    v_mul_f32 v54, v54, v12
    v_mul_f32 v55, v55, v12
    v_mul_f32 v56, v56, v12
    v_mul_f32 v57, v57, v12
    v_mul_f32 v58, v58, v12
    v_mul_f32 v59, v59, v12
    v_mul_f32 v60, v60, v12
    v_mul_f32 v61, v61, v12
    v_mul_f32 v62, v62, v12
    v_mul_f32 v63, v63, v12
    v_mul_f32 v64, v64, v12
    v_mul_f32 v65, v65, v12
    v_mul_f32 v66, v66, v12
    v_mul_f32 v67, v67, v12
    v_mul_f32 v68, v68, v12
    v_mul_f32 v69, v69, v12
    v_mul_f32 v70, v70, v12
    v_mul_f32 v71, v71, v12
    v_mul_f32 v72, v72, v12
    v_mul_f32 v73, v73, v12
    v_mul_f32 v74, v74, v12
    v_mul_f32 v75, v75, v12
    v_mul_f32 v76, v76, v12
    v_mul_f32 v77, v77, v12
    v_mul_f32 v78, v78, v12
    v_mul_f32 v79, v79, v12
    v_mul_f32 v80, v80, v12
    v_mul_f32 v81, v81, v12
    v_mul_f32 v82, v82, v12
    v_mul_f32 v83, v83, v12
    v_mul_f32 v84, v84, v12
    v_mul_f32 v85, v85, v12
    v_mul_f32 v86, v86, v12
    v_mul_f32 v87, v87, v12
    v_mul_f32 v88, v88, v12
    v_mul_f32 v89, v89, v12
    v_mul_f32 v90, v90, v12
    v_mul_f32 v91, v91, v12
    v_mul_f32 v92, v92, v12
    v_mul_f32 v93, v93, v12
    v_mul_f32 v94, v94, v12
    v_mul_f32 v95, v95, v12
    v_mul_f32 v192, v192, v12
    v_lshlrev_b32 v13, 16, v168
    v_and_b32 v14, 0xffff0000, v168
    v_mul_f32 v13, v13, v12
    v_mul_f32 v14, v14, v12
    v_cvt_pk_bf16_f32 v168, v13, v14
    v_lshlrev_b32 v13, 16, v169
    v_and_b32 v14, 0xffff0000, v169
    v_mul_f32 v13, v13, v12
    v_mul_f32 v14, v14, v12
    v_cvt_pk_bf16_f32 v169, v13, v14
    v_lshlrev_b32 v13, 16, v170
    v_and_b32 v14, 0xffff0000, v170
    v_mul_f32 v13, v13, v12
    v_mul_f32 v14, v14, v12
    v_cvt_pk_bf16_f32 v170, v13, v14
    v_lshlrev_b32 v13, 16, v171
    v_and_b32 v14, 0xffff0000, v171
    v_mul_f32 v13, v13, v12
    v_mul_f32 v14, v14, v12
    v_cvt_pk_bf16_f32 v171, v13, v14
    v_lshlrev_b32 v13, 16, v172
    v_and_b32 v14, 0xffff0000, v172
    v_mul_f32 v13, v13, v12
    v_mul_f32 v14, v14, v12
    v_cvt_pk_bf16_f32 v172, v13, v14
    v_lshlrev_b32 v13, 16, v173
    v_and_b32 v14, 0xffff0000, v173
    v_mul_f32 v13, v13, v12
    v_mul_f32 v14, v14, v12
    v_cvt_pk_bf16_f32 v173, v13, v14
    v_lshlrev_b32 v13, 16, v174
    v_and_b32 v14, 0xffff0000, v174
    v_mul_f32 v13, v13, v12
    v_mul_f32 v14, v14, v12
    v_cvt_pk_bf16_f32 v174, v13, v14
    v_lshlrev_b32 v13, 16, v175
    v_and_b32 v14, 0xffff0000, v175
    v_mul_f32 v13, v13, v12
    v_mul_f32 v14, v14, v12
    v_cvt_pk_bf16_f32 v175, v13, v14
    v_sub_f32 v128, v128, v11
    v_sub_f32 v176, v176, v11
    v_sub_f32 v129, v129, v11
    v_sub_f32 v177, v177, v11
    v_sub_f32 v130, v130, v11
    v_sub_f32 v178, v178, v11
    v_sub_f32 v131, v131, v11
    v_sub_f32 v179, v179, v11
    v_sub_f32 v132, v132, v11
    v_sub_f32 v180, v180, v11
    v_sub_f32 v133, v133, v11
    v_sub_f32 v181, v181, v11
    v_sub_f32 v134, v134, v11
    v_sub_f32 v182, v182, v11
    v_sub_f32 v135, v135, v11
    v_sub_f32 v183, v183, v11
    v_sub_f32 v136, v136, v11
    v_sub_f32 v184, v184, v11
    v_sub_f32 v137, v137, v11
    v_sub_f32 v185, v185, v11
    v_sub_f32 v138, v138, v11
    v_sub_f32 v186, v186, v11
    v_sub_f32 v139, v139, v11
    v_sub_f32 v187, v187, v11
    v_sub_f32 v140, v140, v11
    v_sub_f32 v188, v188, v11
    v_sub_f32 v141, v141, v11
    v_sub_f32 v189, v189, v11
    v_sub_f32 v142, v142, v11
    v_sub_f32 v190, v190, v11
    v_sub_f32 v143, v143, v11
    v_sub_f32 v191, v191, v11
    s_nop 1
    s_branch L_back_23
L_rare_24:
    s_nop 15
    s_nop 3
    v_mov_b32 v12, v11
    s_nop 1
    v_permlane32_swap_b32 v11, v12
    s_nop 0
    v_max3_f32 v11, v11, v12, 0
    v_ceil_f32 v11, v11
    v_min_f32 v12, 0x43480000, v11
    v_cvt_i32_f32 v12, v12
    v_sub_u32 v12, 0, v12
    v_ldexp_f32 v12, 1.0, v12
    v_mul_f32 v32, v32, v12
    v_mul_f32 v33, v33, v12
    v_mul_f32 v34, v34, v12
    v_mul_f32 v35, v35, v12
    v_mul_f32 v36, v36, v12
    v_mul_f32 v37, v37, v12
    v_mul_f32 v38, v38, v12
    v_mul_f32 v39, v39, v12
    v_mul_f32 v40, v40, v12
    v_mul_f32 v41, v41, v12
    v_mul_f32 v42, v42, v12
    v_mul_f32 v43, v43, v12
    v_mul_f32 v44, v44, v12
    v_mul_f32 v45, v45, v12
    v_mul_f32 v46, v46, v12
    v_mul_f32 v47, v47, v12
    v_mul_f32 v48, v48, v12
    v_mul_f32 v49, v49, v12
    v_mul_f32 v50, v50, v12
    v_mul_f32 v51, v51, v12
    v_mul_f32 v52, v52, v12
    v_mul_f32 v53, v53, v12
    v_mul_f32 v54, v54, v12
    v_mul_f32 v55, v55, v12
    v_mul_f32 v56, v56, v12
    v_mul_f32 v57, v57, v12
    v_mul_f32 v58, v58, v12
    v_mul_f32 v59, v59, v12
    v_mul_f32 v60, v60, v12
    v_mul_f32 v61, v61, v12
    v_mul_f32 v62, v62, v12
    v_mul_f32 v63, v63, v12
    v_mul_f32 v64, v64, v12
    v_mul_f32 v65, v65, v12
    v_mul_f32 v66, v66, v12
    v_mul_f32 v67, v67, v12
    v_mul_f32 v68, v68, v12
    v_mul_f32 v69, v69, v12
    v_mul_f32 v70, v70, v12
    v_mul_f32 v71, v71, v12
    v_mul_f32 v72, v72, v12
    v_mul_f32 v73, v73, v12
    v_mul_f32 v74, v74, v12
    v_mul_f32 v75, v75, v12
    v_mul_f32 v76, v76, v12
    v_mul_f32 v77, v77, v12
    v_mul_f32 v78, v78, v12
    v_mul_f32 v79, v79, v12
    v_mul_f32 v80, v80, v12
    v_mul_f32 v81, v81, v12
    v_mul_f32 v82, v82, v12
    v_mul_f32 v83, v83, v12
    v_mul_f32 v84, v84, v12
    v_mul_f32 v85, v85, v12
    v_mul_f32 v86, v86, v12
    v_mul_f32 v87, v87, v12
    v_mul_f32 v88, v88, v12
    v_mul_f32 v89, v89, v12
    v_mul_f32 v90, v90, v12
    v_mul_f32 v91, v91, v12
    v_mul_f32 v92, v92, v12
    v_mul_f32 v93, v93, v12
    v_mul_f32 v94, v94, v12
    v_mul_f32 v95, v95, v12
    v_mul_f32 v192, v192, v12
    v_lshlrev_b32 v13, 16, v160
    v_and_b32 v14, 0xffff0000, v160
    v_mul_f32 v13, v13, v12
    v_mul_f32 v14, v14, v12
    v_cvt_pk_bf16_f32 v160, v13, v14
    v_lshlrev_b32 v13, 16, v161
    v_and_b32 v14, 0xffff0000, v161
    v_mul_f32 v13, v13, v12
    v_mul_f32 v14, v14, v12
    v_cvt_pk_bf16_f32 v161, v13, v14
    v_lshlrev_b32 v13, 16, v162
    v_and_b32 v14, 0xffff0000, v162
    v_mul_f32 v13, v13, v12
    v_mul_f32 v14, v14, v12
    v_cvt_pk_bf16_f32 v162, v13, v14
    v_lshlrev_b32 v13, 16, v163
    v_and_b32 v14, 0xffff0000, v163
    v_mul_f32 v13, v13, v12
    v_mul_f32 v14, v14, v12
    v_cvt_pk_bf16_f32 v163, v13, v14
    v_lshlrev_b32 v13, 16, v164
    v_and_b32 v14, 0xffff0000, v164
    v_mul_f32 v13, v13, v12
    v_mul_f32 v14, v14, v12
    v_cvt_pk_bf16_f32 v164, v13, v14
    v_lshlrev_b32 v13, 16, v165
    v_and_b32 v14, 0xffff0000, v165
    v_mul_f32 v13, v13, v12
    v_mul_f32 v14, v14, v12
    v_cvt_pk_bf16_f32 v165, v13, v14
    v_lshlrev_b32 v13, 16, v166
    v_and_b32 v14, 0xffff0000, v166
    v_mul_f32 v13, v13, v12
    v_mul_f32 v14, v14, v12
    v_cvt_pk_bf16_f32 v166, v13, v14
    v_lshlrev_b32 v13, 16, v167
    v_and_b32 v14, 0xffff0000, v167
    v_mul_f32 v13, v13, v12
    v_mul_f32 v14, v14, v12
    v_cvt_pk_bf16_f32 v167, v13, v14
    v_sub_f32 v144, v144, v11
    v_sub_f32 v176, v176, v11
    v_sub_f32 v145, v145, v11
    v_sub_f32 v177, v177, v11
    v_sub_f32 v146, v146, v11
    v_sub_f32 v178, v178, v11
    v_sub_f32 v147, v147, v11
    v_sub_f32 v179, v179, v11
    v_sub_f32 v148, v148, v11
    v_sub_f32 v180, v180, v11
    v_sub_f32 v149, v149, v11
    v_sub_f32 v181, v181, v11
    v_sub_f32 v150, v150, v11
    v_sub_f32 v182, v182, v11
    v_sub_f32 v151, v151, v11
    v_sub_f32 v183, v183, v11
    v_sub_f32 v152, v152, v11
    v_sub_f32 v184, v184, v11
    v_sub_f32 v153, v153, v11
    v_sub_f32 v185, v185, v11
    v_sub_f32 v154, v154, v11
    v_sub_f32 v186, v186, v11
    v_sub_f32 v155, v155, v11
    v_sub_f32 v187, v187, v11
    v_sub_f32 v156, v156, v11
    v_sub_f32 v188, v188, v11
    v_sub_f32 v157, v157, v11
    v_sub_f32 v189, v189, v11
    v_sub_f32 v158, v158, v11
    v_sub_f32 v190, v190, v11
    v_sub_f32 v159, v159, v11
    v_sub_f32 v191, v191, v11
    s_nop 1
    s_branch L_back_24
L_rare_25:
    s_nop 15
    s_nop 3
    v_mov_b32 v12, v11
    s_nop 1
    v_permlane32_swap_b32 v11, v12
    s_nop 0
    v_max3_f32 v11, v11, v12, 0
    v_ceil_f32 v11, v11
    v_min_f32 v12, 0x43480000, v11
    v_cvt_i32_f32 v12, v12
    v_sub_u32 v12, 0, v12
    v_ldexp_f32 v12, 1.0, v12
    v_mul_f32 v32, v32, v12
    v_mul_f32 v33, v33, v12
    v_mul_f32 v34, v34, v12
    v_mul_f32 v35, v35, v12
    v_mul_f32 v36, v36, v12
    v_mul_f32 v37, v37, v12
    v_mul_f32 v38, v38, v12
    v_mul_f32 v39, v39, v12
    v_mul_f32 v40, v40, v12
    v_mul_f32 v41, v41, v12
    v_mul_f32 v42, v42, v12
    v_mul_f32 v43, v43, v12
    v_mul_f32 v44, v44, v12
    v_mul_f32 v45, v45, v12
    v_mul_f32 v46, v46, v12
    v_mul_f32 v47, v47, v12
    v_mul_f32 v48, v48, v12
    v_mul_f32 v49, v49, v12
    v_mul_f32 v50, v50, v12
    v_mul_f32 v51, v51, v12
    v_mul_f32 v52, v52, v12
    v_mul_f32 v53, v53, v12
    v_mul_f32 v54, v54, v12
    v_mul_f32 v55, v55, v12
    v_mul_f32 v56, v56, v12
    v_mul_f32 v57, v57, v12
    v_mul_f32 v58, v58, v12
    v_mul_f32 v59, v59, v12
    v_mul_f32 v60, v60, v12
    v_mul_f32 v61, v61, v12
    v_mul_f32 v62, v62, v12
    v_mul_f32 v63, v63, v12
    v_mul_f32 v64, v64, v12
    v_mul_f32 v65, v65, v12
    v_mul_f32 v66, v66, v12
    v_mul_f32 v67, v67, v12
    v_mul_f32 v68, v68, v12
    v_mul_f32 v69, v69, v12
    v_mul_f32 v70, v70, v12
    v_mul_f32 v71, v71, v12
    v_mul_f32 v72, v72, v12
    v_mul_f32 v73, v73, v12
    v_mul_f32 v74, v74, v12
    v_mul_f32 v75, v75, v12
    v_mul_f32 v76, v76, v12
    v_mul_f32 v77, v77, v12
    v_mul_f32 v78, v78, v12
    v_mul_f32 v79, v79, v12
    v_mul_f32 v80, v80, v12
    v_mul_f32 v81, v81, v12
    v_mul_f32 v82, v82, v12
    v_mul_f32 v83, v83, v12
    v_mul_f32 v84, v84, v12
    v_mul_f32 v85, v85, v12
    v_mul_f32 v86, v86, v12
    v_mul_f32 v87, v87, v12
    v_mul_f32 v88, v88, v12
    v_mul_f32 v89, v89, v12
    v_mul_f32 v90, v90, v12
    v_mul_f32 v91, v91, v12
    v_mul_f32 v92, v92, v12
    v_mul_f32 v93, v93, v12
    v_mul_f32 v94, v94, v12
    v_mul_f32 v95, v95, v12
    v_mul_f32 v192, v192, v12
    v_lshlrev_b32 v13, 16, v168
    v_and_b32 v14, 0xffff0000, v168
    v_mul_f32 v13, v13, v12
    v_mul_f32 v14, v14, v12
    v_cvt_pk_bf16_f32 v168, v13, v14
    v_lshlrev_b32 v13, 16, v169
    v_and_b32 v14, 0xffff0000, v169
    v_mul_f32 v13, v13, v12
    v_mul_f32 v14, v14, v12
    v_cvt_pk_bf16_f32 v169, v13, v14
    v_lshlrev_b32 v13, 16, v170
    v_and_b32 v14, 0xffff0000, v170
    v_mul_f32 v13, v13, v12
    v_mul_f32 v14, v14, v12
    v_cvt_pk_bf16_f32 v170, v13, v14
    v_lshlrev_b32 v13, 16, v171
    v_and_b32 v14, 0xffff0000, v171
    v_mul_f32 v13, v13, v12
    v_mul_f32 v14, v14, v12
    v_cvt_pk_bf16_f32 v171, v13, v14
    v_lshlrev_b32 v13, 16, v172
    v_and_b32 v14, 0xffff0000, v172
    v_mul_f32 v13, v13, v12
    v_mul_f32 v14, v14, v12
    v_cvt_pk_bf16_f32 v172, v13, v14
    v_lshlrev_b32 v13, 16, v173
    v_and_b32 v14, 0xffff0000, v173
    v_mul_f32 v13, v13, v12
    v_mul_f32 v14, v14, v12
    v_cvt_pk_bf16_f32 v173, v13, v14
    v_lshlrev_b32 v13, 16, v174
    v_and_b32 v14, 0xffff0000, v174
    v_mul_f32 v13, v13, v12
    v_mul_f32 v14, v14, v12
    v_cvt_pk_bf16_f32 v174, v13, v14
    v_lshlrev_b32 v13, 16, v175
    v_and_b32 v14, 0xffff0000, v175
    v_mul_f32 v13, v13, v12
    v_mul_f32 v14, v14, v12
    v_cvt_pk_bf16_f32 v175, v13, v14
    v_sub_f32 v128, v128, v11
    v_sub_f32 v176, v176, v11
    v_sub_f32 v129, v129, v11
    v_sub_f32 v177, v177, v11
    v_sub_f32 v130, v130, v11
    v_sub_f32 v178, v178, v11
    v_sub_f32 v131, v131, v11
    v_sub_f32 v179, v179, v11
    v_sub_f32 v132, v132, v11
    v_sub_f32 v180, v180, v11
    v_sub_f32 v133, v133, v11
    v_sub_f32 v181, v181, v11
    v_sub_f32 v134, v134, v11
    v_sub_f32 v182, v182, v11
    v_sub_f32 v135, v135, v11
    v_sub_f32 v183, v183, v11
    v_sub_f32 v136, v136, v11
    v_sub_f32 v184, v184, v11
    v_sub_f32 v137, v137, v11
    v_sub_f32 v185, v185, v11
    v_sub_f32 v138, v138, v11
    v_sub_f32 v186, v186, v11
    v_sub_f32 v139, v139, v11
    v_sub_f32 v187, v187, v11
    v_sub_f32 v140, v140, v11
    v_sub_f32 v188, v188, v11
    v_sub_f32 v141, v141, v11
    v_sub_f32 v189, v189, v11
    v_sub_f32 v142, v142, v11
    v_sub_f32 v190, v190, v11
    v_sub_f32 v143, v143, v11
    v_sub_f32 v191, v191, v11
    s_nop 1
    s_branch L_back_25
L_rare_26:
    s_nop 15
    s_nop 3
    v_mov_b32 v12, v11
    s_nop 1
    v_permlane32_swap_b32 v11, v12
    s_nop 0
    v_max3_f32 v11, v11, v12, 0
    v_ceil_f32 v11, v11
    v_min_f32 v12, 0x43480000, v11
    v_cvt_i32_f32 v12, v12
    v_sub_u32 v12, 0, v12
    v_ldexp_f32 v12, 1.0, v12
    v_mul_f32 v32, v32, v12
    v_mul_f32 v33, v33, v12
    v_mul_f32 v34, v34, v12
    v_mul_f32 v35, v35, v12
    v_mul_f32 v36, v36, v12
    v_mul_f32 v37, v37, v12
    v_mul_f32 v38, v38, v12
    v_mul_f32 v39, v39, v12
    v_mul_f32 v40, v40, v12
    v_mul_f32 v41, v41, v12
    v_mul_f32 v42, v42, v12
    v_mul_f32 v43, v43, v12
    v_mul_f32 v44, v44, v12
    v_mul_f32 v45, v45, v12
    v_mul_f32 v46, v46, v12
    v_mul_f32 v47, v47, v12
    v_mul_f32 v48, v48, v12
    v_mul_f32 v49, v49, v12
    v_mul_f32 v50, v50, v12
    v_mul_f32 v51, v51, v12
    v_mul_f32 v52, v52, v12
    v_mul_f32 v53, v53, v12
    v_mul_f32 v54, v54, v12
    v_mul_f32 v55, v55, v12
    v_mul_f32 v56, v56, v12
    v_mul_f32 v57, v57, v12
    v_mul_f32 v58, v58, v12
    v_mul_f32 v59, v59, v12
    v_mul_f32 v60, v60, v12
    v_mul_f32 v61, v61, v12
    v_mul_f32 v62, v62, v12
    v_mul_f32 v63, v63, v12
    v_mul_f32 v64, v64, v12
    v_mul_f32 v65, v65, v12
    v_mul_f32 v66, v66, v12
    v_mul_f32 v67, v67, v12
    v_mul_f32 v68, v68, v12
    v_mul_f32 v69, v69, v12
    v_mul_f32 v70, v70, v12
    v_mul_f32 v71, v71, v12
    v_mul_f32 v72, v72, v12
    v_mul_f32 v73, v73, v12
    v_mul_f32 v74, v74, v12
    v_mul_f32 v75, v75, v12
    v_mul_f32 v76, v76, v12
    v_mul_f32 v77, v77, v12
    v_mul_f32 v78, v78, v12
    v_mul_f32 v79, v79, v12
    v_mul_f32 v80, v80, v12
    v_mul_f32 v81, v81, v12
    v_mul_f32 v82, v82, v12
    v_mul_f32 v83, v83, v12
    v_mul_f32 v84, v84, v12
    v_mul_f32 v85, v85, v12
    v_mul_f32 v86, v86, v12
    v_mul_f32 v87, v87, v12
    v_mul_f32 v88, v88, v12
    v_mul_f32 v89, v89, v12
    v_mul_f32 v90, v90, v12
    v_mul_f32 v91, v91, v12
    v_mul_f32 v92, v92, v12
    v_mul_f32 v93, v93, v12
    v_mul_f32 v94, v94, v12
    v_mul_f32 v95, v95, v12
    v_mul_f32 v192, v192, v12
    v_lshlrev_b32 v13, 16, v160
    v_and_b32 v14, 0xffff0000, v160
    v_mul_f32 v13, v13, v12
    v_mul_f32 v14, v14, v12
    v_cvt_pk_bf16_f32 v160, v13, v14
    v_lshlrev_b32 v13, 16, v161
    v_and_b32 v14, 0xffff0000, v161
    v_mul_f32 v13, v13, v12
    v_mul_f32 v14, v14, v12
    v_cvt_pk_bf16_f32 v161, v13, v14
    v_lshlrev_b32 v13, 16, v162
    v_and_b32 v14, 0xffff0000, v162
    v_mul_f32 v13, v13, v12
    v_mul_f32 v14, v14, v12
    v_cvt_pk_bf16_f32 v162, v13, v14
    v_lshlrev_b32 v13, 16, v163
    v_and_b32 v14, 0xffff0000, v163
    v_mul_f32 v13, v13, v12
    v_mul_f32 v14, v14, v12
    v_cvt_pk_bf16_f32 v163, v13, v14
    v_lshlrev_b32 v13, 16, v164
    v_and_b32 v14, 0xffff0000, v164
    v_mul_f32 v13, v13, v12
    v_mul_f32 v14, v14, v12
    v_cvt_pk_bf16_f32 v164, v13, v14
    v_lshlrev_b32 v13, 16, v165
    v_and_b32 v14, 0xffff0000, v165
    v_mul_f32 v13, v13, v12
    v_mul_f32 v14, v14, v12
    v_cvt_pk_bf16_f32 v165, v13, v14
    v_lshlrev_b32 v13, 16, v166
    v_and_b32 v14, 0xffff0000, v166
    v_mul_f32 v13, v13, v12
    v_mul_f32 v14, v14, v12
    v_cvt_pk_bf16_f32 v166, v13, v14
    v_lshlrev_b32 v13, 16, v167
    v_and_b32 v14, 0xffff0000, v167
    v_mul_f32 v13, v13, v12
    v_mul_f32 v14, v14, v12
    v_cvt_pk_bf16_f32 v167, v13, v14
    v_sub_f32 v144, v144, v11
    v_sub_f32 v176, v176, v11
    v_sub_f32 v145, v145, v11
    v_sub_f32 v177, v177, v11
    v_sub_f32 v146, v146, v11
    v_sub_f32 v178, v178, v11
    v_sub_f32 v147, v147, v11
    v_sub_f32 v179, v179, v11
    v_sub_f32 v148, v148, v11
    v_sub_f32 v180, v180, v11
    v_sub_f32 v149, v149, v11
    v_sub_f32 v181, v181, v11
    v_sub_f32 v150, v150, v11
    v_sub_f32 v182, v182, v11
    v_sub_f32 v151, v151, v11
    v_sub_f32 v183, v183, v11
    v_sub_f32 v152, v152, v11
    v_sub_f32 v184, v184, v11
    v_sub_f32 v153, v153, v11
    v_sub_f32 v185, v185, v11
    v_sub_f32 v154, v154, v11
    v_sub_f32 v186, v186, v11
    v_sub_f32 v155, v155, v11
    v_sub_f32 v187, v187, v11
    v_sub_f32 v156, v156, v11
    v_sub_f32 v188, v188, v11
    v_sub_f32 v157, v157, v11
    v_sub_f32 v189, v189, v11
    v_sub_f32 v158, v158, v11
    v_sub_f32 v190, v190, v11
    v_sub_f32 v159, v159, v11
    v_sub_f32 v191, v191, v11
    s_nop 1
    s_branch L_back_26
L_rare_27:
    s_nop 15
    s_nop 3
    v_mov_b32 v12, v11
    s_nop 1
    v_permlane32_swap_b32 v11, v12
    s_nop 0
    v_max3_f32 v11, v11, v12, 0
    v_ceil_f32 v11, v11
    v_min_f32 v12, 0x43480000, v11
    v_cvt_i32_f32 v12, v12
    v_sub_u32 v12, 0, v12
    v_ldexp_f32 v12, 1.0, v12
    v_mul_f32 v32, v32, v12
    v_mul_f32 v33, v33, v12
    v_mul_f32 v34, v34, v12
    v_mul_f32 v35, v35, v12
    v_mul_f32 v36, v36, v12
    v_mul_f32 v37, v37, v12
    v_mul_f32 v38, v38, v12
    v_mul_f32 v39, v39, v12
    v_mul_f32 v40, v40, v12
    v_mul_f32 v41, v41, v12
    v_mul_f32 v42, v42, v12
    v_mul_f32 v43, v43, v12
    v_mul_f32 v44, v44, v12
    v_mul_f32 v45, v45, v12
    v_mul_f32 v46, v46, v12
    v_mul_f32 v47, v47, v12
    v_mul_f32 v48, v48, v12
    v_mul_f32 v49, v49, v12
    v_mul_f32 v50, v50, v12
    v_mul_f32 v51, v51, v12
    v_mul_f32 v52, v52, v12
    v_mul_f32 v53, v53, v12
    v_mul_f32 v54, v54, v12
    v_mul_f32 v55, v55, v12
    v_mul_f32 v56, v56, v12
    v_mul_f32 v57, v57, v12
    v_mul_f32 v58, v58, v12
    v_mul_f32 v59, v59, v12
    v_mul_f32 v60, v60, v12
    v_mul_f32 v61, v61, v12
    v_mul_f32 v62, v62, v12
    v_mul_f32 v63, v63, v12
    v_mul_f32 v64, v64, v12
    v_mul_f32 v65, v65, v12
    v_mul_f32 v66, v66, v12
    v_mul_f32 v67, v67, v12
    v_mul_f32 v68, v68, v12
    v_mul_f32 v69, v69, v12
    v_mul_f32 v70, v70, v12
    v_mul_f32 v71, v71, v12
    v_mul_f32 v72, v72, v12
    v_mul_f32 v73, v73, v12
    v_mul_f32 v74, v74, v12
    v_mul_f32 v75, v75, v12
    v_mul_f32 v76, v76, v12
    v_mul_f32 v77, v77, v12
    v_mul_f32 v78, v78, v12
    v_mul_f32 v79, v79, v12
    v_mul_f32 v80, v80, v12
    v_mul_f32 v81, v81, v12
    v_mul_f32 v82, v82, v12
    v_mul_f32 v83, v83, v12
    v_mul_f32 v84, v84, v12
    v_mul_f32 v85, v85, v12
    v_mul_f32 v86, v86, v12
    v_mul_f32 v87, v87, v12
    v_mul_f32 v88, v88, v12
    v_mul_f32 v89, v89, v12
    v_mul_f32 v90, v90, v12
    v_mul_f32 v91, v91, v12
    v_mul_f32 v92, v92, v12
    v_mul_f32 v93, v93, v12
    v_mul_f32 v94, v94, v12
    v_mul_f32 v95, v95, v12
    v_mul_f32 v192, v192, v12
    v_lshlrev_b32 v13, 16, v168
    v_and_b32 v14, 0xffff0000, v168
    v_mul_f32 v13, v13, v12
    v_mul_f32 v14, v14, v12
    v_cvt_pk_bf16_f32 v168, v13, v14
    v_lshlrev_b32 v13, 16, v169
    v_and_b32 v14, 0xffff0000, v169
    v_mul_f32 v13, v13, v12
    v_mul_f32 v14, v14, v12
    v_cvt_pk_bf16_f32 v169, v13, v14
    v_lshlrev_b32 v13, 16, v170
    v_and_b32 v14, 0xffff0000, v170
    v_mul_f32 v13, v13, v12
    v_mul_f32 v14, v14, v12
    v_cvt_pk_bf16_f32 v170, v13, v14
    v_lshlrev_b32 v13, 16, v171
    v_and_b32 v14, 0xffff0000, v171
    v_mul_f32 v13, v13, v12
    v_mul_f32 v14, v14, v12
    v_cvt_pk_bf16_f32 v171, v13, v14
    v_lshlrev_b32 v13, 16, v172
    v_and_b32 v14, 0xffff0000, v172
    v_mul_f32 v13, v13, v12
    v_mul_f32 v14, v14, v12
    v_cvt_pk_bf16_f32 v172, v13, v14
    v_lshlrev_b32 v13, 16, v173
    v_and_b32 v14, 0xffff0000, v173
    v_mul_f32 v13, v13, v12
    v_mul_f32 v14, v14, v12
    v_cvt_pk_bf16_f32 v173, v13, v14
    v_lshlrev_b32 v13, 16, v174
    v_and_b32 v14, 0xffff0000, v174
    v_mul_f32 v13, v13, v12
    v_mul_f32 v14, v14, v12
    v_cvt_pk_bf16_f32 v174, v13, v14
    v_lshlrev_b32 v13, 16, v175
    v_and_b32 v14, 0xffff0000, v175
    v_mul_f32 v13, v13, v12
    v_mul_f32 v14, v14, v12
    v_cvt_pk_bf16_f32 v175, v13, v14
    v_sub_f32 v128, v128, v11
    v_sub_f32 v176, v176, v11
    v_sub_f32 v129, v129, v11
    v_sub_f32 v177, v177, v11
    v_sub_f32 v130, v130, v11
    v_sub_f32 v178, v178, v11
    v_sub_f32 v131, v131, v11
    v_sub_f32 v179, v179, v11
    v_sub_f32 v132, v132, v11
    v_sub_f32 v180, v180, v11
    v_sub_f32 v133, v133, v11
    v_sub_f32 v181, v181, v11
    v_sub_f32 v134, v134, v11
    v_sub_f32 v182, v182, v11
    v_sub_f32 v135, v135, v11
    v_sub_f32 v183, v183, v11
    v_sub_f32 v136, v136, v11
    v_sub_f32 v184, v184, v11
    v_sub_f32 v137, v137, v11
    v_sub_f32 v185, v185, v11
    v_sub_f32 v138, v138, v11
    v_sub_f32 v186, v186, v11
    v_sub_f32 v139, v139, v11
    v_sub_f32 v187, v187, v11
    v_sub_f32 v140, v140, v11
    v_sub_f32 v188, v188, v11
    v_sub_f32 v141, v141, v11
    v_sub_f32 v189, v189, v11
    v_sub_f32 v142, v142, v11
    v_sub_f32 v190, v190, v11
    v_sub_f32 v143, v143, v11
    v_sub_f32 v191, v191, v11
    s_nop 1
    s_branch L_back_27
L_rare_28:
    s_nop 15
    s_nop 3
    v_mov_b32 v12, v11
    s_nop 1
    v_permlane32_swap_b32 v11, v12
    s_nop 0
    v_max3_f32 v11, v11, v12, 0
    v_ceil_f32 v11, v11
    v_min_f32 v12, 0x43480000, v11
    v_cvt_i32_f32 v12, v12
    v_sub_u32 v12, 0, v12
    v_ldexp_f32 v12, 1.0, v12
    v_mul_f32 v32, v32, v12
    v_mul_f32 v33, v33, v12
    v_mul_f32 v34, v34, v12
    v_mul_f32 v35, v35, v12
    v_mul_f32 v36, v36, v12
    v_mul_f32 v37, v37, v12
    v_mul_f32 v38, v38, v12
    v_mul_f32 v39, v39, v12
    v_mul_f32 v40, v40, v12
    v_mul_f32 v41, v41, v12
    v_mul_f32 v42, v42, v12
    v_mul_f32 v43, v43, v12
    v_mul_f32 v44, v44, v12
    v_mul_f32 v45, v45, v12
    v_mul_f32 v46, v46, v12
    v_mul_f32 v47, v47, v12
    v_mul_f32 v48, v48, v12
    v_mul_f32 v49, v49, v12
    v_mul_f32 v50, v50, v12
    v_mul_f32 v51, v51, v12
    v_mul_f32 v52, v52, v12
    v_mul_f32 v53, v53, v12
    v_mul_f32 v54, v54, v12
    v_mul_f32 v55, v55, v12
    v_mul_f32 v56, v56, v12
    v_mul_f32 v57, v57, v12
    v_mul_f32 v58, v58, v12
    v_mul_f32 v59, v59, v12
    v_mul_f32 v60, v60, v12
    v_mul_f32 v61, v61, v12
    v_mul_f32 v62, v62, v12
    v_mul_f32 v63, v63, v12
    v_mul_f32 v64, v64, v12
    v_mul_f32 v65, v65, v12
    v_mul_f32 v66, v66, v12
    v_mul_f32 v67, v67, v12
    v_mul_f32 v68, v68, v12
    v_mul_f32 v69, v69, v12
    v_mul_f32 v70, v70, v12
    v_mul_f32 v71, v71, v12
    v_mul_f32 v72, v72, v12
    v_mul_f32 v73, v73, v12
    v_mul_f32 v74, v74, v12
    v_mul_f32 v75, v75, v12
    v_mul_f32 v76, v76, v12
    v_mul_f32 v77, v77, v12
    v_mul_f32 v78, v78, v12
    v_mul_f32 v79, v79, v12
    v_mul_f32 v80, v80, v12
    v_mul_f32 v81, v81, v12
    v_mul_f32 v82, v82, v12
    v_mul_f32 v83, v83, v12
    v_mul_f32 v84, v84, v12
    v_mul_f32 v85, v85, v12
    v_mul_f32 v86, v86, v12
    v_mul_f32 v87, v87, v12
    v_mul_f32 v88, v88, v12
    v_mul_f32 v89, v89, v12
    v_mul_f32 v90, v90, v12
    v_mul_f32 v91, v91, v12
    v_mul_f32 v92, v92, v12
    v_mul_f32 v93, v93, v12
    v_mul_f32 v94, v94, v12
    v_mul_f32 v95, v95, v12
    v_mul_f32 v192, v192, v12
    v_lshlrev_b32 v13, 16, v160
    v_and_b32 v14, 0xffff0000, v160
    v_mul_f32 v13, v13, v12
    v_mul_f32 v14, v14, v12
    v_cvt_pk_bf16_f32 v160, v13, v14
    v_lshlrev_b32 v13, 16, v161
    v_and_b32 v14, 0xffff0000, v161
    v_mul_f32 v13, v13, v12
    v_mul_f32 v14, v14, v12
    v_cvt_pk_bf16_f32 v161, v13, v14
    v_lshlrev_b32 v13, 16, v162
    v_and_b32 v14, 0xffff0000, v162
    v_mul_f32 v13, v13, v12
    v_mul_f32 v14, v14, v12
    v_cvt_pk_bf16_f32 v162, v13, v14
    v_lshlrev_b32 v13, 16, v163
    v_and_b32 v14, 0xffff0000, v163
    v_mul_f32 v13, v13, v12
    v_mul_f32 v14, v14, v12
    v_cvt_pk_bf16_f32 v163, v13, v14
    v_lshlrev_b32 v13, 16, v164
    v_and_b32 v14, 0xffff0000, v164
    v_mul_f32 v13, v13, v12
    v_mul_f32 v14, v14, v12
    v_cvt_pk_bf16_f32 v164, v13, v14
    v_lshlrev_b32 v13, 16, v165
    v_and_b32 v14, 0xffff0000, v165
    v_mul_f32 v13, v13, v12
    v_mul_f32 v14, v14, v12
    v_cvt_pk_bf16_f32 v165, v13, v14
    v_lshlrev_b32 v13, 16, v166
    v_and_b32 v14, 0xffff0000, v166
    v_mul_f32 v13, v13, v12
    v_mul_f32 v14, v14, v12
    v_cvt_pk_bf16_f32 v166, v13, v14
    v_lshlrev_b32 v13, 16, v167
    v_and_b32 v14, 0xffff0000, v167
    v_mul_f32 v13, v13, v12
    v_mul_f32 v14, v14, v12
    v_cvt_pk_bf16_f32 v167, v13, v14
    v_sub_f32 v144, v144, v11
    v_sub_f32 v176, v176, v11
    v_sub_f32 v145, v145, v11
    v_sub_f32 v177, v177, v11
    v_sub_f32 v146, v146, v11
    v_sub_f32 v178, v178, v11
    v_sub_f32 v147, v147, v11
    v_sub_f32 v179, v179, v11
    v_sub_f32 v148, v148, v11
    v_sub_f32 v180, v180, v11
    v_sub_f32 v149, v149, v11
    v_sub_f32 v181, v181, v11
    v_sub_f32 v150, v150, v11
    v_sub_f32 v182, v182, v11
    v_sub_f32 v151, v151, v11
    v_sub_f32 v183, v183, v11
    v_sub_f32 v152, v152, v11
    v_sub_f32 v184, v184, v11
    v_sub_f32 v153, v153, v11
    v_sub_f32 v185, v185, v11
    v_sub_f32 v154, v154, v11
    v_sub_f32 v186, v186, v11
    v_sub_f32 v155, v155, v11
    v_sub_f32 v187, v187, v11
    v_sub_f32 v156, v156, v11
    v_sub_f32 v188, v188, v11
    v_sub_f32 v157, v157, v11
    v_sub_f32 v189, v189, v11
    v_sub_f32 v158, v158, v11
    v_sub_f32 v190, v190, v11
    v_sub_f32 v159, v159, v11
    v_sub_f32 v191, v191, v11
    s_nop 1
    s_branch L_back_28
L_rare_29:
    s_nop 15
    s_nop 3
    v_mov_b32 v12, v11
    s_nop 1
    v_permlane32_swap_b32 v11, v12
    s_nop 0
    v_max3_f32 v11, v11, v12, 0
    v_ceil_f32 v11, v11
    v_min_f32 v12, 0x43480000, v11
    v_cvt_i32_f32 v12, v12
    v_sub_u32 v12, 0, v12
    v_ldexp_f32 v12, 1.0, v12
    v_mul_f32 v32, v32, v12
    v_mul_f32 v33, v33, v12
    v_mul_f32 v34, v34, v12
    v_mul_f32 v35, v35, v12
    v_mul_f32 v36, v36, v12
    v_mul_f32 v37, v37, v12
    v_mul_f32 v38, v38, v12
    v_mul_f32 v39, v39, v12
    v_mul_f32 v40, v40, v12
    v_mul_f32 v41, v41, v12
    v_mul_f32 v42, v42, v12
    v_mul_f32 v43, v43, v12
    v_mul_f32 v44, v44, v12
    v_mul_f32 v45, v45, v12
    v_mul_f32 v46, v46, v12
    v_mul_f32 v47, v47, v12
    v_mul_f32 v48, v48, v12
    v_mul_f32 v49, v49, v12
    v_mul_f32 v50, v50, v12
    v_mul_f32 v51, v51, v12
    v_mul_f32 v52, v52, v12
    v_mul_f32 v53, v53, v12
    v_mul_f32 v54, v54, v12
    v_mul_f32 v55, v55, v12
    v_mul_f32 v56, v56, v12
    v_mul_f32 v57, v57, v12
    v_mul_f32 v58, v58, v12
    v_mul_f32 v59, v59, v12
    v_mul_f32 v60, v60, v12
    v_mul_f32 v61, v61, v12
    v_mul_f32 v62, v62, v12
    v_mul_f32 v63, v63, v12
    v_mul_f32 v64, v64, v12
    v_mul_f32 v65, v65, v12
    v_mul_f32 v66, v66, v12
    v_mul_f32 v67, v67, v12
    v_mul_f32 v68, v68, v12
    v_mul_f32 v69, v69, v12
    v_mul_f32 v70, v70, v12
    v_mul_f32 v71, v71, v12
    v_mul_f32 v72, v72, v12
    v_mul_f32 v73, v73, v12
    v_mul_f32 v74, v74, v12
    v_mul_f32 v75, v75, v12
    v_mul_f32 v76, v76, v12
    v_mul_f32 v77, v77, v12
    v_mul_f32 v78, v78, v12
    v_mul_f32 v79, v79, v12
    v_mul_f32 v80, v80, v12
    v_mul_f32 v81, v81, v12
    v_mul_f32 v82, v82, v12
    v_mul_f32 v83, v83, v12
    v_mul_f32 v84, v84, v12
    v_mul_f32 v85, v85, v12
    v_mul_f32 v86, v86, v12
    v_mul_f32 v87, v87, v12
    v_mul_f32 v88, v88, v12
    v_mul_f32 v89, v89, v12
    v_mul_f32 v90, v90, v12
    v_mul_f32 v91, v91, v12
    v_mul_f32 v92, v92, v12
    v_mul_f32 v93, v93, v12
    v_mul_f32 v94, v94, v12
    v_mul_f32 v95, v95, v12
    v_mul_f32 v192, v192, v12
    v_lshlrev_b32 v13, 16, v168
    v_and_b32 v14, 0xffff0000, v168
    v_mul_f32 v13, v13, v12
    v_mul_f32 v14, v14, v12
    v_cvt_pk_bf16_f32 v168, v13, v14
    v_lshlrev_b32 v13, 16, v169
    v_and_b32 v14, 0xffff0000, v169
    v_mul_f32 v13, v13, v12
    v_mul_f32 v14, v14, v12
    v_cvt_pk_bf16_f32 v169, v13, v14
    v_lshlrev_b32 v13, 16, v170
    v_and_b32 v14, 0xffff0000, v170
    v_mul_f32 v13, v13, v12
    v_mul_f32 v14, v14, v12
    v_cvt_pk_bf16_f32 v170, v13, v14
    v_lshlrev_b32 v13, 16, v171
    v_and_b32 v14, 0xffff0000, v171
    v_mul_f32 v13, v13, v12
    v_mul_f32 v14, v14, v12
    v_cvt_pk_bf16_f32 v171, v13, v14
    v_lshlrev_b32 v13, 16, v172
    v_and_b32 v14, 0xffff0000, v172
    v_mul_f32 v13, v13, v12
    v_mul_f32 v14, v14, v12
    v_cvt_pk_bf16_f32 v172, v13, v14
    v_lshlrev_b32 v13, 16, v173
    v_and_b32 v14, 0xffff0000, v173
    v_mul_f32 v13, v13, v12
    v_mul_f32 v14, v14, v12
    v_cvt_pk_bf16_f32 v173, v13, v14
    v_lshlrev_b32 v13, 16, v174
    v_and_b32 v14, 0xffff0000, v174
    v_mul_f32 v13, v13, v12
    v_mul_f32 v14, v14, v12
    v_cvt_pk_bf16_f32 v174, v13, v14
    v_lshlrev_b32 v13, 16, v175
    v_and_b32 v14, 0xffff0000, v175
    v_mul_f32 v13, v13, v12
    v_mul_f32 v14, v14, v12
    v_cvt_pk_bf16_f32 v175, v13, v14
    v_sub_f32 v128, v128, v11
    v_sub_f32 v176, v176, v11
    v_sub_f32 v129, v129, v11
    v_sub_f32 v177, v177, v11
    v_sub_f32 v130, v130, v11
    v_sub_f32 v178, v178, v11
    v_sub_f32 v131, v131, v11
    v_sub_f32 v179, v179, v11
    v_sub_f32 v132, v132, v11
    v_sub_f32 v180, v180, v11
    v_sub_f32 v133, v133, v11
    v_sub_f32 v181, v181, v11
    v_sub_f32 v134, v134, v11
    v_sub_f32 v182, v182, v11
    v_sub_f32 v135, v135, v11
    v_sub_f32 v183, v183, v11
    v_sub_f32 v136, v136, v11
    v_sub_f32 v184, v184, v11
    v_sub_f32 v137, v137, v11
    v_sub_f32 v185, v185, v11
    v_sub_f32 v138, v138, v11
    v_sub_f32 v186, v186, v11
    v_sub_f32 v139, v139, v11
    v_sub_f32 v187, v187, v11
    v_sub_f32 v140, v140, v11
    v_sub_f32 v188, v188, v11
    v_sub_f32 v141, v141, v11
    v_sub_f32 v189, v189, v11
    v_sub_f32 v142, v142, v11
    v_sub_f32 v190, v190, v11
    v_sub_f32 v143, v143, v11
    v_sub_f32 v191, v191, v11
    s_nop 1
    s_branch L_back_29
L_rare_30:
    s_nop 15
    s_nop 3
    v_mov_b32 v12, v11
    s_nop 1
    v_permlane32_swap_b32 v11, v12
    s_nop 0
    v_max3_f32 v11, v11, v12, 0
    v_ceil_f32 v11, v11
    v_min_f32 v12, 0x43480000, v11
    v_cvt_i32_f32 v12, v12
    v_sub_u32 v12, 0, v12
    v_ldexp_f32 v12, 1.0, v12
    v_mul_f32 v32, v32, v12
    v_mul_f32 v33, v33, v12
    v_mul_f32 v34, v34, v12
    v_mul_f32 v35, v35, v12
    v_mul_f32 v36, v36, v12
    v_mul_f32 v37, v37, v12
    v_mul_f32 v38, v38, v12
    v_mul_f32 v39, v39, v12
    v_mul_f32 v40, v40, v12
    v_mul_f32 v41, v41, v12
    v_mul_f32 v42, v42, v12
    v_mul_f32 v43, v43, v12
    v_mul_f32 v44, v44, v12
    v_mul_f32 v45, v45, v12
    v_mul_f32 v46, v46, v12
    v_mul_f32 v47, v47, v12
    v_mul_f32 v48, v48, v12
    v_mul_f32 v49, v49, v12
    v_mul_f32 v50, v50, v12
    v_mul_f32 v51, v51, v12
    v_mul_f32 v52, v52, v12
    v_mul_f32 v53, v53, v12
    v_mul_f32 v54, v54, v12
    v_mul_f32 v55, v55, v12
    v_mul_f32 v56, v56, v12
    v_mul_f32 v57, v57, v12
    v_mul_f32 v58, v58, v12
    v_mul_f32 v59, v59, v12
    v_mul_f32 v60, v60, v12
    v_mul_f32 v61, v61, v12
    v_mul_f32 v62, v62, v12
    v_mul_f32 v63, v63, v12
    v_mul_f32 v64, v64, v12
    v_mul_f32 v65, v65, v12
    v_mul_f32 v66, v66, v12
    v_mul_f32 v67, v67, v12
    v_mul_f32 v68, v68, v12
    v_mul_f32 v69, v69, v12
    v_mul_f32 v70, v70, v12
    v_mul_f32 v71, v71, v12
    v_mul_f32 v72, v72, v12
    v_mul_f32 v73, v73, v12
    v_mul_f32 v74, v74, v12
    v_mul_f32 v75, v75, v12
    v_mul_f32 v76, v76, v12
    v_mul_f32 v77, v77, v12
    v_mul_f32 v78, v78, v12
    v_mul_f32 v79, v79, v12
    v_mul_f32 v80, v80, v12
    v_mul_f32 v81, v81, v12
    v_mul_f32 v82, v82, v12
    v_mul_f32 v83, v83, v12
    v_mul_f32 v84, v84, v12
    v_mul_f32 v85, v85, v12
    v_mul_f32 v86, v86, v12
    v_mul_f32 v87, v87, v12
    v_mul_f32 v88, v88, v12
    v_mul_f32 v89, v89, v12
    v_mul_f32 v90, v90, v12
    v_mul_f32 v91, v91, v12
    v_mul_f32 v92, v92, v12
    v_mul_f32 v93, v93, v12
    v_mul_f32 v94, v94, v12
    v_mul_f32 v95, v95, v12
    v_mul_f32 v192, v192, v12
    v_lshlrev_b32 v13, 16, v160
    v_and_b32 v14, 0xffff0000, v160
    v_mul_f32 v13, v13, v12
    v_mul_f32 v14, v14, v12
    v_cvt_pk_bf16_f32 v160, v13, v14
    v_lshlrev_b32 v13, 16, v161
    v_and_b32 v14, 0xffff0000, v161
    v_mul_f32 v13, v13, v12
    v_mul_f32 v14, v14, v12
    v_cvt_pk_bf16_f32 v161, v13, v14
    v_lshlrev_b32 v13, 16, v162
    v_and_b32 v14, 0xffff0000, v162
    v_mul_f32 v13, v13, v12
    v_mul_f32 v14, v14, v12
    v_cvt_pk_bf16_f32 v162, v13, v14
    v_lshlrev_b32 v13, 16, v163
    v_and_b32 v14, 0xffff0000, v163
    v_mul_f32 v13, v13, v12
    v_mul_f32 v14, v14, v12
    v_cvt_pk_bf16_f32 v163, v13, v14
    v_lshlrev_b32 v13, 16, v164
    v_and_b32 v14, 0xffff0000, v164
    v_mul_f32 v13, v13, v12
    v_mul_f32 v14, v14, v12
    v_cvt_pk_bf16_f32 v164, v13, v14
    v_lshlrev_b32 v13, 16, v165
    v_and_b32 v14, 0xffff0000, v165
    v_mul_f32 v13, v13, v12
    v_mul_f32 v14, v14, v12
    v_cvt_pk_bf16_f32 v165, v13, v14
    v_lshlrev_b32 v13, 16, v166
    v_and_b32 v14, 0xffff0000, v166
    v_mul_f32 v13, v13, v12
    v_mul_f32 v14, v14, v12
    v_cvt_pk_bf16_f32 v166, v13, v14
    v_lshlrev_b32 v13, 16, v167
    v_and_b32 v14, 0xffff0000, v167
    v_mul_f32 v13, v13, v12
    v_mul_f32 v14, v14, v12
    v_cvt_pk_bf16_f32 v167, v13, v14
    v_sub_f32 v144, v144, v11
    v_sub_f32 v176, v176, v11
    v_sub_f32 v145, v145, v11
    v_sub_f32 v177, v177, v11
    v_sub_f32 v146, v146, v11
    v_sub_f32 v178, v178, v11
    v_sub_f32 v147, v147, v11
    v_sub_f32 v179, v179, v11
    v_sub_f32 v148, v148, v11
    v_sub_f32 v180, v180, v11
    v_sub_f32 v149, v149, v11
    v_sub_f32 v181, v181, v11
    v_sub_f32 v150, v150, v11
    v_sub_f32 v182, v182, v11
    v_sub_f32 v151, v151, v11
    v_sub_f32 v183, v183, v11
    v_sub_f32 v152, v152, v11
    v_sub_f32 v184, v184, v11
    v_sub_f32 v153, v153, v11
    v_sub_f32 v185, v185, v11
    v_sub_f32 v154, v154, v11
    v_sub_f32 v186, v186, v11
    v_sub_f32 v155, v155, v11
    v_sub_f32 v187, v187, v11
    v_sub_f32 v156, v156, v11
    v_sub_f32 v188, v188, v11
    v_sub_f32 v157, v157, v11
    v_sub_f32 v189, v189, v11
    v_sub_f32 v158, v158, v11
    v_sub_f32 v190, v190, v11
    v_sub_f32 v159, v159, v11
    v_sub_f32 v191, v191, v11
    s_nop 1
    s_branch L_back_30
L_loader:
    v_xor_b32 v11, v5, v4
    v_lshlrev_b32 v11, 4, v11
    v_lshl_add_u32 v2, v4, 8, v11
    v_xor_b32 v3, 64, v2
    v_xor_b32 v8, 128, v2
    v_xor_b32 v9, 192, v2
    v_lshlrev_b32 v11, 2, v4
    v_xor_b32 v11, v5, v11
    v_lshlrev_b32 v11, 4, v11
    v_lshl_add_u32 v10, v4, 8, v11
    v_lshl_add_u32 v216, v4, 13, v11
    v_add_u32 v217, 31744, v216
    v_add_u32 v218, 63488, v216
    v_add_u32 v219, 95232, v216
    v_mul_u32_u24 v12, 1280, v4
    v_add_u32 v224, v12, v11
    v_add_u32 v225, 4096, v224
    v_add_u32 v226, 8192, v224
    v_add_u32 v227, 12288, v224
    v_lshrrev_b32 v11, 3, v1
    v_mul_u32_u24 v11, 1280, v11
    v_and_b32 v12, 7, v1
    v_xor_b32 v12, v12, v4
    v_lshl_add_u32 v220, v12, 4, v11
    v_xor_b32 v221, 64, v220
    v_add_u32 v222, 18432, v220
    v_add_u32 v223, 27648, v221
    v_add_u32 v221, 9216, v221
    v_lshrrev_b32 v11, 2, v1
    v_mul_u32_u24 v11, 1280, v11
    v_and_b32 v12, 3, v1
    v_lshl_add_u32 v228, v12, 4, v11
    v_add_u32 v229, 19456, v228
    v_add_u32 v230, 38912, v228
    v_add_u32 v231, 58368, v228
    v_lshlrev_b32 v232, 4, v1
    v_add_u32 v233, 0x10000, v232
    v_add_u32 v234, 0x20000, v232
    s_lshl_b32 s53, s41, 8
    s_mul_i32 s59, s42, 163840
    s_mul_i32 s62, s45, 3
    s_add_u32 s62, s62, s42
    s_cmp_ge_u32 s62, 10
    s_cselect_b32 s47, 10, 0
    s_sub_u32 s62, s62, s47
    s_waitcnt lgkmcnt(0)
    s_mov_b32 s20, s4
    s_mov_b32 s21, s5
    s_mov_b32 s22, 1310720
    s_mov_b32 s23, 0x00020000
    s_mov_b32 s24, s6
    s_mov_b32 s25, s7
    s_mov_b32 s26, 67108864
    s_mov_b32 s27, 0x00020000
    s_mov_b32 s28, s8
    s_mov_b32 s29, s9
    s_mov_b32 s30, 67108864
    s_mov_b32 s31, 0x00020000
    s_mov_b32 s32, s10
    s_mov_b32 s33, s11
    s_mov_b32 s34, 5242880
    s_mov_b32 s35, 0x00020000
    s_mov_b32 s36, s18
    s_mov_b32 s37, s19
    s_mov_b32 s38, 268435456
    s_mov_b32 s39, 0x00020000
    s_mov_b32 s64, s12
    s_mov_b32 s65, s13
    s_mov_b32 s66, 5242880
    s_mov_b32 s67, 0x00020000
    s_mov_b32 s68, s16
    s_mov_b32 s69, s17
    s_mov_b32 s70, 256
    s_mov_b32 s71, 0x00020000
    s_mov_b32 s72, s14
    s_mov_b32 s73, s15
    s_mov_b32 s74, 1310720
    s_mov_b32 s75, 0x00020000
    s_cmp_eq_u32 s40, 5
    s_cbranch_scc1 L_loader_b
L_lda0:
    s_lshl_b32 s48, s62, 19
    s_add_u32 s48, s48, s53
    s_lshl_b32 s51, s62, 7
    s_add_u32 s51, s51, s59
    s_add_u32 s62, s62, 1
    s_cmp_eq_u32 s62, 10
    s_cselect_b32 s62, 0, s62
    s_mov_b32 m0, 49152
    s_nop 0
    buffer_load_dwordx4 v216, s[32:35], s48 offen offset:0 lds
    buffer_load_dwordx4 v217, s[32:35], s48 offen offset:1024 lds
    buffer_load_dwordx4 v218, s[32:35], s48 offen offset:2048 lds
    buffer_load_dwordx4 v219, s[32:35], s48 offen offset:3072 lds
    s_add_u32 s48, s48, 131072
    s_mov_b32 m0, 131072
    s_nop 0
    buffer_load_dwordx4 v220, s[20:23], s51 offen offset:0 lds
    buffer_load_dwordx4 v221, s[20:23], s51 offen offset:1024 lds
    buffer_load_dwordx4 v222, s[20:23], s51 offen offset:2048 lds
    buffer_load_dwordx4 v223, s[20:23], s51 offen offset:3072 lds
    s_add_u32 s51, s51, 40960
    s_mov_b32 m0, 53248
    s_nop 0
    buffer_load_dwordx4 v216, s[32:35], s48 offen offset:0 lds
    buffer_load_dwordx4 v217, s[32:35], s48 offen offset:1024 lds
    buffer_load_dwordx4 v218, s[32:35], s48 offen offset:2048 lds
    buffer_load_dwordx4 v219, s[32:35], s48 offen offset:3072 lds
    s_add_u32 s48, s48, 131072
    s_mov_b32 m0, 135168
    s_nop 0
    buffer_load_dwordx4 v220, s[20:23], s51 offen offset:0 lds
    buffer_load_dwordx4 v221, s[20:23], s51 offen offset:1024 lds
    buffer_load_dwordx4 v222, s[20:23], s51 offen offset:2048 lds
    buffer_load_dwordx4 v223, s[20:23], s51 offen offset:3072 lds
    s_add_u32 s51, s51, 40960
    s_mov_b32 m0, 57344
    s_nop 0
    buffer_load_dwordx4 v216, s[32:35], s48 offen offset:0 lds
    buffer_load_dwordx4 v217, s[32:35], s48 offen offset:1024 lds
    buffer_load_dwordx4 v218, s[32:35], s48 offen offset:2048 lds
    buffer_load_dwordx4 v219, s[32:35], s48 offen offset:3072 lds
    s_add_u32 s48, s48, 131072
    s_mov_b32 m0, 139264
    s_nop 0
    buffer_load_dwordx4 v220, s[20:23], s51 offen offset:0 lds
    buffer_load_dwordx4 v221, s[20:23], s51 offen offset:1024 lds
    buffer_load_dwordx4 v222, s[20:23], s51 offen offset:2048 lds
    buffer_load_dwordx4 v223, s[20:23], s51 offen offset:3072 lds
    s_add_u32 s51, s51, 40960
    s_mov_b32 m0, 61440
    s_nop 0
    buffer_load_dwordx4 v216, s[32:35], s48 offen offset:0 lds
    buffer_load_dwordx4 v217, s[32:35], s48 offen offset:1024 lds
    buffer_load_dwordx4 v218, s[32:35], s48 offen offset:2048 lds
    buffer_load_dwordx4 v219, s[32:35], s48 offen offset:3072 lds
    s_mov_b32 m0, 143360
    s_nop 0
    buffer_load_dwordx4 v220, s[20:23], s51 offen offset:0 lds
    buffer_load_dwordx4 v221, s[20:23], s51 offen offset:1024 lds
    buffer_load_dwordx4 v222, s[20:23], s51 offen offset:2048 lds
    buffer_load_dwordx4 v223, s[20:23], s51 offen offset:3072 lds
    s_lshl_b32 s48, s62, 19
    s_add_u32 s48, s48, s53
    s_lshl_b32 s51, s62, 7
    s_add_u32 s51, s51, s59
    s_add_u32 s62, s62, 1
    s_cmp_eq_u32 s62, 10
    s_cselect_b32 s62, 0, s62
    s_mov_b32 m0, 65536
    s_nop 0
    buffer_load_dwordx4 v216, s[32:35], s48 offen offset:0 lds
    buffer_load_dwordx4 v217, s[32:35], s48 offen offset:1024 lds
    buffer_load_dwordx4 v218, s[32:35], s48 offen offset:2048 lds
    buffer_load_dwordx4 v219, s[32:35], s48 offen offset:3072 lds
    s_add_u32 s48, s48, 131072
    s_mov_b32 m0, 147456
    s_nop 0
    buffer_load_dwordx4 v220, s[20:23], s51 offen offset:0 lds
    buffer_load_dwordx4 v221, s[20:23], s51 offen offset:1024 lds
    buffer_load_dwordx4 v222, s[20:23], s51 offen offset:2048 lds
    buffer_load_dwordx4 v223, s[20:23], s51 offen offset:3072 lds
    s_add_u32 s51, s51, 40960
    s_mov_b32 m0, 69632
    s_nop 0
    buffer_load_dwordx4 v216, s[32:35], s48 offen offset:0 lds
    buffer_load_dwordx4 v217, s[32:35], s48 offen offset:1024 lds
    buffer_load_dwordx4 v218, s[32:35], s48 offen offset:2048 lds
    buffer_load_dwordx4 v219, s[32:35], s48 offen offset:3072 lds
    s_add_u32 s48, s48, 131072
    s_mov_b32 m0, 151552
    s_nop 0
    buffer_load_dwordx4 v220, s[20:23], s51 offen offset:0 lds
    buffer_load_dwordx4 v221, s[20:23], s51 offen offset:1024 lds
    buffer_load_dwordx4 v222, s[20:23], s51 offen offset:2048 lds
    buffer_load_dwordx4 v223, s[20:23], s51 offen offset:3072 lds
    s_add_u32 s51, s51, 40960
    s_mov_b32 m0, 73728
    s_nop 0
    buffer_load_dwordx4 v216, s[32:35], s48 offen offset:0 lds
    buffer_load_dwordx4 v217, s[32:35], s48 offen offset:1024 lds
    buffer_load_dwordx4 v218, s[32:35], s48 offen offset:2048 lds
    buffer_load_dwordx4 v219, s[32:35], s48 offen offset:3072 lds
    s_add_u32 s48, s48, 131072
    s_mov_b32 m0, 155648
    s_nop 0
    buffer_load_dwordx4 v220, s[20:23], s51 offen offset:0 lds
    buffer_load_dwordx4 v221, s[20:23], s51 offen offset:1024 lds
    buffer_load_dwordx4 v222, s[20:23], s51 offen offset:2048 lds
    buffer_load_dwordx4 v223, s[20:23], s51 offen offset:3072 lds
    s_add_u32 s51, s51, 40960
    s_mov_b32 m0, 77824
    s_nop 0
    buffer_load_dwordx4 v216, s[32:35], s48 offen offset:0 lds
    buffer_load_dwordx4 v217, s[32:35], s48 offen offset:1024 lds
    buffer_load_dwordx4 v218, s[32:35], s48 offen offset:2048 lds
    buffer_load_dwordx4 v219, s[32:35], s48 offen offset:3072 lds
    s_mov_b32 m0, 159744
    s_nop 0
    buffer_load_dwordx4 v220, s[20:23], s51 offen offset:0 lds
    buffer_load_dwordx4 v221, s[20:23], s51 offen offset:1024 lds
    buffer_load_dwordx4 v222, s[20:23], s51 offen offset:2048 lds
    buffer_load_dwordx4 v223, s[20:23], s51 offen offset:3072 lds
    s_lshl_b32 s48, s62, 19
    s_add_u32 s48, s48, s53
    s_lshl_b32 s51, s62, 7
    s_add_u32 s51, s51, s59
    s_add_u32 s62, s62, 1
    s_cmp_eq_u32 s62, 10
    s_cselect_b32 s62, 0, s62
    s_mov_b32 m0, 16384
    s_nop 0
    buffer_load_dwordx4 v216, s[32:35], s48 offen offset:0 lds
    buffer_load_dwordx4 v217, s[32:35], s48 offen offset:1024 lds
    buffer_load_dwordx4 v218, s[32:35], s48 offen offset:2048 lds
    buffer_load_dwordx4 v219, s[32:35], s48 offen offset:3072 lds
    s_add_u32 s48, s48, 131072
    s_mov_b32 m0, 98304
    s_nop 0
    buffer_load_dwordx4 v220, s[20:23], s51 offen offset:0 lds
    buffer_load_dwordx4 v221, s[20:23], s51 offen offset:1024 lds
    buffer_load_dwordx4 v222, s[20:23], s51 offen offset:2048 lds
    buffer_load_dwordx4 v223, s[20:23], s51 offen offset:3072 lds
    s_add_u32 s51, s51, 40960
    s_mov_b32 m0, 20480
    s_nop 0
    buffer_load_dwordx4 v216, s[32:35], s48 offen offset:0 lds
    buffer_load_dwordx4 v217, s[32:35], s48 offen offset:1024 lds
    buffer_load_dwordx4 v218, s[32:35], s48 offen offset:2048 lds
    buffer_load_dwordx4 v219, s[32:35], s48 offen offset:3072 lds
    s_add_u32 s48, s48, 131072
    s_mov_b32 m0, 102400
    s_nop 0
    buffer_load_dwordx4 v220, s[20:23], s51 offen offset:0 lds
    buffer_load_dwordx4 v221, s[20:23], s51 offen offset:1024 lds
    buffer_load_dwordx4 v222, s[20:23], s51 offen offset:2048 lds
    buffer_load_dwordx4 v223, s[20:23], s51 offen offset:3072 lds
    s_add_u32 s51, s51, 40960
    s_mov_b32 m0, 24576
    s_nop 0
    buffer_load_dwordx4 v216, s[32:35], s48 offen offset:0 lds
    buffer_load_dwordx4 v217, s[32:35], s48 offen offset:1024 lds
    buffer_load_dwordx4 v218, s[32:35], s48 offen offset:2048 lds
    buffer_load_dwordx4 v219, s[32:35], s48 offen offset:3072 lds
    s_add_u32 s48, s48, 131072
    s_mov_b32 m0, 106496
    s_nop 0
    buffer_load_dwordx4 v220, s[20:23], s51 offen offset:0 lds
    buffer_load_dwordx4 v221, s[20:23], s51 offen offset:1024 lds
    buffer_load_dwordx4 v222, s[20:23], s51 offen offset:2048 lds
    buffer_load_dwordx4 v223, s[20:23], s51 offen offset:3072 lds
    s_add_u32 s51, s51, 40960
    s_mov_b32 m0, 28672
    s_nop 0
    buffer_load_dwordx4 v216, s[32:35], s48 offen offset:0 lds
    buffer_load_dwordx4 v217, s[32:35], s48 offen offset:1024 lds
    buffer_load_dwordx4 v218, s[32:35], s48 offen offset:2048 lds
    buffer_load_dwordx4 v219, s[32:35], s48 offen offset:3072 lds
    s_mov_b32 m0, 110592
    s_nop 0
    buffer_load_dwordx4 v220, s[20:23], s51 offen offset:0 lds
    buffer_load_dwordx4 v221, s[20:23], s51 offen offset:1024 lds
    buffer_load_dwordx4 v222, s[20:23], s51 offen offset:2048 lds
    buffer_load_dwordx4 v223, s[20:23], s51 offen offset:3072 lds
    s_waitcnt vmcnt(63)
    s_barrier
    s_lshl_b32 s48, s62, 19
    s_add_u32 s48, s48, s53
    s_lshl_b32 s51, s62, 7
    s_add_u32 s51, s51, s59
    s_add_u32 s62, s62, 1
    s_cmp_eq_u32 s62, 10
    s_cselect_b32 s62, 0, s62
    s_mov_b32 m0, 32768
    s_nop 0
    buffer_load_dwordx4 v216, s[32:35], s48 offen offset:0 lds
    buffer_load_dwordx4 v217, s[32:35], s48 offen offset:1024 lds
    buffer_load_dwordx4 v218, s[32:35], s48 offen offset:2048 lds
    buffer_load_dwordx4 v219, s[32:35], s48 offen offset:3072 lds
    s_add_u32 s48, s48, 131072
    s_mov_b32 m0, 114688
    s_nop 0
    buffer_load_dwordx4 v220, s[20:23], s51 offen offset:0 lds
    buffer_load_dwordx4 v221, s[20:23], s51 offen offset:1024 lds
    buffer_load_dwordx4 v222, s[20:23], s51 offen offset:2048 lds
    buffer_load_dwordx4 v223, s[20:23], s51 offen offset:3072 lds
    s_add_u32 s51, s51, 40960
    s_mov_b32 m0, 36864
    s_nop 0
    buffer_load_dwordx4 v216, s[32:35], s48 offen offset:0 lds
    buffer_load_dwordx4 v217, s[32:35], s48 offen offset:1024 lds
    buffer_load_dwordx4 v218, s[32:35], s48 offen offset:2048 lds
    buffer_load_dwordx4 v219, s[32:35], s48 offen offset:3072 lds
    s_add_u32 s48, s48, 131072
    s_mov_b32 m0, 118784
    s_nop 0
    buffer_load_dwordx4 v220, s[20:23], s51 offen offset:0 lds
    buffer_load_dwordx4 v221, s[20:23], s51 offen offset:1024 lds
    buffer_load_dwordx4 v222, s[20:23], s51 offen offset:2048 lds
    buffer_load_dwordx4 v223, s[20:23], s51 offen offset:3072 lds
    s_add_u32 s51, s51, 40960
    s_mov_b32 m0, 40960
    s_nop 0
    buffer_load_dwordx4 v216, s[32:35], s48 offen offset:0 lds
    buffer_load_dwordx4 v217, s[32:35], s48 offen offset:1024 lds
    buffer_load_dwordx4 v218, s[32:35], s48 offen offset:2048 lds
    buffer_load_dwordx4 v219, s[32:35], s48 offen offset:3072 lds
    s_add_u32 s48, s48, 131072
    s_mov_b32 m0, 122880
    s_nop 0
    buffer_load_dwordx4 v220, s[20:23], s51 offen offset:0 lds
    buffer_load_dwordx4 v221, s[20:23], s51 offen offset:1024 lds
    buffer_load_dwordx4 v222, s[20:23], s51 offen offset:2048 lds
    buffer_load_dwordx4 v223, s[20:23], s51 offen offset:3072 lds
    s_add_u32 s51, s51, 40960
    s_mov_b32 m0, 45056
    s_nop 0
    buffer_load_dwordx4 v216, s[32:35], s48 offen offset:0 lds
    buffer_load_dwordx4 v217, s[32:35], s48 offen offset:1024 lds
    buffer_load_dwordx4 v218, s[32:35], s48 offen offset:2048 lds
    buffer_load_dwordx4 v219, s[32:35], s48 offen offset:3072 lds
    s_mov_b32 m0, 126976
    s_nop 0
    buffer_load_dwordx4 v220, s[20:23], s51 offen offset:0 lds
    buffer_load_dwordx4 v221, s[20:23], s51 offen offset:1024 lds
    buffer_load_dwordx4 v222, s[20:23], s51 offen offset:2048 lds
    buffer_load_dwordx4 v223, s[20:23], s51 offen offset:3072 lds
    s_waitcnt vmcnt(63)
    s_barrier
    s_lshl_b32 s48, s62, 19
    s_add_u32 s48, s48, s53
    s_lshl_b32 s51, s62, 7
    s_add_u32 s51, s51, s59
    s_add_u32 s62, s62, 1
    s_cmp_eq_u32 s62, 10
    s_cselect_b32 s62, 0, s62
    s_mov_b32 m0, 49152
    s_nop 0
    buffer_load_dwordx4 v216, s[32:35], s48 offen offset:0 lds
    buffer_load_dwordx4 v217, s[32:35], s48 offen offset:1024 lds
    buffer_load_dwordx4 v218, s[32:35], s48 offen offset:2048 lds
    buffer_load_dwordx4 v219, s[32:35], s48 offen offset:3072 lds
    s_add_u32 s48, s48, 131072
    s_mov_b32 m0, 131072
    s_nop 0
    buffer_load_dwordx4 v220, s[20:23], s51 offen offset:0 lds
    buffer_load_dwordx4 v221, s[20:23], s51 offen offset:1024 lds
    buffer_load_dwordx4 v222, s[20:23], s51 offen offset:2048 lds
    buffer_load_dwordx4 v223, s[20:23], s51 offen offset:3072 lds
    s_add_u32 s51, s51, 40960
    s_mov_b32 m0, 53248
    s_nop 0
    buffer_load_dwordx4 v216, s[32:35], s48 offen offset:0 lds
    buffer_load_dwordx4 v217, s[32:35], s48 offen offset:1024 lds
    buffer_load_dwordx4 v218, s[32:35], s48 offen offset:2048 lds
    buffer_load_dwordx4 v219, s[32:35], s48 offen offset:3072 lds
    s_add_u32 s48, s48, 131072
    s_mov_b32 m0, 135168
    s_nop 0
    buffer_load_dwordx4 v220, s[20:23], s51 offen offset:0 lds
    buffer_load_dwordx4 v221, s[20:23], s51 offen offset:1024 lds
    buffer_load_dwordx4 v222, s[20:23], s51 offen offset:2048 lds
    buffer_load_dwordx4 v223, s[20:23], s51 offen offset:3072 lds
    s_add_u32 s51, s51, 40960
    s_mov_b32 m0, 57344
    s_nop 0
    buffer_load_dwordx4 v216, s[32:35], s48 offen offset:0 lds
    buffer_load_dwordx4 v217, s[32:35], s48 offen offset:1024 lds
    buffer_load_dwordx4 v218, s[32:35], s48 offen offset:2048 lds
    buffer_load_dwordx4 v219, s[32:35], s48 offen offset:3072 lds
    s_add_u32 s48, s48, 131072
    s_mov_b32 m0, 139264
    s_nop 0
    buffer_load_dwordx4 v220, s[20:23], s51 offen offset:0 lds
    buffer_load_dwordx4 v221, s[20:23], s51 offen offset:1024 lds
    buffer_load_dwordx4 v222, s[20:23], s51 offen offset:2048 lds
    buffer_load_dwordx4 v223, s[20:23], s51 offen offset:3072 lds
    s_add_u32 s51, s51, 40960
    s_mov_b32 m0, 61440
    s_nop 0
    buffer_load_dwordx4 v216, s[32:35], s48 offen offset:0 lds
    buffer_load_dwordx4 v217, s[32:35], s48 offen offset:1024 lds
    buffer_load_dwordx4 v218, s[32:35], s48 offen offset:2048 lds
    buffer_load_dwordx4 v219, s[32:35], s48 offen offset:3072 lds
    s_mov_b32 m0, 143360
    s_nop 0
    buffer_load_dwordx4 v220, s[20:23], s51 offen offset:0 lds
    buffer_load_dwordx4 v221, s[20:23], s51 offen offset:1024 lds
    buffer_load_dwordx4 v222, s[20:23], s51 offen offset:2048 lds
    buffer_load_dwordx4 v223, s[20:23], s51 offen offset:3072 lds
    s_waitcnt vmcnt(63)
    s_barrier
    s_lshl_b32 s48, s62, 19
    s_add_u32 s48, s48, s53
    s_lshl_b32 s51, s62, 7
    s_add_u32 s51, s51, s59
    s_add_u32 s62, s62, 1
    s_cmp_eq_u32 s62, 10
    s_cselect_b32 s62, 0, s62
    s_mov_b32 m0, 65536
    s_nop 0
    buffer_load_dwordx4 v216, s[32:35], s48 offen offset:0 lds
    buffer_load_dwordx4 v217, s[32:35], s48 offen offset:1024 lds
    buffer_load_dwordx4 v218, s[32:35], s48 offen offset:2048 lds
    buffer_load_dwordx4 v219, s[32:35], s48 offen offset:3072 lds
    s_add_u32 s48, s48, 131072
    s_mov_b32 m0, 147456
    s_nop 0
    buffer_load_dwordx4 v220, s[20:23], s51 offen offset:0 lds
    buffer_load_dwordx4 v221, s[20:23], s51 offen offset:1024 lds
    buffer_load_dwordx4 v222, s[20:23], s51 offen offset:2048 lds
    buffer_load_dwordx4 v223, s[20:23], s51 offen offset:3072 lds
    s_add_u32 s51, s51, 40960
    s_mov_b32 m0, 69632
    s_nop 0
    buffer_load_dwordx4 v216, s[32:35], s48 offen offset:0 lds
    buffer_load_dwordx4 v217, s[32:35], s48 offen offset:1024 lds
    buffer_load_dwordx4 v218, s[32:35], s48 offen offset:2048 lds
    buffer_load_dwordx4 v219, s[32:35], s48 offen offset:3072 lds
    s_add_u32 s48, s48, 131072
    s_mov_b32 m0, 151552
    s_nop 0
    buffer_load_dwordx4 v220, s[20:23], s51 offen offset:0 lds
    buffer_load_dwordx4 v221, s[20:23], s51 offen offset:1024 lds
    buffer_load_dwordx4 v222, s[20:23], s51 offen offset:2048 lds
    buffer_load_dwordx4 v223, s[20:23], s51 offen offset:3072 lds
    s_add_u32 s51, s51, 40960
    s_mov_b32 m0, 73728
    s_nop 0
    buffer_load_dwordx4 v216, s[32:35], s48 offen offset:0 lds
    buffer_load_dwordx4 v217, s[32:35], s48 offen offset:1024 lds
    buffer_load_dwordx4 v218, s[32:35], s48 offen offset:2048 lds
    buffer_load_dwordx4 v219, s[32:35], s48 offen offset:3072 lds
    s_add_u32 s48, s48, 131072
    s_mov_b32 m0, 155648
    s_nop 0
    buffer_load_dwordx4 v220, s[20:23], s51 offen offset:0 lds
    buffer_load_dwordx4 v221, s[20:23], s51 offen offset:1024 lds
    buffer_load_dwordx4 v222, s[20:23], s51 offen offset:2048 lds
    buffer_load_dwordx4 v223, s[20:23], s51 offen offset:3072 lds
    s_add_u32 s51, s51, 40960
    s_mov_b32 m0, 77824
    s_nop 0
    buffer_load_dwordx4 v216, s[32:35], s48 offen offset:0 lds
    buffer_load_dwordx4 v217, s[32:35], s48 offen offset:1024 lds
    buffer_load_dwordx4 v218, s[32:35], s48 offen offset:2048 lds
    buffer_load_dwordx4 v219, s[32:35], s48 offen offset:3072 lds
    s_mov_b32 m0, 159744
    s_nop 0
    buffer_load_dwordx4 v220, s[20:23], s51 offen offset:0 lds
    buffer_load_dwordx4 v221, s[20:23], s51 offen offset:1024 lds
    buffer_load_dwordx4 v222, s[20:23], s51 offen offset:2048 lds
    buffer_load_dwordx4 v223, s[20:23], s51 offen offset:3072 lds
    s_waitcnt vmcnt(63)
    s_barrier
    s_lshl_b32 s48, s62, 19
    s_add_u32 s48, s48, s53
    s_lshl_b32 s51, s62, 7
    s_add_u32 s51, s51, s59
    s_add_u32 s62, s62, 1
    s_cmp_eq_u32 s62, 10
    s_cselect_b32 s62, 0, s62
    s_mov_b32 m0, 16384
    s_nop 0
    buffer_load_dwordx4 v216, s[32:35], s48 offen offset:0 lds
    buffer_load_dwordx4 v217, s[32:35], s48 offen offset:1024 lds
    buffer_load_dwordx4 v218, s[32:35], s48 offen offset:2048 lds
    buffer_load_dwordx4 v219, s[32:35], s48 offen offset:3072 lds
    s_add_u32 s48, s48, 131072
    s_mov_b32 m0, 98304
    s_nop 0
    buffer_load_dwordx4 v220, s[20:23], s51 offen offset:0 lds
    buffer_load_dwordx4 v221, s[20:23], s51 offen offset:1024 lds
    buffer_load_dwordx4 v222, s[20:23], s51 offen offset:2048 lds
    buffer_load_dwordx4 v223, s[20:23], s51 offen offset:3072 lds
    s_add_u32 s51, s51, 40960
    s_mov_b32 m0, 20480
    s_nop 0
    buffer_load_dwordx4 v216, s[32:35], s48 offen offset:0 lds
    buffer_load_dwordx4 v217, s[32:35], s48 offen offset:1024 lds
    buffer_load_dwordx4 v218, s[32:35], s48 offen offset:2048 lds
    buffer_load_dwordx4 v219, s[32:35], s48 offen offset:3072 lds
    s_add_u32 s48, s48, 131072
    s_mov_b32 m0, 102400
    s_nop 0
    buffer_load_dwordx4 v220, s[20:23], s51 offen offset:0 lds
    buffer_load_dwordx4 v221, s[20:23], s51 offen offset:1024 lds
    buffer_load_dwordx4 v222, s[20:23], s51 offen offset:2048 lds
    buffer_load_dwordx4 v223, s[20:23], s51 offen offset:3072 lds
    s_add_u32 s51, s51, 40960
    s_mov_b32 m0, 24576
    s_nop 0
    buffer_load_dwordx4 v216, s[32:35], s48 offen offset:0 lds
    buffer_load_dwordx4 v217, s[32:35], s48 offen offset:1024 lds
    buffer_load_dwordx4 v218, s[32:35], s48 offen offset:2048 lds
    buffer_load_dwordx4 v219, s[32:35], s48 offen offset:3072 lds
    s_add_u32 s48, s48, 131072
    s_mov_b32 m0, 106496
    s_nop 0
    buffer_load_dwordx4 v220, s[20:23], s51 offen offset:0 lds
    buffer_load_dwordx4 v221, s[20:23], s51 offen offset:1024 lds
    buffer_load_dwordx4 v222, s[20:23], s51 offen offset:2048 lds
    buffer_load_dwordx4 v223, s[20:23], s51 offen offset:3072 lds
    s_add_u32 s51, s51, 40960
    s_mov_b32 m0, 28672
    s_nop 0
    buffer_load_dwordx4 v216, s[32:35], s48 offen offset:0 lds
    buffer_load_dwordx4 v217, s[32:35], s48 offen offset:1024 lds
    buffer_load_dwordx4 v218, s[32:35], s48 offen offset:2048 lds
    buffer_load_dwordx4 v219, s[32:35], s48 offen offset:3072 lds
    s_mov_b32 m0, 110592
    s_nop 0
    buffer_load_dwordx4 v220, s[20:23], s51 offen offset:0 lds
    buffer_load_dwordx4 v221, s[20:23], s51 offen offset:1024 lds
    buffer_load_dwordx4 v222, s[20:23], s51 offen offset:2048 lds
    buffer_load_dwordx4 v223, s[20:23], s51 offen offset:3072 lds
    s_waitcnt vmcnt(63)
    s_barrier
    s_lshl_b32 s48, s62, 19
    s_add_u32 s48, s48, s53
    s_lshl_b32 s51, s62, 7
    s_add_u32 s51, s51, s59
    s_add_u32 s62, s62, 1
    s_cmp_eq_u32 s62, 10
    s_cselect_b32 s62, 0, s62
    s_mov_b32 m0, 32768
    s_nop 0
    buffer_load_dwordx4 v216, s[32:35], s48 offen offset:0 lds
    buffer_load_dwordx4 v217, s[32:35], s48 offen offset:1024 lds
    buffer_load_dwordx4 v218, s[32:35], s48 offen offset:2048 lds
    buffer_load_dwordx4 v219, s[32:35], s48 offen offset:3072 lds
    s_add_u32 s48, s48, 131072
    s_mov_b32 m0, 114688
    s_nop 0
    buffer_load_dwordx4 v220, s[20:23], s51 offen offset:0 lds
    buffer_load_dwordx4 v221, s[20:23], s51 offen offset:1024 lds
    buffer_load_dwordx4 v222, s[20:23], s51 offen offset:2048 lds
    buffer_load_dwordx4 v223, s[20:23], s51 offen offset:3072 lds
    s_add_u32 s51, s51, 40960
    s_mov_b32 m0, 36864
    s_nop 0
    buffer_load_dwordx4 v216, s[32:35], s48 offen offset:0 lds
    buffer_load_dwordx4 v217, s[32:35], s48 offen offset:1024 lds
    buffer_load_dwordx4 v218, s[32:35], s48 offen offset:2048 lds
    buffer_load_dwordx4 v219, s[32:35], s48 offen offset:3072 lds
    s_add_u32 s48, s48, 131072
    s_mov_b32 m0, 118784
    s_nop 0
    buffer_load_dwordx4 v220, s[20:23], s51 offen offset:0 lds
    buffer_load_dwordx4 v221, s[20:23], s51 offen offset:1024 lds
    buffer_load_dwordx4 v222, s[20:23], s51 offen offset:2048 lds
    buffer_load_dwordx4 v223, s[20:23], s51 offen offset:3072 lds
    s_add_u32 s51, s51, 40960
    s_mov_b32 m0, 40960
    s_nop 0
    buffer_load_dwordx4 v216, s[32:35], s48 offen offset:0 lds
    buffer_load_dwordx4 v217, s[32:35], s48 offen offset:1024 lds
    buffer_load_dwordx4 v218, s[32:35], s48 offen offset:2048 lds
    buffer_load_dwordx4 v219, s[32:35], s48 offen offset:3072 lds
    s_add_u32 s48, s48, 131072
    s_mov_b32 m0, 122880
    s_nop 0
    buffer_load_dwordx4 v220, s[20:23], s51 offen offset:0 lds
    buffer_load_dwordx4 v221, s[20:23], s51 offen offset:1024 lds
    buffer_load_dwordx4 v222, s[20:23], s51 offen offset:2048 lds
    buffer_load_dwordx4 v223, s[20:23], s51 offen offset:3072 lds
    s_add_u32 s51, s51, 40960
    s_mov_b32 m0, 45056
    s_nop 0
    buffer_load_dwordx4 v216, s[32:35], s48 offen offset:0 lds
    buffer_load_dwordx4 v217, s[32:35], s48 offen offset:1024 lds
    buffer_load_dwordx4 v218, s[32:35], s48 offen offset:2048 lds
    buffer_load_dwordx4 v219, s[32:35], s48 offen offset:3072 lds
    s_mov_b32 m0, 126976
    s_nop 0
    buffer_load_dwordx4 v220, s[20:23], s51 offen offset:0 lds
    buffer_load_dwordx4 v221, s[20:23], s51 offen offset:1024 lds
    buffer_load_dwordx4 v222, s[20:23], s51 offen offset:2048 lds
    buffer_load_dwordx4 v223, s[20:23], s51 offen offset:3072 lds
    s_waitcnt vmcnt(63)
    s_barrier
    s_lshl_b32 s48, s62, 19
    s_add_u32 s48, s48, s53
    s_lshl_b32 s51, s62, 7
    s_add_u32 s51, s51, s59
    s_add_u32 s62, s62, 1
    s_cmp_eq_u32 s62, 10
    s_cselect_b32 s62, 0, s62
    s_mov_b32 m0, 49152
    s_nop 0
    buffer_load_dwordx4 v216, s[32:35], s48 offen offset:0 lds
    buffer_load_dwordx4 v217, s[32:35], s48 offen offset:1024 lds
    buffer_load_dwordx4 v218, s[32:35], s48 offen offset:2048 lds
    buffer_load_dwordx4 v219, s[32:35], s48 offen offset:3072 lds
    s_add_u32 s48, s48, 131072
    s_mov_b32 m0, 131072
    s_nop 0
    buffer_load_dwordx4 v220, s[20:23], s51 offen offset:0 lds
    buffer_load_dwordx4 v221, s[20:23], s51 offen offset:1024 lds
    buffer_load_dwordx4 v222, s[20:23], s51 offen offset:2048 lds
    buffer_load_dwordx4 v223, s[20:23], s51 offen offset:3072 lds
    s_add_u32 s51, s51, 40960
    s_mov_b32 m0, 53248
    s_nop 0
    buffer_load_dwordx4 v216, s[32:35], s48 offen offset:0 lds
    buffer_load_dwordx4 v217, s[32:35], s48 offen offset:1024 lds
    buffer_load_dwordx4 v218, s[32:35], s48 offen offset:2048 lds
    buffer_load_dwordx4 v219, s[32:35], s48 offen offset:3072 lds
    s_add_u32 s48, s48, 131072
    s_mov_b32 m0, 135168
    s_nop 0
    buffer_load_dwordx4 v220, s[20:23], s51 offen offset:0 lds
    buffer_load_dwordx4 v221, s[20:23], s51 offen offset:1024 lds
    buffer_load_dwordx4 v222, s[20:23], s51 offen offset:2048 lds
    buffer_load_dwordx4 v223, s[20:23], s51 offen offset:3072 lds
    s_add_u32 s51, s51, 40960
    s_mov_b32 m0, 57344
    s_nop 0
    buffer_load_dwordx4 v216, s[32:35], s48 offen offset:0 lds
    buffer_load_dwordx4 v217, s[32:35], s48 offen offset:1024 lds
    buffer_load_dwordx4 v218, s[32:35], s48 offen offset:2048 lds
    buffer_load_dwordx4 v219, s[32:35], s48 offen offset:3072 lds
    s_add_u32 s48, s48, 131072
    s_mov_b32 m0, 139264
    s_nop 0
    buffer_load_dwordx4 v220, s[20:23], s51 offen offset:0 lds
    buffer_load_dwordx4 v221, s[20:23], s51 offen offset:1024 lds
    buffer_load_dwordx4 v222, s[20:23], s51 offen offset:2048 lds
    buffer_load_dwordx4 v223, s[20:23], s51 offen offset:3072 lds
    s_add_u32 s51, s51, 40960
    s_mov_b32 m0, 61440
    s_nop 0
    buffer_load_dwordx4 v216, s[32:35], s48 offen offset:0 lds
    buffer_load_dwordx4 v217, s[32:35], s48 offen offset:1024 lds
    buffer_load_dwordx4 v218, s[32:35], s48 offen offset:2048 lds
    buffer_load_dwordx4 v219, s[32:35], s48 offen offset:3072 lds
    s_mov_b32 m0, 143360
    s_nop 0
    buffer_load_dwordx4 v220, s[20:23], s51 offen offset:0 lds
    buffer_load_dwordx4 v221, s[20:23], s51 offen offset:1024 lds
    buffer_load_dwordx4 v222, s[20:23], s51 offen offset:2048 lds
    buffer_load_dwordx4 v223, s[20:23], s51 offen offset:3072 lds
    s_waitcnt vmcnt(63)
    s_barrier
    s_lshl_b32 s48, s62, 19
    s_add_u32 s48, s48, s53
    s_lshl_b32 s51, s62, 7
    s_add_u32 s51, s51, s59
    s_add_u32 s62, s62, 1
    s_cmp_eq_u32 s62, 10
    s_cselect_b32 s62, 0, s62
    s_mov_b32 m0, 65536
    s_nop 0
    buffer_load_dwordx4 v216, s[32:35], s48 offen offset:0 lds
    buffer_load_dwordx4 v217, s[32:35], s48 offen offset:1024 lds
    buffer_load_dwordx4 v218, s[32:35], s48 offen offset:2048 lds
    buffer_load_dwordx4 v219, s[32:35], s48 offen offset:3072 lds
    s_add_u32 s48, s48, 131072
    s_mov_b32 m0, 147456
    s_nop 0
    buffer_load_dwordx4 v220, s[20:23], s51 offen offset:0 lds
    buffer_load_dwordx4 v221, s[20:23], s51 offen offset:1024 lds
    buffer_load_dwordx4 v222, s[20:23], s51 offen offset:2048 lds
    buffer_load_dwordx4 v223, s[20:23], s51 offen offset:3072 lds
    s_add_u32 s51, s51, 40960
    s_mov_b32 m0, 69632
    s_nop 0
    buffer_load_dwordx4 v216, s[32:35], s48 offen offset:0 lds
    buffer_load_dwordx4 v217, s[32:35], s48 offen offset:1024 lds
    buffer_load_dwordx4 v218, s[32:35], s48 offen offset:2048 lds
    buffer_load_dwordx4 v219, s[32:35], s48 offen offset:3072 lds
    s_add_u32 s48, s48, 131072
    s_mov_b32 m0, 151552
    s_nop 0
    buffer_load_dwordx4 v220, s[20:23], s51 offen offset:0 lds
    buffer_load_dwordx4 v221, s[20:23], s51 offen offset:1024 lds
    buffer_load_dwordx4 v222, s[20:23], s51 offen offset:2048 lds
    buffer_load_dwordx4 v223, s[20:23], s51 offen offset:3072 lds
    s_add_u32 s51, s51, 40960
    s_mov_b32 m0, 73728
    s_nop 0
    buffer_load_dwordx4 v216, s[32:35], s48 offen offset:0 lds
    buffer_load_dwordx4 v217, s[32:35], s48 offen offset:1024 lds
    buffer_load_dwordx4 v218, s[32:35], s48 offen offset:2048 lds
    buffer_load_dwordx4 v219, s[32:35], s48 offen offset:3072 lds
    s_add_u32 s48, s48, 131072
    s_mov_b32 m0, 155648
    s_nop 0
    buffer_load_dwordx4 v220, s[20:23], s51 offen offset:0 lds
    buffer_load_dwordx4 v221, s[20:23], s51 offen offset:1024 lds
    buffer_load_dwordx4 v222, s[20:23], s51 offen offset:2048 lds
    buffer_load_dwordx4 v223, s[20:23], s51 offen offset:3072 lds
    s_add_u32 s51, s51, 40960
    s_mov_b32 m0, 77824
    s_nop 0
    buffer_load_dwordx4 v216, s[32:35], s48 offen offset:0 lds
    buffer_load_dwordx4 v217, s[32:35], s48 offen offset:1024 lds
    buffer_load_dwordx4 v218, s[32:35], s48 offen offset:2048 lds
    buffer_load_dwordx4 v219, s[32:35], s48 offen offset:3072 lds
    s_mov_b32 m0, 159744
    s_nop 0
    buffer_load_dwordx4 v220, s[20:23], s51 offen offset:0 lds
    buffer_load_dwordx4 v221, s[20:23], s51 offen offset:1024 lds
    buffer_load_dwordx4 v222, s[20:23], s51 offen offset:2048 lds
    buffer_load_dwordx4 v223, s[20:23], s51 offen offset:3072 lds
    s_add_u32 s48, s43, 32768
    buffer_load_dwordx4 v[16:19], v10, s[28:31], s48 offen offset:0 nt
    buffer_load_dwordx4 v[20:23], v10, s[28:31], s48 offen offset:1024 nt
    buffer_load_dwordx4 v[24:27], v10, s[28:31], s48 offen offset:2048 nt
    buffer_load_dwordx4 v[28:31], v10, s[28:31], s48 offen offset:3072 nt
    s_add_u32 s48, s43, 36864
    buffer_load_dwordx4 v[32:35], v10, s[28:31], s48 offen offset:0 nt
    buffer_load_dwordx4 v[36:39], v10, s[28:31], s48 offen offset:1024 nt
    buffer_load_dwordx4 v[40:43], v10, s[28:31], s48 offen offset:2048 nt
    buffer_load_dwordx4 v[44:47], v10, s[28:31], s48 offen offset:3072 nt
    s_add_u32 s48, s43, 40960
    buffer_load_dwordx4 v[48:51], v10, s[28:31], s48 offen offset:0 nt
    buffer_load_dwordx4 v[52:55], v10, s[28:31], s48 offen offset:1024 nt
    buffer_load_dwordx4 v[56:59], v10, s[28:31], s48 offen offset:2048 nt
    buffer_load_dwordx4 v[60:63], v10, s[28:31], s48 offen offset:3072 nt
    s_add_u32 s48, s43, 45056
    buffer_load_dwordx4 v[64:67], v10, s[28:31], s48 offen offset:0 nt
    buffer_load_dwordx4 v[68:71], v10, s[28:31], s48 offen offset:1024 nt
    buffer_load_dwordx4 v[72:75], v10, s[28:31], s48 offen offset:2048 nt
    buffer_load_dwordx4 v[76:79], v10, s[28:31], s48 offen offset:3072 nt
    s_waitcnt vmcnt(63)
    s_barrier
    s_add_u32 s48, s43, 49152
    buffer_load_dwordx4 v[80:83], v2, s[24:27], s48 offen offset:0 nt
    buffer_load_dwordx4 v[84:87], v3, s[24:27], s48 offen offset:1024 nt
    buffer_load_dwordx4 v[88:91], v8, s[24:27], s48 offen offset:2048 nt
    buffer_load_dwordx4 v[92:95], v9, s[24:27], s48 offen offset:3072 nt
    s_add_u32 s48, s43, 53248
    buffer_load_dwordx4 v[96:99], v2, s[24:27], s48 offen offset:0 nt
    buffer_load_dwordx4 v[100:103], v3, s[24:27], s48 offen offset:1024 nt
    buffer_load_dwordx4 v[104:107], v8, s[24:27], s48 offen offset:2048 nt
    buffer_load_dwordx4 v[108:111], v9, s[24:27], s48 offen offset:3072 nt
    s_add_u32 s48, s43, 57344
    buffer_load_dwordx4 v[112:115], v2, s[24:27], s48 offen offset:0 nt
    buffer_load_dwordx4 v[116:119], v3, s[24:27], s48 offen offset:1024 nt
    buffer_load_dwordx4 v[120:123], v8, s[24:27], s48 offen offset:2048 nt
    buffer_load_dwordx4 v[124:127], v9, s[24:27], s48 offen offset:3072 nt
    s_add_u32 s48, s43, 61440
    buffer_load_dwordx4 v[128:131], v2, s[24:27], s48 offen offset:0 nt
    buffer_load_dwordx4 v[132:135], v3, s[24:27], s48 offen offset:1024 nt
    buffer_load_dwordx4 v[136:139], v8, s[24:27], s48 offen offset:2048 nt
    buffer_load_dwordx4 v[140:143], v9, s[24:27], s48 offen offset:3072 nt
    s_waitcnt vmcnt(63)
    s_barrier
    s_add_u32 s48, s43, 49152
    buffer_load_dwordx4 v[144:147], v10, s[28:31], s48 offen offset:0 nt
    buffer_load_dwordx4 v[148:151], v10, s[28:31], s48 offen offset:1024 nt
    buffer_load_dwordx4 v[152:155], v10, s[28:31], s48 offen offset:2048 nt
    buffer_load_dwordx4 v[156:159], v10, s[28:31], s48 offen offset:3072 nt
    s_add_u32 s48, s43, 53248
    buffer_load_dwordx4 v[160:163], v10, s[28:31], s48 offen offset:0 nt
    buffer_load_dwordx4 v[164:167], v10, s[28:31], s48 offen offset:1024 nt
    buffer_load_dwordx4 v[168:171], v10, s[28:31], s48 offen offset:2048 nt
    buffer_load_dwordx4 v[172:175], v10, s[28:31], s48 offen offset:3072 nt
    s_add_u32 s48, s43, 57344
    buffer_load_dwordx4 v[176:179], v10, s[28:31], s48 offen offset:0 nt
    buffer_load_dwordx4 v[180:183], v10, s[28:31], s48 offen offset:1024 nt
    buffer_load_dwordx4 v[184:187], v10, s[28:31], s48 offen offset:2048 nt
    buffer_load_dwordx4 v[188:191], v10, s[28:31], s48 offen offset:3072 nt
    s_add_u32 s48, s43, 61440
    buffer_load_dwordx4 v[192:195], v10, s[28:31], s48 offen offset:0 nt
    buffer_load_dwordx4 v[196:199], v10, s[28:31], s48 offen offset:1024 nt
    buffer_load_dwordx4 v[200:203], v10, s[28:31], s48 offen offset:2048 nt
    buffer_load_dwordx4 v[204:207], v10, s[28:31], s48 offen offset:3072 nt
    s_waitcnt vmcnt(48)
    s_barrier
    s_barrier
    s_waitcnt lgkmcnt(0)
    s_barrier
    s_add_u32 s48, s43, 81920
    s_mov_b32 m0, 0
    s_nop 0
    buffer_load_dwordx4 v2, s[24:27], s48 offen offset:0 nt lds
    buffer_load_dwordx4 v3, s[24:27], s48 offen offset:1024 nt lds
    buffer_load_dwordx4 v8, s[24:27], s48 offen offset:2048 nt lds
    buffer_load_dwordx4 v9, s[24:27], s48 offen offset:3072 nt lds
    s_add_u32 s48, s43, 86016
    s_mov_b32 m0, 4096
    s_nop 0
    buffer_load_dwordx4 v2, s[24:27], s48 offen offset:0 nt lds
    buffer_load_dwordx4 v3, s[24:27], s48 offen offset:1024 nt lds
    buffer_load_dwordx4 v8, s[24:27], s48 offen offset:2048 nt lds
    buffer_load_dwordx4 v9, s[24:27], s48 offen offset:3072 nt lds
    s_add_u32 s48, s43, 90112
    s_mov_b32 m0, 8192
    s_nop 0
    buffer_load_dwordx4 v2, s[24:27], s48 offen offset:0 nt lds
    buffer_load_dwordx4 v3, s[24:27], s48 offen offset:1024 nt lds
    buffer_load_dwordx4 v8, s[24:27], s48 offen offset:2048 nt lds
    buffer_load_dwordx4 v9, s[24:27], s48 offen offset:3072 nt lds
    s_add_u32 s48, s43, 94208
    s_mov_b32 m0, 12288
    s_nop 0
    buffer_load_dwordx4 v2, s[24:27], s48 offen offset:0 nt lds
    buffer_load_dwordx4 v3, s[24:27], s48 offen offset:1024 nt lds
    buffer_load_dwordx4 v8, s[24:27], s48 offen offset:2048 nt lds
    buffer_load_dwordx4 v9, s[24:27], s48 offen offset:3072 nt lds
    s_waitcnt vmcnt(48)
    ds_write_b128 v233, v[16:19] offset:49152
    ds_write_b128 v233, v[20:23] offset:50176
    ds_write_b128 v233, v[24:27] offset:51200
    ds_write_b128 v233, v[28:31] offset:52224
    ds_write_b128 v233, v[32:35] offset:53248
    ds_write_b128 v233, v[36:39] offset:54272
    ds_write_b128 v233, v[40:43] offset:55296
    ds_write_b128 v233, v[44:47] offset:56320
    ds_write_b128 v233, v[48:51] offset:57344
    ds_write_b128 v233, v[52:55] offset:58368
    ds_write_b128 v233, v[56:59] offset:59392
    ds_write_b128 v233, v[60:63] offset:60416
    ds_write_b128 v233, v[64:67] offset:61440
    ds_write_b128 v233, v[68:71] offset:62464
    ds_write_b128 v233, v[72:75] offset:63488
    ds_write_b128 v233, v[76:79] offset:64512
    s_waitcnt lgkmcnt(0)
    s_barrier
    s_add_u32 s48, s43, 98304
    s_mov_b32 m0, 16384
    s_nop 0
    buffer_load_dwordx4 v2, s[24:27], s48 offen offset:0 nt lds
    buffer_load_dwordx4 v3, s[24:27], s48 offen offset:1024 nt lds
    buffer_load_dwordx4 v8, s[24:27], s48 offen offset:2048 nt lds
    buffer_load_dwordx4 v9, s[24:27], s48 offen offset:3072 nt lds
    s_add_u32 s48, s43, 102400
    s_mov_b32 m0, 20480
    s_nop 0
    buffer_load_dwordx4 v2, s[24:27], s48 offen offset:0 nt lds
    buffer_load_dwordx4 v3, s[24:27], s48 offen offset:1024 nt lds
    buffer_load_dwordx4 v8, s[24:27], s48 offen offset:2048 nt lds
    buffer_load_dwordx4 v9, s[24:27], s48 offen offset:3072 nt lds
    s_add_u32 s48, s43, 106496
    s_mov_b32 m0, 24576
    s_nop 0
    buffer_load_dwordx4 v2, s[24:27], s48 offen offset:0 nt lds
    buffer_load_dwordx4 v3, s[24:27], s48 offen offset:1024 nt lds
    buffer_load_dwordx4 v8, s[24:27], s48 offen offset:2048 nt lds
    buffer_load_dwordx4 v9, s[24:27], s48 offen offset:3072 nt lds
    s_add_u32 s48, s43, 110592
    s_mov_b32 m0, 28672
    s_nop 0
    buffer_load_dwordx4 v2, s[24:27], s48 offen offset:0 nt lds
    buffer_load_dwordx4 v3, s[24:27], s48 offen offset:1024 nt lds
    buffer_load_dwordx4 v8, s[24:27], s48 offen offset:2048 nt lds
    buffer_load_dwordx4 v9, s[24:27], s48 offen offset:3072 nt lds
    s_waitcnt vmcnt(48)
    ds_write_b128 v232, v[80:83] offset:49152
    ds_write_b128 v232, v[84:87] offset:50176
    ds_write_b128 v232, v[88:91] offset:51200
    ds_write_b128 v232, v[92:95] offset:52224
    ds_write_b128 v232, v[96:99] offset:53248
    ds_write_b128 v232, v[100:103] offset:54272
    ds_write_b128 v232, v[104:107] offset:55296
    ds_write_b128 v232, v[108:111] offset:56320
    ds_write_b128 v232, v[112:115] offset:57344
    ds_write_b128 v232, v[116:119] offset:58368
    ds_write_b128 v232, v[120:123] offset:59392
    ds_write_b128 v232, v[124:127] offset:60416
    ds_write_b128 v232, v[128:131] offset:61440
    ds_write_b128 v232, v[132:135] offset:62464
    ds_write_b128 v232, v[136:139] offset:63488
    ds_write_b128 v232, v[140:143] offset:64512
    s_waitcnt lgkmcnt(0)
    s_barrier
    s_add_u32 s48, s43, 114688
    s_mov_b32 m0, 32768
    s_nop 0
    buffer_load_dwordx4 v2, s[24:27], s48 offen offset:0 nt lds
    buffer_load_dwordx4 v3, s[24:27], s48 offen offset:1024 nt lds
    buffer_load_dwordx4 v8, s[24:27], s48 offen offset:2048 nt lds
    buffer_load_dwordx4 v9, s[24:27], s48 offen offset:3072 nt lds
    s_add_u32 s48, s43, 118784
    s_mov_b32 m0, 36864
    s_nop 0
    buffer_load_dwordx4 v2, s[24:27], s48 offen offset:0 nt lds
    buffer_load_dwordx4 v3, s[24:27], s48 offen offset:1024 nt lds
    buffer_load_dwordx4 v8, s[24:27], s48 offen offset:2048 nt lds
    buffer_load_dwordx4 v9, s[24:27], s48 offen offset:3072 nt lds
    s_add_u32 s48, s43, 122880
    s_mov_b32 m0, 40960
    s_nop 0
    buffer_load_dwordx4 v2, s[24:27], s48 offen offset:0 nt lds
    buffer_load_dwordx4 v3, s[24:27], s48 offen offset:1024 nt lds
    buffer_load_dwordx4 v8, s[24:27], s48 offen offset:2048 nt lds
    buffer_load_dwordx4 v9, s[24:27], s48 offen offset:3072 nt lds
    s_add_u32 s48, s43, 126976
    s_mov_b32 m0, 45056
    s_nop 0
    buffer_load_dwordx4 v2, s[24:27], s48 offen offset:0 nt lds
    buffer_load_dwordx4 v3, s[24:27], s48 offen offset:1024 nt lds
    buffer_load_dwordx4 v8, s[24:27], s48 offen offset:2048 nt lds
    buffer_load_dwordx4 v9, s[24:27], s48 offen offset:3072 nt lds
    s_waitcnt vmcnt(48)
    ds_write_b128 v234, v[144:147] offset:0
    ds_write_b128 v234, v[148:151] offset:1024
    ds_write_b128 v234, v[152:155] offset:2048
    ds_write_b128 v234, v[156:159] offset:3072
    ds_write_b128 v234, v[160:163] offset:4096
    ds_write_b128 v234, v[164:167] offset:5120
    ds_write_b128 v234, v[168:171] offset:6144
    ds_write_b128 v234, v[172:175] offset:7168
    ds_write_b128 v234, v[176:179] offset:8192
    ds_write_b128 v234, v[180:183] offset:9216
    ds_write_b128 v234, v[184:187] offset:10240
    ds_write_b128 v234, v[188:191] offset:11264
    ds_write_b128 v234, v[192:195] offset:12288
    ds_write_b128 v234, v[196:199] offset:13312
    ds_write_b128 v234, v[200:203] offset:14336
    ds_write_b128 v234, v[204:207] offset:15360
    s_lshr_b32 s57, s42, 1
    s_sub_u32 s58, s57, s45
    s_mul_i32 s58, s58, 0
    s_add_u32 s58, s58, s44
    s_and_b32 s58, s58, 7
    s_lshl_b32 s57, s57, 3
    s_add_u32 s57, s57, s58
    s_lshl_b32 s57, s57, 7
    s_and_b32 s58, s42, 1
    s_lshl_b32 s58, s58, 6
    s_add_u32 s57, s57, s58
    s_add_u32 s57, s57, 0
    s_mul_i32 s57, s57, 1280
    s_mul_i32 s58, s45, 320
    s_add_u32 s57, s57, s58
    s_add_u32 s48, s57, 0
    buffer_load_dwordx4 v[16:19], v224, s[64:67], s48 offen offset:0
    buffer_load_dwordx4 v[20:23], v225, s[64:67], s48 offen offset:1024
    buffer_load_dwordx4 v[24:27], v226, s[64:67], s48 offen offset:2048
    buffer_load_dwordx4 v[28:31], v227, s[64:67], s48 offen offset:3072
    s_add_u32 s48, s57, 20480
    buffer_load_dwordx4 v[16:19], v224, s[64:67], s48 offen offset:0
    buffer_load_dwordx4 v[20:23], v225, s[64:67], s48 offen offset:1024
    buffer_load_dwordx4 v[24:27], v226, s[64:67], s48 offen offset:2048
    buffer_load_dwordx4 v[28:31], v227, s[64:67], s48 offen offset:3072
    s_add_u32 s48, s57, 256
    buffer_load_dwordx4 v[16:19], v228, s[64:67], s48 offen offset:0
    buffer_load_dwordx4 v[20:23], v229, s[64:67], s48 offen offset:1024
    s_waitcnt lgkmcnt(0)
    s_barrier
    s_add_u32 s48, s43, 131072
    s_mov_b32 m0, 49152
    s_nop 0
    buffer_load_dwordx4 v2, s[24:27], s48 offen offset:0 nt lds
    buffer_load_dwordx4 v3, s[24:27], s48 offen offset:1024 nt lds
    buffer_load_dwordx4 v8, s[24:27], s48 offen offset:2048 nt lds
    buffer_load_dwordx4 v9, s[24:27], s48 offen offset:3072 nt lds
    s_add_u32 s48, s43, 135168
    s_mov_b32 m0, 53248
    s_nop 0
    buffer_load_dwordx4 v2, s[24:27], s48 offen offset:0 nt lds
    buffer_load_dwordx4 v3, s[24:27], s48 offen offset:1024 nt lds
    buffer_load_dwordx4 v8, s[24:27], s48 offen offset:2048 nt lds
    buffer_load_dwordx4 v9, s[24:27], s48 offen offset:3072 nt lds
    s_add_u32 s48, s43, 139264
    s_mov_b32 m0, 57344
    s_nop 0
    buffer_load_dwordx4 v2, s[24:27], s48 offen offset:0 nt lds
    buffer_load_dwordx4 v3, s[24:27], s48 offen offset:1024 nt lds
    buffer_load_dwordx4 v8, s[24:27], s48 offen offset:2048 nt lds
    buffer_load_dwordx4 v9, s[24:27], s48 offen offset:3072 nt lds
    s_add_u32 s48, s43, 143360
    s_mov_b32 m0, 61440
    s_nop 0
    buffer_load_dwordx4 v2, s[24:27], s48 offen offset:0 nt lds
    buffer_load_dwordx4 v3, s[24:27], s48 offen offset:1024 nt lds
    buffer_load_dwordx4 v8, s[24:27], s48 offen offset:2048 nt lds
    buffer_load_dwordx4 v9, s[24:27], s48 offen offset:3072 nt lds
    s_lshr_b32 s57, s42, 1
    s_sub_u32 s58, s57, s45
    s_mul_i32 s58, s58, 0
    s_add_u32 s58, s58, s44
    s_and_b32 s58, s58, 7
    s_lshl_b32 s57, s57, 3
    s_add_u32 s57, s57, s58
    s_lshl_b32 s57, s57, 7
    s_and_b32 s58, s42, 1
    s_lshl_b32 s58, s58, 6
    s_add_u32 s57, s57, s58
    s_add_u32 s57, s57, 32
    s_mul_i32 s57, s57, 1280
    s_mul_i32 s58, s45, 320
    s_add_u32 s57, s57, s58
    s_add_u32 s48, s57, 0
    buffer_load_dwordx4 v[16:19], v224, s[64:67], s48 offen offset:0
    buffer_load_dwordx4 v[20:23], v225, s[64:67], s48 offen offset:1024
    buffer_load_dwordx4 v[24:27], v226, s[64:67], s48 offen offset:2048
    buffer_load_dwordx4 v[28:31], v227, s[64:67], s48 offen offset:3072
    s_add_u32 s48, s57, 20480
    buffer_load_dwordx4 v[16:19], v224, s[64:67], s48 offen offset:0
    buffer_load_dwordx4 v[20:23], v225, s[64:67], s48 offen offset:1024
    buffer_load_dwordx4 v[24:27], v226, s[64:67], s48 offen offset:2048
    buffer_load_dwordx4 v[28:31], v227, s[64:67], s48 offen offset:3072
    s_add_u32 s48, s57, 256
    buffer_load_dwordx4 v[16:19], v228, s[64:67], s48 offen offset:0
    buffer_load_dwordx4 v[20:23], v229, s[64:67], s48 offen offset:1024
    s_waitcnt vmcnt(63)
    s_waitcnt lgkmcnt(0)
    s_barrier
    s_add_u32 s48, s43, 147456
    s_mov_b32 m0, 65536
    s_nop 0
    buffer_load_dwordx4 v2, s[24:27], s48 offen offset:0 nt lds
    buffer_load_dwordx4 v3, s[24:27], s48 offen offset:1024 nt lds
    buffer_load_dwordx4 v8, s[24:27], s48 offen offset:2048 nt lds
    buffer_load_dwordx4 v9, s[24:27], s48 offen offset:3072 nt lds
    s_add_u32 s48, s43, 151552
    s_mov_b32 m0, 69632
    s_nop 0
    buffer_load_dwordx4 v2, s[24:27], s48 offen offset:0 nt lds
    buffer_load_dwordx4 v3, s[24:27], s48 offen offset:1024 nt lds
    buffer_load_dwordx4 v8, s[24:27], s48 offen offset:2048 nt lds
    buffer_load_dwordx4 v9, s[24:27], s48 offen offset:3072 nt lds
    s_add_u32 s48, s43, 155648
    s_mov_b32 m0, 73728
    s_nop 0
    buffer_load_dwordx4 v2, s[24:27], s48 offen offset:0 nt lds
    buffer_load_dwordx4 v3, s[24:27], s48 offen offset:1024 nt lds
    buffer_load_dwordx4 v8, s[24:27], s48 offen offset:2048 nt lds
    buffer_load_dwordx4 v9, s[24:27], s48 offen offset:3072 nt lds
    s_add_u32 s48, s43, 159744
    s_mov_b32 m0, 77824
    s_nop 0
    buffer_load_dwordx4 v2, s[24:27], s48 offen offset:0 nt lds
    buffer_load_dwordx4 v3, s[24:27], s48 offen offset:1024 nt lds
    buffer_load_dwordx4 v8, s[24:27], s48 offen offset:2048 nt lds
    buffer_load_dwordx4 v9, s[24:27], s48 offen offset:3072 nt lds
    s_waitcnt vmcnt(63)
    s_waitcnt lgkmcnt(0)
    s_barrier
    s_add_u32 s48, s43, 163840
    s_mov_b32 m0, 0
    s_nop 0
    buffer_load_dwordx4 v2, s[24:27], s48 offen offset:0 nt lds
    buffer_load_dwordx4 v3, s[24:27], s48 offen offset:1024 nt lds
    buffer_load_dwordx4 v8, s[24:27], s48 offen offset:2048 nt lds
    buffer_load_dwordx4 v9, s[24:27], s48 offen offset:3072 nt lds
    s_add_u32 s48, s43, 167936
    s_mov_b32 m0, 4096
    s_nop 0
    buffer_load_dwordx4 v2, s[24:27], s48 offen offset:0 nt lds
    buffer_load_dwordx4 v3, s[24:27], s48 offen offset:1024 nt lds
    buffer_load_dwordx4 v8, s[24:27], s48 offen offset:2048 nt lds
    buffer_load_dwordx4 v9, s[24:27], s48 offen offset:3072 nt lds
    s_add_u32 s48, s43, 172032
    s_mov_b32 m0, 8192
    s_nop 0
    buffer_load_dwordx4 v2, s[24:27], s48 offen offset:0 nt lds
    buffer_load_dwordx4 v3, s[24:27], s48 offen offset:1024 nt lds
    buffer_load_dwordx4 v8, s[24:27], s48 offen offset:2048 nt lds
    buffer_load_dwordx4 v9, s[24:27], s48 offen offset:3072 nt lds
    s_add_u32 s48, s43, 176128
    s_mov_b32 m0, 12288
    s_nop 0
    buffer_load_dwordx4 v2, s[24:27], s48 offen offset:0 nt lds
    buffer_load_dwordx4 v3, s[24:27], s48 offen offset:1024 nt lds
    buffer_load_dwordx4 v8, s[24:27], s48 offen offset:2048 nt lds
    buffer_load_dwordx4 v9, s[24:27], s48 offen offset:3072 nt lds
    s_waitcnt vmcnt(63)
    s_waitcnt lgkmcnt(0)
    s_barrier
    s_add_u32 s48, s43, 180224
    s_mov_b32 m0, 16384
    s_nop 0
    buffer_load_dwordx4 v2, s[24:27], s48 offen offset:0 nt lds
    buffer_load_dwordx4 v3, s[24:27], s48 offen offset:1024 nt lds
    buffer_load_dwordx4 v8, s[24:27], s48 offen offset:2048 nt lds
    buffer_load_dwordx4 v9, s[24:27], s48 offen offset:3072 nt lds
    s_add_u32 s48, s43, 184320
    s_mov_b32 m0, 20480
    s_nop 0
    buffer_load_dwordx4 v2, s[24:27], s48 offen offset:0 nt lds
    buffer_load_dwordx4 v3, s[24:27], s48 offen offset:1024 nt lds
    buffer_load_dwordx4 v8, s[24:27], s48 offen offset:2048 nt lds
    buffer_load_dwordx4 v9, s[24:27], s48 offen offset:3072 nt lds
    s_add_u32 s48, s43, 188416
    s_mov_b32 m0, 24576
    s_nop 0
    buffer_load_dwordx4 v2, s[24:27], s48 offen offset:0 nt lds
    buffer_load_dwordx4 v3, s[24:27], s48 offen offset:1024 nt lds
    buffer_load_dwordx4 v8, s[24:27], s48 offen offset:2048 nt lds
    buffer_load_dwordx4 v9, s[24:27], s48 offen offset:3072 nt lds
    s_add_u32 s48, s43, 192512
    s_mov_b32 m0, 28672
    s_nop 0
    buffer_load_dwordx4 v2, s[24:27], s48 offen offset:0 nt lds
    buffer_load_dwordx4 v3, s[24:27], s48 offen offset:1024 nt lds
    buffer_load_dwordx4 v8, s[24:27], s48 offen offset:2048 nt lds
    buffer_load_dwordx4 v9, s[24:27], s48 offen offset:3072 nt lds
    s_waitcnt vmcnt(58)
    s_waitcnt lgkmcnt(0)
    s_barrier
    s_add_u32 s48, s43, 196608
    s_mov_b32 m0, 32768
    s_nop 0
    buffer_load_dwordx4 v2, s[24:27], s48 offen offset:0 nt lds
    buffer_load_dwordx4 v3, s[24:27], s48 offen offset:1024 nt lds
    buffer_load_dwordx4 v8, s[24:27], s48 offen offset:2048 nt lds
    buffer_load_dwordx4 v9, s[24:27], s48 offen offset:3072 nt lds
    s_add_u32 s48, s43, 200704
    s_mov_b32 m0, 36864
    s_nop 0
    buffer_load_dwordx4 v2, s[24:27], s48 offen offset:0 nt lds
    buffer_load_dwordx4 v3, s[24:27], s48 offen offset:1024 nt lds
    buffer_load_dwordx4 v8, s[24:27], s48 offen offset:2048 nt lds
    buffer_load_dwordx4 v9, s[24:27], s48 offen offset:3072 nt lds
    s_add_u32 s48, s43, 204800
    s_mov_b32 m0, 40960
    s_nop 0
    buffer_load_dwordx4 v2, s[24:27], s48 offen offset:0 nt lds
    buffer_load_dwordx4 v3, s[24:27], s48 offen offset:1024 nt lds
    buffer_load_dwordx4 v8, s[24:27], s48 offen offset:2048 nt lds
    buffer_load_dwordx4 v9, s[24:27], s48 offen offset:3072 nt lds
    s_add_u32 s48, s43, 208896
    s_mov_b32 m0, 45056
    s_nop 0
    buffer_load_dwordx4 v2, s[24:27], s48 offen offset:0 nt lds
    buffer_load_dwordx4 v3, s[24:27], s48 offen offset:1024 nt lds
    buffer_load_dwordx4 v8, s[24:27], s48 offen offset:2048 nt lds
    buffer_load_dwordx4 v9, s[24:27], s48 offen offset:3072 nt lds
    s_waitcnt vmcnt(48)
    s_waitcnt lgkmcnt(0)
    s_barrier
    s_add_u32 s48, s43, 212992
    s_mov_b32 m0, 49152
    s_nop 0
    buffer_load_dwordx4 v2, s[24:27], s48 offen offset:0 nt lds
    buffer_load_dwordx4 v3, s[24:27], s48 offen offset:1024 nt lds
    buffer_load_dwordx4 v8, s[24:27], s48 offen offset:2048 nt lds
    buffer_load_dwordx4 v9, s[24:27], s48 offen offset:3072 nt lds
    s_add_u32 s48, s43, 217088
    s_mov_b32 m0, 53248
    s_nop 0
    buffer_load_dwordx4 v2, s[24:27], s48 offen offset:0 nt lds
    buffer_load_dwordx4 v3, s[24:27], s48 offen offset:1024 nt lds
    buffer_load_dwordx4 v8, s[24:27], s48 offen offset:2048 nt lds
    buffer_load_dwordx4 v9, s[24:27], s48 offen offset:3072 nt lds
    s_add_u32 s48, s43, 221184
    s_mov_b32 m0, 57344
    s_nop 0
    buffer_load_dwordx4 v2, s[24:27], s48 offen offset:0 nt lds
    buffer_load_dwordx4 v3, s[24:27], s48 offen offset:1024 nt lds
    buffer_load_dwordx4 v8, s[24:27], s48 offen offset:2048 nt lds
    buffer_load_dwordx4 v9, s[24:27], s48 offen offset:3072 nt lds
    s_add_u32 s48, s43, 225280
    s_mov_b32 m0, 61440
    s_nop 0
    buffer_load_dwordx4 v2, s[24:27], s48 offen offset:0 nt lds
    buffer_load_dwordx4 v3, s[24:27], s48 offen offset:1024 nt lds
    buffer_load_dwordx4 v8, s[24:27], s48 offen offset:2048 nt lds
    buffer_load_dwordx4 v9, s[24:27], s48 offen offset:3072 nt lds
    s_waitcnt vmcnt(48)
    s_waitcnt lgkmcnt(0)
    s_barrier
    v_lshlrev_b32 v19, 2, v1
    s_lshl_b32 s54, s42, 5
    s_mov_b64 exec, 0xff
    buffer_load_dword v20, v19, s[68:71], s54 offen sc1
    s_mov_b64 exec, -1
    s_add_u32 s48, s43, 229376
    s_mov_b32 m0, 65536
    s_nop 0
    buffer_load_dwordx4 v2, s[24:27], s48 offen offset:0 nt lds
    buffer_load_dwordx4 v3, s[24:27], s48 offen offset:1024 nt lds
    buffer_load_dwordx4 v8, s[24:27], s48 offen offset:2048 nt lds
    buffer_load_dwordx4 v9, s[24:27], s48 offen offset:3072 nt lds
    s_add_u32 s48, s43, 233472
    s_mov_b32 m0, 69632
    s_nop 0
    buffer_load_dwordx4 v2, s[24:27], s48 offen offset:0 nt lds
    buffer_load_dwordx4 v3, s[24:27], s48 offen offset:1024 nt lds
    buffer_load_dwordx4 v8, s[24:27], s48 offen offset:2048 nt lds
    buffer_load_dwordx4 v9, s[24:27], s48 offen offset:3072 nt lds
    s_add_u32 s48, s43, 237568
    s_mov_b32 m0, 73728
    s_nop 0
    buffer_load_dwordx4 v2, s[24:27], s48 offen offset:0 nt lds
    buffer_load_dwordx4 v3, s[24:27], s48 offen offset:1024 nt lds
    buffer_load_dwordx4 v8, s[24:27], s48 offen offset:2048 nt lds
    buffer_load_dwordx4 v9, s[24:27], s48 offen offset:3072 nt lds
    s_add_u32 s48, s43, 241664
    s_mov_b32 m0, 77824
    s_nop 0
    buffer_load_dwordx4 v2, s[24:27], s48 offen offset:0 nt lds
    buffer_load_dwordx4 v3, s[24:27], s48 offen offset:1024 nt lds
    buffer_load_dwordx4 v8, s[24:27], s48 offen offset:2048 nt lds
    buffer_load_dwordx4 v9, s[24:27], s48 offen offset:3072 nt lds
    s_waitcnt vmcnt(49)
    s_waitcnt lgkmcnt(0)
    s_barrier
    s_add_u32 s48, s43, 245760
    s_mov_b32 m0, 0
    s_nop 0
    buffer_load_dwordx4 v2, s[24:27], s48 offen offset:0 nt lds
    buffer_load_dwordx4 v3, s[24:27], s48 offen offset:1024 nt lds
    buffer_load_dwordx4 v8, s[24:27], s48 offen offset:2048 nt lds
    buffer_load_dwordx4 v9, s[24:27], s48 offen offset:3072 nt lds
    s_add_u32 s48, s43, 249856
    s_mov_b32 m0, 4096
    s_nop 0
    buffer_load_dwordx4 v2, s[24:27], s48 offen offset:0 nt lds
    buffer_load_dwordx4 v3, s[24:27], s48 offen offset:1024 nt lds
    buffer_load_dwordx4 v8, s[24:27], s48 offen offset:2048 nt lds
    buffer_load_dwordx4 v9, s[24:27], s48 offen offset:3072 nt lds
    s_add_u32 s48, s43, 253952
    s_mov_b32 m0, 8192
    s_nop 0
    buffer_load_dwordx4 v2, s[24:27], s48 offen offset:0 nt lds
    buffer_load_dwordx4 v3, s[24:27], s48 offen offset:1024 nt lds
    buffer_load_dwordx4 v8, s[24:27], s48 offen offset:2048 nt lds
    buffer_load_dwordx4 v9, s[24:27], s48 offen offset:3072 nt lds
    s_add_u32 s48, s43, 258048
    s_mov_b32 m0, 12288
    s_nop 0
    buffer_load_dwordx4 v2, s[24:27], s48 offen offset:0 nt lds
    buffer_load_dwordx4 v3, s[24:27], s48 offen offset:1024 nt lds
    buffer_load_dwordx4 v8, s[24:27], s48 offen offset:2048 nt lds
    buffer_load_dwordx4 v9, s[24:27], s48 offen offset:3072 nt lds
    s_waitcnt vmcnt(49)
    s_waitcnt lgkmcnt(0)
    s_barrier
    s_add_u32 s57, s45, 0
    s_and_b32 s57, s57, 3
    s_add_u32 s58, s44, 0
    s_and_b32 s58, s58, 7
    s_lshl_b32 s57, s57, 3
    s_add_u32 s57, s57, s58
    s_mul_i32 s57, s57, 163840
    s_mul_i32 s58, s45, 320
    s_add_u32 s57, s57, s58
    s_add_u32 s48, s57, 0
    s_mov_b32 m0, 16384
    s_nop 0
    buffer_load_dwordx4 v224, s[64:67], s48 offen offset:0 lds
    buffer_load_dwordx4 v225, s[64:67], s48 offen offset:1024 lds
    buffer_load_dwordx4 v226, s[64:67], s48 offen offset:2048 lds
    buffer_load_dwordx4 v227, s[64:67], s48 offen offset:3072 lds
    s_add_u32 s48, s57, 20480
    s_mov_b32 m0, 20480
    s_nop 0
    buffer_load_dwordx4 v224, s[64:67], s48 offen offset:0 lds
    buffer_load_dwordx4 v225, s[64:67], s48 offen offset:1024 lds
    buffer_load_dwordx4 v226, s[64:67], s48 offen offset:2048 lds
    buffer_load_dwordx4 v227, s[64:67], s48 offen offset:3072 lds
    s_add_u32 s48, s57, 40960
    s_mov_b32 m0, 24576
    s_nop 0
    buffer_load_dwordx4 v224, s[64:67], s48 offen offset:0 lds
    buffer_load_dwordx4 v225, s[64:67], s48 offen offset:1024 lds
    buffer_load_dwordx4 v226, s[64:67], s48 offen offset:2048 lds
    buffer_load_dwordx4 v227, s[64:67], s48 offen offset:3072 lds
    s_add_u32 s48, s57, 61440
    s_mov_b32 m0, 28672
    s_nop 0
    buffer_load_dwordx4 v224, s[64:67], s48 offen offset:0 lds
    buffer_load_dwordx4 v225, s[64:67], s48 offen offset:1024 lds
    buffer_load_dwordx4 v226, s[64:67], s48 offen offset:2048 lds
    buffer_load_dwordx4 v227, s[64:67], s48 offen offset:3072 lds
    s_waitcnt vmcnt(49)
    s_waitcnt lgkmcnt(0)
    s_barrier
    s_add_u32 s57, s45, 0
    s_and_b32 s57, s57, 3
    s_add_u32 s58, s44, 0
    s_and_b32 s58, s58, 7
    s_lshl_b32 s57, s57, 3
    s_add_u32 s57, s57, s58
    s_mul_i32 s57, s57, 163840
    s_mul_i32 s58, s45, 320
    s_add_u32 s57, s57, s58
    s_add_u32 s48, s57, 81920
    s_mov_b32 m0, 32768
    s_nop 0
    buffer_load_dwordx4 v224, s[64:67], s48 offen offset:0 lds
    buffer_load_dwordx4 v225, s[64:67], s48 offen offset:1024 lds
    buffer_load_dwordx4 v226, s[64:67], s48 offen offset:2048 lds
    buffer_load_dwordx4 v227, s[64:67], s48 offen offset:3072 lds
    s_add_u32 s48, s57, 102400
    s_mov_b32 m0, 36864
    s_nop 0
    buffer_load_dwordx4 v224, s[64:67], s48 offen offset:0 lds
    buffer_load_dwordx4 v225, s[64:67], s48 offen offset:1024 lds
    buffer_load_dwordx4 v226, s[64:67], s48 offen offset:2048 lds
    buffer_load_dwordx4 v227, s[64:67], s48 offen offset:3072 lds
    s_add_u32 s48, s57, 122880
    s_mov_b32 m0, 40960
    s_nop 0
    buffer_load_dwordx4 v224, s[64:67], s48 offen offset:0 lds
    buffer_load_dwordx4 v225, s[64:67], s48 offen offset:1024 lds
    buffer_load_dwordx4 v226, s[64:67], s48 offen offset:2048 lds
    buffer_load_dwordx4 v227, s[64:67], s48 offen offset:3072 lds
    s_add_u32 s48, s57, 143360
    s_mov_b32 m0, 45056
    s_nop 0
    buffer_load_dwordx4 v224, s[64:67], s48 offen offset:0 lds
    buffer_load_dwordx4 v225, s[64:67], s48 offen offset:1024 lds
    buffer_load_dwordx4 v226, s[64:67], s48 offen offset:2048 lds
    buffer_load_dwordx4 v227, s[64:67], s48 offen offset:3072 lds
    s_waitcnt vmcnt(48)
    s_waitcnt lgkmcnt(0)
    s_barrier
    s_mov_b64 exec, 0xff
    s_mov_b32 s56, 0
L_g2poll0:
    v_cmp_eq_u32 vcc, 0x01010101, v20
    s_nop 1
    s_cmp_eq_u32 vcc_lo, 0xff
    s_cbranch_scc1 L_g2poll0_done
    s_sleep 2
    buffer_load_dword v20, v19, s[68:71], s54 offen sc1
    s_add_u32 s56, s56, 1
    s_waitcnt vmcnt(0)
    s_cmp_lt_u32 s56, 0x40000
    s_cbranch_scc1 L_g2poll0
L_g2poll0_done:
    s_mov_b64 exec, -1
    s_add_u32 s57, s45, 1
    s_and_b32 s57, s57, 3
    s_add_u32 s58, s44, 0
    s_and_b32 s58, s58, 7
    s_lshl_b32 s57, s57, 3
    s_add_u32 s57, s57, s58
    s_mul_i32 s57, s57, 163840
    s_mul_i32 s58, s45, 320
    s_add_u32 s57, s57, s58
    s_add_u32 s48, s57, 0
    s_mov_b32 m0, 49152
    s_nop 0
    buffer_load_dwordx4 v224, s[64:67], s48 offen offset:0 lds
    buffer_load_dwordx4 v225, s[64:67], s48 offen offset:1024 lds
    buffer_load_dwordx4 v226, s[64:67], s48 offen offset:2048 lds
    buffer_load_dwordx4 v227, s[64:67], s48 offen offset:3072 lds
    s_add_u32 s48, s57, 20480
    s_mov_b32 m0, 53248
    s_nop 0
    buffer_load_dwordx4 v224, s[64:67], s48 offen offset:0 lds
    buffer_load_dwordx4 v225, s[64:67], s48 offen offset:1024 lds
    buffer_load_dwordx4 v226, s[64:67], s48 offen offset:2048 lds
    buffer_load_dwordx4 v227, s[64:67], s48 offen offset:3072 lds
    s_add_u32 s48, s57, 40960
    s_mov_b32 m0, 57344
    s_nop 0
    buffer_load_dwordx4 v224, s[64:67], s48 offen offset:0 lds
    buffer_load_dwordx4 v225, s[64:67], s48 offen offset:1024 lds
    buffer_load_dwordx4 v226, s[64:67], s48 offen offset:2048 lds
    buffer_load_dwordx4 v227, s[64:67], s48 offen offset:3072 lds
    s_add_u32 s48, s57, 61440
    s_mov_b32 m0, 61440
    s_nop 0
    buffer_load_dwordx4 v224, s[64:67], s48 offen offset:0 lds
    buffer_load_dwordx4 v225, s[64:67], s48 offen offset:1024 lds
    buffer_load_dwordx4 v226, s[64:67], s48 offen offset:2048 lds
    buffer_load_dwordx4 v227, s[64:67], s48 offen offset:3072 lds
    s_waitcnt vmcnt(48)
    s_waitcnt lgkmcnt(0)
    s_barrier
    s_add_u32 s57, s45, 2
    s_and_b32 s57, s57, 3
    s_add_u32 s58, s44, 0
    s_and_b32 s58, s58, 7
    s_lshl_b32 s57, s57, 3
    s_add_u32 s57, s57, s58
    s_mul_i32 s57, s57, 163840
    s_mul_i32 s58, s45, 320
    s_add_u32 s57, s57, s58
    s_add_u32 s48, s57, 0
    s_mov_b32 m0, 65536
    s_nop 0
    buffer_load_dwordx4 v224, s[64:67], s48 offen offset:0 lds
    buffer_load_dwordx4 v225, s[64:67], s48 offen offset:1024 lds
    buffer_load_dwordx4 v226, s[64:67], s48 offen offset:2048 lds
    buffer_load_dwordx4 v227, s[64:67], s48 offen offset:3072 lds
    s_add_u32 s48, s57, 20480
    s_mov_b32 m0, 69632
    s_nop 0
    buffer_load_dwordx4 v224, s[64:67], s48 offen offset:0 lds
    buffer_load_dwordx4 v225, s[64:67], s48 offen offset:1024 lds
    buffer_load_dwordx4 v226, s[64:67], s48 offen offset:2048 lds
    buffer_load_dwordx4 v227, s[64:67], s48 offen offset:3072 lds
    s_add_u32 s48, s57, 40960
    s_mov_b32 m0, 73728
    s_nop 0
    buffer_load_dwordx4 v224, s[64:67], s48 offen offset:0 lds
    buffer_load_dwordx4 v225, s[64:67], s48 offen offset:1024 lds
    buffer_load_dwordx4 v226, s[64:67], s48 offen offset:2048 lds
    buffer_load_dwordx4 v227, s[64:67], s48 offen offset:3072 lds
    s_add_u32 s48, s57, 61440
    s_mov_b32 m0, 77824
    s_nop 0
    buffer_load_dwordx4 v224, s[64:67], s48 offen offset:0 lds
    buffer_load_dwordx4 v225, s[64:67], s48 offen offset:1024 lds
    buffer_load_dwordx4 v226, s[64:67], s48 offen offset:2048 lds
    buffer_load_dwordx4 v227, s[64:67], s48 offen offset:3072 lds
    s_waitcnt lgkmcnt(0)
    s_barrier
    s_add_u32 s57, s45, 2
    s_and_b32 s57, s57, 3
    s_add_u32 s58, s44, 0
    s_and_b32 s58, s58, 7
    s_lshl_b32 s57, s57, 3
    s_add_u32 s57, s57, s58
    s_mul_i32 s57, s57, 163840
    s_mul_i32 s58, s45, 320
    s_add_u32 s57, s57, s58
    s_add_u32 s48, s57, 256
    s_mov_b32 m0, 0
    s_nop 0
    buffer_load_dwordx4 v228, s[64:67], s48 offen offset:0 lds
    buffer_load_dwordx4 v229, s[64:67], s48 offen offset:1024 lds
    buffer_load_dwordx4 v230, s[64:67], s48 offen offset:2048 lds
    buffer_load_dwordx4 v231, s[64:67], s48 offen offset:3072 lds
    s_add_u32 s48, s57, 82176
    s_mov_b32 m0, 4096
    s_nop 0
    buffer_load_dwordx4 v228, s[64:67], s48 offen offset:0 lds
    buffer_load_dwordx4 v229, s[64:67], s48 offen offset:1024 lds
    buffer_load_dwordx4 v230, s[64:67], s48 offen offset:2048 lds
    buffer_load_dwordx4 v231, s[64:67], s48 offen offset:3072 lds
    s_add_u32 s57, s45, 3
    s_and_b32 s57, s57, 3
    s_add_u32 s58, s44, 0
    s_and_b32 s58, s58, 7
    s_lshl_b32 s57, s57, 3
    s_add_u32 s57, s57, s58
    s_mul_i32 s57, s57, 163840
    s_mul_i32 s58, s45, 320
    s_add_u32 s57, s57, s58
    s_add_u32 s48, s57, 256
    s_mov_b32 m0, 8192
    s_nop 0
    buffer_load_dwordx4 v228, s[64:67], s48 offen offset:0 lds
    buffer_load_dwordx4 v229, s[64:67], s48 offen offset:1024 lds
    buffer_load_dwordx4 v230, s[64:67], s48 offen offset:2048 lds
    buffer_load_dwordx4 v231, s[64:67], s48 offen offset:3072 lds
    s_add_u32 s48, s57, 82176
    s_mov_b32 m0, 12288
    s_nop 0
    buffer_load_dwordx4 v228, s[64:67], s48 offen offset:0 lds
    buffer_load_dwordx4 v229, s[64:67], s48 offen offset:1024 lds
    buffer_load_dwordx4 v230, s[64:67], s48 offen offset:2048 lds
    buffer_load_dwordx4 v231, s[64:67], s48 offen offset:3072 lds
    s_waitcnt vmcnt(48)
    s_barrier
    s_lshl_b32 s47, s42, 2
    s_add_u32 s47, s47, s45
    s_mul_i32 s47, s47, 327680
    s_lshr_b32 s48, s44, 1
    s_mul_i32 s48, s48, 10240
    s_add_u32 s47, s47, s48
    s_and_b32 s48, s44, 1
    s_lshl_b32 s48, s48, 8
    s_add_u32 s47, s47, s48
    s_add_u32 s47, s47, 8388608
    v_lshrrev_b32 v20, 5, v1
    v_bfe_u32 v21, v1, 4, 1
    v_and_b32 v22, 15, v1
    v_lshlrev_b32 v23, 4, v22
    v_lshl_add_u32 v23, v20, 9, v23
    v_lshl_add_u32 v23, v21, 10, v23
    v_add_u32 v25, 0x1000, v23
    v_mul_u32_u24 v24, 1280, v22
    v_lshl_add_u32 v24, v21, 5, v24
    v_lshl_add_u32 v24, v20, 4, v24
    s_lshl_b32 s56, s42, 7
    s_lshl_b32 s54, s44, 4
    s_add_u32 s56, s56, s54
    s_mul_i32 s56, s56, 1280
    s_mul_i32 s54, s45, 320
    s_add_u32 s56, s56, s54
    s_lshl_b32 s54, s42, 5
    s_lshl_b32 s58, s45, 3
    s_add_u32 s54, s54, s58
    s_and_b32 s58, s44, 6
    s_add_u32 s54, s54, s58
    s_lshl_b32 s54, s54, 8
    s_add_u32 s54, s54, 50331776
    v_lshlrev_b32 v19, 2, v1
    v_mov_b32 v128, 0
    v_mov_b32 v129, 0
    v_mov_b32 v130, 0
    v_mov_b32 v131, 0
    v_mov_b32 v132, 0
    v_mov_b32 v133, 0
    v_mov_b32 v134, 0
    v_mov_b32 v135, 0
    v_mov_b32 v136, 0
    v_mov_b32 v137, 0
    v_mov_b32 v138, 0
    v_mov_b32 v139, 0
    v_mov_b32 v140, 0
    v_mov_b32 v141, 0
    v_mov_b32 v142, 0
    v_mov_b32 v143, 0
    v_mov_b32 v144, 0
    v_mov_b32 v145, 0
    v_mov_b32 v146, 0
    v_mov_b32 v147, 0
    v_mov_b32 v148, 0
    v_mov_b32 v149, 0
    v_mov_b32 v150, 0
    v_mov_b32 v151, 0
    s_mov_b32 s58, 0
    s_mov_b32 s62, 0
    s_mov_b32 s57, 0
    s_waitcnt vmcnt(0)
    s_barrier
    s_sleep 40
    s_mov_b64 exec, 0xff
    buffer_load_dword v16, v19, s[36:39], s54 offen sc1
L_rsa2:
    s_sleep 3
    buffer_load_dword v17, v19, s[36:39], s54 offen sc1
    s_waitcnt vmcnt(1)
    v_cmp_eq_u32 vcc, 1, v16
    s_add_u32 s57, s57, 1
    s_andn2_b32 s59, vcc_lo, s58
    s_cbranch_scc1 L_rha2
L_rs2a2:
    s_sleep 3
    buffer_load_dword v16, v19, s[36:39], s54 offen sc1
    s_waitcnt vmcnt(1)
    v_cmp_eq_u32 vcc, 1, v17
    s_add_u32 s57, s57, 1
    s_andn2_b32 s59, vcc_lo, s58
    s_cbranch_scc1 L_rha2
    s_cmp_lt_u32 s57, 0x40000
    s_cbranch_scc1 L_rsa2
    s_andn2_b32 s59, 0xff, s58
L_rha2:
    s_mov_b64 exec, -1
    s_bitcmp1_b32 s59, 0
    s_cbranch_scc0 L_rla2_0
    s_add_u32 s48, s47, 0
    buffer_load_dwordx4 v[32:35], v23, s[36:39], s48 offen offset:0 sc1
    buffer_load_dwordx4 v[36:39], v23, s[36:39], s48 offen offset:2048 sc1
    buffer_load_dwordx4 v[40:43], v25, s[36:39], s48 offen offset:0 sc1
L_rla2_0:
    s_bitcmp1_b32 s59, 1
    s_cbranch_scc0 L_rla2_1
    s_add_u32 s48, s47, 40960
    buffer_load_dwordx4 v[44:47], v23, s[36:39], s48 offen offset:0 sc1
    buffer_load_dwordx4 v[48:51], v23, s[36:39], s48 offen offset:2048 sc1
    buffer_load_dwordx4 v[52:55], v25, s[36:39], s48 offen offset:0 sc1
L_rla2_1:
    s_bitcmp1_b32 s59, 2
    s_cbranch_scc0 L_rla2_2
    s_add_u32 s48, s47, 81920
    buffer_load_dwordx4 v[56:59], v23, s[36:39], s48 offen offset:0 sc1
    buffer_load_dwordx4 v[60:63], v23, s[36:39], s48 offen offset:2048 sc1
    buffer_load_dwordx4 v[64:67], v25, s[36:39], s48 offen offset:0 sc1
L_rla2_2:
    s_bitcmp1_b32 s59, 3
    s_cbranch_scc0 L_rla2_3
    s_add_u32 s48, s47, 122880
    buffer_load_dwordx4 v[68:71], v23, s[36:39], s48 offen offset:0 sc1
    buffer_load_dwordx4 v[72:75], v23, s[36:39], s48 offen offset:2048 sc1
    buffer_load_dwordx4 v[76:79], v25, s[36:39], s48 offen offset:0 sc1
L_rla2_3:
    s_bitcmp1_b32 s59, 4
    s_cbranch_scc0 L_rla2_4
    s_add_u32 s48, s47, 163840
    buffer_load_dwordx4 v[80:83], v23, s[36:39], s48 offen offset:0 sc1
    buffer_load_dwordx4 v[84:87], v23, s[36:39], s48 offen offset:2048 sc1
    buffer_load_dwordx4 v[88:91], v25, s[36:39], s48 offen offset:0 sc1
L_rla2_4:
    s_bitcmp1_b32 s59, 5
    s_cbranch_scc0 L_rla2_5
    s_add_u32 s48, s47, 204800
    buffer_load_dwordx4 v[92:95], v23, s[36:39], s48 offen offset:0 sc1
    buffer_load_dwordx4 v[96:99], v23, s[36:39], s48 offen offset:2048 sc1
    buffer_load_dwordx4 v[100:103], v25, s[36:39], s48 offen offset:0 sc1
L_rla2_5:
    s_bitcmp1_b32 s59, 6
    s_cbranch_scc0 L_rla2_6
    s_add_u32 s48, s47, 245760
    buffer_load_dwordx4 v[104:107], v23, s[36:39], s48 offen offset:0 sc1
    buffer_load_dwordx4 v[108:111], v23, s[36:39], s48 offen offset:2048 sc1
    buffer_load_dwordx4 v[112:115], v25, s[36:39], s48 offen offset:0 sc1
L_rla2_6:
    s_bitcmp1_b32 s59, 7
    s_cbranch_scc0 L_rla2_7
    s_add_u32 s48, s47, 286720
    buffer_load_dwordx4 v[116:119], v23, s[36:39], s48 offen offset:0 sc1
    buffer_load_dwordx4 v[120:123], v23, s[36:39], s48 offen offset:2048 sc1
    buffer_load_dwordx4 v[124:127], v25, s[36:39], s48 offen offset:0 sc1
L_rla2_7:
    s_or_b32 s58, s58, s59
    s_mov_b64 exec, 0xff
    buffer_load_dword v16, v19, s[36:39], s54 offen sc1
    s_mov_b64 exec, -1
    s_bitcmp1_b32 s62, 0
    s_cbranch_scc0 L_rba2_0
    v_lshlrev_b32 v160, 16, v32
    v_and_b32 v161, 0xffff0000, v32
    v_add_f32 v128, v128, v160
    v_add_f32 v129, v129, v161
    v_lshlrev_b32 v162, 16, v33
    v_and_b32 v163, 0xffff0000, v33
    v_add_f32 v130, v130, v162
    v_add_f32 v131, v131, v163
    v_lshlrev_b32 v160, 16, v34
    v_and_b32 v161, 0xffff0000, v34
    v_add_f32 v132, v132, v160
    v_add_f32 v133, v133, v161
    v_lshlrev_b32 v162, 16, v35
    v_and_b32 v163, 0xffff0000, v35
    v_add_f32 v134, v134, v162
    v_add_f32 v135, v135, v163
    v_lshlrev_b32 v160, 16, v36
    v_and_b32 v161, 0xffff0000, v36
    v_add_f32 v136, v136, v160
    v_add_f32 v137, v137, v161
    v_lshlrev_b32 v162, 16, v37
    v_and_b32 v163, 0xffff0000, v37
    v_add_f32 v138, v138, v162
    v_add_f32 v139, v139, v163
    v_lshlrev_b32 v160, 16, v38
    v_and_b32 v161, 0xffff0000, v38
    v_add_f32 v140, v140, v160
    v_add_f32 v141, v141, v161
    v_lshlrev_b32 v162, 16, v39
    v_and_b32 v163, 0xffff0000, v39
    v_add_f32 v142, v142, v162
    v_add_f32 v143, v143, v163
    v_lshlrev_b32 v160, 16, v40
    v_and_b32 v161, 0xffff0000, v40
    v_add_f32 v144, v144, v160
    v_add_f32 v145, v145, v161
    v_lshlrev_b32 v162, 16, v41
    v_and_b32 v163, 0xffff0000, v41
    v_add_f32 v146, v146, v162
    v_add_f32 v147, v147, v163
    v_lshlrev_b32 v160, 16, v42
    v_and_b32 v161, 0xffff0000, v42
    v_add_f32 v148, v148, v160
    v_add_f32 v149, v149, v161
    v_lshlrev_b32 v162, 16, v43
    v_and_b32 v163, 0xffff0000, v43
    v_add_f32 v150, v150, v162
    v_add_f32 v151, v151, v163
L_rba2_0:
    s_bitcmp1_b32 s62, 1
    s_cbranch_scc0 L_rba2_1
    v_lshlrev_b32 v160, 16, v44
    v_and_b32 v161, 0xffff0000, v44
    v_add_f32 v128, v128, v160
    v_add_f32 v129, v129, v161
    v_lshlrev_b32 v162, 16, v45
    v_and_b32 v163, 0xffff0000, v45
    v_add_f32 v130, v130, v162
    v_add_f32 v131, v131, v163
    v_lshlrev_b32 v160, 16, v46
    v_and_b32 v161, 0xffff0000, v46
    v_add_f32 v132, v132, v160
    v_add_f32 v133, v133, v161
    v_lshlrev_b32 v162, 16, v47
    v_and_b32 v163, 0xffff0000, v47
    v_add_f32 v134, v134, v162
    v_add_f32 v135, v135, v163
    v_lshlrev_b32 v160, 16, v48
    v_and_b32 v161, 0xffff0000, v48
    v_add_f32 v136, v136, v160
    v_add_f32 v137, v137, v161
    v_lshlrev_b32 v162, 16, v49
    v_and_b32 v163, 0xffff0000, v49
    v_add_f32 v138, v138, v162
    v_add_f32 v139, v139, v163
    v_lshlrev_b32 v160, 16, v50
    v_and_b32 v161, 0xffff0000, v50
    v_add_f32 v140, v140, v160
    v_add_f32 v141, v141, v161
    v_lshlrev_b32 v162, 16, v51
    v_and_b32 v163, 0xffff0000, v51
    v_add_f32 v142, v142, v162
    v_add_f32 v143, v143, v163
    v_lshlrev_b32 v160, 16, v52
    v_and_b32 v161, 0xffff0000, v52
    v_add_f32 v144, v144, v160
    v_add_f32 v145, v145, v161
    v_lshlrev_b32 v162, 16, v53
    v_and_b32 v163, 0xffff0000, v53
    v_add_f32 v146, v146, v162
    v_add_f32 v147, v147, v163
    v_lshlrev_b32 v160, 16, v54
    v_and_b32 v161, 0xffff0000, v54
    v_add_f32 v148, v148, v160
    v_add_f32 v149, v149, v161
    v_lshlrev_b32 v162, 16, v55
    v_and_b32 v163, 0xffff0000, v55
    v_add_f32 v150, v150, v162
    v_add_f32 v151, v151, v163
L_rba2_1:
    s_bitcmp1_b32 s62, 2
    s_cbranch_scc0 L_rba2_2
    v_lshlrev_b32 v160, 16, v56
    v_and_b32 v161, 0xffff0000, v56
    v_add_f32 v128, v128, v160
    v_add_f32 v129, v129, v161
    v_lshlrev_b32 v162, 16, v57
    v_and_b32 v163, 0xffff0000, v57
    v_add_f32 v130, v130, v162
    v_add_f32 v131, v131, v163
    v_lshlrev_b32 v160, 16, v58
    v_and_b32 v161, 0xffff0000, v58
    v_add_f32 v132, v132, v160
    v_add_f32 v133, v133, v161
    v_lshlrev_b32 v162, 16, v59
    v_and_b32 v163, 0xffff0000, v59
    v_add_f32 v134, v134, v162
    v_add_f32 v135, v135, v163
    v_lshlrev_b32 v160, 16, v60
    v_and_b32 v161, 0xffff0000, v60
    v_add_f32 v136, v136, v160
    v_add_f32 v137, v137, v161
    v_lshlrev_b32 v162, 16, v61
    v_and_b32 v163, 0xffff0000, v61
    v_add_f32 v138, v138, v162
    v_add_f32 v139, v139, v163
    v_lshlrev_b32 v160, 16, v62
    v_and_b32 v161, 0xffff0000, v62
    v_add_f32 v140, v140, v160
    v_add_f32 v141, v141, v161
    v_lshlrev_b32 v162, 16, v63
    v_and_b32 v163, 0xffff0000, v63
    v_add_f32 v142, v142, v162
    v_add_f32 v143, v143, v163
    v_lshlrev_b32 v160, 16, v64
    v_and_b32 v161, 0xffff0000, v64
    v_add_f32 v144, v144, v160
    v_add_f32 v145, v145, v161
    v_lshlrev_b32 v162, 16, v65
    v_and_b32 v163, 0xffff0000, v65
    v_add_f32 v146, v146, v162
    v_add_f32 v147, v147, v163
    v_lshlrev_b32 v160, 16, v66
    v_and_b32 v161, 0xffff0000, v66
    v_add_f32 v148, v148, v160
    v_add_f32 v149, v149, v161
    v_lshlrev_b32 v162, 16, v67
    v_and_b32 v163, 0xffff0000, v67
    v_add_f32 v150, v150, v162
    v_add_f32 v151, v151, v163
L_rba2_2:
    s_bitcmp1_b32 s62, 3
    s_cbranch_scc0 L_rba2_3
    v_lshlrev_b32 v160, 16, v68
    v_and_b32 v161, 0xffff0000, v68
    v_add_f32 v128, v128, v160
    v_add_f32 v129, v129, v161
    v_lshlrev_b32 v162, 16, v69
    v_and_b32 v163, 0xffff0000, v69
    v_add_f32 v130, v130, v162
    v_add_f32 v131, v131, v163
    v_lshlrev_b32 v160, 16, v70
    v_and_b32 v161, 0xffff0000, v70
    v_add_f32 v132, v132, v160
    v_add_f32 v133, v133, v161
    v_lshlrev_b32 v162, 16, v71
    v_and_b32 v163, 0xffff0000, v71
    v_add_f32 v134, v134, v162
    v_add_f32 v135, v135, v163
    v_lshlrev_b32 v160, 16, v72
    v_and_b32 v161, 0xffff0000, v72
    v_add_f32 v136, v136, v160
    v_add_f32 v137, v137, v161
    v_lshlrev_b32 v162, 16, v73
    v_and_b32 v163, 0xffff0000, v73
    v_add_f32 v138, v138, v162
    v_add_f32 v139, v139, v163
    v_lshlrev_b32 v160, 16, v74
    v_and_b32 v161, 0xffff0000, v74
    v_add_f32 v140, v140, v160
    v_add_f32 v141, v141, v161
    v_lshlrev_b32 v162, 16, v75
    v_and_b32 v163, 0xffff0000, v75
    v_add_f32 v142, v142, v162
    v_add_f32 v143, v143, v163
    v_lshlrev_b32 v160, 16, v76
    v_and_b32 v161, 0xffff0000, v76
    v_add_f32 v144, v144, v160
    v_add_f32 v145, v145, v161
    v_lshlrev_b32 v162, 16, v77
    v_and_b32 v163, 0xffff0000, v77
    v_add_f32 v146, v146, v162
    v_add_f32 v147, v147, v163
    v_lshlrev_b32 v160, 16, v78
    v_and_b32 v161, 0xffff0000, v78
    v_add_f32 v148, v148, v160
    v_add_f32 v149, v149, v161
    v_lshlrev_b32 v162, 16, v79
    v_and_b32 v163, 0xffff0000, v79
    v_add_f32 v150, v150, v162
    v_add_f32 v151, v151, v163
L_rba2_3:
    s_bitcmp1_b32 s62, 4
    s_cbranch_scc0 L_rba2_4
    v_lshlrev_b32 v160, 16, v80
    v_and_b32 v161, 0xffff0000, v80
    v_add_f32 v128, v128, v160
    v_add_f32 v129, v129, v161
    v_lshlrev_b32 v162, 16, v81
    v_and_b32 v163, 0xffff0000, v81
    v_add_f32 v130, v130, v162
    v_add_f32 v131, v131, v163
    v_lshlrev_b32 v160, 16, v82
    v_and_b32 v161, 0xffff0000, v82
    v_add_f32 v132, v132, v160
    v_add_f32 v133, v133, v161
    v_lshlrev_b32 v162, 16, v83
    v_and_b32 v163, 0xffff0000, v83
    v_add_f32 v134, v134, v162
    v_add_f32 v135, v135, v163
    v_lshlrev_b32 v160, 16, v84
    v_and_b32 v161, 0xffff0000, v84
    v_add_f32 v136, v136, v160
    v_add_f32 v137, v137, v161
    v_lshlrev_b32 v162, 16, v85
    v_and_b32 v163, 0xffff0000, v85
    v_add_f32 v138, v138, v162
    v_add_f32 v139, v139, v163
    v_lshlrev_b32 v160, 16, v86
    v_and_b32 v161, 0xffff0000, v86
    v_add_f32 v140, v140, v160
    v_add_f32 v141, v141, v161
    v_lshlrev_b32 v162, 16, v87
    v_and_b32 v163, 0xffff0000, v87
    v_add_f32 v142, v142, v162
    v_add_f32 v143, v143, v163
    v_lshlrev_b32 v160, 16, v88
    v_and_b32 v161, 0xffff0000, v88
    v_add_f32 v144, v144, v160
    v_add_f32 v145, v145, v161
    v_lshlrev_b32 v162, 16, v89
    v_and_b32 v163, 0xffff0000, v89
    v_add_f32 v146, v146, v162
    v_add_f32 v147, v147, v163
    v_lshlrev_b32 v160, 16, v90
    v_and_b32 v161, 0xffff0000, v90
    v_add_f32 v148, v148, v160
    v_add_f32 v149, v149, v161
    v_lshlrev_b32 v162, 16, v91
    v_and_b32 v163, 0xffff0000, v91
    v_add_f32 v150, v150, v162
    v_add_f32 v151, v151, v163
L_rba2_4:
    s_bitcmp1_b32 s62, 5
    s_cbranch_scc0 L_rba2_5
    v_lshlrev_b32 v160, 16, v92
    v_and_b32 v161, 0xffff0000, v92
    v_add_f32 v128, v128, v160
    v_add_f32 v129, v129, v161
    v_lshlrev_b32 v162, 16, v93
    v_and_b32 v163, 0xffff0000, v93
    v_add_f32 v130, v130, v162
    v_add_f32 v131, v131, v163
    v_lshlrev_b32 v160, 16, v94
    v_and_b32 v161, 0xffff0000, v94
    v_add_f32 v132, v132, v160
    v_add_f32 v133, v133, v161
    v_lshlrev_b32 v162, 16, v95
    v_and_b32 v163, 0xffff0000, v95
    v_add_f32 v134, v134, v162
    v_add_f32 v135, v135, v163
    v_lshlrev_b32 v160, 16, v96
    v_and_b32 v161, 0xffff0000, v96
    v_add_f32 v136, v136, v160
    v_add_f32 v137, v137, v161
    v_lshlrev_b32 v162, 16, v97
    v_and_b32 v163, 0xffff0000, v97
    v_add_f32 v138, v138, v162
    v_add_f32 v139, v139, v163
    v_lshlrev_b32 v160, 16, v98
    v_and_b32 v161, 0xffff0000, v98
    v_add_f32 v140, v140, v160
    v_add_f32 v141, v141, v161
    v_lshlrev_b32 v162, 16, v99
    v_and_b32 v163, 0xffff0000, v99
    v_add_f32 v142, v142, v162
    v_add_f32 v143, v143, v163
    v_lshlrev_b32 v160, 16, v100
    v_and_b32 v161, 0xffff0000, v100
    v_add_f32 v144, v144, v160
    v_add_f32 v145, v145, v161
    v_lshlrev_b32 v162, 16, v101
    v_and_b32 v163, 0xffff0000, v101
    v_add_f32 v146, v146, v162
    v_add_f32 v147, v147, v163
    v_lshlrev_b32 v160, 16, v102
    v_and_b32 v161, 0xffff0000, v102
    v_add_f32 v148, v148, v160
    v_add_f32 v149, v149, v161
    v_lshlrev_b32 v162, 16, v103
    v_and_b32 v163, 0xffff0000, v103
    v_add_f32 v150, v150, v162
    v_add_f32 v151, v151, v163
L_rba2_5:
    s_bitcmp1_b32 s62, 6
    s_cbranch_scc0 L_rba2_6
    v_lshlrev_b32 v160, 16, v104
    v_and_b32 v161, 0xffff0000, v104
    v_add_f32 v128, v128, v160
    v_add_f32 v129, v129, v161
    v_lshlrev_b32 v162, 16, v105
    v_and_b32 v163, 0xffff0000, v105
    v_add_f32 v130, v130, v162
    v_add_f32 v131, v131, v163
    v_lshlrev_b32 v160, 16, v106
    v_and_b32 v161, 0xffff0000, v106
    v_add_f32 v132, v132, v160
    v_add_f32 v133, v133, v161
    v_lshlrev_b32 v162, 16, v107
    v_and_b32 v163, 0xffff0000, v107
    v_add_f32 v134, v134, v162
    v_add_f32 v135, v135, v163
    v_lshlrev_b32 v160, 16, v108
    v_and_b32 v161, 0xffff0000, v108
    v_add_f32 v136, v136, v160
    v_add_f32 v137, v137, v161
    v_lshlrev_b32 v162, 16, v109
    v_and_b32 v163, 0xffff0000, v109
    v_add_f32 v138, v138, v162
    v_add_f32 v139, v139, v163
    v_lshlrev_b32 v160, 16, v110
    v_and_b32 v161, 0xffff0000, v110
    v_add_f32 v140, v140, v160
    v_add_f32 v141, v141, v161
    v_lshlrev_b32 v162, 16, v111
    v_and_b32 v163, 0xffff0000, v111
    v_add_f32 v142, v142, v162
    v_add_f32 v143, v143, v163
    v_lshlrev_b32 v160, 16, v112
    v_and_b32 v161, 0xffff0000, v112
    v_add_f32 v144, v144, v160
    v_add_f32 v145, v145, v161
    v_lshlrev_b32 v162, 16, v113
    v_and_b32 v163, 0xffff0000, v113
    v_add_f32 v146, v146, v162
    v_add_f32 v147, v147, v163
    v_lshlrev_b32 v160, 16, v114
    v_and_b32 v161, 0xffff0000, v114
    v_add_f32 v148, v148, v160
    v_add_f32 v149, v149, v161
    v_lshlrev_b32 v162, 16, v115
    v_and_b32 v163, 0xffff0000, v115
    v_add_f32 v150, v150, v162
    v_add_f32 v151, v151, v163
L_rba2_6:
    s_bitcmp1_b32 s62, 7
    s_cbranch_scc0 L_rba2_7
    v_lshlrev_b32 v160, 16, v116
    v_and_b32 v161, 0xffff0000, v116
    v_add_f32 v128, v128, v160
    v_add_f32 v129, v129, v161
    v_lshlrev_b32 v162, 16, v117
    v_and_b32 v163, 0xffff0000, v117
    v_add_f32 v130, v130, v162
    v_add_f32 v131, v131, v163
    v_lshlrev_b32 v160, 16, v118
    v_and_b32 v161, 0xffff0000, v118
    v_add_f32 v132, v132, v160
    v_add_f32 v133, v133, v161
    v_lshlrev_b32 v162, 16, v119
    v_and_b32 v163, 0xffff0000, v119
    v_add_f32 v134, v134, v162
    v_add_f32 v135, v135, v163
    v_lshlrev_b32 v160, 16, v120
    v_and_b32 v161, 0xffff0000, v120
    v_add_f32 v136, v136, v160
    v_add_f32 v137, v137, v161
    v_lshlrev_b32 v162, 16, v121
    v_and_b32 v163, 0xffff0000, v121
    v_add_f32 v138, v138, v162
    v_add_f32 v139, v139, v163
    v_lshlrev_b32 v160, 16, v122
    v_and_b32 v161, 0xffff0000, v122
    v_add_f32 v140, v140, v160
    v_add_f32 v141, v141, v161
    v_lshlrev_b32 v162, 16, v123
    v_and_b32 v163, 0xffff0000, v123
    v_add_f32 v142, v142, v162
    v_add_f32 v143, v143, v163
    v_lshlrev_b32 v160, 16, v124
    v_and_b32 v161, 0xffff0000, v124
    v_add_f32 v144, v144, v160
    v_add_f32 v145, v145, v161
    v_lshlrev_b32 v162, 16, v125
    v_and_b32 v163, 0xffff0000, v125
    v_add_f32 v146, v146, v162
    v_add_f32 v147, v147, v163
    v_lshlrev_b32 v160, 16, v126
    v_and_b32 v161, 0xffff0000, v126
    v_add_f32 v148, v148, v160
    v_add_f32 v149, v149, v161
    v_lshlrev_b32 v162, 16, v127
    v_and_b32 v163, 0xffff0000, v127
    v_add_f32 v150, v150, v162
    v_add_f32 v151, v151, v163
L_rba2_7:
    s_mov_b32 s62, s59
    s_cmp_eq_u32 s58, 0xff
    s_cbranch_scc1 L_rla2
    s_waitcnt vmcnt(0)
    v_cmp_eq_u32 vcc, 1, v16
    s_nop 0
    s_and_b32 s59, vcc_lo, 0xff
    s_andn2_b32 s59, s59, s58
    s_cbranch_scc1 L_rha2
    s_mov_b64 exec, 0xff
    buffer_load_dword v16, v19, s[36:39], s54 offen sc1
    s_mov_b64 exec, -1
L_rla2:
    s_waitcnt vmcnt(1)
    s_bitcmp1_b32 s62, 0
    s_cbranch_scc0 L_raa2_0
    v_lshlrev_b32 v160, 16, v32
    v_and_b32 v161, 0xffff0000, v32
    v_add_f32 v128, v128, v160
    v_add_f32 v129, v129, v161
    v_lshlrev_b32 v162, 16, v33
    v_and_b32 v163, 0xffff0000, v33
    v_add_f32 v130, v130, v162
    v_add_f32 v131, v131, v163
    v_lshlrev_b32 v160, 16, v34
    v_and_b32 v161, 0xffff0000, v34
    v_add_f32 v132, v132, v160
    v_add_f32 v133, v133, v161
    v_lshlrev_b32 v162, 16, v35
    v_and_b32 v163, 0xffff0000, v35
    v_add_f32 v134, v134, v162
    v_add_f32 v135, v135, v163
    v_lshlrev_b32 v160, 16, v36
    v_and_b32 v161, 0xffff0000, v36
    v_add_f32 v136, v136, v160
    v_add_f32 v137, v137, v161
    v_lshlrev_b32 v162, 16, v37
    v_and_b32 v163, 0xffff0000, v37
    v_add_f32 v138, v138, v162
    v_add_f32 v139, v139, v163
    v_lshlrev_b32 v160, 16, v38
    v_and_b32 v161, 0xffff0000, v38
    v_add_f32 v140, v140, v160
    v_add_f32 v141, v141, v161
    v_lshlrev_b32 v162, 16, v39
    v_and_b32 v163, 0xffff0000, v39
    v_add_f32 v142, v142, v162
    v_add_f32 v143, v143, v163
    v_lshlrev_b32 v160, 16, v40
    v_and_b32 v161, 0xffff0000, v40
    v_add_f32 v144, v144, v160
    v_add_f32 v145, v145, v161
    v_lshlrev_b32 v162, 16, v41
    v_and_b32 v163, 0xffff0000, v41
    v_add_f32 v146, v146, v162
    v_add_f32 v147, v147, v163
    v_lshlrev_b32 v160, 16, v42
    v_and_b32 v161, 0xffff0000, v42
    v_add_f32 v148, v148, v160
    v_add_f32 v149, v149, v161
    v_lshlrev_b32 v162, 16, v43
    v_and_b32 v163, 0xffff0000, v43
    v_add_f32 v150, v150, v162
    v_add_f32 v151, v151, v163
L_raa2_0:
    s_bitcmp1_b32 s62, 1
    s_cbranch_scc0 L_raa2_1
    v_lshlrev_b32 v160, 16, v44
    v_and_b32 v161, 0xffff0000, v44
    v_add_f32 v128, v128, v160
    v_add_f32 v129, v129, v161
    v_lshlrev_b32 v162, 16, v45
    v_and_b32 v163, 0xffff0000, v45
    v_add_f32 v130, v130, v162
    v_add_f32 v131, v131, v163
    v_lshlrev_b32 v160, 16, v46
    v_and_b32 v161, 0xffff0000, v46
    v_add_f32 v132, v132, v160
    v_add_f32 v133, v133, v161
    v_lshlrev_b32 v162, 16, v47
    v_and_b32 v163, 0xffff0000, v47
    v_add_f32 v134, v134, v162
    v_add_f32 v135, v135, v163
    v_lshlrev_b32 v160, 16, v48
    v_and_b32 v161, 0xffff0000, v48
    v_add_f32 v136, v136, v160
    v_add_f32 v137, v137, v161
    v_lshlrev_b32 v162, 16, v49
    v_and_b32 v163, 0xffff0000, v49
    v_add_f32 v138, v138, v162
    v_add_f32 v139, v139, v163
    v_lshlrev_b32 v160, 16, v50
    v_and_b32 v161, 0xffff0000, v50
    v_add_f32 v140, v140, v160
    v_add_f32 v141, v141, v161
    v_lshlrev_b32 v162, 16, v51
    v_and_b32 v163, 0xffff0000, v51
    v_add_f32 v142, v142, v162
    v_add_f32 v143, v143, v163
    v_lshlrev_b32 v160, 16, v52
    v_and_b32 v161, 0xffff0000, v52
    v_add_f32 v144, v144, v160
    v_add_f32 v145, v145, v161
    v_lshlrev_b32 v162, 16, v53
    v_and_b32 v163, 0xffff0000, v53
    v_add_f32 v146, v146, v162
    v_add_f32 v147, v147, v163
    v_lshlrev_b32 v160, 16, v54
    v_and_b32 v161, 0xffff0000, v54
    v_add_f32 v148, v148, v160
    v_add_f32 v149, v149, v161
    v_lshlrev_b32 v162, 16, v55
    v_and_b32 v163, 0xffff0000, v55
    v_add_f32 v150, v150, v162
    v_add_f32 v151, v151, v163
L_raa2_1:
    s_bitcmp1_b32 s62, 2
    s_cbranch_scc0 L_raa2_2
    v_lshlrev_b32 v160, 16, v56
    v_and_b32 v161, 0xffff0000, v56
    v_add_f32 v128, v128, v160
    v_add_f32 v129, v129, v161
    v_lshlrev_b32 v162, 16, v57
    v_and_b32 v163, 0xffff0000, v57
    v_add_f32 v130, v130, v162
    v_add_f32 v131, v131, v163
    v_lshlrev_b32 v160, 16, v58
    v_and_b32 v161, 0xffff0000, v58
    v_add_f32 v132, v132, v160
    v_add_f32 v133, v133, v161
    v_lshlrev_b32 v162, 16, v59
    v_and_b32 v163, 0xffff0000, v59
    v_add_f32 v134, v134, v162
    v_add_f32 v135, v135, v163
    v_lshlrev_b32 v160, 16, v60
    v_and_b32 v161, 0xffff0000, v60
    v_add_f32 v136, v136, v160
    v_add_f32 v137, v137, v161
    v_lshlrev_b32 v162, 16, v61
    v_and_b32 v163, 0xffff0000, v61
    v_add_f32 v138, v138, v162
    v_add_f32 v139, v139, v163
    v_lshlrev_b32 v160, 16, v62
    v_and_b32 v161, 0xffff0000, v62
    v_add_f32 v140, v140, v160
    v_add_f32 v141, v141, v161
    v_lshlrev_b32 v162, 16, v63
    v_and_b32 v163, 0xffff0000, v63
    v_add_f32 v142, v142, v162
    v_add_f32 v143, v143, v163
    v_lshlrev_b32 v160, 16, v64
    v_and_b32 v161, 0xffff0000, v64
    v_add_f32 v144, v144, v160
    v_add_f32 v145, v145, v161
    v_lshlrev_b32 v162, 16, v65
    v_and_b32 v163, 0xffff0000, v65
    v_add_f32 v146, v146, v162
    v_add_f32 v147, v147, v163
    v_lshlrev_b32 v160, 16, v66
    v_and_b32 v161, 0xffff0000, v66
    v_add_f32 v148, v148, v160
    v_add_f32 v149, v149, v161
    v_lshlrev_b32 v162, 16, v67
    v_and_b32 v163, 0xffff0000, v67
    v_add_f32 v150, v150, v162
    v_add_f32 v151, v151, v163
L_raa2_2:
    s_bitcmp1_b32 s62, 3
    s_cbranch_scc0 L_raa2_3
    v_lshlrev_b32 v160, 16, v68
    v_and_b32 v161, 0xffff0000, v68
    v_add_f32 v128, v128, v160
    v_add_f32 v129, v129, v161
    v_lshlrev_b32 v162, 16, v69
    v_and_b32 v163, 0xffff0000, v69
    v_add_f32 v130, v130, v162
    v_add_f32 v131, v131, v163
    v_lshlrev_b32 v160, 16, v70
    v_and_b32 v161, 0xffff0000, v70
    v_add_f32 v132, v132, v160
    v_add_f32 v133, v133, v161
    v_lshlrev_b32 v162, 16, v71
    v_and_b32 v163, 0xffff0000, v71
    v_add_f32 v134, v134, v162
    v_add_f32 v135, v135, v163
    v_lshlrev_b32 v160, 16, v72
    v_and_b32 v161, 0xffff0000, v72
    v_add_f32 v136, v136, v160
    v_add_f32 v137, v137, v161
    v_lshlrev_b32 v162, 16, v73
    v_and_b32 v163, 0xffff0000, v73
    v_add_f32 v138, v138, v162
    v_add_f32 v139, v139, v163
    v_lshlrev_b32 v160, 16, v74
    v_and_b32 v161, 0xffff0000, v74
    v_add_f32 v140, v140, v160
    v_add_f32 v141, v141, v161
    v_lshlrev_b32 v162, 16, v75
    v_and_b32 v163, 0xffff0000, v75
    v_add_f32 v142, v142, v162
    v_add_f32 v143, v143, v163
    v_lshlrev_b32 v160, 16, v76
    v_and_b32 v161, 0xffff0000, v76
    v_add_f32 v144, v144, v160
    v_add_f32 v145, v145, v161
    v_lshlrev_b32 v162, 16, v77
    v_and_b32 v163, 0xffff0000, v77
    v_add_f32 v146, v146, v162
    v_add_f32 v147, v147, v163
    v_lshlrev_b32 v160, 16, v78
    v_and_b32 v161, 0xffff0000, v78
    v_add_f32 v148, v148, v160
    v_add_f32 v149, v149, v161
    v_lshlrev_b32 v162, 16, v79
    v_and_b32 v163, 0xffff0000, v79
    v_add_f32 v150, v150, v162
    v_add_f32 v151, v151, v163
L_raa2_3:
    s_bitcmp1_b32 s62, 4
    s_cbranch_scc0 L_raa2_4
    v_lshlrev_b32 v160, 16, v80
    v_and_b32 v161, 0xffff0000, v80
    v_add_f32 v128, v128, v160
    v_add_f32 v129, v129, v161
    v_lshlrev_b32 v162, 16, v81
    v_and_b32 v163, 0xffff0000, v81
    v_add_f32 v130, v130, v162
    v_add_f32 v131, v131, v163
    v_lshlrev_b32 v160, 16, v82
    v_and_b32 v161, 0xffff0000, v82
    v_add_f32 v132, v132, v160
    v_add_f32 v133, v133, v161
    v_lshlrev_b32 v162, 16, v83
    v_and_b32 v163, 0xffff0000, v83
    v_add_f32 v134, v134, v162
    v_add_f32 v135, v135, v163
    v_lshlrev_b32 v160, 16, v84
    v_and_b32 v161, 0xffff0000, v84
    v_add_f32 v136, v136, v160
    v_add_f32 v137, v137, v161
    v_lshlrev_b32 v162, 16, v85
    v_and_b32 v163, 0xffff0000, v85
    v_add_f32 v138, v138, v162
    v_add_f32 v139, v139, v163
    v_lshlrev_b32 v160, 16, v86
    v_and_b32 v161, 0xffff0000, v86
    v_add_f32 v140, v140, v160
    v_add_f32 v141, v141, v161
    v_lshlrev_b32 v162, 16, v87
    v_and_b32 v163, 0xffff0000, v87
    v_add_f32 v142, v142, v162
    v_add_f32 v143, v143, v163
    v_lshlrev_b32 v160, 16, v88
    v_and_b32 v161, 0xffff0000, v88
    v_add_f32 v144, v144, v160
    v_add_f32 v145, v145, v161
    v_lshlrev_b32 v162, 16, v89
    v_and_b32 v163, 0xffff0000, v89
    v_add_f32 v146, v146, v162
    v_add_f32 v147, v147, v163
    v_lshlrev_b32 v160, 16, v90
    v_and_b32 v161, 0xffff0000, v90
    v_add_f32 v148, v148, v160
    v_add_f32 v149, v149, v161
    v_lshlrev_b32 v162, 16, v91
    v_and_b32 v163, 0xffff0000, v91
    v_add_f32 v150, v150, v162
    v_add_f32 v151, v151, v163
L_raa2_4:
    s_bitcmp1_b32 s62, 5
    s_cbranch_scc0 L_raa2_5
    v_lshlrev_b32 v160, 16, v92
    v_and_b32 v161, 0xffff0000, v92
    v_add_f32 v128, v128, v160
    v_add_f32 v129, v129, v161
    v_lshlrev_b32 v162, 16, v93
    v_and_b32 v163, 0xffff0000, v93
    v_add_f32 v130, v130, v162
    v_add_f32 v131, v131, v163
    v_lshlrev_b32 v160, 16, v94
    v_and_b32 v161, 0xffff0000, v94
    v_add_f32 v132, v132, v160
    v_add_f32 v133, v133, v161
    v_lshlrev_b32 v162, 16, v95
    v_and_b32 v163, 0xffff0000, v95
    v_add_f32 v134, v134, v162
    v_add_f32 v135, v135, v163
    v_lshlrev_b32 v160, 16, v96
    v_and_b32 v161, 0xffff0000, v96
    v_add_f32 v136, v136, v160
    v_add_f32 v137, v137, v161
    v_lshlrev_b32 v162, 16, v97
    v_and_b32 v163, 0xffff0000, v97
    v_add_f32 v138, v138, v162
    v_add_f32 v139, v139, v163
    v_lshlrev_b32 v160, 16, v98
    v_and_b32 v161, 0xffff0000, v98
    v_add_f32 v140, v140, v160
    v_add_f32 v141, v141, v161
    v_lshlrev_b32 v162, 16, v99
    v_and_b32 v163, 0xffff0000, v99
    v_add_f32 v142, v142, v162
    v_add_f32 v143, v143, v163
    v_lshlrev_b32 v160, 16, v100
    v_and_b32 v161, 0xffff0000, v100
    v_add_f32 v144, v144, v160
    v_add_f32 v145, v145, v161
    v_lshlrev_b32 v162, 16, v101
    v_and_b32 v163, 0xffff0000, v101
    v_add_f32 v146, v146, v162
    v_add_f32 v147, v147, v163
    v_lshlrev_b32 v160, 16, v102
    v_and_b32 v161, 0xffff0000, v102
    v_add_f32 v148, v148, v160
    v_add_f32 v149, v149, v161
    v_lshlrev_b32 v162, 16, v103
    v_and_b32 v163, 0xffff0000, v103
    v_add_f32 v150, v150, v162
    v_add_f32 v151, v151, v163
L_raa2_5:
    s_bitcmp1_b32 s62, 6
    s_cbranch_scc0 L_raa2_6
    v_lshlrev_b32 v160, 16, v104
    v_and_b32 v161, 0xffff0000, v104
    v_add_f32 v128, v128, v160
    v_add_f32 v129, v129, v161
    v_lshlrev_b32 v162, 16, v105
    v_and_b32 v163, 0xffff0000, v105
    v_add_f32 v130, v130, v162
    v_add_f32 v131, v131, v163
    v_lshlrev_b32 v160, 16, v106
    v_and_b32 v161, 0xffff0000, v106
    v_add_f32 v132, v132, v160
    v_add_f32 v133, v133, v161
    v_lshlrev_b32 v162, 16, v107
    v_and_b32 v163, 0xffff0000, v107
    v_add_f32 v134, v134, v162
    v_add_f32 v135, v135, v163
    v_lshlrev_b32 v160, 16, v108
    v_and_b32 v161, 0xffff0000, v108
    v_add_f32 v136, v136, v160
    v_add_f32 v137, v137, v161
    v_lshlrev_b32 v162, 16, v109
    v_and_b32 v163, 0xffff0000, v109
    v_add_f32 v138, v138, v162
    v_add_f32 v139, v139, v163
    v_lshlrev_b32 v160, 16, v110
    v_and_b32 v161, 0xffff0000, v110
    v_add_f32 v140, v140, v160
    v_add_f32 v141, v141, v161
    v_lshlrev_b32 v162, 16, v111
    v_and_b32 v163, 0xffff0000, v111
    v_add_f32 v142, v142, v162
    v_add_f32 v143, v143, v163
    v_lshlrev_b32 v160, 16, v112
    v_and_b32 v161, 0xffff0000, v112
    v_add_f32 v144, v144, v160
    v_add_f32 v145, v145, v161
    v_lshlrev_b32 v162, 16, v113
    v_and_b32 v163, 0xffff0000, v113
    v_add_f32 v146, v146, v162
    v_add_f32 v147, v147, v163
    v_lshlrev_b32 v160, 16, v114
    v_and_b32 v161, 0xffff0000, v114
    v_add_f32 v148, v148, v160
    v_add_f32 v149, v149, v161
    v_lshlrev_b32 v162, 16, v115
    v_and_b32 v163, 0xffff0000, v115
    v_add_f32 v150, v150, v162
    v_add_f32 v151, v151, v163
L_raa2_6:
    s_bitcmp1_b32 s62, 7
    s_cbranch_scc0 L_raa2_7
    v_lshlrev_b32 v160, 16, v116
    v_and_b32 v161, 0xffff0000, v116
    v_add_f32 v128, v128, v160
    v_add_f32 v129, v129, v161
    v_lshlrev_b32 v162, 16, v117
    v_and_b32 v163, 0xffff0000, v117
    v_add_f32 v130, v130, v162
    v_add_f32 v131, v131, v163
    v_lshlrev_b32 v160, 16, v118
    v_and_b32 v161, 0xffff0000, v118
    v_add_f32 v132, v132, v160
    v_add_f32 v133, v133, v161
    v_lshlrev_b32 v162, 16, v119
    v_and_b32 v163, 0xffff0000, v119
    v_add_f32 v134, v134, v162
    v_add_f32 v135, v135, v163
    v_lshlrev_b32 v160, 16, v120
    v_and_b32 v161, 0xffff0000, v120
    v_add_f32 v136, v136, v160
    v_add_f32 v137, v137, v161
    v_lshlrev_b32 v162, 16, v121
    v_and_b32 v163, 0xffff0000, v121
    v_add_f32 v138, v138, v162
    v_add_f32 v139, v139, v163
    v_lshlrev_b32 v160, 16, v122
    v_and_b32 v161, 0xffff0000, v122
    v_add_f32 v140, v140, v160
    v_add_f32 v141, v141, v161
    v_lshlrev_b32 v162, 16, v123
    v_and_b32 v163, 0xffff0000, v123
    v_add_f32 v142, v142, v162
    v_add_f32 v143, v143, v163
    v_lshlrev_b32 v160, 16, v124
    v_and_b32 v161, 0xffff0000, v124
    v_add_f32 v144, v144, v160
    v_add_f32 v145, v145, v161
    v_lshlrev_b32 v162, 16, v125
    v_and_b32 v163, 0xffff0000, v125
    v_add_f32 v146, v146, v162
    v_add_f32 v147, v147, v163
    v_lshlrev_b32 v160, 16, v126
    v_and_b32 v161, 0xffff0000, v126
    v_add_f32 v148, v148, v160
    v_add_f32 v149, v149, v161
    v_lshlrev_b32 v162, 16, v127
    v_and_b32 v163, 0xffff0000, v127
    v_add_f32 v150, v150, v162
    v_add_f32 v151, v151, v163
L_raa2_7:
    s_mov_b32 s62, 0
    s_mov_b64 exec, 0xff
    s_cmp_eq_u32 s58, 0xff
    s_cbranch_scc1 L_rfa2
    buffer_load_dword v17, v19, s[36:39], s54 offen sc1
    s_waitcnt vmcnt(1)
    v_cmp_eq_u32 vcc, 1, v16
    s_nop 0
    s_andn2_b32 s59, vcc_lo, s58
    s_cbranch_scc1 L_rha2
    s_branch L_rs2a2
L_rfa2:
    s_mov_b64 exec, -1
    v_cvt_pk_bf16_f32 v164, v128, v129
    v_cvt_pk_bf16_f32 v165, v130, v131
    v_cvt_pk_bf16_f32 v166, v132, v133
    v_cvt_pk_bf16_f32 v167, v134, v135
    v_cvt_pk_bf16_f32 v168, v136, v137
    v_cvt_pk_bf16_f32 v169, v138, v139
    v_cvt_pk_bf16_f32 v170, v140, v141
    v_cvt_pk_bf16_f32 v171, v142, v143
    v_cvt_pk_bf16_f32 v172, v144, v145
    v_cvt_pk_bf16_f32 v173, v146, v147
    v_cvt_pk_bf16_f32 v174, v148, v149
    v_cvt_pk_bf16_f32 v175, v150, v151
    s_nop 1
    v_permlane32_swap_b32 v164, v166
    v_permlane32_swap_b32 v165, v167
    v_permlane32_swap_b32 v168, v170
    v_permlane32_swap_b32 v169, v171
    v_permlane32_swap_b32 v172, v174
    v_permlane32_swap_b32 v173, v175
    s_nop 1
    buffer_store_dwordx4 v[164:167], v24, s[72:75], s56 offen offset:0
    buffer_store_dwordx4 v[168:171], v24, s[72:75], s56 offen offset:64
    buffer_store_dwordx4 v[172:175], v24, s[72:75], s56 offen offset:128
    s_endpgm
L_loader_b:
    s_lshr_b32 s56, s2, 3
    s_and_b32 s56, s56, 15
    s_lshl_b32 s55, s2, 8
    s_add_u32 s55, s55, 50331648
    v_mov_b32 v240, 0
    v_mov_b32 v241, 0
    v_mov_b32 v242, 1
    v_lshlrev_b32 v243, 2, v1
    buffer_store_dword v240, v243, s[36:39], s55 offen sc1
    s_sleep 4
    s_add_u32 s48, s43, 0
    s_mov_b32 m0, 0
    s_nop 0
    buffer_load_dwordx4 v2, s[24:27], s48 offen offset:0 nt lds
    buffer_load_dwordx4 v3, s[24:27], s48 offen offset:1024 nt lds
    buffer_load_dwordx4 v8, s[24:27], s48 offen offset:2048 nt lds
    buffer_load_dwordx4 v9, s[24:27], s48 offen offset:3072 nt lds
    s_add_u32 s48, s43, 4096
    s_mov_b32 m0, 4096
    s_nop 0
    buffer_load_dwordx4 v2, s[24:27], s48 offen offset:0 nt lds
    buffer_load_dwordx4 v3, s[24:27], s48 offen offset:1024 nt lds
    buffer_load_dwordx4 v8, s[24:27], s48 offen offset:2048 nt lds
    buffer_load_dwordx4 v9, s[24:27], s48 offen offset:3072 nt lds
    s_sleep 8
    s_add_u32 s48, s43, 8192
    s_mov_b32 m0, 8192
    s_nop 0
    buffer_load_dwordx4 v2, s[24:27], s48 offen offset:0 nt lds
    buffer_load_dwordx4 v3, s[24:27], s48 offen offset:1024 nt lds
    buffer_load_dwordx4 v8, s[24:27], s48 offen offset:2048 nt lds
    buffer_load_dwordx4 v9, s[24:27], s48 offen offset:3072 nt lds
    s_add_u32 s48, s43, 12288
    s_mov_b32 m0, 12288
    s_nop 0
    buffer_load_dwordx4 v2, s[24:27], s48 offen offset:0 nt lds
    buffer_load_dwordx4 v3, s[24:27], s48 offen offset:1024 nt lds
    buffer_load_dwordx4 v8, s[24:27], s48 offen offset:2048 nt lds
    buffer_load_dwordx4 v9, s[24:27], s48 offen offset:3072 nt lds
    s_sleep 8
    s_add_u32 s48, s43, 0
    s_mov_b32 m0, 81920
    s_nop 0
    buffer_load_dwordx4 v10, s[28:31], s48 offen offset:0 nt lds
    buffer_load_dwordx4 v10, s[28:31], s48 offen offset:1024 nt lds
    buffer_load_dwordx4 v10, s[28:31], s48 offen offset:2048 nt lds
    buffer_load_dwordx4 v10, s[28:31], s48 offen offset:3072 nt lds
    s_add_u32 s48, s43, 4096
    s_mov_b32 m0, 86016
    s_nop 0
    buffer_load_dwordx4 v10, s[28:31], s48 offen offset:0 nt lds
    buffer_load_dwordx4 v10, s[28:31], s48 offen offset:1024 nt lds
    buffer_load_dwordx4 v10, s[28:31], s48 offen offset:2048 nt lds
    buffer_load_dwordx4 v10, s[28:31], s48 offen offset:3072 nt lds
    s_barrier
    s_add_u32 s48, s43, 8192
    s_mov_b32 m0, 90112
    s_nop 0
    buffer_load_dwordx4 v10, s[28:31], s48 offen offset:0 nt lds
    buffer_load_dwordx4 v10, s[28:31], s48 offen offset:1024 nt lds
    buffer_load_dwordx4 v10, s[28:31], s48 offen offset:2048 nt lds
    buffer_load_dwordx4 v10, s[28:31], s48 offen offset:3072 nt lds
    s_add_u32 s48, s43, 12288
    s_mov_b32 m0, 94208
    s_nop 0
    buffer_load_dwordx4 v10, s[28:31], s48 offen offset:0 nt lds
    buffer_load_dwordx4 v10, s[28:31], s48 offen offset:1024 nt lds
    buffer_load_dwordx4 v10, s[28:31], s48 offen offset:2048 nt lds
    buffer_load_dwordx4 v10, s[28:31], s48 offen offset:3072 nt lds
    s_add_u32 s48, s43, 16384
    buffer_load_dwordx4 v[16:19], v2, s[24:27], s48 offen offset:0 nt
    buffer_load_dwordx4 v[20:23], v3, s[24:27], s48 offen offset:1024 nt
    buffer_load_dwordx4 v[24:27], v8, s[24:27], s48 offen offset:2048 nt
    buffer_load_dwordx4 v[28:31], v9, s[24:27], s48 offen offset:3072 nt
    s_barrier
    s_waitcnt vmcnt(36)
    s_add_u32 s48, s43, 20480
    buffer_load_dwordx4 v[32:35], v2, s[24:27], s48 offen offset:0 nt
    buffer_load_dwordx4 v[36:39], v3, s[24:27], s48 offen offset:1024 nt
    buffer_load_dwordx4 v[40:43], v8, s[24:27], s48 offen offset:2048 nt
    buffer_load_dwordx4 v[44:47], v9, s[24:27], s48 offen offset:3072 nt
    s_add_u32 s48, s43, 24576
    buffer_load_dwordx4 v[48:51], v2, s[24:27], s48 offen offset:0 nt
    buffer_load_dwordx4 v[52:55], v3, s[24:27], s48 offen offset:1024 nt
    buffer_load_dwordx4 v[56:59], v8, s[24:27], s48 offen offset:2048 nt
    buffer_load_dwordx4 v[60:63], v9, s[24:27], s48 offen offset:3072 nt
    s_add_u32 s48, s43, 28672
    buffer_load_dwordx4 v[64:67], v2, s[24:27], s48 offen offset:0 nt
    buffer_load_dwordx4 v[68:71], v3, s[24:27], s48 offen offset:1024 nt
    buffer_load_dwordx4 v[72:75], v8, s[24:27], s48 offen offset:2048 nt
    buffer_load_dwordx4 v[76:79], v9, s[24:27], s48 offen offset:3072 nt
    s_barrier
    s_cmp_eq_u32 s56, 0
    s_cbranch_scc0 L_g2ann0
    s_mov_b64 exec, 1
    buffer_store_byte v242, v240, s[68:71], s2 offen sc1
    s_mov_b64 exec, -1
L_g2ann0:
    s_add_u32 s48, s43, 16384
    buffer_load_dwordx4 v[80:83], v10, s[28:31], s48 offen offset:0 nt
    buffer_load_dwordx4 v[84:87], v10, s[28:31], s48 offen offset:1024 nt
    buffer_load_dwordx4 v[88:91], v10, s[28:31], s48 offen offset:2048 nt
    buffer_load_dwordx4 v[92:95], v10, s[28:31], s48 offen offset:3072 nt
    s_add_u32 s48, s43, 20480
    buffer_load_dwordx4 v[96:99], v10, s[28:31], s48 offen offset:0 nt
    buffer_load_dwordx4 v[100:103], v10, s[28:31], s48 offen offset:1024 nt
    buffer_load_dwordx4 v[104:107], v10, s[28:31], s48 offen offset:2048 nt
    buffer_load_dwordx4 v[108:111], v10, s[28:31], s48 offen offset:3072 nt
    s_add_u32 s48, s43, 24576
    buffer_load_dwordx4 v[112:115], v10, s[28:31], s48 offen offset:0 nt
    buffer_load_dwordx4 v[116:119], v10, s[28:31], s48 offen offset:1024 nt
    buffer_load_dwordx4 v[120:123], v10, s[28:31], s48 offen offset:2048 nt
    buffer_load_dwordx4 v[124:127], v10, s[28:31], s48 offen offset:3072 nt
    s_barrier
    s_cmp_eq_u32 s56, 1
    s_cbranch_scc0 L_g2ann1
    s_mov_b64 exec, 1
    buffer_store_byte v242, v240, s[68:71], s2 offen sc1
    s_mov_b64 exec, -1
L_g2ann1:
    s_add_u32 s48, s43, 28672
    buffer_load_dwordx4 v[128:131], v10, s[28:31], s48 offen offset:0 nt
    buffer_load_dwordx4 v[132:135], v10, s[28:31], s48 offen offset:1024 nt
    buffer_load_dwordx4 v[136:139], v10, s[28:31], s48 offen offset:2048 nt
    buffer_load_dwordx4 v[140:143], v10, s[28:31], s48 offen offset:3072 nt
    s_add_u32 s48, s43, 32768
    buffer_load_dwordx4 v[144:147], v2, s[24:27], s48 offen offset:0 nt
    buffer_load_dwordx4 v[148:151], v3, s[24:27], s48 offen offset:1024 nt
    buffer_load_dwordx4 v[152:155], v8, s[24:27], s48 offen offset:2048 nt
    buffer_load_dwordx4 v[156:159], v9, s[24:27], s48 offen offset:3072 nt
    s_add_u32 s48, s43, 36864
    buffer_load_dwordx4 v[160:163], v2, s[24:27], s48 offen offset:0 nt
    buffer_load_dwordx4 v[164:167], v3, s[24:27], s48 offen offset:1024 nt
    buffer_load_dwordx4 v[168:171], v8, s[24:27], s48 offen offset:2048 nt
    buffer_load_dwordx4 v[172:175], v9, s[24:27], s48 offen offset:3072 nt
    s_barrier
    s_cmp_eq_u32 s56, 2
    s_cbranch_scc0 L_g2ann2
    s_mov_b64 exec, 1
    buffer_store_byte v242, v240, s[68:71], s2 offen sc1
    s_mov_b64 exec, -1
L_g2ann2:
    s_add_u32 s48, s43, 40960
    buffer_load_dwordx4 v[176:179], v2, s[24:27], s48 offen offset:0 nt
    buffer_load_dwordx4 v[180:183], v3, s[24:27], s48 offen offset:1024 nt
    buffer_load_dwordx4 v[184:187], v8, s[24:27], s48 offen offset:2048 nt
    buffer_load_dwordx4 v[188:191], v9, s[24:27], s48 offen offset:3072 nt
    s_add_u32 s48, s43, 45056
    buffer_load_dwordx4 v[192:195], v2, s[24:27], s48 offen offset:0 nt
    buffer_load_dwordx4 v[196:199], v3, s[24:27], s48 offen offset:1024 nt
    buffer_load_dwordx4 v[200:203], v8, s[24:27], s48 offen offset:2048 nt
    buffer_load_dwordx4 v[204:207], v9, s[24:27], s48 offen offset:3072 nt
    s_barrier
    s_cmp_eq_u32 s56, 3
    s_cbranch_scc0 L_g2ann3
    s_mov_b64 exec, 1
    buffer_store_byte v242, v240, s[68:71], s2 offen sc1
    s_mov_b64 exec, -1
L_g2ann3:
    s_barrier
    s_cmp_eq_u32 s56, 4
    s_cbranch_scc0 L_g2ann4
    s_mov_b64 exec, 1
    buffer_store_byte v242, v240, s[68:71], s2 offen sc1
    s_mov_b64 exec, -1
L_g2ann4:
    s_barrier
    s_cmp_eq_u32 s56, 5
    s_cbranch_scc0 L_g2ann5
    s_mov_b64 exec, 1
    buffer_store_byte v242, v240, s[68:71], s2 offen sc1
    s_mov_b64 exec, -1
L_g2ann5:
    s_barrier
    s_cmp_eq_u32 s56, 6
    s_cbranch_scc0 L_g2ann6
    s_mov_b64 exec, 1
    buffer_store_byte v242, v240, s[68:71], s2 offen sc1
    s_mov_b64 exec, -1
L_g2ann6:
    s_waitcnt vmcnt(32)
    ds_write_b128 v232, v[16:19] offset:16384
    ds_write_b128 v232, v[20:23] offset:17408
    ds_write_b128 v232, v[24:27] offset:18432
    ds_write_b128 v232, v[28:31] offset:19456
    ds_write_b128 v232, v[32:35] offset:20480
    ds_write_b128 v232, v[36:39] offset:21504
    ds_write_b128 v232, v[40:43] offset:22528
    ds_write_b128 v232, v[44:47] offset:23552
    ds_write_b128 v232, v[48:51] offset:24576
    ds_write_b128 v232, v[52:55] offset:25600
    ds_write_b128 v232, v[56:59] offset:26624
    ds_write_b128 v232, v[60:63] offset:27648
    ds_write_b128 v232, v[64:67] offset:28672
    ds_write_b128 v232, v[68:71] offset:29696
    ds_write_b128 v232, v[72:75] offset:30720
    ds_write_b128 v232, v[76:79] offset:31744
    s_barrier
    s_cmp_eq_u32 s56, 7
    s_cbranch_scc0 L_g2ann7
    s_mov_b64 exec, 1
    buffer_store_byte v242, v240, s[68:71], s2 offen sc1
    s_mov_b64 exec, -1
L_g2ann7:
    s_waitcnt lgkmcnt(0)
    s_add_u32 s48, s43, 65536
    buffer_load_dwordx4 v[16:19], v2, s[24:27], s48 offen offset:0 nt
    buffer_load_dwordx4 v[20:23], v3, s[24:27], s48 offen offset:1024 nt
    buffer_load_dwordx4 v[24:27], v8, s[24:27], s48 offen offset:2048 nt
    buffer_load_dwordx4 v[28:31], v9, s[24:27], s48 offen offset:3072 nt
    s_add_u32 s48, s43, 69632
    buffer_load_dwordx4 v[32:35], v2, s[24:27], s48 offen offset:0 nt
    buffer_load_dwordx4 v[36:39], v3, s[24:27], s48 offen offset:1024 nt
    buffer_load_dwordx4 v[40:43], v8, s[24:27], s48 offen offset:2048 nt
    buffer_load_dwordx4 v[44:47], v9, s[24:27], s48 offen offset:3072 nt
    s_add_u32 s48, s43, 73728
    buffer_load_dwordx4 v[48:51], v2, s[24:27], s48 offen offset:0 nt
    buffer_load_dwordx4 v[52:55], v3, s[24:27], s48 offen offset:1024 nt
    buffer_load_dwordx4 v[56:59], v8, s[24:27], s48 offen offset:2048 nt
    buffer_load_dwordx4 v[60:63], v9, s[24:27], s48 offen offset:3072 nt
    s_add_u32 s48, s43, 77824
    buffer_load_dwordx4 v[64:67], v2, s[24:27], s48 offen offset:0 nt
    buffer_load_dwordx4 v[68:71], v3, s[24:27], s48 offen offset:1024 nt
    buffer_load_dwordx4 v[72:75], v8, s[24:27], s48 offen offset:2048 nt
    buffer_load_dwordx4 v[76:79], v9, s[24:27], s48 offen offset:3072 nt
    s_waitcnt vmcnt(32)
    ds_write_b128 v233, v[80:83] offset:32768
    ds_write_b128 v233, v[84:87] offset:33792
    ds_write_b128 v233, v[88:91] offset:34816
    ds_write_b128 v233, v[92:95] offset:35840
    ds_write_b128 v233, v[96:99] offset:36864
    ds_write_b128 v233, v[100:103] offset:37888
    ds_write_b128 v233, v[104:107] offset:38912
    ds_write_b128 v233, v[108:111] offset:39936
    ds_write_b128 v233, v[112:115] offset:40960
    ds_write_b128 v233, v[116:119] offset:41984
    ds_write_b128 v233, v[120:123] offset:43008
    ds_write_b128 v233, v[124:127] offset:44032
    ds_write_b128 v233, v[128:131] offset:45056
    ds_write_b128 v233, v[132:135] offset:46080
    ds_write_b128 v233, v[136:139] offset:47104
    ds_write_b128 v233, v[140:143] offset:48128
    s_barrier
    s_cmp_eq_u32 s56, 8
    s_cbranch_scc0 L_g2ann8
    s_mov_b64 exec, 1
    buffer_store_byte v242, v240, s[68:71], s2 offen sc1
    s_mov_b64 exec, -1
L_g2ann8:
    s_add_u32 s48, s43, 65536
    s_mov_b32 m0, 147456
    s_nop 0
    buffer_load_dwordx4 v10, s[28:31], s48 offen offset:0 nt lds
    buffer_load_dwordx4 v10, s[28:31], s48 offen offset:1024 nt lds
    buffer_load_dwordx4 v10, s[28:31], s48 offen offset:2048 nt lds
    buffer_load_dwordx4 v10, s[28:31], s48 offen offset:3072 nt lds
    s_add_u32 s48, s43, 69632
    s_mov_b32 m0, 151552
    s_nop 0
    buffer_load_dwordx4 v10, s[28:31], s48 offen offset:0 nt lds
    buffer_load_dwordx4 v10, s[28:31], s48 offen offset:1024 nt lds
    buffer_load_dwordx4 v10, s[28:31], s48 offen offset:2048 nt lds
    buffer_load_dwordx4 v10, s[28:31], s48 offen offset:3072 nt lds
    s_add_u32 s48, s43, 73728
    s_mov_b32 m0, 155648
    s_nop 0
    buffer_load_dwordx4 v10, s[28:31], s48 offen offset:0 nt lds
    buffer_load_dwordx4 v10, s[28:31], s48 offen offset:1024 nt lds
    buffer_load_dwordx4 v10, s[28:31], s48 offen offset:2048 nt lds
    buffer_load_dwordx4 v10, s[28:31], s48 offen offset:3072 nt lds
    s_add_u32 s48, s43, 77824
    s_mov_b32 m0, 159744
    s_nop 0
    buffer_load_dwordx4 v10, s[28:31], s48 offen offset:0 nt lds
    buffer_load_dwordx4 v10, s[28:31], s48 offen offset:1024 nt lds
    buffer_load_dwordx4 v10, s[28:31], s48 offen offset:2048 nt lds
    buffer_load_dwordx4 v10, s[28:31], s48 offen offset:3072 nt lds
    s_waitcnt vmcnt(32)
    ds_write_b128 v232, v[144:147] offset:32768
    ds_write_b128 v232, v[148:151] offset:33792
    ds_write_b128 v232, v[152:155] offset:34816
    ds_write_b128 v232, v[156:159] offset:35840
    ds_write_b128 v232, v[160:163] offset:36864
    ds_write_b128 v232, v[164:167] offset:37888
    ds_write_b128 v232, v[168:171] offset:38912
    ds_write_b128 v232, v[172:175] offset:39936
    ds_write_b128 v232, v[176:179] offset:40960
    ds_write_b128 v232, v[180:183] offset:41984
    ds_write_b128 v232, v[184:187] offset:43008
    ds_write_b128 v232, v[188:191] offset:44032
    ds_write_b128 v232, v[192:195] offset:45056
    ds_write_b128 v232, v[196:199] offset:46080
    ds_write_b128 v232, v[200:203] offset:47104
    ds_write_b128 v232, v[204:207] offset:48128
    s_waitcnt lgkmcnt(0)
    s_barrier
    s_cmp_eq_u32 s56, 9
    s_cbranch_scc0 L_g2ann9
    s_mov_b64 exec, 1
    buffer_store_byte v242, v240, s[68:71], s2 offen sc1
    s_mov_b64 exec, -1
L_g2ann9:
    s_waitcnt lgkmcnt(0)
    s_barrier
    s_cmp_eq_u32 s56, 10
    s_cbranch_scc0 L_g2ann10
    s_mov_b64 exec, 1
    buffer_store_byte v242, v240, s[68:71], s2 offen sc1
    s_mov_b64 exec, -1
L_g2ann10:
    s_add_u32 s48, s43, 81920
    s_mov_b32 m0, 81920
    s_nop 0
    buffer_load_dwordx4 v10, s[28:31], s48 offen offset:0 nt lds
    buffer_load_dwordx4 v10, s[28:31], s48 offen offset:1024 nt lds
    buffer_load_dwordx4 v10, s[28:31], s48 offen offset:2048 nt lds
    buffer_load_dwordx4 v10, s[28:31], s48 offen offset:3072 nt lds
    s_add_u32 s48, s43, 86016
    s_mov_b32 m0, 86016
    s_nop 0
    buffer_load_dwordx4 v10, s[28:31], s48 offen offset:0 nt lds
    buffer_load_dwordx4 v10, s[28:31], s48 offen offset:1024 nt lds
    buffer_load_dwordx4 v10, s[28:31], s48 offen offset:2048 nt lds
    buffer_load_dwordx4 v10, s[28:31], s48 offen offset:3072 nt lds
    s_add_u32 s48, s43, 90112
    s_mov_b32 m0, 90112
    s_nop 0
    buffer_load_dwordx4 v10, s[28:31], s48 offen offset:0 nt lds
    buffer_load_dwordx4 v10, s[28:31], s48 offen offset:1024 nt lds
    buffer_load_dwordx4 v10, s[28:31], s48 offen offset:2048 nt lds
    buffer_load_dwordx4 v10, s[28:31], s48 offen offset:3072 nt lds
    s_add_u32 s48, s43, 94208
    s_mov_b32 m0, 94208
    s_nop 0
    buffer_load_dwordx4 v10, s[28:31], s48 offen offset:0 nt lds
    buffer_load_dwordx4 v10, s[28:31], s48 offen offset:1024 nt lds
    buffer_load_dwordx4 v10, s[28:31], s48 offen offset:2048 nt lds
    buffer_load_dwordx4 v10, s[28:31], s48 offen offset:3072 nt lds
    s_waitcnt vmcnt(32)
    ds_write_b128 v233, v[16:19] offset:0
    ds_write_b128 v233, v[20:23] offset:1024
    ds_write_b128 v233, v[24:27] offset:2048
    ds_write_b128 v233, v[28:31] offset:3072
    ds_write_b128 v233, v[32:35] offset:4096
    ds_write_b128 v233, v[36:39] offset:5120
    ds_write_b128 v233, v[40:43] offset:6144
    ds_write_b128 v233, v[44:47] offset:7168
    ds_write_b128 v233, v[48:51] offset:8192
    ds_write_b128 v233, v[52:55] offset:9216
    ds_write_b128 v233, v[56:59] offset:10240
    ds_write_b128 v233, v[60:63] offset:11264
    ds_write_b128 v233, v[64:67] offset:12288
    ds_write_b128 v233, v[68:71] offset:13312
    ds_write_b128 v233, v[72:75] offset:14336
    ds_write_b128 v233, v[76:79] offset:15360
    s_waitcnt lgkmcnt(0)
    s_barrier
    s_cmp_eq_u32 s56, 11
    s_cbranch_scc0 L_g2ann11
    s_mov_b64 exec, 1
    buffer_store_byte v242, v240, s[68:71], s2 offen sc1
    s_mov_b64 exec, -1
L_g2ann11:
    s_add_u32 s48, s43, 98304
    s_mov_b32 m0, 98304
    s_nop 0
    buffer_load_dwordx4 v10, s[28:31], s48 offen offset:0 nt lds
    buffer_load_dwordx4 v10, s[28:31], s48 offen offset:1024 nt lds
    buffer_load_dwordx4 v10, s[28:31], s48 offen offset:2048 nt lds
    buffer_load_dwordx4 v10, s[28:31], s48 offen offset:3072 nt lds
    s_add_u32 s48, s43, 102400
    s_mov_b32 m0, 102400
    s_nop 0
    buffer_load_dwordx4 v10, s[28:31], s48 offen offset:0 nt lds
    buffer_load_dwordx4 v10, s[28:31], s48 offen offset:1024 nt lds
    buffer_load_dwordx4 v10, s[28:31], s48 offen offset:2048 nt lds
    buffer_load_dwordx4 v10, s[28:31], s48 offen offset:3072 nt lds
    s_add_u32 s48, s43, 106496
    s_mov_b32 m0, 106496
    s_nop 0
    buffer_load_dwordx4 v10, s[28:31], s48 offen offset:0 nt lds
    buffer_load_dwordx4 v10, s[28:31], s48 offen offset:1024 nt lds
    buffer_load_dwordx4 v10, s[28:31], s48 offen offset:2048 nt lds
    buffer_load_dwordx4 v10, s[28:31], s48 offen offset:3072 nt lds
    s_add_u32 s48, s43, 110592
    s_mov_b32 m0, 110592
    s_nop 0
    buffer_load_dwordx4 v10, s[28:31], s48 offen offset:0 nt lds
    buffer_load_dwordx4 v10, s[28:31], s48 offen offset:1024 nt lds
    buffer_load_dwordx4 v10, s[28:31], s48 offen offset:2048 nt lds
    buffer_load_dwordx4 v10, s[28:31], s48 offen offset:3072 nt lds
    s_waitcnt lgkmcnt(0)
    s_barrier
    s_cmp_eq_u32 s56, 12
    s_cbranch_scc0 L_g2ann12
    s_mov_b64 exec, 1
    buffer_store_byte v242, v240, s[68:71], s2 offen sc1
    s_mov_b64 exec, -1
L_g2ann12:
    s_add_u32 s48, s43, 114688
    s_mov_b32 m0, 114688
    s_nop 0
    buffer_load_dwordx4 v10, s[28:31], s48 offen offset:0 nt lds
    buffer_load_dwordx4 v10, s[28:31], s48 offen offset:1024 nt lds
    buffer_load_dwordx4 v10, s[28:31], s48 offen offset:2048 nt lds
    buffer_load_dwordx4 v10, s[28:31], s48 offen offset:3072 nt lds
    s_add_u32 s48, s43, 118784
    s_mov_b32 m0, 118784
    s_nop 0
    buffer_load_dwordx4 v10, s[28:31], s48 offen offset:0 nt lds
    buffer_load_dwordx4 v10, s[28:31], s48 offen offset:1024 nt lds
    buffer_load_dwordx4 v10, s[28:31], s48 offen offset:2048 nt lds
    buffer_load_dwordx4 v10, s[28:31], s48 offen offset:3072 nt lds
    s_add_u32 s48, s43, 122880
    s_mov_b32 m0, 122880
    s_nop 0
    buffer_load_dwordx4 v10, s[28:31], s48 offen offset:0 nt lds
    buffer_load_dwordx4 v10, s[28:31], s48 offen offset:1024 nt lds
    buffer_load_dwordx4 v10, s[28:31], s48 offen offset:2048 nt lds
    buffer_load_dwordx4 v10, s[28:31], s48 offen offset:3072 nt lds
    s_add_u32 s48, s43, 126976
    s_mov_b32 m0, 126976
    s_nop 0
    buffer_load_dwordx4 v10, s[28:31], s48 offen offset:0 nt lds
    buffer_load_dwordx4 v10, s[28:31], s48 offen offset:1024 nt lds
    buffer_load_dwordx4 v10, s[28:31], s48 offen offset:2048 nt lds
    buffer_load_dwordx4 v10, s[28:31], s48 offen offset:3072 nt lds
    s_waitcnt vmcnt(48)
    s_waitcnt lgkmcnt(0)
    s_barrier
    s_cmp_eq_u32 s56, 13
    s_cbranch_scc0 L_g2ann13
    s_mov_b64 exec, 1
    buffer_store_byte v242, v240, s[68:71], s2 offen sc1
    s_mov_b64 exec, -1
L_g2ann13:
    s_add_u32 s48, s43, 131072
    s_mov_b32 m0, 131072
    s_nop 0
    buffer_load_dwordx4 v10, s[28:31], s48 offen offset:0 nt lds
    buffer_load_dwordx4 v10, s[28:31], s48 offen offset:1024 nt lds
    buffer_load_dwordx4 v10, s[28:31], s48 offen offset:2048 nt lds
    buffer_load_dwordx4 v10, s[28:31], s48 offen offset:3072 nt lds
    s_add_u32 s48, s43, 135168
    s_mov_b32 m0, 135168
    s_nop 0
    buffer_load_dwordx4 v10, s[28:31], s48 offen offset:0 nt lds
    buffer_load_dwordx4 v10, s[28:31], s48 offen offset:1024 nt lds
    buffer_load_dwordx4 v10, s[28:31], s48 offen offset:2048 nt lds
    buffer_load_dwordx4 v10, s[28:31], s48 offen offset:3072 nt lds
    s_add_u32 s48, s43, 139264
    s_mov_b32 m0, 139264
    s_nop 0
    buffer_load_dwordx4 v10, s[28:31], s48 offen offset:0 nt lds
    buffer_load_dwordx4 v10, s[28:31], s48 offen offset:1024 nt lds
    buffer_load_dwordx4 v10, s[28:31], s48 offen offset:2048 nt lds
    buffer_load_dwordx4 v10, s[28:31], s48 offen offset:3072 nt lds
    s_add_u32 s48, s43, 143360
    s_mov_b32 m0, 143360
    s_nop 0
    buffer_load_dwordx4 v10, s[28:31], s48 offen offset:0 nt lds
    buffer_load_dwordx4 v10, s[28:31], s48 offen offset:1024 nt lds
    buffer_load_dwordx4 v10, s[28:31], s48 offen offset:2048 nt lds
    buffer_load_dwordx4 v10, s[28:31], s48 offen offset:3072 nt lds
    s_waitcnt vmcnt(48)
    s_waitcnt lgkmcnt(0)
    s_barrier
    s_cmp_eq_u32 s56, 14
    s_cbranch_scc0 L_g2ann14
    s_mov_b64 exec, 1
    buffer_store_byte v242, v240, s[68:71], s2 offen sc1
    s_mov_b64 exec, -1
L_g2ann14:
    s_add_u32 s48, s43, 147456
    s_mov_b32 m0, 147456
    s_nop 0
    buffer_load_dwordx4 v10, s[28:31], s48 offen offset:0 nt lds
    buffer_load_dwordx4 v10, s[28:31], s48 offen offset:1024 nt lds
    buffer_load_dwordx4 v10, s[28:31], s48 offen offset:2048 nt lds
    buffer_load_dwordx4 v10, s[28:31], s48 offen offset:3072 nt lds
    s_add_u32 s48, s43, 151552
    s_mov_b32 m0, 151552
    s_nop 0
    buffer_load_dwordx4 v10, s[28:31], s48 offen offset:0 nt lds
    buffer_load_dwordx4 v10, s[28:31], s48 offen offset:1024 nt lds
    buffer_load_dwordx4 v10, s[28:31], s48 offen offset:2048 nt lds
    buffer_load_dwordx4 v10, s[28:31], s48 offen offset:3072 nt lds
    s_add_u32 s48, s43, 155648
    s_mov_b32 m0, 155648
    s_nop 0
    buffer_load_dwordx4 v10, s[28:31], s48 offen offset:0 nt lds
    buffer_load_dwordx4 v10, s[28:31], s48 offen offset:1024 nt lds
    buffer_load_dwordx4 v10, s[28:31], s48 offen offset:2048 nt lds
    buffer_load_dwordx4 v10, s[28:31], s48 offen offset:3072 nt lds
    s_add_u32 s48, s43, 159744
    s_mov_b32 m0, 159744
    s_nop 0
    buffer_load_dwordx4 v10, s[28:31], s48 offen offset:0 nt lds
    buffer_load_dwordx4 v10, s[28:31], s48 offen offset:1024 nt lds
    buffer_load_dwordx4 v10, s[28:31], s48 offen offset:2048 nt lds
    buffer_load_dwordx4 v10, s[28:31], s48 offen offset:3072 nt lds
    s_waitcnt vmcnt(48)
    s_waitcnt lgkmcnt(0)
    s_barrier
    s_cmp_eq_u32 s56, 15
    s_cbranch_scc0 L_g2ann15
    s_mov_b64 exec, 1
    buffer_store_byte v242, v240, s[68:71], s2 offen sc1
    s_mov_b64 exec, -1
L_g2ann15:
    s_add_u32 s48, s43, 163840
    s_mov_b32 m0, 81920
    s_nop 0
    buffer_load_dwordx4 v10, s[28:31], s48 offen offset:0 nt lds
    buffer_load_dwordx4 v10, s[28:31], s48 offen offset:1024 nt lds
    buffer_load_dwordx4 v10, s[28:31], s48 offen offset:2048 nt lds
    buffer_load_dwordx4 v10, s[28:31], s48 offen offset:3072 nt lds
    s_add_u32 s48, s43, 167936
    s_mov_b32 m0, 86016
    s_nop 0
    buffer_load_dwordx4 v10, s[28:31], s48 offen offset:0 nt lds
    buffer_load_dwordx4 v10, s[28:31], s48 offen offset:1024 nt lds
    buffer_load_dwordx4 v10, s[28:31], s48 offen offset:2048 nt lds
    buffer_load_dwordx4 v10, s[28:31], s48 offen offset:3072 nt lds
    s_add_u32 s48, s43, 172032
    s_mov_b32 m0, 90112
    s_nop 0
    buffer_load_dwordx4 v10, s[28:31], s48 offen offset:0 nt lds
    buffer_load_dwordx4 v10, s[28:31], s48 offen offset:1024 nt lds
    buffer_load_dwordx4 v10, s[28:31], s48 offen offset:2048 nt lds
    buffer_load_dwordx4 v10, s[28:31], s48 offen offset:3072 nt lds
    s_add_u32 s48, s43, 176128
    s_mov_b32 m0, 94208
    s_nop 0
    buffer_load_dwordx4 v10, s[28:31], s48 offen offset:0 nt lds
    buffer_load_dwordx4 v10, s[28:31], s48 offen offset:1024 nt lds
    buffer_load_dwordx4 v10, s[28:31], s48 offen offset:2048 nt lds
    buffer_load_dwordx4 v10, s[28:31], s48 offen offset:3072 nt lds
    s_waitcnt vmcnt(48)
    s_waitcnt lgkmcnt(0)
    s_barrier
    s_add_u32 s48, s43, 180224
    s_mov_b32 m0, 98304
    s_nop 0
    buffer_load_dwordx4 v10, s[28:31], s48 offen offset:0 nt lds
    buffer_load_dwordx4 v10, s[28:31], s48 offen offset:1024 nt lds
    buffer_load_dwordx4 v10, s[28:31], s48 offen offset:2048 nt lds
    buffer_load_dwordx4 v10, s[28:31], s48 offen offset:3072 nt lds
    s_add_u32 s48, s43, 184320
    s_mov_b32 m0, 102400
    s_nop 0
    buffer_load_dwordx4 v10, s[28:31], s48 offen offset:0 nt lds
    buffer_load_dwordx4 v10, s[28:31], s48 offen offset:1024 nt lds
    buffer_load_dwordx4 v10, s[28:31], s48 offen offset:2048 nt lds
    buffer_load_dwordx4 v10, s[28:31], s48 offen offset:3072 nt lds
    s_add_u32 s48, s43, 188416
    s_mov_b32 m0, 106496
    s_nop 0
    buffer_load_dwordx4 v10, s[28:31], s48 offen offset:0 nt lds
    buffer_load_dwordx4 v10, s[28:31], s48 offen offset:1024 nt lds
    buffer_load_dwordx4 v10, s[28:31], s48 offen offset:2048 nt lds
    buffer_load_dwordx4 v10, s[28:31], s48 offen offset:3072 nt lds
    s_add_u32 s48, s43, 192512
    s_mov_b32 m0, 110592
    s_nop 0
    buffer_load_dwordx4 v10, s[28:31], s48 offen offset:0 nt lds
    buffer_load_dwordx4 v10, s[28:31], s48 offen offset:1024 nt lds
    buffer_load_dwordx4 v10, s[28:31], s48 offen offset:2048 nt lds
    buffer_load_dwordx4 v10, s[28:31], s48 offen offset:3072 nt lds
    s_waitcnt vmcnt(48)
    s_waitcnt lgkmcnt(0)
    s_barrier
    s_add_u32 s48, s43, 196608
    s_mov_b32 m0, 114688
    s_nop 0
    buffer_load_dwordx4 v10, s[28:31], s48 offen offset:0 nt lds
    buffer_load_dwordx4 v10, s[28:31], s48 offen offset:1024 nt lds
    buffer_load_dwordx4 v10, s[28:31], s48 offen offset:2048 nt lds
    buffer_load_dwordx4 v10, s[28:31], s48 offen offset:3072 nt lds
    s_add_u32 s48, s43, 200704
    s_mov_b32 m0, 118784
    s_nop 0
    buffer_load_dwordx4 v10, s[28:31], s48 offen offset:0 nt lds
    buffer_load_dwordx4 v10, s[28:31], s48 offen offset:1024 nt lds
    buffer_load_dwordx4 v10, s[28:31], s48 offen offset:2048 nt lds
    buffer_load_dwordx4 v10, s[28:31], s48 offen offset:3072 nt lds
    s_add_u32 s48, s43, 204800
    s_mov_b32 m0, 122880
    s_nop 0
    buffer_load_dwordx4 v10, s[28:31], s48 offen offset:0 nt lds
    buffer_load_dwordx4 v10, s[28:31], s48 offen offset:1024 nt lds
    buffer_load_dwordx4 v10, s[28:31], s48 offen offset:2048 nt lds
    buffer_load_dwordx4 v10, s[28:31], s48 offen offset:3072 nt lds
    s_add_u32 s48, s43, 208896
    s_mov_b32 m0, 126976
    s_nop 0
    buffer_load_dwordx4 v10, s[28:31], s48 offen offset:0 nt lds
    buffer_load_dwordx4 v10, s[28:31], s48 offen offset:1024 nt lds
    buffer_load_dwordx4 v10, s[28:31], s48 offen offset:2048 nt lds
    buffer_load_dwordx4 v10, s[28:31], s48 offen offset:3072 nt lds
    s_waitcnt vmcnt(48)
    s_waitcnt lgkmcnt(0)
    s_barrier
    s_add_u32 s48, s43, 212992
    s_mov_b32 m0, 131072
    s_nop 0
    buffer_load_dwordx4 v10, s[28:31], s48 offen offset:0 nt lds
    buffer_load_dwordx4 v10, s[28:31], s48 offen offset:1024 nt lds
    buffer_load_dwordx4 v10, s[28:31], s48 offen offset:2048 nt lds
    buffer_load_dwordx4 v10, s[28:31], s48 offen offset:3072 nt lds
    s_add_u32 s48, s43, 217088
    s_mov_b32 m0, 135168
    s_nop 0
    buffer_load_dwordx4 v10, s[28:31], s48 offen offset:0 nt lds
    buffer_load_dwordx4 v10, s[28:31], s48 offen offset:1024 nt lds
    buffer_load_dwordx4 v10, s[28:31], s48 offen offset:2048 nt lds
    buffer_load_dwordx4 v10, s[28:31], s48 offen offset:3072 nt lds
    s_add_u32 s48, s43, 221184
    s_mov_b32 m0, 139264
    s_nop 0
    buffer_load_dwordx4 v10, s[28:31], s48 offen offset:0 nt lds
    buffer_load_dwordx4 v10, s[28:31], s48 offen offset:1024 nt lds
    buffer_load_dwordx4 v10, s[28:31], s48 offen offset:2048 nt lds
    buffer_load_dwordx4 v10, s[28:31], s48 offen offset:3072 nt lds
    s_add_u32 s48, s43, 225280
    s_mov_b32 m0, 143360
    s_nop 0
    buffer_load_dwordx4 v10, s[28:31], s48 offen offset:0 nt lds
    buffer_load_dwordx4 v10, s[28:31], s48 offen offset:1024 nt lds
    buffer_load_dwordx4 v10, s[28:31], s48 offen offset:2048 nt lds
    buffer_load_dwordx4 v10, s[28:31], s48 offen offset:3072 nt lds
    s_waitcnt vmcnt(48)
    s_waitcnt lgkmcnt(0)
    s_barrier
    s_add_u32 s48, s43, 229376
    s_mov_b32 m0, 147456
    s_nop 0
    buffer_load_dwordx4 v10, s[28:31], s48 offen offset:0 nt lds
    buffer_load_dwordx4 v10, s[28:31], s48 offen offset:1024 nt lds
    buffer_load_dwordx4 v10, s[28:31], s48 offen offset:2048 nt lds
    buffer_load_dwordx4 v10, s[28:31], s48 offen offset:3072 nt lds
    s_add_u32 s48, s43, 233472
    s_mov_b32 m0, 151552
    s_nop 0
    buffer_load_dwordx4 v10, s[28:31], s48 offen offset:0 nt lds
    buffer_load_dwordx4 v10, s[28:31], s48 offen offset:1024 nt lds
    buffer_load_dwordx4 v10, s[28:31], s48 offen offset:2048 nt lds
    buffer_load_dwordx4 v10, s[28:31], s48 offen offset:3072 nt lds
    s_add_u32 s48, s43, 237568
    s_mov_b32 m0, 155648
    s_nop 0
    buffer_load_dwordx4 v10, s[28:31], s48 offen offset:0 nt lds
    buffer_load_dwordx4 v10, s[28:31], s48 offen offset:1024 nt lds
    buffer_load_dwordx4 v10, s[28:31], s48 offen offset:2048 nt lds
    buffer_load_dwordx4 v10, s[28:31], s48 offen offset:3072 nt lds
    s_add_u32 s48, s43, 241664
    s_mov_b32 m0, 159744
    s_nop 0
    buffer_load_dwordx4 v10, s[28:31], s48 offen offset:0 nt lds
    buffer_load_dwordx4 v10, s[28:31], s48 offen offset:1024 nt lds
    buffer_load_dwordx4 v10, s[28:31], s48 offen offset:2048 nt lds
    buffer_load_dwordx4 v10, s[28:31], s48 offen offset:3072 nt lds
    s_waitcnt vmcnt(48)
    s_waitcnt lgkmcnt(0)
    s_barrier
    s_add_u32 s48, s43, 245760
    s_mov_b32 m0, 81920
    s_nop 0
    buffer_load_dwordx4 v10, s[28:31], s48 offen offset:0 nt lds
    buffer_load_dwordx4 v10, s[28:31], s48 offen offset:1024 nt lds
    buffer_load_dwordx4 v10, s[28:31], s48 offen offset:2048 nt lds
    buffer_load_dwordx4 v10, s[28:31], s48 offen offset:3072 nt lds
    s_add_u32 s48, s43, 249856
    s_mov_b32 m0, 86016
    s_nop 0
    buffer_load_dwordx4 v10, s[28:31], s48 offen offset:0 nt lds
    buffer_load_dwordx4 v10, s[28:31], s48 offen offset:1024 nt lds
    buffer_load_dwordx4 v10, s[28:31], s48 offen offset:2048 nt lds
    buffer_load_dwordx4 v10, s[28:31], s48 offen offset:3072 nt lds
    s_add_u32 s48, s43, 253952
    s_mov_b32 m0, 90112
    s_nop 0
    buffer_load_dwordx4 v10, s[28:31], s48 offen offset:0 nt lds
    buffer_load_dwordx4 v10, s[28:31], s48 offen offset:1024 nt lds
    buffer_load_dwordx4 v10, s[28:31], s48 offen offset:2048 nt lds
    buffer_load_dwordx4 v10, s[28:31], s48 offen offset:3072 nt lds
    s_add_u32 s48, s43, 258048
    s_mov_b32 m0, 94208
    s_nop 0
    buffer_load_dwordx4 v10, s[28:31], s48 offen offset:0 nt lds
    buffer_load_dwordx4 v10, s[28:31], s48 offen offset:1024 nt lds
    buffer_load_dwordx4 v10, s[28:31], s48 offen offset:2048 nt lds
    buffer_load_dwordx4 v10, s[28:31], s48 offen offset:3072 nt lds
    s_waitcnt vmcnt(48)
    s_waitcnt lgkmcnt(0)
    s_barrier
    s_add_u32 s57, s45, 0
    s_and_b32 s57, s57, 3
    s_add_u32 s58, s44, 0
    s_and_b32 s58, s58, 7
    s_lshl_b32 s57, s57, 3
    s_add_u32 s57, s57, s58
    s_mul_i32 s57, s57, 163840
    s_mul_i32 s58, s45, 320
    s_add_u32 s57, s57, s58
    s_add_u32 s48, s57, 256
    s_mov_b32 m0, 98304
    s_nop 0
    buffer_load_dwordx4 v228, s[64:67], s48 offen offset:0 lds
    buffer_load_dwordx4 v229, s[64:67], s48 offen offset:1024 lds
    buffer_load_dwordx4 v230, s[64:67], s48 offen offset:2048 lds
    buffer_load_dwordx4 v231, s[64:67], s48 offen offset:3072 lds
    s_add_u32 s48, s57, 82176
    s_mov_b32 m0, 102400
    s_nop 0
    buffer_load_dwordx4 v228, s[64:67], s48 offen offset:0 lds
    buffer_load_dwordx4 v229, s[64:67], s48 offen offset:1024 lds
    buffer_load_dwordx4 v230, s[64:67], s48 offen offset:2048 lds
    buffer_load_dwordx4 v231, s[64:67], s48 offen offset:3072 lds
    s_add_u32 s57, s45, 1
    s_and_b32 s57, s57, 3
    s_add_u32 s58, s44, 0
    s_and_b32 s58, s58, 7
    s_lshl_b32 s57, s57, 3
    s_add_u32 s57, s57, s58
    s_mul_i32 s57, s57, 163840
    s_mul_i32 s58, s45, 320
    s_add_u32 s57, s57, s58
    s_add_u32 s48, s57, 256
    s_mov_b32 m0, 106496
    s_nop 0
    buffer_load_dwordx4 v228, s[64:67], s48 offen offset:0 lds
    buffer_load_dwordx4 v229, s[64:67], s48 offen offset:1024 lds
    buffer_load_dwordx4 v230, s[64:67], s48 offen offset:2048 lds
    buffer_load_dwordx4 v231, s[64:67], s48 offen offset:3072 lds
    s_add_u32 s48, s57, 82176
    s_mov_b32 m0, 110592
    s_nop 0
    buffer_load_dwordx4 v228, s[64:67], s48 offen offset:0 lds
    buffer_load_dwordx4 v229, s[64:67], s48 offen offset:1024 lds
    buffer_load_dwordx4 v230, s[64:67], s48 offen offset:2048 lds
    buffer_load_dwordx4 v231, s[64:67], s48 offen offset:3072 lds
    s_waitcnt vmcnt(48)
    s_waitcnt lgkmcnt(0)
    s_barrier
    s_add_u32 s57, s45, 1
    s_and_b32 s57, s57, 3
    s_add_u32 s58, s44, 0
    s_and_b32 s58, s58, 7
    s_lshl_b32 s57, s57, 3
    s_add_u32 s57, s57, s58
    s_mul_i32 s57, s57, 163840
    s_mul_i32 s58, s45, 320
    s_add_u32 s57, s57, s58
    s_add_u32 s48, s57, 81920
    s_mov_b32 m0, 114688
    s_nop 0
    buffer_load_dwordx4 v224, s[64:67], s48 offen offset:0 lds
    buffer_load_dwordx4 v225, s[64:67], s48 offen offset:1024 lds
    buffer_load_dwordx4 v226, s[64:67], s48 offen offset:2048 lds
    buffer_load_dwordx4 v227, s[64:67], s48 offen offset:3072 lds
    s_add_u32 s48, s57, 102400
    s_mov_b32 m0, 118784
    s_nop 0
    buffer_load_dwordx4 v224, s[64:67], s48 offen offset:0 lds
    buffer_load_dwordx4 v225, s[64:67], s48 offen offset:1024 lds
    buffer_load_dwordx4 v226, s[64:67], s48 offen offset:2048 lds
    buffer_load_dwordx4 v227, s[64:67], s48 offen offset:3072 lds
    s_add_u32 s48, s57, 122880
    s_mov_b32 m0, 122880
    s_nop 0
    buffer_load_dwordx4 v224, s[64:67], s48 offen offset:0 lds
    buffer_load_dwordx4 v225, s[64:67], s48 offen offset:1024 lds
    buffer_load_dwordx4 v226, s[64:67], s48 offen offset:2048 lds
    buffer_load_dwordx4 v227, s[64:67], s48 offen offset:3072 lds
    s_add_u32 s48, s57, 143360
    s_mov_b32 m0, 126976
    s_nop 0
    buffer_load_dwordx4 v224, s[64:67], s48 offen offset:0 lds
    buffer_load_dwordx4 v225, s[64:67], s48 offen offset:1024 lds
    buffer_load_dwordx4 v226, s[64:67], s48 offen offset:2048 lds
    buffer_load_dwordx4 v227, s[64:67], s48 offen offset:3072 lds
    s_waitcnt vmcnt(48)
    s_waitcnt lgkmcnt(0)
    s_barrier
    s_add_u32 s57, s45, 2
    s_and_b32 s57, s57, 3
    s_add_u32 s58, s44, 0
    s_and_b32 s58, s58, 7
    s_lshl_b32 s57, s57, 3
    s_add_u32 s57, s57, s58
    s_mul_i32 s57, s57, 163840
    s_mul_i32 s58, s45, 320
    s_add_u32 s57, s57, s58
    s_add_u32 s48, s57, 81920
    s_mov_b32 m0, 131072
    s_nop 0
    buffer_load_dwordx4 v224, s[64:67], s48 offen offset:0 lds
    buffer_load_dwordx4 v225, s[64:67], s48 offen offset:1024 lds
    buffer_load_dwordx4 v226, s[64:67], s48 offen offset:2048 lds
    buffer_load_dwordx4 v227, s[64:67], s48 offen offset:3072 lds
    s_add_u32 s48, s57, 102400
    s_mov_b32 m0, 135168
    s_nop 0
    buffer_load_dwordx4 v224, s[64:67], s48 offen offset:0 lds
    buffer_load_dwordx4 v225, s[64:67], s48 offen offset:1024 lds
    buffer_load_dwordx4 v226, s[64:67], s48 offen offset:2048 lds
    buffer_load_dwordx4 v227, s[64:67], s48 offen offset:3072 lds
    s_add_u32 s48, s57, 122880
    s_mov_b32 m0, 139264
    s_nop 0
    buffer_load_dwordx4 v224, s[64:67], s48 offen offset:0 lds
    buffer_load_dwordx4 v225, s[64:67], s48 offen offset:1024 lds
    buffer_load_dwordx4 v226, s[64:67], s48 offen offset:2048 lds
    buffer_load_dwordx4 v227, s[64:67], s48 offen offset:3072 lds
    s_add_u32 s48, s57, 143360
    s_mov_b32 m0, 143360
    s_nop 0
    buffer_load_dwordx4 v224, s[64:67], s48 offen offset:0 lds
    buffer_load_dwordx4 v225, s[64:67], s48 offen offset:1024 lds
    buffer_load_dwordx4 v226, s[64:67], s48 offen offset:2048 lds
    buffer_load_dwordx4 v227, s[64:67], s48 offen offset:3072 lds
    s_waitcnt vmcnt(48)
    s_waitcnt lgkmcnt(0)
    s_barrier
    s_add_u32 s57, s45, 3
    s_and_b32 s57, s57, 3
    s_add_u32 s58, s44, 0
    s_and_b32 s58, s58, 7
    s_lshl_b32 s57, s57, 3
    s_add_u32 s57, s57, s58
    s_mul_i32 s57, s57, 163840
    s_mul_i32 s58, s45, 320
    s_add_u32 s57, s57, s58
    s_add_u32 s48, s57, 0
    s_mov_b32 m0, 147456
    s_nop 0
    buffer_load_dwordx4 v224, s[64:67], s48 offen offset:0 lds
    buffer_load_dwordx4 v225, s[64:67], s48 offen offset:1024 lds
    buffer_load_dwordx4 v226, s[64:67], s48 offen offset:2048 lds
    buffer_load_dwordx4 v227, s[64:67], s48 offen offset:3072 lds
    s_add_u32 s48, s57, 20480
    s_mov_b32 m0, 151552
    s_nop 0
    buffer_load_dwordx4 v224, s[64:67], s48 offen offset:0 lds
    buffer_load_dwordx4 v225, s[64:67], s48 offen offset:1024 lds
    buffer_load_dwordx4 v226, s[64:67], s48 offen offset:2048 lds
    buffer_load_dwordx4 v227, s[64:67], s48 offen offset:3072 lds
    s_add_u32 s48, s57, 40960
    s_mov_b32 m0, 155648
    s_nop 0
    buffer_load_dwordx4 v224, s[64:67], s48 offen offset:0 lds
    buffer_load_dwordx4 v225, s[64:67], s48 offen offset:1024 lds
    buffer_load_dwordx4 v226, s[64:67], s48 offen offset:2048 lds
    buffer_load_dwordx4 v227, s[64:67], s48 offen offset:3072 lds
    s_add_u32 s48, s57, 61440
    s_mov_b32 m0, 159744
    s_nop 0
    buffer_load_dwordx4 v224, s[64:67], s48 offen offset:0 lds
    buffer_load_dwordx4 v225, s[64:67], s48 offen offset:1024 lds
    buffer_load_dwordx4 v226, s[64:67], s48 offen offset:2048 lds
    buffer_load_dwordx4 v227, s[64:67], s48 offen offset:3072 lds
    s_waitcnt vmcnt(48)
    s_barrier
    s_add_u32 s57, s45, 3
    s_and_b32 s57, s57, 3
    s_add_u32 s58, s44, 0
    s_and_b32 s58, s58, 7
    s_lshl_b32 s57, s57, 3
    s_add_u32 s57, s57, s58
    s_mul_i32 s57, s57, 163840
    s_mul_i32 s58, s45, 320
    s_add_u32 s57, s57, s58
    s_add_u32 s48, s57, 81920
    s_mov_b32 m0, 81920
    s_nop 0
    buffer_load_dwordx4 v224, s[64:67], s48 offen offset:0 lds
    buffer_load_dwordx4 v225, s[64:67], s48 offen offset:1024 lds
    buffer_load_dwordx4 v226, s[64:67], s48 offen offset:2048 lds
    buffer_load_dwordx4 v227, s[64:67], s48 offen offset:3072 lds
    s_add_u32 s48, s57, 102400
    s_mov_b32 m0, 86016
    s_nop 0
    buffer_load_dwordx4 v224, s[64:67], s48 offen offset:0 lds
    buffer_load_dwordx4 v225, s[64:67], s48 offen offset:1024 lds
    buffer_load_dwordx4 v226, s[64:67], s48 offen offset:2048 lds
    buffer_load_dwordx4 v227, s[64:67], s48 offen offset:3072 lds
    s_add_u32 s48, s57, 122880
    s_mov_b32 m0, 90112
    s_nop 0
    buffer_load_dwordx4 v224, s[64:67], s48 offen offset:0 lds
    buffer_load_dwordx4 v225, s[64:67], s48 offen offset:1024 lds
    buffer_load_dwordx4 v226, s[64:67], s48 offen offset:2048 lds
    buffer_load_dwordx4 v227, s[64:67], s48 offen offset:3072 lds
    s_add_u32 s48, s57, 143360
    s_mov_b32 m0, 94208
    s_nop 0
    buffer_load_dwordx4 v224, s[64:67], s48 offen offset:0 lds
    buffer_load_dwordx4 v225, s[64:67], s48 offen offset:1024 lds
    buffer_load_dwordx4 v226, s[64:67], s48 offen offset:2048 lds
    buffer_load_dwordx4 v227, s[64:67], s48 offen offset:3072 lds
    s_lshl_b32 s47, s42, 2
    s_add_u32 s47, s47, s45
    s_mul_i32 s47, s47, 327680
    s_lshr_b32 s48, s44, 1
    s_mul_i32 s48, s48, 10240
    s_add_u32 s47, s47, s48
    s_and_b32 s48, s44, 1
    s_lshl_b32 s48, s48, 8
    s_add_u32 s47, s47, s48
    s_add_u32 s47, s47, 8394752
    v_lshrrev_b32 v20, 5, v1
    v_bfe_u32 v21, v1, 4, 1
    v_and_b32 v22, 15, v1
    v_lshlrev_b32 v23, 4, v22
    v_lshl_add_u32 v23, v20, 9, v23
    v_lshl_add_u32 v23, v21, 10, v23
    v_add_u32 v25, 0x1000, v23
    v_mul_u32_u24 v24, 1280, v22
    v_lshl_add_u32 v24, v21, 5, v24
    v_lshl_add_u32 v24, v20, 4, v24
    s_lshl_b32 s56, s42, 7
    s_lshl_b32 s54, s44, 4
    s_add_u32 s56, s56, s54
    s_mul_i32 s56, s56, 1280
    s_mul_i32 s54, s45, 320
    s_add_u32 s56, s56, s54
    s_lshl_b32 s54, s42, 5
    s_lshl_b32 s58, s45, 3
    s_add_u32 s54, s54, s58
    s_and_b32 s58, s44, 6
    s_add_u32 s54, s54, s58
    s_lshl_b32 s54, s54, 8
    s_add_u32 s54, s54, 50331776
    v_lshlrev_b32 v19, 2, v1
    v_mov_b32 v128, 0
    v_mov_b32 v129, 0
    v_mov_b32 v130, 0
    v_mov_b32 v131, 0
    v_mov_b32 v132, 0
    v_mov_b32 v133, 0
    v_mov_b32 v134, 0
    v_mov_b32 v135, 0
    v_mov_b32 v136, 0
    v_mov_b32 v137, 0
    v_mov_b32 v138, 0
    v_mov_b32 v139, 0
    v_mov_b32 v140, 0
    v_mov_b32 v141, 0
    v_mov_b32 v142, 0
    v_mov_b32 v143, 0
    s_mov_b32 s58, 0
    s_mov_b32 s62, 0
    s_mov_b32 s57, 0
    s_waitcnt vmcnt(0)
    s_barrier
    s_sleep 40
    s_mov_b64 exec, 0xff
    buffer_load_dword v16, v19, s[36:39], s54 offen sc1
L_rsb2:
    s_sleep 3
    buffer_load_dword v17, v19, s[36:39], s54 offen sc1
    s_waitcnt vmcnt(1)
    v_cmp_eq_u32 vcc, 1, v16
    s_add_u32 s57, s57, 1
    s_andn2_b32 s59, vcc_lo, s58
    s_cbranch_scc1 L_rhb2
L_rs2b2:
    s_sleep 3
    buffer_load_dword v16, v19, s[36:39], s54 offen sc1
    s_waitcnt vmcnt(1)
    v_cmp_eq_u32 vcc, 1, v17
    s_add_u32 s57, s57, 1
    s_andn2_b32 s59, vcc_lo, s58
    s_cbranch_scc1 L_rhb2
    s_cmp_lt_u32 s57, 0x40000
    s_cbranch_scc1 L_rsb2
    s_andn2_b32 s59, 0xff, s58
L_rhb2:
    s_mov_b64 exec, -1
    s_bitcmp1_b32 s59, 0
    s_cbranch_scc0 L_rlb2_0
    s_add_u32 s48, s47, 0
    buffer_load_dwordx4 v[32:35], v23, s[36:39], s48 offen offset:0 sc1
    buffer_load_dwordx4 v[36:39], v23, s[36:39], s48 offen offset:2048 sc1
L_rlb2_0:
    s_bitcmp1_b32 s59, 1
    s_cbranch_scc0 L_rlb2_1
    s_add_u32 s48, s47, 40960
    buffer_load_dwordx4 v[44:47], v23, s[36:39], s48 offen offset:0 sc1
    buffer_load_dwordx4 v[48:51], v23, s[36:39], s48 offen offset:2048 sc1
L_rlb2_1:
    s_bitcmp1_b32 s59, 2
    s_cbranch_scc0 L_rlb2_2
    s_add_u32 s48, s47, 81920
    buffer_load_dwordx4 v[56:59], v23, s[36:39], s48 offen offset:0 sc1
    buffer_load_dwordx4 v[60:63], v23, s[36:39], s48 offen offset:2048 sc1
L_rlb2_2:
    s_bitcmp1_b32 s59, 3
    s_cbranch_scc0 L_rlb2_3
    s_add_u32 s48, s47, 122880
    buffer_load_dwordx4 v[68:71], v23, s[36:39], s48 offen offset:0 sc1
    buffer_load_dwordx4 v[72:75], v23, s[36:39], s48 offen offset:2048 sc1
L_rlb2_3:
    s_bitcmp1_b32 s59, 4
    s_cbranch_scc0 L_rlb2_4
    s_add_u32 s48, s47, 163840
    buffer_load_dwordx4 v[80:83], v23, s[36:39], s48 offen offset:0 sc1
    buffer_load_dwordx4 v[84:87], v23, s[36:39], s48 offen offset:2048 sc1
L_rlb2_4:
    s_bitcmp1_b32 s59, 5
    s_cbranch_scc0 L_rlb2_5
    s_add_u32 s48, s47, 204800
    buffer_load_dwordx4 v[92:95], v23, s[36:39], s48 offen offset:0 sc1
    buffer_load_dwordx4 v[96:99], v23, s[36:39], s48 offen offset:2048 sc1
L_rlb2_5:
    s_bitcmp1_b32 s59, 6
    s_cbranch_scc0 L_rlb2_6
    s_add_u32 s48, s47, 245760
    buffer_load_dwordx4 v[104:107], v23, s[36:39], s48 offen offset:0 sc1
    buffer_load_dwordx4 v[108:111], v23, s[36:39], s48 offen offset:2048 sc1
L_rlb2_6:
    s_bitcmp1_b32 s59, 7
    s_cbranch_scc0 L_rlb2_7
    s_add_u32 s48, s47, 286720
    buffer_load_dwordx4 v[116:119], v23, s[36:39], s48 offen offset:0 sc1
    buffer_load_dwordx4 v[120:123], v23, s[36:39], s48 offen offset:2048 sc1
L_rlb2_7:
    s_or_b32 s58, s58, s59
    s_mov_b64 exec, 0xff
    buffer_load_dword v16, v19, s[36:39], s54 offen sc1
    s_mov_b64 exec, -1
    s_bitcmp1_b32 s62, 0
    s_cbranch_scc0 L_rbb2_0
    v_lshlrev_b32 v160, 16, v32
    v_and_b32 v161, 0xffff0000, v32
    v_add_f32 v128, v128, v160
    v_add_f32 v129, v129, v161
    v_lshlrev_b32 v162, 16, v33
    v_and_b32 v163, 0xffff0000, v33
    v_add_f32 v130, v130, v162
    v_add_f32 v131, v131, v163
    v_lshlrev_b32 v160, 16, v34
    v_and_b32 v161, 0xffff0000, v34
    v_add_f32 v132, v132, v160
    v_add_f32 v133, v133, v161
    v_lshlrev_b32 v162, 16, v35
    v_and_b32 v163, 0xffff0000, v35
    v_add_f32 v134, v134, v162
    v_add_f32 v135, v135, v163
    v_lshlrev_b32 v160, 16, v36
    v_and_b32 v161, 0xffff0000, v36
    v_add_f32 v136, v136, v160
    v_add_f32 v137, v137, v161
    v_lshlrev_b32 v162, 16, v37
    v_and_b32 v163, 0xffff0000, v37
    v_add_f32 v138, v138, v162
    v_add_f32 v139, v139, v163
    v_lshlrev_b32 v160, 16, v38
    v_and_b32 v161, 0xffff0000, v38
    v_add_f32 v140, v140, v160
    v_add_f32 v141, v141, v161
    v_lshlrev_b32 v162, 16, v39
    v_and_b32 v163, 0xffff0000, v39
    v_add_f32 v142, v142, v162
    v_add_f32 v143, v143, v163
L_rbb2_0:
    s_bitcmp1_b32 s62, 1
    s_cbranch_scc0 L_rbb2_1
    v_lshlrev_b32 v160, 16, v44
    v_and_b32 v161, 0xffff0000, v44
    v_add_f32 v128, v128, v160
    v_add_f32 v129, v129, v161
    v_lshlrev_b32 v162, 16, v45
    v_and_b32 v163, 0xffff0000, v45
    v_add_f32 v130, v130, v162
    v_add_f32 v131, v131, v163
    v_lshlrev_b32 v160, 16, v46
    v_and_b32 v161, 0xffff0000, v46
    v_add_f32 v132, v132, v160
    v_add_f32 v133, v133, v161
    v_lshlrev_b32 v162, 16, v47
    v_and_b32 v163, 0xffff0000, v47
    v_add_f32 v134, v134, v162
    v_add_f32 v135, v135, v163
    v_lshlrev_b32 v160, 16, v48
    v_and_b32 v161, 0xffff0000, v48
    v_add_f32 v136, v136, v160
    v_add_f32 v137, v137, v161
    v_lshlrev_b32 v162, 16, v49
    v_and_b32 v163, 0xffff0000, v49
    v_add_f32 v138, v138, v162
    v_add_f32 v139, v139, v163
    v_lshlrev_b32 v160, 16, v50
    v_and_b32 v161, 0xffff0000, v50
    v_add_f32 v140, v140, v160
    v_add_f32 v141, v141, v161
    v_lshlrev_b32 v162, 16, v51
    v_and_b32 v163, 0xffff0000, v51
    v_add_f32 v142, v142, v162
    v_add_f32 v143, v143, v163
L_rbb2_1:
    s_bitcmp1_b32 s62, 2
    s_cbranch_scc0 L_rbb2_2
    v_lshlrev_b32 v160, 16, v56
    v_and_b32 v161, 0xffff0000, v56
    v_add_f32 v128, v128, v160
    v_add_f32 v129, v129, v161
    v_lshlrev_b32 v162, 16, v57
    v_and_b32 v163, 0xffff0000, v57
    v_add_f32 v130, v130, v162
    v_add_f32 v131, v131, v163
    v_lshlrev_b32 v160, 16, v58
    v_and_b32 v161, 0xffff0000, v58
    v_add_f32 v132, v132, v160
    v_add_f32 v133, v133, v161
    v_lshlrev_b32 v162, 16, v59
    v_and_b32 v163, 0xffff0000, v59
    v_add_f32 v134, v134, v162
    v_add_f32 v135, v135, v163
    v_lshlrev_b32 v160, 16, v60
    v_and_b32 v161, 0xffff0000, v60
    v_add_f32 v136, v136, v160
    v_add_f32 v137, v137, v161
    v_lshlrev_b32 v162, 16, v61
    v_and_b32 v163, 0xffff0000, v61
    v_add_f32 v138, v138, v162
    v_add_f32 v139, v139, v163
    v_lshlrev_b32 v160, 16, v62
    v_and_b32 v161, 0xffff0000, v62
    v_add_f32 v140, v140, v160
    v_add_f32 v141, v141, v161
    v_lshlrev_b32 v162, 16, v63
    v_and_b32 v163, 0xffff0000, v63
    v_add_f32 v142, v142, v162
    v_add_f32 v143, v143, v163
L_rbb2_2:
    s_bitcmp1_b32 s62, 3
    s_cbranch_scc0 L_rbb2_3
    v_lshlrev_b32 v160, 16, v68
    v_and_b32 v161, 0xffff0000, v68
    v_add_f32 v128, v128, v160
    v_add_f32 v129, v129, v161
    v_lshlrev_b32 v162, 16, v69
    v_and_b32 v163, 0xffff0000, v69
    v_add_f32 v130, v130, v162
    v_add_f32 v131, v131, v163
    v_lshlrev_b32 v160, 16, v70
    v_and_b32 v161, 0xffff0000, v70
    v_add_f32 v132, v132, v160
    v_add_f32 v133, v133, v161
    v_lshlrev_b32 v162, 16, v71
    v_and_b32 v163, 0xffff0000, v71
    v_add_f32 v134, v134, v162
    v_add_f32 v135, v135, v163
    v_lshlrev_b32 v160, 16, v72
    v_and_b32 v161, 0xffff0000, v72
    v_add_f32 v136, v136, v160
    v_add_f32 v137, v137, v161
    v_lshlrev_b32 v162, 16, v73
    v_and_b32 v163, 0xffff0000, v73
    v_add_f32 v138, v138, v162
    v_add_f32 v139, v139, v163
    v_lshlrev_b32 v160, 16, v74
    v_and_b32 v161, 0xffff0000, v74
    v_add_f32 v140, v140, v160
    v_add_f32 v141, v141, v161
    v_lshlrev_b32 v162, 16, v75
    v_and_b32 v163, 0xffff0000, v75
    v_add_f32 v142, v142, v162
    v_add_f32 v143, v143, v163
L_rbb2_3:
    s_bitcmp1_b32 s62, 4
    s_cbranch_scc0 L_rbb2_4
    v_lshlrev_b32 v160, 16, v80
    v_and_b32 v161, 0xffff0000, v80
    v_add_f32 v128, v128, v160
    v_add_f32 v129, v129, v161
    v_lshlrev_b32 v162, 16, v81
    v_and_b32 v163, 0xffff0000, v81
    v_add_f32 v130, v130, v162
    v_add_f32 v131, v131, v163
    v_lshlrev_b32 v160, 16, v82
    v_and_b32 v161, 0xffff0000, v82
    v_add_f32 v132, v132, v160
    v_add_f32 v133, v133, v161
    v_lshlrev_b32 v162, 16, v83
    v_and_b32 v163, 0xffff0000, v83
    v_add_f32 v134, v134, v162
    v_add_f32 v135, v135, v163
    v_lshlrev_b32 v160, 16, v84
    v_and_b32 v161, 0xffff0000, v84
    v_add_f32 v136, v136, v160
    v_add_f32 v137, v137, v161
    v_lshlrev_b32 v162, 16, v85
    v_and_b32 v163, 0xffff0000, v85
    v_add_f32 v138, v138, v162
    v_add_f32 v139, v139, v163
    v_lshlrev_b32 v160, 16, v86
    v_and_b32 v161, 0xffff0000, v86
    v_add_f32 v140, v140, v160
    v_add_f32 v141, v141, v161
    v_lshlrev_b32 v162, 16, v87
    v_and_b32 v163, 0xffff0000, v87
    v_add_f32 v142, v142, v162
    v_add_f32 v143, v143, v163
L_rbb2_4:
    s_bitcmp1_b32 s62, 5
    s_cbranch_scc0 L_rbb2_5
    v_lshlrev_b32 v160, 16, v92
    v_and_b32 v161, 0xffff0000, v92
    v_add_f32 v128, v128, v160
    v_add_f32 v129, v129, v161
    v_lshlrev_b32 v162, 16, v93
    v_and_b32 v163, 0xffff0000, v93
    v_add_f32 v130, v130, v162
    v_add_f32 v131, v131, v163
    v_lshlrev_b32 v160, 16, v94
    v_and_b32 v161, 0xffff0000, v94
    v_add_f32 v132, v132, v160
    v_add_f32 v133, v133, v161
    v_lshlrev_b32 v162, 16, v95
    v_and_b32 v163, 0xffff0000, v95
    v_add_f32 v134, v134, v162
    v_add_f32 v135, v135, v163
    v_lshlrev_b32 v160, 16, v96
    v_and_b32 v161, 0xffff0000, v96
    v_add_f32 v136, v136, v160
    v_add_f32 v137, v137, v161
    v_lshlrev_b32 v162, 16, v97
    v_and_b32 v163, 0xffff0000, v97
    v_add_f32 v138, v138, v162
    v_add_f32 v139, v139, v163
    v_lshlrev_b32 v160, 16, v98
    v_and_b32 v161, 0xffff0000, v98
    v_add_f32 v140, v140, v160
    v_add_f32 v141, v141, v161
    v_lshlrev_b32 v162, 16, v99
    v_and_b32 v163, 0xffff0000, v99
    v_add_f32 v142, v142, v162
    v_add_f32 v143, v143, v163
L_rbb2_5:
    s_bitcmp1_b32 s62, 6
    s_cbranch_scc0 L_rbb2_6
    v_lshlrev_b32 v160, 16, v104
    v_and_b32 v161, 0xffff0000, v104
    v_add_f32 v128, v128, v160
    v_add_f32 v129, v129, v161
    v_lshlrev_b32 v162, 16, v105
    v_and_b32 v163, 0xffff0000, v105
    v_add_f32 v130, v130, v162
    v_add_f32 v131, v131, v163
    v_lshlrev_b32 v160, 16, v106
    v_and_b32 v161, 0xffff0000, v106
    v_add_f32 v132, v132, v160
    v_add_f32 v133, v133, v161
    v_lshlrev_b32 v162, 16, v107
    v_and_b32 v163, 0xffff0000, v107
    v_add_f32 v134, v134, v162
    v_add_f32 v135, v135, v163
    v_lshlrev_b32 v160, 16, v108
    v_and_b32 v161, 0xffff0000, v108
    v_add_f32 v136, v136, v160
    v_add_f32 v137, v137, v161
    v_lshlrev_b32 v162, 16, v109
    v_and_b32 v163, 0xffff0000, v109
    v_add_f32 v138, v138, v162
    v_add_f32 v139, v139, v163
    v_lshlrev_b32 v160, 16, v110
    v_and_b32 v161, 0xffff0000, v110
    v_add_f32 v140, v140, v160
    v_add_f32 v141, v141, v161
    v_lshlrev_b32 v162, 16, v111
    v_and_b32 v163, 0xffff0000, v111
    v_add_f32 v142, v142, v162
    v_add_f32 v143, v143, v163
L_rbb2_6:
    s_bitcmp1_b32 s62, 7
    s_cbranch_scc0 L_rbb2_7
    v_lshlrev_b32 v160, 16, v116
    v_and_b32 v161, 0xffff0000, v116
    v_add_f32 v128, v128, v160
    v_add_f32 v129, v129, v161
    v_lshlrev_b32 v162, 16, v117
    v_and_b32 v163, 0xffff0000, v117
    v_add_f32 v130, v130, v162
    v_add_f32 v131, v131, v163
    v_lshlrev_b32 v160, 16, v118
    v_and_b32 v161, 0xffff0000, v118
    v_add_f32 v132, v132, v160
    v_add_f32 v133, v133, v161
    v_lshlrev_b32 v162, 16, v119
    v_and_b32 v163, 0xffff0000, v119
    v_add_f32 v134, v134, v162
    v_add_f32 v135, v135, v163
    v_lshlrev_b32 v160, 16, v120
    v_and_b32 v161, 0xffff0000, v120
    v_add_f32 v136, v136, v160
    v_add_f32 v137, v137, v161
    v_lshlrev_b32 v162, 16, v121
    v_and_b32 v163, 0xffff0000, v121
    v_add_f32 v138, v138, v162
    v_add_f32 v139, v139, v163
    v_lshlrev_b32 v160, 16, v122
    v_and_b32 v161, 0xffff0000, v122
    v_add_f32 v140, v140, v160
    v_add_f32 v141, v141, v161
    v_lshlrev_b32 v162, 16, v123
    v_and_b32 v163, 0xffff0000, v123
    v_add_f32 v142, v142, v162
    v_add_f32 v143, v143, v163
L_rbb2_7:
    s_mov_b32 s62, s59
    s_cmp_eq_u32 s58, 0xff
    s_cbranch_scc1 L_rlb2
    s_waitcnt vmcnt(0)
    v_cmp_eq_u32 vcc, 1, v16
    s_nop 0
    s_and_b32 s59, vcc_lo, 0xff
    s_andn2_b32 s59, s59, s58
    s_cbranch_scc1 L_rhb2
    s_mov_b64 exec, 0xff
    buffer_load_dword v16, v19, s[36:39], s54 offen sc1
    s_mov_b64 exec, -1
L_rlb2:
    s_waitcnt vmcnt(1)
    s_bitcmp1_b32 s62, 0
    s_cbranch_scc0 L_rab2_0
    v_lshlrev_b32 v160, 16, v32
    v_and_b32 v161, 0xffff0000, v32
    v_add_f32 v128, v128, v160
    v_add_f32 v129, v129, v161
    v_lshlrev_b32 v162, 16, v33
    v_and_b32 v163, 0xffff0000, v33
    v_add_f32 v130, v130, v162
    v_add_f32 v131, v131, v163
    v_lshlrev_b32 v160, 16, v34
    v_and_b32 v161, 0xffff0000, v34
    v_add_f32 v132, v132, v160
    v_add_f32 v133, v133, v161
    v_lshlrev_b32 v162, 16, v35
    v_and_b32 v163, 0xffff0000, v35
    v_add_f32 v134, v134, v162
    v_add_f32 v135, v135, v163
    v_lshlrev_b32 v160, 16, v36
    v_and_b32 v161, 0xffff0000, v36
    v_add_f32 v136, v136, v160
    v_add_f32 v137, v137, v161
    v_lshlrev_b32 v162, 16, v37
    v_and_b32 v163, 0xffff0000, v37
    v_add_f32 v138, v138, v162
    v_add_f32 v139, v139, v163
    v_lshlrev_b32 v160, 16, v38
    v_and_b32 v161, 0xffff0000, v38
    v_add_f32 v140, v140, v160
    v_add_f32 v141, v141, v161
    v_lshlrev_b32 v162, 16, v39
    v_and_b32 v163, 0xffff0000, v39
    v_add_f32 v142, v142, v162
    v_add_f32 v143, v143, v163
L_rab2_0:
    s_bitcmp1_b32 s62, 1
    s_cbranch_scc0 L_rab2_1
    v_lshlrev_b32 v160, 16, v44
    v_and_b32 v161, 0xffff0000, v44
    v_add_f32 v128, v128, v160
    v_add_f32 v129, v129, v161
    v_lshlrev_b32 v162, 16, v45
    v_and_b32 v163, 0xffff0000, v45
    v_add_f32 v130, v130, v162
    v_add_f32 v131, v131, v163
    v_lshlrev_b32 v160, 16, v46
    v_and_b32 v161, 0xffff0000, v46
    v_add_f32 v132, v132, v160
    v_add_f32 v133, v133, v161
    v_lshlrev_b32 v162, 16, v47
    v_and_b32 v163, 0xffff0000, v47
    v_add_f32 v134, v134, v162
    v_add_f32 v135, v135, v163
    v_lshlrev_b32 v160, 16, v48
    v_and_b32 v161, 0xffff0000, v48
    v_add_f32 v136, v136, v160
    v_add_f32 v137, v137, v161
    v_lshlrev_b32 v162, 16, v49
    v_and_b32 v163, 0xffff0000, v49
    v_add_f32 v138, v138, v162
    v_add_f32 v139, v139, v163
    v_lshlrev_b32 v160, 16, v50
    v_and_b32 v161, 0xffff0000, v50
    v_add_f32 v140, v140, v160
    v_add_f32 v141, v141, v161
    v_lshlrev_b32 v162, 16, v51
    v_and_b32 v163, 0xffff0000, v51
    v_add_f32 v142, v142, v162
    v_add_f32 v143, v143, v163
L_rab2_1:
    s_bitcmp1_b32 s62, 2
    s_cbranch_scc0 L_rab2_2
    v_lshlrev_b32 v160, 16, v56
    v_and_b32 v161, 0xffff0000, v56
    v_add_f32 v128, v128, v160
    v_add_f32 v129, v129, v161
    v_lshlrev_b32 v162, 16, v57
    v_and_b32 v163, 0xffff0000, v57
    v_add_f32 v130, v130, v162
    v_add_f32 v131, v131, v163
    v_lshlrev_b32 v160, 16, v58
    v_and_b32 v161, 0xffff0000, v58
    v_add_f32 v132, v132, v160
    v_add_f32 v133, v133, v161
    v_lshlrev_b32 v162, 16, v59
    v_and_b32 v163, 0xffff0000, v59
    v_add_f32 v134, v134, v162
    v_add_f32 v135, v135, v163
    v_lshlrev_b32 v160, 16, v60
    v_and_b32 v161, 0xffff0000, v60
    v_add_f32 v136, v136, v160
    v_add_f32 v137, v137, v161
    v_lshlrev_b32 v162, 16, v61
    v_and_b32 v163, 0xffff0000, v61
    v_add_f32 v138, v138, v162
    v_add_f32 v139, v139, v163
    v_lshlrev_b32 v160, 16, v62
    v_and_b32 v161, 0xffff0000, v62
    v_add_f32 v140, v140, v160
    v_add_f32 v141, v141, v161
    v_lshlrev_b32 v162, 16, v63
    v_and_b32 v163, 0xffff0000, v63
    v_add_f32 v142, v142, v162
    v_add_f32 v143, v143, v163
L_rab2_2:
    s_bitcmp1_b32 s62, 3
    s_cbranch_scc0 L_rab2_3
    v_lshlrev_b32 v160, 16, v68
    v_and_b32 v161, 0xffff0000, v68
    v_add_f32 v128, v128, v160
    v_add_f32 v129, v129, v161
    v_lshlrev_b32 v162, 16, v69
    v_and_b32 v163, 0xffff0000, v69
    v_add_f32 v130, v130, v162
    v_add_f32 v131, v131, v163
    v_lshlrev_b32 v160, 16, v70
    v_and_b32 v161, 0xffff0000, v70
    v_add_f32 v132, v132, v160
    v_add_f32 v133, v133, v161
    v_lshlrev_b32 v162, 16, v71
    v_and_b32 v163, 0xffff0000, v71
    v_add_f32 v134, v134, v162
    v_add_f32 v135, v135, v163
    v_lshlrev_b32 v160, 16, v72
    v_and_b32 v161, 0xffff0000, v72
    v_add_f32 v136, v136, v160
    v_add_f32 v137, v137, v161
    v_lshlrev_b32 v162, 16, v73
    v_and_b32 v163, 0xffff0000, v73
    v_add_f32 v138, v138, v162
    v_add_f32 v139, v139, v163
    v_lshlrev_b32 v160, 16, v74
    v_and_b32 v161, 0xffff0000, v74
    v_add_f32 v140, v140, v160
    v_add_f32 v141, v141, v161
    v_lshlrev_b32 v162, 16, v75
    v_and_b32 v163, 0xffff0000, v75
    v_add_f32 v142, v142, v162
    v_add_f32 v143, v143, v163
L_rab2_3:
    s_bitcmp1_b32 s62, 4
    s_cbranch_scc0 L_rab2_4
    v_lshlrev_b32 v160, 16, v80
    v_and_b32 v161, 0xffff0000, v80
    v_add_f32 v128, v128, v160
    v_add_f32 v129, v129, v161
    v_lshlrev_b32 v162, 16, v81
    v_and_b32 v163, 0xffff0000, v81
    v_add_f32 v130, v130, v162
    v_add_f32 v131, v131, v163
    v_lshlrev_b32 v160, 16, v82
    v_and_b32 v161, 0xffff0000, v82
    v_add_f32 v132, v132, v160
    v_add_f32 v133, v133, v161
    v_lshlrev_b32 v162, 16, v83
    v_and_b32 v163, 0xffff0000, v83
    v_add_f32 v134, v134, v162
    v_add_f32 v135, v135, v163
    v_lshlrev_b32 v160, 16, v84
    v_and_b32 v161, 0xffff0000, v84
    v_add_f32 v136, v136, v160
    v_add_f32 v137, v137, v161
    v_lshlrev_b32 v162, 16, v85
    v_and_b32 v163, 0xffff0000, v85
    v_add_f32 v138, v138, v162
    v_add_f32 v139, v139, v163
    v_lshlrev_b32 v160, 16, v86
    v_and_b32 v161, 0xffff0000, v86
    v_add_f32 v140, v140, v160
    v_add_f32 v141, v141, v161
    v_lshlrev_b32 v162, 16, v87
    v_and_b32 v163, 0xffff0000, v87
    v_add_f32 v142, v142, v162
    v_add_f32 v143, v143, v163
L_rab2_4:
    s_bitcmp1_b32 s62, 5
    s_cbranch_scc0 L_rab2_5
    v_lshlrev_b32 v160, 16, v92
    v_and_b32 v161, 0xffff0000, v92
    v_add_f32 v128, v128, v160
    v_add_f32 v129, v129, v161
    v_lshlrev_b32 v162, 16, v93
    v_and_b32 v163, 0xffff0000, v93
    v_add_f32 v130, v130, v162
    v_add_f32 v131, v131, v163
    v_lshlrev_b32 v160, 16, v94
    v_and_b32 v161, 0xffff0000, v94
    v_add_f32 v132, v132, v160
    v_add_f32 v133, v133, v161
    v_lshlrev_b32 v162, 16, v95
    v_and_b32 v163, 0xffff0000, v95
    v_add_f32 v134, v134, v162
    v_add_f32 v135, v135, v163
    v_lshlrev_b32 v160, 16, v96
    v_and_b32 v161, 0xffff0000, v96
    v_add_f32 v136, v136, v160
    v_add_f32 v137, v137, v161
    v_lshlrev_b32 v162, 16, v97
    v_and_b32 v163, 0xffff0000, v97
    v_add_f32 v138, v138, v162
    v_add_f32 v139, v139, v163
    v_lshlrev_b32 v160, 16, v98
    v_and_b32 v161, 0xffff0000, v98
    v_add_f32 v140, v140, v160
    v_add_f32 v141, v141, v161
    v_lshlrev_b32 v162, 16, v99
    v_and_b32 v163, 0xffff0000, v99
    v_add_f32 v142, v142, v162
    v_add_f32 v143, v143, v163
L_rab2_5:
    s_bitcmp1_b32 s62, 6
    s_cbranch_scc0 L_rab2_6
    v_lshlrev_b32 v160, 16, v104
    v_and_b32 v161, 0xffff0000, v104
    v_add_f32 v128, v128, v160
    v_add_f32 v129, v129, v161
    v_lshlrev_b32 v162, 16, v105
    v_and_b32 v163, 0xffff0000, v105
    v_add_f32 v130, v130, v162
    v_add_f32 v131, v131, v163
    v_lshlrev_b32 v160, 16, v106
    v_and_b32 v161, 0xffff0000, v106
    v_add_f32 v132, v132, v160
    v_add_f32 v133, v133, v161
    v_lshlrev_b32 v162, 16, v107
    v_and_b32 v163, 0xffff0000, v107
    v_add_f32 v134, v134, v162
    v_add_f32 v135, v135, v163
    v_lshlrev_b32 v160, 16, v108
    v_and_b32 v161, 0xffff0000, v108
    v_add_f32 v136, v136, v160
    v_add_f32 v137, v137, v161
    v_lshlrev_b32 v162, 16, v109
    v_and_b32 v163, 0xffff0000, v109
    v_add_f32 v138, v138, v162
    v_add_f32 v139, v139, v163
    v_lshlrev_b32 v160, 16, v110
    v_and_b32 v161, 0xffff0000, v110
    v_add_f32 v140, v140, v160
    v_add_f32 v141, v141, v161
    v_lshlrev_b32 v162, 16, v111
    v_and_b32 v163, 0xffff0000, v111
    v_add_f32 v142, v142, v162
    v_add_f32 v143, v143, v163
L_rab2_6:
    s_bitcmp1_b32 s62, 7
    s_cbranch_scc0 L_rab2_7
    v_lshlrev_b32 v160, 16, v116
    v_and_b32 v161, 0xffff0000, v116
    v_add_f32 v128, v128, v160
    v_add_f32 v129, v129, v161
    v_lshlrev_b32 v162, 16, v117
    v_and_b32 v163, 0xffff0000, v117
    v_add_f32 v130, v130, v162
    v_add_f32 v131, v131, v163
    v_lshlrev_b32 v160, 16, v118
    v_and_b32 v161, 0xffff0000, v118
    v_add_f32 v132, v132, v160
    v_add_f32 v133, v133, v161
    v_lshlrev_b32 v162, 16, v119
    v_and_b32 v163, 0xffff0000, v119
    v_add_f32 v134, v134, v162
    v_add_f32 v135, v135, v163
    v_lshlrev_b32 v160, 16, v120
    v_and_b32 v161, 0xffff0000, v120
    v_add_f32 v136, v136, v160
    v_add_f32 v137, v137, v161
    v_lshlrev_b32 v162, 16, v121
    v_and_b32 v163, 0xffff0000, v121
    v_add_f32 v138, v138, v162
    v_add_f32 v139, v139, v163
    v_lshlrev_b32 v160, 16, v122
    v_and_b32 v161, 0xffff0000, v122
    v_add_f32 v140, v140, v160
    v_add_f32 v141, v141, v161
    v_lshlrev_b32 v162, 16, v123
    v_and_b32 v163, 0xffff0000, v123
    v_add_f32 v142, v142, v162
    v_add_f32 v143, v143, v163
L_rab2_7:
    s_mov_b32 s62, 0
    s_mov_b64 exec, 0xff
    s_cmp_eq_u32 s58, 0xff
    s_cbranch_scc1 L_rfb2
    buffer_load_dword v17, v19, s[36:39], s54 offen sc1
    s_waitcnt vmcnt(1)
    v_cmp_eq_u32 vcc, 1, v16
    s_nop 0
    s_andn2_b32 s59, vcc_lo, s58
    s_cbranch_scc1 L_rhb2
    s_branch L_rs2b2
L_rfb2:
    s_mov_b64 exec, -1
    v_cvt_pk_bf16_f32 v164, v128, v129
    v_cvt_pk_bf16_f32 v165, v130, v131
    v_cvt_pk_bf16_f32 v166, v132, v133
    v_cvt_pk_bf16_f32 v167, v134, v135
    v_cvt_pk_bf16_f32 v168, v136, v137
    v_cvt_pk_bf16_f32 v169, v138, v139
    v_cvt_pk_bf16_f32 v170, v140, v141
    v_cvt_pk_bf16_f32 v171, v142, v143
    s_nop 1
    v_permlane32_swap_b32 v164, v166
    v_permlane32_swap_b32 v165, v167
    v_permlane32_swap_b32 v168, v170
    v_permlane32_swap_b32 v169, v171
    s_nop 1
    buffer_store_dwordx4 v[164:167], v24, s[72:75], s56 offen offset:192
    buffer_store_dwordx4 v[168:171], v24, s[72:75], s56 offen offset:256
    s_endpgm
L_end:
    s_endpgm
.section .rodata,"a"
.p2align 6
.amdhsa_kernel mha_kernel
  .amdhsa_next_free_vgpr 256
  .amdhsa_next_free_sgpr 102
  .amdhsa_accum_offset 256
  .amdhsa_group_segment_fixed_size 0
  .amdhsa_kernarg_size 64
  .amdhsa_user_sgpr_count 2
  .amdhsa_user_sgpr_kernarg_segment_ptr 1
  .amdhsa_system_sgpr_workgroup_id_x 1
.end_amdhsa_kernel
```
